```python
import torch

def _softmax(x, axis=-1):
    return torch.softmax(x, dim=axis)

def _gelu(x):
    return torch.nn.functional.gelu(x, approximate='tanh')

def _silu(x):
    return torch.nn.functional.silu(x)

def _sigmoid(x):
    return torch.sigmoid(x)

def _layernorm(x, axis=-1, eps=1e-05):
    m = x.mean(dim=axis, keepdim=True)
    v = x.var(dim=axis, keepdim=True, unbiased=False)
    return (x - m) / torch.sqrt(v + eps)

def _scatter_add(tgt, idx, src, axis=0):
    return tgt.clone().index_add_(axis, idx, src)

def _segment_sum(src, seg, n):
    out = torch.zeros((n,) + src.shape[1:], dtype=src.dtype)
    return out.index_add_(0, seg, src)

def _pad(x, pw):
    flat = tuple((v for pair in reversed(pw) for v in pair))
    return torch.nn.functional.pad(x, flat)
kernel_name = 'gated_mix__mha_block__mixer_gmlp__prompt'

def setup_inputs():

    _w = lambda a: (lambda t: t.to(torch.bfloat16) if t.is_floating_point() else t)(torch.as_tensor(a))

    def _A_setup():
        B, S, D, H = (1, 2048, 576, 32)
        return {'x': _w((lambda *s: torch.randn(*s, dtype=torch.bfloat16) * 0.05)(B, S, D)), 'wqkv': _w((lambda *s: torch.randn(*s, dtype=torch.bfloat16) * 1.6)(D, 3 * D)), 'wo': _w((lambda *s: torch.randn(*s, dtype=torch.bfloat16) * 0.1)(D, D))}
    _A_in = _A_setup()

    def _B_setup():
        B, S, D, F = (1, 2048, 576, 4608)
        Fh = F // 2
        return {'x': _w((lambda *s: torch.randn(*s, dtype=torch.bfloat16) * 0.05)(B, S, D)), 'w_in': _w((lambda *s: torch.randn(*s, dtype=torch.bfloat16) * 1.6)(D, 2 * Fh)), 'w_sp': _w(0.01 * (lambda *s: torch.randn(*s, dtype=torch.bfloat16) * 1.6)(S, S)), 'b_sp': _w(1.0 + 0.01 * (lambda *s: torch.randn(*s, dtype=torch.bfloat16) * 0.05)(S)), 'w_out': _w((lambda *s: torch.randn(*s, dtype=torch.bfloat16) * 0.05)(Fh, D))}
    _B_in = _B_setup()
    return {'A_x': _A_in['x'], 'A_wqkv': _A_in['wqkv'], 'A_wo': _A_in['wo'], 'B_x': _B_in['x'], 'B_w_in': _B_in['w_in'], 'B_w_sp': _B_in['w_sp'], 'B_b_sp': _B_in['b_sp'], 'B_w_out': _B_in['w_out'], 'gate_w': _w((lambda *s: torch.randn(*s, dtype=torch.bfloat16) * 0.05)(576) * 16.0)}

def reference(A_x, A_wqkv, A_wo, B_x, B_w_in, B_w_sp, B_b_sp, B_w_out, gate_w):

    def _A_ref(x, wqkv, wo):
        B, S, D = x.shape
        H = 32
        Dh = D // H
        qkv = (lambda x, *d: x.permute(*d))((x @ wqkv).reshape(B, S, 3, H, Dh), 2, 0, 3, 1, 4)
        q, k, v = (qkv[0], qkv[1], qkv[2])
        scores = torch.einsum('bhqd,bhkd->bhqk', q, k) * Dh ** (-0.5)
        p = _softmax(scores, axis=-1)
        o = torch.einsum('bhqk,bhkd->bhqd', p, v)
        return (lambda x, *d: x.permute(*d))(o, 0, 2, 1, 3).reshape(B, S, D) @ wo

    def _B_ref(x, w_in, w_sp, b_sp, w_out):
        B, S, D = x.shape
        F = w_in.shape[-1]
        Fh = F // 2
        z = _gelu(torch.einsum('bsd,df->bsf', x, w_in))
        z1 = z[..., :Fh].clone()
        z2 = _layernorm(z[..., Fh:], axis=-1)
        g = torch.einsum('ts,bsf->btf', w_sp, z2) + b_sp[None, :, None]
        return torch.einsum('bsf,fd->bsd', z1 * g, w_out)
    x = A_x
    g = _sigmoid((x * gate_w).sum(-1, keepdims=True))
    a = _A_ref(x, A_wqkv, A_wo)
    b = _B_ref(x, B_w_in, B_w_sp, B_b_sp, B_w_out)
    return g * a + (1 - g) * b
```

```asm
; @launch kernel=k1_gemm_kernel grid=(256,1,1) block=(512,1,1) lds=163840
; @launch kernel=k23_fused_kernel grid=(512,1,1) block=(256,1,1) lds=74240
.amdgcn_target "amdgcn-amd-amdhsa--gfx950"
.text
.globl k1_gemm_kernel
.p2align 8
.type k1_gemm_kernel,@function
k1_gemm_kernel:
    s_load_dwordx4 s[4:7], s[0:1], 0
    s_load_dwordx2 s[24:25], s[0:1], 32
    s_load_dwordx2 s[26:27], s[0:1], 64
    s_load_dwordx2 s[28:29], s[0:1], 88
    s_load_dwordx2 s[52:53], s[0:1], 16
    s_load_dwordx2 s[54:55], s[0:1], 56
    s_load_dwordx2 s[56:57], s[0:1], 40
    v_and_b32 v1, 63, v0
    v_lshrrev_b32 v4, 6, v0
    v_lshrrev_b32 v6, 5, v1
    v_readfirstlane_b32 s32, v4
    s_and_b32 s47, s2, 7
    s_lshr_b32 s46, s2, 3
    s_mul_i32 s45, s46, 52
    s_lshr_b32 s45, s45, 8
    s_mul_i32 s44, s45, 5
    s_sub_u32 s31, s46, s44
    s_lshl_b32 s30, s45, 3
    s_add_u32 s30, s30, s47
    s_cmp_lt_u32 s2, 240
    s_cbranch_scc1 K1_map_done
    s_cmp_ge_u32 s2, 250
    s_cbranch_scc1 K1_exit
    s_sub_u32 s31, s2, 240
    s_mov_b32 s30, 48
    s_cmp_lt_u32 s31, 5
    s_cbranch_scc1 K1_map_done
    s_sub_u32 s31, s31, 5
    s_mov_b32 s30, 49
K1_map_done:
    s_getpc_b64 s[16:17]
K1_pc0:
    s_mov_b32 s18, K1_L_body-K1_pc0
    s_sub_u32 s19, s30, 13
    s_cmp_lt_u32 s19, 36
    s_cselect_b32 s18, K1_G_body-K1_pc0, s18
    s_cmp_lt_u32 s19, 18
    s_cselect_b32 s18, K1_N_body-K1_pc0, s18
    s_add_u32 s16, s16, s18
    s_addc_u32 s17, s17, 0
    v_lshlrev_b32 v88, 5, v0
    v_and_b32 v88, 0x3f80, v88
    s_mov_b32 exec_lo, 0x11111111
    s_mov_b32 exec_hi, 0x11111111
    global_load_dword v89, v88, s[16:17]
    s_mov_b64 exec, -1
    s_and_b32 s33, s32, 3
    s_lshr_b32 s34, s32, 2
    s_mul_i32 s36, s32, 3072
    s_lshl_b32 s40, s32, 10
    s_sub_u32 s47, s30, 13
    s_movk_i32 s50, 3456
    s_cmp_lt_u32 s47, 36
    s_cselect_b32 s58, 1, 0
    s_cselect_b32 s50, 9216, s50
    s_cselect_b32 s45, s47, s30
    s_cmp_eq_u32 s30, 49
    s_cselect_b32 s45, 13, s45
    s_lshl_b32 s46, s45, 2
    s_add_u32 s46, s46, s33
    s_lshl_b32 s38, s50, 5
    s_lshl_b32 s39, s32, 2
    s_mul_i32 s39, s39, s50
    s_lshl_b32 s47, s45, 8
    s_add_u32 s39, s39, s47
    v_lshrrev_b32 v4, 4, v1
    v_mul_lo_u32 v2, v4, s50
    v_bfe_u32 v5, v1, 2, 2
    v_xor_b32 v5, v5, v4
    v_lshl_add_u32 v2, v5, 6, v2
    s_sub_u32 s47, s30, 13
    s_cmp_lt_u32 s47, 18
    s_cselect_b32 s47, 1, 0
    s_and_b32 s44, s32, 2
    s_lshr_b32 s47, s44, s47
    v_and_b32 v5, 3, v1
    v_xor_b32 v5, s47, v5
    v_lshl_add_u32 v96, v5, 4, v2
    s_mul_i32 s14, s50, 576
    s_mov_b32 s15, 0x00020000
    v_lshrrev_b32 v2, 3, v0
    v_mul_u32_u24 v2, 1152, v2
    v_bfe_u32 v4, v0, 4, 3
    v_and_b32 v5, 7, v0
    v_xor_b32 v4, v4, v5
    s_and_b32 s47, s32, 2
    v_xor_b32 v4, s47, v4
    v_lshl_add_u32 v97, v4, 4, v2
    s_mul_i32 s35, s31, 442368
    s_mov_b32 s10, 2359296
    s_mov_b32 s11, 0x00020000
    s_waitcnt lgkmcnt(0)
    s_cmp_eq_u32 s58, 1
    s_cselect_b32 s12, s24, s6
    s_cselect_b32 s13, s25, s7
    s_mov_b32 s8, s4
    s_mov_b32 s9, s5
    s_add_u32 m0, s40, 49152
    s_nop 0
    buffer_load_dwordx4 v96, s[12:15], s39 offen lds
    s_add_u32 s39, s39, s38
    s_add_u32 m0, s40, 57344
    s_nop 0
    buffer_load_dwordx4 v96, s[12:15], s39 offen lds
    s_add_u32 s39, s39, s38
    s_add_u32 m0, s40, 65536
    s_nop 0
    buffer_load_dwordx4 v96, s[12:15], s39 offen lds
    s_add_u32 s39, s39, s38
    s_add_u32 m0, s40, 73728
    s_nop 0
    buffer_load_dwordx4 v96, s[12:15], s39 offen lds
    s_add_u32 s39, s39, s38
    s_add_u32 m0, s40, 81920
    s_nop 0
    buffer_load_dwordx4 v96, s[12:15], s39 offen lds
    s_add_u32 s39, s39, s38
    s_add_u32 m0, s40, 90112
    s_nop 0
    buffer_load_dwordx4 v96, s[12:15], s39 offen lds
    s_add_u32 s39, s39, s38
    s_add_u32 m0, s40, 98304
    s_nop 0
    buffer_load_dwordx4 v96, s[12:15], s39 offen lds
    s_add_u32 s39, s39, s38
    s_add_u32 s37, s35, 0
    s_add_u32 m0, s36, 0
    s_nop 0
    buffer_load_dwordx4 v97, s[8:11], s37 offen offset:0 lds
    s_add_u32 m0, s36, 896
    s_nop 0
    buffer_load_dwordx4 v97, s[8:11], s37 offen offset:128 lds
    s_add_u32 m0, s36, 1792
    s_nop 0
    buffer_load_dwordx4 v97, s[8:11], s37 offen offset:256 lds
    s_mov_b32 s20, s28
    s_mov_b32 s21, s29
    s_mov_b32 s22, 59768832
    s_mov_b32 s23, 0x00020000
    s_mul_i32 s59, s34, 12288
    s_lshr_b32 s47, s31, 1
    s_add_u32 s47, s47, 30
    s_mul_i32 s33, s47, 73728
    s_add_u32 s44, s31, 60
    s_cmp_lt_u32 s31, 4
    s_cselect_b32 s33, s33, 0x7f000000
    s_cselect_b32 s48, 1, 0
    s_cmp_eq_u32 s34, 0
    s_cselect_b32 s48, s48, 0
    s_and_b32 s49, s31, s48
    s_mul_i32 s49, s49, 12288
    s_mul_i32 s42, s31, 12
    s_add_u32 s42, s42, s34
    s_lshl_b32 s41, s2, 3
    s_add_u32 s41, s41, s32
    v_lshlrev_b32 v8, 7, v1
    s_mov_b32 s19, 0x00020000
    v_mov_b32 v9, 0x7f000000
    v_cmp_gt_u32 vcc, 32, v1
    s_nop 1
    v_cndmask_b32 v8, v9, v8, vcc
    s_barrier
    s_add_u32 s37, s35, 384
    s_add_u32 m0, s36, 24576
    s_nop 0
    buffer_load_dwordx4 v97, s[8:11], s37 offen offset:0 lds
    s_add_u32 m0, s36, 25472
    s_nop 0
    buffer_load_dwordx4 v97, s[8:11], s37 offen offset:128 lds
    s_add_u32 m0, s36, 26368
    s_nop 0
    buffer_load_dwordx4 v97, s[8:11], s37 offen offset:256 lds
    s_mul_i32 s47, s41, 1280
    s_mov_b64 exec, 0x3ff
    buffer_load_dword v9, v8, s[8:11], s47 offen
    s_mov_b64 exec, -1
    v_lshrrev_b32 v4, 3, v0
    v_mul_u32_u24 v4, 9344, v4
    v_and_b32 v5, 7, v0
    v_lshl_add_u32 v4, v5, 4, v4
    v_lshlrev_b32 v5, 4, v0
    s_mul_i32 s47, s2, 598016
    s_add_u32 s47, s47, 2401280
    s_lshl_b32 s43, s2, 13
    s_add_u32 s43, s43, 57737216
    s_sub_u32 s45, s2, 128
    s_cmp_lt_u32 s45, 6
    s_cselect_b32 s43, s43, 0x7f000000
    s_cmp_lt_u32 s2, 8
    s_cselect_b32 s47, s47, s43
    s_cselect_b32 s43, 0x3f803f80, 0
    s_cselect_b64 vcc, -1, 0
    v_cndmask_b32 v4, v5, v4, vcc
    v_mov_b32 v92, s43
    v_mov_b32 v93, s43
    v_mov_b32 v94, s43
    v_mov_b32 v95, s43
    buffer_store_dwordx4 v[92:95], v4, s[20:23], s47 offen sc1
    s_cmp_eq_u32 s58, 0
    s_cbranch_scc1 K1_LT
    s_cmp_lt_u32 s46, 72
    s_cbranch_scc1 K1_N
K1_G_body:
    v_and_b32 v2, 15, v1
    v_lshrrev_b32 v3, 4, v1
    v_lshrrev_b32 v4, 2, v2
    v_lshlrev_b32 v4, 3, v4
    v_and_b32 v5, 3, v2
    v_add3_u32 v4, v4, v5, 0
    v_bfe_u32 v5, v4, 1, 3
    v_lshrrev_b32 v7, 3, v4
    v_and_b32 v11, 2, v7
    v_xor_b32 v5, v5, v11
    v_xor_b32 v5, v5, v3
    v_lshlrev_b32 v5, 4, v5
    v_and_b32 v11, 7, v4
    v_lshl_add_u32 v5, v11, 7, v5
    v_mul_u32_u24 v7, 3072, v7
    v_add3_u32 v98, s59, v5, v7
    v_xor_b32 v100, 64, v98
    v_lshrrev_b32 v4, 2, v2
    v_lshlrev_b32 v4, 3, v4
    v_and_b32 v5, 3, v2
    v_add3_u32 v4, v4, v5, 4
    v_bfe_u32 v5, v4, 1, 3
    v_lshrrev_b32 v7, 3, v4
    v_and_b32 v11, 2, v7
    v_xor_b32 v5, v5, v11
    v_xor_b32 v5, v5, v3
    v_lshlrev_b32 v5, 4, v5
    v_and_b32 v11, 7, v4
    v_lshl_add_u32 v5, v11, 7, v5
    v_mul_u32_u24 v7, 3072, v7
    v_add3_u32 v99, s59, v5, v7
    v_xor_b32 v101, 64, v99
    v_add_u32 v102, 49152, v98
    v_add_u32 v106, 98304, v98
    v_add_u32 v103, 49152, v99
    v_add_u32 v107, 98304, v99
    v_add_u32 v104, 49152, v100
    v_add_u32 v108, 98304, v100
    v_add_u32 v105, 49152, v101
    v_add_u32 v109, 98304, v101
    v_bfe_u32 v4, v1, 2, 2
    v_lshl_add_u32 v5, v3, 3, v4
    v_lshlrev_b32 v5, 8, v5
    s_and_b32 s47, s32, 3
    v_xor_b32 v4, s47, v4
    v_lshl_add_u32 v5, v4, 6, v5
    v_and_b32 v4, 3, v1
    v_lshl_add_u32 v5, v4, 3, v5
    v_and_b32 v4, 1, v3
    v_lshl_add_u32 v5, v4, 5, v5
    v_xor_b32 v4, 32, v5
    v_add_u32 v72, 49152, v5
    v_add_u32 v73, 49152, v4
    v_add_u32 v74, 106496, v5
    v_add_u32 v75, 106496, v4
    v_add_u32 v76, 73728, v5
    v_add_u32 v77, 73728, v4
    v_mul_u32_u24 v4, 36864, v3
    v_lshl_add_u32 v4, v2, 4, v4
    s_sub_u32 s47, s46, 72
    s_lshl_b32 s47, s47, 9
    s_add_u32 s47, s47, 8388608
    v_add_u32 v110, s47, v4
    v_add_u32 v10, 256, v110
    v_mov_b32 v111, 0xbdd2d3e8
    s_cmp_eq_u32 s34, 1
    s_cselect_b64 vcc, -1, 0
    s_waitcnt vmcnt(5)
    s_barrier
    ds_read_b64_tr_b16 v[112:113], v72 offset:0
    ds_read_b64_tr_b16 v[114:115], v72 offset:1024
    ds_read_b64_tr_b16 v[116:117], v73 offset:0
    ds_read_b64_tr_b16 v[118:119], v73 offset:1024
    ds_read_b128 v[44:47], v98 offset:0
    ds_read_b128 v[48:51], v99 offset:0
    ds_read_b128 v[52:55], v100 offset:0
    ds_read_b128 v[56:59], v101 offset:0
    ds_read_b128 v[60:63], v98 offset:1024
    ds_read_b64_tr_b16 v[120:121], v72 offset:8192
    ds_read_b64_tr_b16 v[122:123], v72 offset:9216
    ds_read_b64_tr_b16 v[124:125], v73 offset:8192
    ds_read_b64_tr_b16 v[126:127], v73 offset:9216
    ds_read_b64_tr_b16 v[128:129], v72 offset:16384
    ds_read_b64_tr_b16 v[130:131], v72 offset:17408
    ds_read_b64_tr_b16 v[132:133], v73 offset:16384
    ds_read_b64_tr_b16 v[134:135], v73 offset:17408
    ds_read_b64_tr_b16 v[136:137], v72 offset:24576
    ds_read_b64_tr_b16 v[138:139], v72 offset:25600
    ds_read_b64_tr_b16 v[140:141], v73 offset:24576
    ds_read_b64_tr_b16 v[142:143], v73 offset:25600
    ds_read_b64_tr_b16 v[144:145], v72 offset:32768
    ds_read_b64_tr_b16 v[146:147], v72 offset:33792
    ds_read_b64_tr_b16 v[148:149], v73 offset:32768
    ds_read_b64_tr_b16 v[150:151], v73 offset:33792
    ds_read_b64_tr_b16 v[152:153], v72 offset:40960
    ds_read_b64_tr_b16 v[154:155], v72 offset:41984
    ds_read_b64_tr_b16 v[156:157], v73 offset:40960
    ds_read_b64_tr_b16 v[158:159], v73 offset:41984
    ds_read_b64_tr_b16 v[160:161], v72 offset:49152
    ds_read_b64_tr_b16 v[162:163], v72 offset:50176
    ds_read_b64_tr_b16 v[164:165], v73 offset:49152
    ds_read_b64_tr_b16 v[166:167], v73 offset:50176
    s_waitcnt lgkmcnt(0)
    s_barrier
    v_mfma_f32_16x16x32_bf16 v[12:15], v[44:47], v[112:115], 0
    ds_read_b128 v[64:67], v99 offset:1024
    v_mfma_f32_16x16x32_bf16 v[20:23], v[44:47], v[116:119], 0
    s_add_u32 m0, s40, 106496
    s_nop 0
    buffer_load_dwordx4 v96, s[12:15], s39 offen lds
    s_add_u32 s39, s39, s38
    v_mfma_f32_16x16x32_bf16 v[16:19], v[48:51], v[112:115], 0
    ds_read_b128 v[68:71], v100 offset:1024
    v_mfma_f32_16x16x32_bf16 v[24:27], v[48:51], v[116:119], 0
    s_add_u32 m0, s40, 114688
    s_nop 0
    buffer_load_dwordx4 v96, s[12:15], s39 offen lds
    s_add_u32 s39, s39, s38
    v_mfma_f32_16x16x32_bf16 v[12:15], v[52:55], v[120:123], v[12:15]
    ds_read_b128 v[44:47], v101 offset:1024
    v_mfma_f32_16x16x32_bf16 v[20:23], v[52:55], v[124:127], v[20:23]
    s_add_u32 m0, s40, 122880
    s_nop 0
    buffer_load_dwordx4 v96, s[12:15], s39 offen lds
    s_add_u32 s39, s39, s38
    v_mfma_f32_16x16x32_bf16 v[16:19], v[56:59], v[120:123], v[16:19]
    ds_read_b128 v[48:51], v98 offset:2048
    v_mfma_f32_16x16x32_bf16 v[24:27], v[56:59], v[124:127], v[24:27]
    s_add_u32 m0, s40, 131072
    s_nop 0
    buffer_load_dwordx4 v96, s[12:15], s39 offen lds
    s_add_u32 s39, s39, s38
    v_mfma_f32_16x16x32_bf16 v[12:15], v[60:63], v[128:131], v[12:15]
    ds_read_b128 v[52:55], v99 offset:2048
    v_mfma_f32_16x16x32_bf16 v[20:23], v[60:63], v[132:135], v[20:23]
    s_add_u32 m0, s40, 139264
    s_nop 0
    buffer_load_dwordx4 v96, s[12:15], s39 offen lds
    s_add_u32 s39, s39, s38
    s_waitcnt lgkmcnt(4)
    v_mfma_f32_16x16x32_bf16 v[16:19], v[64:67], v[128:131], v[16:19]
    ds_read_b128 v[56:59], v100 offset:2048
    v_mfma_f32_16x16x32_bf16 v[24:27], v[64:67], v[132:135], v[24:27]
    s_add_u32 m0, s40, 147456
    s_nop 0
    buffer_load_dwordx4 v96, s[12:15], s39 offen lds
    s_add_u32 s39, s39, s38
    s_waitcnt lgkmcnt(4)
    v_mfma_f32_16x16x32_bf16 v[12:15], v[68:71], v[136:139], v[12:15]
    ds_read_b128 v[60:63], v101 offset:2048
    v_mfma_f32_16x16x32_bf16 v[20:23], v[68:71], v[140:143], v[20:23]
    s_add_u32 m0, s40, 155648
    s_nop 0
    buffer_load_dwordx4 v96, s[12:15], s39 offen lds
    s_add_u32 s39, s39, s38
    s_waitcnt lgkmcnt(4)
    v_mfma_f32_16x16x32_bf16 v[16:19], v[44:47], v[136:139], v[16:19]
    s_add_u32 s37, s35, 768
    s_add_u32 m0, s36, 49152
    s_nop 0
    buffer_load_dwordx4 v97, s[8:11], s37 offen offset:0 lds
    s_add_u32 m0, s36, 50048
    s_nop 0
    buffer_load_dwordx4 v97, s[8:11], s37 offen offset:128 lds
    s_add_u32 m0, s36, 50944
    s_nop 0
    buffer_load_dwordx4 v97, s[8:11], s37 offen offset:256 lds
    s_add_u32 m0, s40, 73728
    s_nop 0
    buffer_load_dwordx4 v96, s[12:15], s39 offen lds
    s_add_u32 s39, s39, s38
    s_add_u32 m0, s40, 81920
    s_nop 0
    buffer_load_dwordx4 v96, s[12:15], s39 offen lds
    s_add_u32 s39, s39, s38
    s_add_u32 m0, s40, 90112
    s_nop 0
    buffer_load_dwordx4 v96, s[12:15], s39 offen lds
    s_add_u32 s39, s39, s38
    s_add_u32 m0, s40, 98304
    s_nop 0
    buffer_load_dwordx4 v96, s[12:15], s39 offen lds
    s_add_u32 s39, s39, s38
    s_waitcnt vmcnt(7)
    s_barrier
    ds_read_b64_tr_b16 v[168:169], v74 offset:0
    ds_read_b64_tr_b16 v[170:171], v74 offset:1024
    ds_read_b64_tr_b16 v[172:173], v75 offset:0
    ds_read_b64_tr_b16 v[174:175], v75 offset:1024
    ds_read_b64_tr_b16 v[176:177], v74 offset:8192
    ds_read_b64_tr_b16 v[178:179], v74 offset:9216
    ds_read_b64_tr_b16 v[180:181], v75 offset:8192
    ds_read_b64_tr_b16 v[182:183], v75 offset:9216
    ds_read_b64_tr_b16 v[184:185], v74 offset:16384
    ds_read_b64_tr_b16 v[186:187], v74 offset:17408
    ds_read_b64_tr_b16 v[188:189], v75 offset:16384
    ds_read_b64_tr_b16 v[190:191], v75 offset:17408
    ds_read_b64_tr_b16 v[192:193], v74 offset:24576
    ds_read_b64_tr_b16 v[194:195], v74 offset:25600
    ds_read_b64_tr_b16 v[196:197], v75 offset:24576
    ds_read_b64_tr_b16 v[198:199], v75 offset:25600
    ds_read_b64_tr_b16 v[200:201], v74 offset:32768
    ds_read_b64_tr_b16 v[202:203], v74 offset:33792
    ds_read_b64_tr_b16 v[204:205], v75 offset:32768
    ds_read_b64_tr_b16 v[206:207], v75 offset:33792
    ds_read_b64_tr_b16 v[208:209], v74 offset:40960
    ds_read_b64_tr_b16 v[210:211], v74 offset:41984
    ds_read_b64_tr_b16 v[212:213], v75 offset:40960
    ds_read_b64_tr_b16 v[214:215], v75 offset:41984
    ds_read_b64_tr_b16 v[216:217], v74 offset:49152
    ds_read_b64_tr_b16 v[218:219], v74 offset:50176
    ds_read_b64_tr_b16 v[220:221], v75 offset:49152
    ds_read_b64_tr_b16 v[222:223], v75 offset:50176
    s_waitcnt lgkmcnt(0)
    s_barrier
    ds_read_b128 v[64:67], v98 offset:24576
    v_mfma_f32_16x16x32_bf16 v[24:27], v[44:47], v[140:143], v[24:27]
    v_mfma_f32_16x16x32_bf16 v[12:15], v[48:51], v[144:147], v[12:15]
    ds_read_b128 v[68:71], v99 offset:24576
    v_mfma_f32_16x16x32_bf16 v[20:23], v[48:51], v[148:151], v[20:23]
    s_add_u32 s37, s35, 73728
    s_add_u32 m0, s36, 122880
    s_nop 0
    buffer_load_dwordx4 v97, s[8:11], s37 offen offset:0 lds
    v_mfma_f32_16x16x32_bf16 v[16:19], v[52:55], v[144:147], v[16:19]
    ds_read_b128 v[44:47], v100 offset:24576
    v_mfma_f32_16x16x32_bf16 v[24:27], v[52:55], v[148:151], v[24:27]
    s_add_u32 m0, s36, 123776
    s_nop 0
    buffer_load_dwordx4 v97, s[8:11], s37 offen offset:128 lds
    v_mfma_f32_16x16x32_bf16 v[12:15], v[56:59], v[152:155], v[12:15]
    ds_read_b128 v[48:51], v101 offset:24576
    v_mfma_f32_16x16x32_bf16 v[20:23], v[56:59], v[156:159], v[20:23]
    s_add_u32 m0, s36, 124672
    s_nop 0
    buffer_load_dwordx4 v97, s[8:11], s37 offen offset:256 lds
    v_mfma_f32_16x16x32_bf16 v[16:19], v[60:63], v[152:155], v[16:19]
    ds_read_b128 v[52:55], v98 offset:25600
    v_mfma_f32_16x16x32_bf16 v[24:27], v[60:63], v[156:159], v[24:27]
    s_waitcnt lgkmcnt(3)
    v_mfma_f32_16x16x32_bf16 v[12:15], v[64:67], v[160:163], v[12:15]
    ds_read_b128 v[56:59], v99 offset:25600
    v_mfma_f32_16x16x32_bf16 v[20:23], v[64:67], v[164:167], v[20:23]
    v_mfma_f32_16x16x32_bf16 v[16:19], v[68:71], v[160:163], v[16:19]
    ds_read_b128 v[60:63], v100 offset:25600
    v_mfma_f32_16x16x32_bf16 v[24:27], v[68:71], v[164:167], v[24:27]
    s_waitcnt lgkmcnt(3)
    v_mfma_f32_16x16x32_bf16 v[12:15], v[44:47], v[168:171], v[12:15]
    ds_read_b128 v[64:67], v101 offset:25600
    v_mfma_f32_16x16x32_bf16 v[20:23], v[44:47], v[172:175], v[20:23]
    v_mfma_f32_16x16x32_bf16 v[16:19], v[48:51], v[168:171], v[16:19]
    ds_read_b128 v[68:71], v98 offset:26624
    v_mfma_f32_16x16x32_bf16 v[24:27], v[48:51], v[172:175], v[24:27]
    s_waitcnt lgkmcnt(3)
    v_mfma_f32_16x16x32_bf16 v[12:15], v[52:55], v[176:179], v[12:15]
    ds_read_b128 v[44:47], v99 offset:26624
    v_mfma_f32_16x16x32_bf16 v[20:23], v[52:55], v[180:183], v[20:23]
    v_mfma_f32_16x16x32_bf16 v[16:19], v[56:59], v[176:179], v[16:19]
    ds_read_b128 v[48:51], v100 offset:26624
    v_mfma_f32_16x16x32_bf16 v[24:27], v[56:59], v[180:183], v[24:27]
    s_waitcnt lgkmcnt(3)
    v_mfma_f32_16x16x32_bf16 v[12:15], v[60:63], v[184:187], v[12:15]
    ds_read_b128 v[52:55], v101 offset:26624
    v_mfma_f32_16x16x32_bf16 v[20:23], v[60:63], v[188:191], v[20:23]
    v_mfma_f32_16x16x32_bf16 v[16:19], v[64:67], v[184:187], v[16:19]
    s_waitcnt vmcnt(3)
    s_barrier
    ds_read_b64_tr_b16 v[224:225], v76 offset:0
    ds_read_b64_tr_b16 v[226:227], v76 offset:1024
    ds_read_b64_tr_b16 v[228:229], v77 offset:0
    ds_read_b64_tr_b16 v[230:231], v77 offset:1024
    ds_read_b64_tr_b16 v[232:233], v76 offset:8192
    ds_read_b64_tr_b16 v[234:235], v76 offset:9216
    ds_read_b64_tr_b16 v[236:237], v77 offset:8192
    ds_read_b64_tr_b16 v[238:239], v77 offset:9216
    ds_read_b64_tr_b16 v[240:241], v76 offset:16384
    ds_read_b64_tr_b16 v[242:243], v76 offset:17408
    ds_read_b64_tr_b16 v[244:245], v77 offset:16384
    ds_read_b64_tr_b16 v[246:247], v77 offset:17408
    ds_read_b64_tr_b16 v[248:249], v76 offset:24576
    ds_read_b64_tr_b16 v[250:251], v76 offset:25600
    ds_read_b64_tr_b16 v[252:253], v77 offset:24576
    ds_read_b64_tr_b16 v[254:255], v77 offset:25600
    s_waitcnt lgkmcnt(0)
    s_barrier
    ds_read_b128 v[56:59], v102 offset:0
    v_mfma_f32_16x16x32_bf16 v[24:27], v[64:67], v[188:191], v[24:27]
    v_mfma_f32_16x16x32_bf16 v[12:15], v[68:71], v[192:195], v[12:15]
    ds_read_b128 v[60:63], v103 offset:0
    v_mfma_f32_16x16x32_bf16 v[20:23], v[68:71], v[196:199], v[20:23]
    s_add_u32 s37, s35, 74112
    s_add_u32 m0, s36, 73728
    s_nop 0
    buffer_load_dwordx4 v97, s[8:11], s37 offen offset:0 lds
    v_mfma_f32_16x16x32_bf16 v[16:19], v[44:47], v[192:195], v[16:19]
    ds_read_b128 v[64:67], v104 offset:0
    v_mfma_f32_16x16x32_bf16 v[24:27], v[44:47], v[196:199], v[24:27]
    s_add_u32 m0, s36, 74624
    s_nop 0
    buffer_load_dwordx4 v97, s[8:11], s37 offen offset:128 lds
    v_mfma_f32_16x16x32_bf16 v[12:15], v[48:51], v[200:203], v[12:15]
    ds_read_b128 v[68:71], v105 offset:0
    v_mfma_f32_16x16x32_bf16 v[20:23], v[48:51], v[204:207], v[20:23]
    s_add_u32 m0, s36, 75520
    s_nop 0
    buffer_load_dwordx4 v97, s[8:11], s37 offen offset:256 lds
    v_mfma_f32_16x16x32_bf16 v[16:19], v[52:55], v[200:203], v[16:19]
    ds_read_b128 v[44:47], v102 offset:1024
    v_mfma_f32_16x16x32_bf16 v[24:27], v[52:55], v[204:207], v[24:27]
    s_add_u32 s37, s35, 74496
    s_add_u32 m0, s36, 98304
    s_nop 0
    buffer_load_dwordx4 v97, s[8:11], s37 offen offset:0 lds
    s_waitcnt lgkmcnt(4)
    v_mfma_f32_16x16x32_bf16 v[12:15], v[56:59], v[208:211], v[12:15]
    ds_read_b128 v[48:51], v103 offset:1024
    v_mfma_f32_16x16x32_bf16 v[20:23], v[56:59], v[212:215], v[20:23]
    s_add_u32 m0, s36, 99200
    s_nop 0
    buffer_load_dwordx4 v97, s[8:11], s37 offen offset:128 lds
    s_waitcnt lgkmcnt(4)
    v_mfma_f32_16x16x32_bf16 v[16:19], v[60:63], v[208:211], v[16:19]
    ds_read_b128 v[52:55], v104 offset:1024
    v_mfma_f32_16x16x32_bf16 v[24:27], v[60:63], v[212:215], v[24:27]
    s_add_u32 m0, s36, 100096
    s_nop 0
    buffer_load_dwordx4 v97, s[8:11], s37 offen offset:256 lds
    s_waitcnt lgkmcnt(4)
    v_mfma_f32_16x16x32_bf16 v[12:15], v[64:67], v[216:219], v[12:15]
    ds_read_b128 v[56:59], v105 offset:1024
    v_mfma_f32_16x16x32_bf16 v[20:23], v[64:67], v[220:223], v[20:23]
    s_waitcnt lgkmcnt(4)
    v_mfma_f32_16x16x32_bf16 v[16:19], v[68:71], v[216:219], v[16:19]
    ds_read_b128 v[60:63], v102 offset:2048
    v_mfma_f32_16x16x32_bf16 v[24:27], v[68:71], v[220:223], v[24:27]
    s_waitcnt lgkmcnt(3)
    v_mfma_f32_16x16x32_bf16 v[12:15], v[44:47], v[224:227], v[12:15]
    ds_read_b128 v[64:67], v103 offset:2048
    v_mfma_f32_16x16x32_bf16 v[20:23], v[44:47], v[228:231], v[20:23]
    s_add_u32 s37, s35, 147456
    s_add_u32 m0, s36, 0
    s_nop 0
    buffer_load_dwordx4 v97, s[8:11], s37 offen offset:0 lds
    v_mfma_f32_16x16x32_bf16 v[16:19], v[48:51], v[224:227], v[16:19]
    ds_read_b128 v[68:71], v104 offset:2048
    v_mfma_f32_16x16x32_bf16 v[24:27], v[48:51], v[228:231], v[24:27]
    s_waitcnt lgkmcnt(3)
    v_mfma_f32_16x16x32_bf16 v[12:15], v[52:55], v[232:235], v[12:15]
    ds_read_b128 v[44:47], v105 offset:2048
    v_mfma_f32_16x16x32_bf16 v[20:23], v[52:55], v[236:239], v[20:23]
    v_mfma_f32_16x16x32_bf16 v[16:19], v[56:59], v[232:235], v[16:19]
    s_waitcnt vmcnt(7)
    s_barrier
    ds_read_b128 v[48:51], v106 offset:24576
    v_mfma_f32_16x16x32_bf16 v[24:27], v[56:59], v[236:239], v[24:27]
    s_waitcnt lgkmcnt(3)
    v_mfma_f32_16x16x32_bf16 v[12:15], v[60:63], v[240:243], v[12:15]
    ds_read_b128 v[52:55], v107 offset:24576
    v_mfma_f32_16x16x32_bf16 v[20:23], v[60:63], v[244:247], v[20:23]
    s_add_u32 m0, s36, 896
    s_nop 0
    buffer_load_dwordx4 v97, s[8:11], s37 offen offset:128 lds
    v_mfma_f32_16x16x32_bf16 v[16:19], v[64:67], v[240:243], v[16:19]
    ds_read_b128 v[56:59], v108 offset:24576
    v_mfma_f32_16x16x32_bf16 v[24:27], v[64:67], v[244:247], v[24:27]
    s_add_u32 m0, s36, 1792
    s_nop 0
    buffer_load_dwordx4 v97, s[8:11], s37 offen offset:256 lds
    s_waitcnt lgkmcnt(4)
    v_mfma_f32_16x16x32_bf16 v[12:15], v[68:71], v[248:251], v[12:15]
    ds_read_b128 v[60:63], v109 offset:24576
    v_mfma_f32_16x16x32_bf16 v[20:23], v[68:71], v[252:255], v[20:23]
    s_waitcnt lgkmcnt(4)
    v_mfma_f32_16x16x32_bf16 v[16:19], v[44:47], v[248:251], v[16:19]
    ds_read_b128 v[64:67], v106 offset:25600
    v_mfma_f32_16x16x32_bf16 v[24:27], v[44:47], v[252:255], v[24:27]
    s_waitcnt lgkmcnt(3)
    v_mfma_f32_16x16x32_bf16 v[28:31], v[48:51], v[112:115], 0
    ds_read_b128 v[68:71], v107 offset:25600
    v_mfma_f32_16x16x32_bf16 v[36:39], v[48:51], v[116:119], 0
    s_add_u32 s37, s35, 147840
    s_add_u32 m0, s36, 24576
    s_nop 0
    buffer_load_dwordx4 v97, s[8:11], s37 offen offset:0 lds
    v_mfma_f32_16x16x32_bf16 v[32:35], v[52:55], v[112:115], 0
    ds_read_b128 v[44:47], v108 offset:25600
    v_mfma_f32_16x16x32_bf16 v[40:43], v[52:55], v[116:119], 0
    s_waitcnt lgkmcnt(3)
    v_mfma_f32_16x16x32_bf16 v[28:31], v[56:59], v[120:123], v[28:31]
    ds_read_b128 v[48:51], v109 offset:25600
    s_add_u32 s45, s42, 0
    s_mul_i32 s45, s45, 147456
    v_mfma_f32_16x16x32_bf16 v[36:39], v[56:59], v[124:127], v[36:39]
    v_mul_f32 v80, v12, v12
    v_mul_f32 v81, v13, v13
    v_mul_f32 v82, v14, v14
    v_mfma_f32_16x16x32_bf16 v[32:35], v[60:63], v[120:123], v[32:35]
    ds_read_b128 v[52:55], v106 offset:26624
    v_mul_f32 v83, v15, v15
    v_fmaak_f32 v80, v80, v111, 0xc0135761
    v_mfma_f32_16x16x32_bf16 v[40:43], v[60:63], v[124:127], v[40:43]
    s_waitcnt lgkmcnt(3)
    v_fmaak_f32 v81, v81, v111, 0xc0135761
    v_fmaak_f32 v82, v82, v111, 0xc0135761
    v_mfma_f32_16x16x32_bf16 v[28:31], v[64:67], v[128:131], v[28:31]
    ds_read_b128 v[56:59], v107 offset:26624
    v_fmaak_f32 v83, v83, v111, 0xc0135761
    v_mul_f32 v80, v80, v12
    v_mfma_f32_16x16x32_bf16 v[36:39], v[64:67], v[132:135], v[36:39]
    s_add_u32 m0, s36, 25472
    s_nop 0
    buffer_load_dwordx4 v97, s[8:11], s37 offen offset:128 lds
    v_mul_f32 v81, v81, v13
    v_mul_f32 v82, v82, v14
    v_mul_f32 v83, v83, v15
    v_mfma_f32_16x16x32_bf16 v[32:35], v[68:71], v[128:131], v[32:35]
    ds_read_b128 v[60:63], v108 offset:26624
    v_exp_f32 v80, v80
    v_mfma_f32_16x16x32_bf16 v[40:43], v[68:71], v[132:135], v[40:43]
    s_waitcnt lgkmcnt(3)
    v_exp_f32 v81, v81
    v_mfma_f32_16x16x32_bf16 v[28:31], v[44:47], v[136:139], v[28:31]
    ds_read_b128 v[64:67], v109 offset:26624
    v_exp_f32 v82, v82
    v_mfma_f32_16x16x32_bf16 v[36:39], v[44:47], v[140:143], v[36:39]
    v_exp_f32 v83, v83
    v_add_f32 v80, 1.0, v80
    v_mfma_f32_16x16x32_bf16 v[32:35], v[48:51], v[136:139], v[32:35]
    s_waitcnt vmcnt(8)
    s_barrier
    ds_read_b128 v[68:71], v102 offset:24576
    v_add_f32 v81, 1.0, v81
    v_add_f32 v82, 1.0, v82
    v_mfma_f32_16x16x32_bf16 v[40:43], v[48:51], v[140:143], v[40:43]
    s_waitcnt lgkmcnt(3)
    v_add_f32 v83, 1.0, v83
    v_rcp_f32 v80, v80
    v_mfma_f32_16x16x32_bf16 v[28:31], v[52:55], v[144:147], v[28:31]
    ds_read_b128 v[44:47], v103 offset:24576
    v_rcp_f32 v81, v81
    v_mfma_f32_16x16x32_bf16 v[36:39], v[52:55], v[148:151], v[36:39]
    s_add_u32 m0, s36, 26368
    s_nop 0
    buffer_load_dwordx4 v97, s[8:11], s37 offen offset:256 lds
    v_rcp_f32 v82, v82
    v_mfma_f32_16x16x32_bf16 v[32:35], v[56:59], v[144:147], v[32:35]
    ds_read_b128 v[48:51], v104 offset:24576
    v_rcp_f32 v83, v83
    v_mfma_f32_16x16x32_bf16 v[40:43], v[56:59], v[148:151], v[40:43]
    s_waitcnt lgkmcnt(3)
    v_mul_f32 v80, v80, v12
    v_mul_f32 v81, v81, v13
    v_mul_f32 v82, v82, v14
    v_mfma_f32_16x16x32_bf16 v[28:31], v[60:63], v[152:155], v[28:31]
    ds_read_b128 v[52:55], v105 offset:24576
    v_mul_f32 v83, v83, v15
    v_cvt_pk_bf16_f32 v88, v80, v81
    v_mfma_f32_16x16x32_bf16 v[36:39], v[60:63], v[156:159], v[36:39]
    v_cvt_pk_bf16_f32 v89, v82, v83
    v_mul_f32 v84, v16, v16
    v_mfma_f32_16x16x32_bf16 v[32:35], v[64:67], v[152:155], v[32:35]
    ds_read_b128 v[56:59], v102 offset:25600
    v_mul_f32 v85, v17, v17
    v_mul_f32 v86, v18, v18
    v_mul_f32 v87, v19, v19
    v_mfma_f32_16x16x32_bf16 v[40:43], v[64:67], v[156:159], v[40:43]
    s_waitcnt lgkmcnt(3)
    v_fmaak_f32 v84, v84, v111, 0xc0135761
    v_fmaak_f32 v85, v85, v111, 0xc0135761
    v_mfma_f32_16x16x32_bf16 v[28:31], v[68:71], v[160:163], v[28:31]
    ds_read_b128 v[60:63], v103 offset:25600
    v_fmaak_f32 v86, v86, v111, 0xc0135761
    v_fmaak_f32 v87, v87, v111, 0xc0135761
    v_mfma_f32_16x16x32_bf16 v[36:39], v[68:71], v[164:167], v[36:39]
    s_add_u32 s37, s35, 148224
    s_add_u32 m0, s36, 49152
    s_nop 0
    buffer_load_dwordx4 v97, s[8:11], s37 offen offset:0 lds
    v_mul_f32 v84, v84, v16
    v_mul_f32 v85, v85, v17
    v_mfma_f32_16x16x32_bf16 v[32:35], v[44:47], v[160:163], v[32:35]
    ds_read_b128 v[64:67], v104 offset:25600
    v_mul_f32 v86, v86, v18
    v_mul_f32 v87, v87, v19
    v_mfma_f32_16x16x32_bf16 v[40:43], v[44:47], v[164:167], v[40:43]
    s_waitcnt lgkmcnt(3)
    v_exp_f32 v84, v84
    v_exp_f32 v85, v85
    v_mfma_f32_16x16x32_bf16 v[28:31], v[48:51], v[168:171], v[28:31]
    ds_read_b128 v[68:71], v105 offset:25600
    v_exp_f32 v86, v86
    v_mfma_f32_16x16x32_bf16 v[36:39], v[48:51], v[172:175], v[36:39]
    v_exp_f32 v87, v87
    v_mfma_f32_16x16x32_bf16 v[32:35], v[52:55], v[168:171], v[32:35]
    ds_read_b128 v[44:47], v102 offset:26624
    v_add_f32 v84, 1.0, v84
    v_add_f32 v85, 1.0, v85
    v_mfma_f32_16x16x32_bf16 v[40:43], v[52:55], v[172:175], v[40:43]
    s_waitcnt lgkmcnt(3)
    v_add_f32 v86, 1.0, v86
    v_add_f32 v87, 1.0, v87
    v_mfma_f32_16x16x32_bf16 v[28:31], v[56:59], v[176:179], v[28:31]
    ds_read_b128 v[48:51], v103 offset:26624
    v_rcp_f32 v84, v84
    v_mfma_f32_16x16x32_bf16 v[36:39], v[56:59], v[180:183], v[36:39]
    s_add_u32 m0, s36, 50048
    s_nop 0
    buffer_load_dwordx4 v97, s[8:11], s37 offen offset:128 lds
    v_rcp_f32 v85, v85
    v_mfma_f32_16x16x32_bf16 v[32:35], v[60:63], v[176:179], v[32:35]
    ds_read_b128 v[52:55], v104 offset:26624
    v_rcp_f32 v86, v86
    v_rcp_f32 v87, v87
    v_mfma_f32_16x16x32_bf16 v[40:43], v[60:63], v[180:183], v[40:43]
    s_waitcnt lgkmcnt(3)
    v_mul_f32 v84, v84, v16
    v_mfma_f32_16x16x32_bf16 v[28:31], v[64:67], v[184:187], v[28:31]
    ds_read_b128 v[56:59], v105 offset:26624
    v_mul_f32 v85, v85, v17
    v_mul_f32 v86, v86, v18
    v_mul_f32 v87, v87, v19
    v_mfma_f32_16x16x32_bf16 v[36:39], v[64:67], v[188:191], v[36:39]
    v_cvt_pk_bf16_f32 v90, v84, v85
    v_cvt_pk_bf16_f32 v91, v86, v87
    v_mfma_f32_16x16x32_bf16 v[32:35], v[68:71], v[184:187], v[32:35]
    s_waitcnt vmcnt(8)
    s_barrier
    ds_read_b128 v[60:63], v106 offset:0
    buffer_store_dwordx4 v[88:91], v110, s[20:23], s45 offen sc1
    v_mul_f32 v80, v20, v20
    v_mfma_f32_16x16x32_bf16 v[40:43], v[68:71], v[188:191], v[40:43]
    s_waitcnt lgkmcnt(3)
    v_mul_f32 v81, v21, v21
    v_mul_f32 v82, v22, v22
    v_mul_f32 v83, v23, v23
    v_mfma_f32_16x16x32_bf16 v[28:31], v[44:47], v[192:195], v[28:31]
    ds_read_b128 v[64:67], v107 offset:0
    v_fmaak_f32 v80, v80, v111, 0xc0135761
    v_fmaak_f32 v81, v81, v111, 0xc0135761
    v_mfma_f32_16x16x32_bf16 v[36:39], v[44:47], v[196:199], v[36:39]
    s_add_u32 m0, s36, 50944
    s_nop 0
    buffer_load_dwordx4 v97, s[8:11], s37 offen offset:256 lds
    v_fmaak_f32 v82, v82, v111, 0xc0135761
    v_fmaak_f32 v83, v83, v111, 0xc0135761
    v_mfma_f32_16x16x32_bf16 v[32:35], v[48:51], v[192:195], v[32:35]
    ds_read_b128 v[68:71], v108 offset:0
    v_mul_f32 v80, v80, v20
    v_mul_f32 v81, v81, v21
    v_mfma_f32_16x16x32_bf16 v[40:43], v[48:51], v[196:199], v[40:43]
    s_waitcnt lgkmcnt(3)
    v_mul_f32 v82, v82, v22
    v_mul_f32 v83, v83, v23
    v_mfma_f32_16x16x32_bf16 v[28:31], v[52:55], v[200:203], v[28:31]
    ds_read_b128 v[44:47], v109 offset:0
    v_exp_f32 v80, v80
    v_exp_f32 v81, v81
    v_mfma_f32_16x16x32_bf16 v[36:39], v[52:55], v[204:207], v[36:39]
    v_exp_f32 v82, v82
    v_mfma_f32_16x16x32_bf16 v[32:35], v[56:59], v[200:203], v[32:35]
    ds_read_b128 v[48:51], v106 offset:1024
    v_exp_f32 v83, v83
    v_mfma_f32_16x16x32_bf16 v[40:43], v[56:59], v[204:207], v[40:43]
    s_waitcnt lgkmcnt(3)
    v_add_f32 v80, 1.0, v80
    v_add_f32 v81, 1.0, v81
    v_mfma_f32_16x16x32_bf16 v[28:31], v[60:63], v[208:211], v[28:31]
    ds_read_b128 v[52:55], v107 offset:1024
    v_add_f32 v82, 1.0, v82
    v_add_f32 v83, 1.0, v83
    v_mfma_f32_16x16x32_bf16 v[36:39], v[60:63], v[212:215], v[36:39]
    s_add_u32 s37, s35, 221184
    s_add_u32 m0, s36, 122880
    s_nop 0
    buffer_load_dwordx4 v97, s[8:11], s37 offen offset:0 lds
    v_rcp_f32 v80, v80
    v_mfma_f32_16x16x32_bf16 v[32:35], v[64:67], v[208:211], v[32:35]
    ds_read_b128 v[56:59], v108 offset:1024
    v_rcp_f32 v81, v81
    v_mfma_f32_16x16x32_bf16 v[40:43], v[64:67], v[212:215], v[40:43]
    s_waitcnt lgkmcnt(3)
    v_rcp_f32 v82, v82
    v_rcp_f32 v83, v83
    v_mfma_f32_16x16x32_bf16 v[28:31], v[68:71], v[216:219], v[28:31]
    ds_read_b128 v[60:63], v109 offset:1024
    v_mul_f32 v80, v80, v20
    v_mfma_f32_16x16x32_bf16 v[36:39], v[68:71], v[220:223], v[36:39]
    v_mul_f32 v81, v81, v21
    v_mul_f32 v82, v82, v22
    v_mul_f32 v83, v83, v23
    v_mfma_f32_16x16x32_bf16 v[32:35], v[44:47], v[216:219], v[32:35]
    ds_read_b128 v[64:67], v106 offset:2048
    v_cvt_pk_bf16_f32 v92, v80, v81
    v_cvt_pk_bf16_f32 v93, v82, v83
    v_mfma_f32_16x16x32_bf16 v[40:43], v[44:47], v[220:223], v[40:43]
    s_waitcnt lgkmcnt(3)
    v_mul_f32 v84, v24, v24
    v_mul_f32 v85, v25, v25
    v_mfma_f32_16x16x32_bf16 v[28:31], v[48:51], v[224:227], v[28:31]
    ds_read_b128 v[68:71], v107 offset:2048
    v_mul_f32 v86, v26, v26
    v_mul_f32 v87, v27, v27
    v_fmaak_f32 v84, v84, v111, 0xc0135761
    v_mfma_f32_16x16x32_bf16 v[36:39], v[48:51], v[228:231], v[36:39]
    s_add_u32 m0, s36, 123776
    s_nop 0
    buffer_load_dwordx4 v97, s[8:11], s37 offen offset:128 lds
    v_fmaak_f32 v85, v85, v111, 0xc0135761
    v_fmaak_f32 v86, v86, v111, 0xc0135761
    v_mfma_f32_16x16x32_bf16 v[32:35], v[52:55], v[224:227], v[32:35]
    ds_read_b128 v[44:47], v108 offset:2048
    v_fmaak_f32 v87, v87, v111, 0xc0135761
    v_mul_f32 v84, v84, v24
    v_mfma_f32_16x16x32_bf16 v[40:43], v[52:55], v[228:231], v[40:43]
    s_waitcnt lgkmcnt(3)
    v_mul_f32 v85, v85, v25
    v_mul_f32 v86, v86, v26
    v_mfma_f32_16x16x32_bf16 v[28:31], v[56:59], v[232:235], v[28:31]
    ds_read_b128 v[48:51], v109 offset:2048
    v_mul_f32 v87, v87, v27
    v_exp_f32 v84, v84
    v_mfma_f32_16x16x32_bf16 v[36:39], v[56:59], v[236:239], v[36:39]
    v_exp_f32 v85, v85
    v_mfma_f32_16x16x32_bf16 v[32:35], v[60:63], v[232:235], v[32:35]
    s_waitcnt vmcnt(9)
    s_barrier
    ds_read_b128 v[52:55], v98 offset:0
    v_exp_f32 v86, v86
    v_mfma_f32_16x16x32_bf16 v[40:43], v[60:63], v[236:239], v[40:43]
    s_waitcnt lgkmcnt(3)
    v_exp_f32 v87, v87
    v_add_f32 v84, 1.0, v84
    v_mfma_f32_16x16x32_bf16 v[28:31], v[64:67], v[240:243], v[28:31]
    ds_read_b128 v[56:59], v99 offset:0
    v_add_f32 v85, 1.0, v85
    v_add_f32 v86, 1.0, v86
    v_mfma_f32_16x16x32_bf16 v[36:39], v[64:67], v[244:247], v[36:39]
    s_add_u32 m0, s36, 124672
    s_nop 0
    buffer_load_dwordx4 v97, s[8:11], s37 offen offset:256 lds
    v_add_f32 v87, 1.0, v87
    v_rcp_f32 v84, v84
    v_mfma_f32_16x16x32_bf16 v[32:35], v[68:71], v[240:243], v[32:35]
    ds_read_b128 v[60:63], v100 offset:0
    v_rcp_f32 v85, v85
    v_mfma_f32_16x16x32_bf16 v[40:43], v[68:71], v[244:247], v[40:43]
    s_waitcnt lgkmcnt(3)
    v_rcp_f32 v86, v86
    v_mfma_f32_16x16x32_bf16 v[28:31], v[44:47], v[248:251], v[28:31]
    ds_read_b128 v[64:67], v101 offset:0
    v_rcp_f32 v87, v87
    v_mfma_f32_16x16x32_bf16 v[36:39], v[44:47], v[252:255], v[36:39]
    v_mul_f32 v84, v84, v24
    v_mul_f32 v85, v85, v25
    v_mfma_f32_16x16x32_bf16 v[32:35], v[48:51], v[248:251], v[32:35]
    ds_read_b128 v[68:71], v98 offset:1024
    v_mul_f32 v86, v86, v26
    v_mul_f32 v87, v87, v27
    v_cvt_pk_bf16_f32 v94, v84, v85
    v_mfma_f32_16x16x32_bf16 v[40:43], v[48:51], v[252:255], v[40:43]
    s_waitcnt lgkmcnt(3)
    v_cvt_pk_bf16_f32 v95, v86, v87
    buffer_store_dwordx4 v[92:95], v10, s[20:23], s45 offen sc1
    v_mfma_f32_16x16x32_bf16 v[12:15], v[52:55], v[112:115], 0
    ds_read_b128 v[44:47], v99 offset:1024
    v_mfma_f32_16x16x32_bf16 v[20:23], v[52:55], v[116:119], 0
    s_add_u32 s37, s35, 221568
    s_add_u32 m0, s36, 73728
    s_nop 0
    buffer_load_dwordx4 v97, s[8:11], s37 offen offset:0 lds
    v_mfma_f32_16x16x32_bf16 v[16:19], v[56:59], v[112:115], 0
    ds_read_b128 v[48:51], v100 offset:1024
    v_mfma_f32_16x16x32_bf16 v[24:27], v[56:59], v[116:119], 0
    s_waitcnt lgkmcnt(3)
    v_mfma_f32_16x16x32_bf16 v[12:15], v[60:63], v[120:123], v[12:15]
    ds_read_b128 v[52:55], v101 offset:1024
    s_add_u32 s45, s42, 2
    s_mul_i32 s45, s45, 147456
    v_mfma_f32_16x16x32_bf16 v[20:23], v[60:63], v[124:127], v[20:23]
    v_mul_f32 v80, v28, v28
    v_mul_f32 v81, v29, v29
    v_mul_f32 v82, v30, v30
    v_mfma_f32_16x16x32_bf16 v[16:19], v[64:67], v[120:123], v[16:19]
    ds_read_b128 v[56:59], v98 offset:2048
    v_mul_f32 v83, v31, v31
    v_fmaak_f32 v80, v80, v111, 0xc0135761
    v_mfma_f32_16x16x32_bf16 v[24:27], v[64:67], v[124:127], v[24:27]
    s_waitcnt lgkmcnt(3)
    v_fmaak_f32 v81, v81, v111, 0xc0135761
    v_fmaak_f32 v82, v82, v111, 0xc0135761
    v_mfma_f32_16x16x32_bf16 v[12:15], v[68:71], v[128:131], v[12:15]
    ds_read_b128 v[60:63], v99 offset:2048
    v_fmaak_f32 v83, v83, v111, 0xc0135761
    v_mul_f32 v80, v80, v28
    v_mfma_f32_16x16x32_bf16 v[20:23], v[68:71], v[132:135], v[20:23]
    s_add_u32 m0, s36, 74624
    s_nop 0
    buffer_load_dwordx4 v97, s[8:11], s37 offen offset:128 lds
    v_mul_f32 v81, v81, v29
    v_mul_f32 v82, v82, v30
    v_mul_f32 v83, v83, v31
    v_mfma_f32_16x16x32_bf16 v[16:19], v[44:47], v[128:131], v[16:19]
    ds_read_b128 v[64:67], v100 offset:2048
    v_exp_f32 v80, v80
    v_mfma_f32_16x16x32_bf16 v[24:27], v[44:47], v[132:135], v[24:27]
    s_waitcnt lgkmcnt(3)
    v_exp_f32 v81, v81
    v_mfma_f32_16x16x32_bf16 v[12:15], v[48:51], v[136:139], v[12:15]
    ds_read_b128 v[68:71], v101 offset:2048
    v_exp_f32 v82, v82
    v_mfma_f32_16x16x32_bf16 v[20:23], v[48:51], v[140:143], v[20:23]
    v_exp_f32 v83, v83
    v_add_f32 v80, 1.0, v80
    v_mfma_f32_16x16x32_bf16 v[16:19], v[52:55], v[136:139], v[16:19]
    s_waitcnt vmcnt(10)
    s_barrier
    s_mov_b32 s16, s56
    s_mov_b32 s17, s57
    s_lshl_b32 s47, s41, 12
    s_add_u32 s18, s47, 1024
    buffer_load_dword v9, v8, s[16:19], s47 offen
    ds_read_b128 v[44:47], v98 offset:24576
    v_add_f32 v81, 1.0, v81
    v_add_f32 v82, 1.0, v82
    v_mfma_f32_16x16x32_bf16 v[24:27], v[52:55], v[140:143], v[24:27]
    s_waitcnt lgkmcnt(3)
    v_add_f32 v83, 1.0, v83
    v_rcp_f32 v80, v80
    v_mfma_f32_16x16x32_bf16 v[12:15], v[56:59], v[144:147], v[12:15]
    ds_read_b128 v[48:51], v99 offset:24576
    v_rcp_f32 v81, v81
    v_mfma_f32_16x16x32_bf16 v[20:23], v[56:59], v[148:151], v[20:23]
    s_add_u32 m0, s36, 75520
    s_nop 0
    buffer_load_dwordx4 v97, s[8:11], s37 offen offset:256 lds
    v_rcp_f32 v82, v82
    v_mfma_f32_16x16x32_bf16 v[16:19], v[60:63], v[144:147], v[16:19]
    ds_read_b128 v[52:55], v100 offset:24576
    v_rcp_f32 v83, v83
    v_mfma_f32_16x16x32_bf16 v[24:27], v[60:63], v[148:151], v[24:27]
    s_waitcnt lgkmcnt(3)
    v_mul_f32 v80, v80, v28
    v_mul_f32 v81, v81, v29
    v_mul_f32 v82, v82, v30
    v_mfma_f32_16x16x32_bf16 v[12:15], v[64:67], v[152:155], v[12:15]
    ds_read_b128 v[56:59], v101 offset:24576
    v_mul_f32 v83, v83, v31
    v_cvt_pk_bf16_f32 v88, v80, v81
    v_mfma_f32_16x16x32_bf16 v[20:23], v[64:67], v[156:159], v[20:23]
    v_cvt_pk_bf16_f32 v89, v82, v83
    v_mul_f32 v84, v32, v32
    v_mfma_f32_16x16x32_bf16 v[16:19], v[68:71], v[152:155], v[16:19]
    ds_read_b128 v[60:63], v98 offset:25600
    v_mul_f32 v85, v33, v33
    v_mul_f32 v86, v34, v34
    v_mul_f32 v87, v35, v35
    v_mfma_f32_16x16x32_bf16 v[24:27], v[68:71], v[156:159], v[24:27]
    s_waitcnt lgkmcnt(3)
    v_fmaak_f32 v84, v84, v111, 0xc0135761
    v_fmaak_f32 v85, v85, v111, 0xc0135761
    v_mfma_f32_16x16x32_bf16 v[12:15], v[44:47], v[160:163], v[12:15]
    ds_read_b128 v[64:67], v99 offset:25600
    v_fmaak_f32 v86, v86, v111, 0xc0135761
    v_fmaak_f32 v87, v87, v111, 0xc0135761
    v_mfma_f32_16x16x32_bf16 v[20:23], v[44:47], v[164:167], v[20:23]
    s_add_u32 s37, s35, 221952
    s_add_u32 m0, s36, 98304
    s_nop 0
    buffer_load_dwordx4 v97, s[8:11], s37 offen offset:0 lds
    v_mul_f32 v84, v84, v32
    v_mul_f32 v85, v85, v33
    v_mfma_f32_16x16x32_bf16 v[16:19], v[48:51], v[160:163], v[16:19]
    ds_read_b128 v[68:71], v100 offset:25600
    v_mul_f32 v86, v86, v34
    v_mul_f32 v87, v87, v35
    v_mfma_f32_16x16x32_bf16 v[24:27], v[48:51], v[164:167], v[24:27]
    s_waitcnt lgkmcnt(3)
    v_exp_f32 v84, v84
    v_exp_f32 v85, v85
    v_mfma_f32_16x16x32_bf16 v[12:15], v[52:55], v[168:171], v[12:15]
    ds_read_b128 v[44:47], v101 offset:25600
    v_exp_f32 v86, v86
    v_mfma_f32_16x16x32_bf16 v[20:23], v[52:55], v[172:175], v[20:23]
    v_exp_f32 v87, v87
    v_mfma_f32_16x16x32_bf16 v[16:19], v[56:59], v[168:171], v[16:19]
    ds_read_b128 v[48:51], v98 offset:26624
    v_add_f32 v84, 1.0, v84
    v_add_f32 v85, 1.0, v85
    v_mfma_f32_16x16x32_bf16 v[24:27], v[56:59], v[172:175], v[24:27]
    s_waitcnt lgkmcnt(3)
    v_add_f32 v86, 1.0, v86
    v_add_f32 v87, 1.0, v87
    v_mfma_f32_16x16x32_bf16 v[12:15], v[60:63], v[176:179], v[12:15]
    ds_read_b128 v[52:55], v99 offset:26624
    v_rcp_f32 v84, v84
    v_mfma_f32_16x16x32_bf16 v[20:23], v[60:63], v[180:183], v[20:23]
    s_add_u32 m0, s36, 99200
    s_nop 0
    buffer_load_dwordx4 v97, s[8:11], s37 offen offset:128 lds
    v_rcp_f32 v85, v85
    v_mfma_f32_16x16x32_bf16 v[16:19], v[64:67], v[176:179], v[16:19]
    ds_read_b128 v[56:59], v100 offset:26624
    v_rcp_f32 v86, v86
    v_rcp_f32 v87, v87
    v_mfma_f32_16x16x32_bf16 v[24:27], v[64:67], v[180:183], v[24:27]
    s_waitcnt lgkmcnt(3)
    v_mul_f32 v84, v84, v32
    v_mfma_f32_16x16x32_bf16 v[12:15], v[68:71], v[184:187], v[12:15]
    ds_read_b128 v[60:63], v101 offset:26624
    v_mul_f32 v85, v85, v33
    v_mul_f32 v86, v86, v34
    v_mul_f32 v87, v87, v35
    v_mfma_f32_16x16x32_bf16 v[20:23], v[68:71], v[188:191], v[20:23]
    v_cvt_pk_bf16_f32 v90, v84, v85
    v_cvt_pk_bf16_f32 v91, v86, v87
    v_mfma_f32_16x16x32_bf16 v[16:19], v[44:47], v[184:187], v[16:19]
    s_waitcnt vmcnt(10)
    s_barrier
    ds_read_b128 v[64:67], v102 offset:0
    buffer_store_dwordx4 v[88:91], v110, s[20:23], s45 offen sc1
    v_mul_f32 v80, v36, v36
    v_mfma_f32_16x16x32_bf16 v[24:27], v[44:47], v[188:191], v[24:27]
    s_waitcnt lgkmcnt(3)
    v_mul_f32 v81, v37, v37
    v_mul_f32 v82, v38, v38
    v_mul_f32 v83, v39, v39
    v_mfma_f32_16x16x32_bf16 v[12:15], v[48:51], v[192:195], v[12:15]
    ds_read_b128 v[68:71], v103 offset:0
    v_fmaak_f32 v80, v80, v111, 0xc0135761
    v_fmaak_f32 v81, v81, v111, 0xc0135761
    v_mfma_f32_16x16x32_bf16 v[20:23], v[48:51], v[196:199], v[20:23]
    s_add_u32 m0, s36, 100096
    s_nop 0
    buffer_load_dwordx4 v97, s[8:11], s37 offen offset:256 lds
    v_fmaak_f32 v82, v82, v111, 0xc0135761
    v_fmaak_f32 v83, v83, v111, 0xc0135761
    v_mfma_f32_16x16x32_bf16 v[16:19], v[52:55], v[192:195], v[16:19]
    ds_read_b128 v[44:47], v104 offset:0
    v_mul_f32 v80, v80, v36
    v_mul_f32 v81, v81, v37
    v_mfma_f32_16x16x32_bf16 v[24:27], v[52:55], v[196:199], v[24:27]
    s_waitcnt lgkmcnt(3)
    v_mul_f32 v82, v82, v38
    v_mul_f32 v83, v83, v39
    v_mfma_f32_16x16x32_bf16 v[12:15], v[56:59], v[200:203], v[12:15]
    ds_read_b128 v[48:51], v105 offset:0
    v_exp_f32 v80, v80
    v_exp_f32 v81, v81
    v_mfma_f32_16x16x32_bf16 v[20:23], v[56:59], v[204:207], v[20:23]
    v_exp_f32 v82, v82
    v_mfma_f32_16x16x32_bf16 v[16:19], v[60:63], v[200:203], v[16:19]
    ds_read_b128 v[52:55], v102 offset:1024
    v_exp_f32 v83, v83
    v_mfma_f32_16x16x32_bf16 v[24:27], v[60:63], v[204:207], v[24:27]
    s_waitcnt lgkmcnt(3)
    v_add_f32 v80, 1.0, v80
    v_add_f32 v81, 1.0, v81
    v_mfma_f32_16x16x32_bf16 v[12:15], v[64:67], v[208:211], v[12:15]
    ds_read_b128 v[56:59], v103 offset:1024
    v_add_f32 v82, 1.0, v82
    v_add_f32 v83, 1.0, v83
    v_mfma_f32_16x16x32_bf16 v[20:23], v[64:67], v[212:215], v[20:23]
    s_add_u32 s37, s35, 294912
    s_add_u32 m0, s36, 0
    s_nop 0
    buffer_load_dwordx4 v97, s[8:11], s37 offen offset:0 lds
    v_rcp_f32 v80, v80
    v_mfma_f32_16x16x32_bf16 v[16:19], v[68:71], v[208:211], v[16:19]
    ds_read_b128 v[60:63], v104 offset:1024
    v_rcp_f32 v81, v81
    v_mfma_f32_16x16x32_bf16 v[24:27], v[68:71], v[212:215], v[24:27]
    s_waitcnt lgkmcnt(3)
    v_rcp_f32 v82, v82
    v_rcp_f32 v83, v83
    v_mfma_f32_16x16x32_bf16 v[12:15], v[44:47], v[216:219], v[12:15]
    ds_read_b128 v[64:67], v105 offset:1024
    v_mul_f32 v80, v80, v36
    v_mfma_f32_16x16x32_bf16 v[20:23], v[44:47], v[220:223], v[20:23]
    v_mul_f32 v81, v81, v37
    v_mul_f32 v82, v82, v38
    v_mul_f32 v83, v83, v39
    v_mfma_f32_16x16x32_bf16 v[16:19], v[48:51], v[216:219], v[16:19]
    ds_read_b128 v[68:71], v102 offset:2048
    v_cvt_pk_bf16_f32 v92, v80, v81
    v_cvt_pk_bf16_f32 v93, v82, v83
    v_mfma_f32_16x16x32_bf16 v[24:27], v[48:51], v[220:223], v[24:27]
    s_waitcnt lgkmcnt(3)
    v_mul_f32 v84, v40, v40
    v_mul_f32 v85, v41, v41
    v_mfma_f32_16x16x32_bf16 v[12:15], v[52:55], v[224:227], v[12:15]
    ds_read_b128 v[44:47], v103 offset:2048
    v_mul_f32 v86, v42, v42
    v_mul_f32 v87, v43, v43
    v_fmaak_f32 v84, v84, v111, 0xc0135761
    v_mfma_f32_16x16x32_bf16 v[20:23], v[52:55], v[228:231], v[20:23]
    s_add_u32 m0, s36, 896
    s_nop 0
    buffer_load_dwordx4 v97, s[8:11], s37 offen offset:128 lds
    v_fmaak_f32 v85, v85, v111, 0xc0135761
    v_fmaak_f32 v86, v86, v111, 0xc0135761
    v_mfma_f32_16x16x32_bf16 v[16:19], v[56:59], v[224:227], v[16:19]
    ds_read_b128 v[48:51], v104 offset:2048
    v_fmaak_f32 v87, v87, v111, 0xc0135761
    v_mul_f32 v84, v84, v40
    v_mfma_f32_16x16x32_bf16 v[24:27], v[56:59], v[228:231], v[24:27]
    s_waitcnt lgkmcnt(3)
    v_mul_f32 v85, v85, v41
    v_mul_f32 v86, v86, v42
    v_mfma_f32_16x16x32_bf16 v[12:15], v[60:63], v[232:235], v[12:15]
    ds_read_b128 v[52:55], v105 offset:2048
    v_mul_f32 v87, v87, v43
    v_exp_f32 v84, v84
    v_mfma_f32_16x16x32_bf16 v[20:23], v[60:63], v[236:239], v[20:23]
    v_exp_f32 v85, v85
    v_mfma_f32_16x16x32_bf16 v[16:19], v[64:67], v[232:235], v[16:19]
    s_waitcnt vmcnt(11)
    s_barrier
    ds_read_b128 v[56:59], v106 offset:24576
    v_exp_f32 v86, v86
    v_mfma_f32_16x16x32_bf16 v[24:27], v[64:67], v[236:239], v[24:27]
    s_waitcnt lgkmcnt(3)
    v_exp_f32 v87, v87
    v_add_f32 v84, 1.0, v84
    v_mfma_f32_16x16x32_bf16 v[12:15], v[68:71], v[240:243], v[12:15]
    ds_read_b128 v[60:63], v107 offset:24576
    v_add_f32 v85, 1.0, v85
    v_add_f32 v86, 1.0, v86
    v_mfma_f32_16x16x32_bf16 v[20:23], v[68:71], v[244:247], v[20:23]
    s_add_u32 m0, s36, 1792
    s_nop 0
    buffer_load_dwordx4 v97, s[8:11], s37 offen offset:256 lds
    v_add_f32 v87, 1.0, v87
    v_rcp_f32 v84, v84
    v_mfma_f32_16x16x32_bf16 v[16:19], v[44:47], v[240:243], v[16:19]
    ds_read_b128 v[64:67], v108 offset:24576
    v_rcp_f32 v85, v85
    v_mfma_f32_16x16x32_bf16 v[24:27], v[44:47], v[244:247], v[24:27]
    s_waitcnt lgkmcnt(3)
    v_rcp_f32 v86, v86
    v_mfma_f32_16x16x32_bf16 v[12:15], v[48:51], v[248:251], v[12:15]
    ds_read_b128 v[68:71], v109 offset:24576
    v_rcp_f32 v87, v87
    v_mfma_f32_16x16x32_bf16 v[20:23], v[48:51], v[252:255], v[20:23]
    v_mul_f32 v84, v84, v40
    v_mul_f32 v85, v85, v41
    v_mfma_f32_16x16x32_bf16 v[16:19], v[52:55], v[248:251], v[16:19]
    ds_read_b128 v[44:47], v106 offset:25600
    v_mul_f32 v86, v86, v42
    v_mul_f32 v87, v87, v43
    v_cvt_pk_bf16_f32 v94, v84, v85
    v_mfma_f32_16x16x32_bf16 v[24:27], v[52:55], v[252:255], v[24:27]
    s_waitcnt lgkmcnt(3)
    v_cvt_pk_bf16_f32 v95, v86, v87
    buffer_store_dwordx4 v[92:95], v10, s[20:23], s45 offen sc1
    v_mfma_f32_16x16x32_bf16 v[28:31], v[56:59], v[112:115], 0
    ds_read_b128 v[48:51], v107 offset:25600
    v_mfma_f32_16x16x32_bf16 v[36:39], v[56:59], v[116:119], 0
    s_add_u32 s37, s35, 295296
    s_add_u32 m0, s36, 24576
    s_nop 0
    buffer_load_dwordx4 v97, s[8:11], s37 offen offset:0 lds
    v_mfma_f32_16x16x32_bf16 v[32:35], v[60:63], v[112:115], 0
    ds_read_b128 v[52:55], v108 offset:25600
    v_mfma_f32_16x16x32_bf16 v[40:43], v[60:63], v[116:119], 0
    s_waitcnt lgkmcnt(3)
    v_mfma_f32_16x16x32_bf16 v[28:31], v[64:67], v[120:123], v[28:31]
    ds_read_b128 v[56:59], v109 offset:25600
    s_add_u32 s45, s42, 4
    s_mul_i32 s45, s45, 147456
    v_mfma_f32_16x16x32_bf16 v[36:39], v[64:67], v[124:127], v[36:39]
    v_mul_f32 v80, v12, v12
    v_mul_f32 v81, v13, v13
    v_mul_f32 v82, v14, v14
    v_mfma_f32_16x16x32_bf16 v[32:35], v[68:71], v[120:123], v[32:35]
    ds_read_b128 v[60:63], v106 offset:26624
    v_mul_f32 v83, v15, v15
    v_fmaak_f32 v80, v80, v111, 0xc0135761
    v_mfma_f32_16x16x32_bf16 v[40:43], v[68:71], v[124:127], v[40:43]
    s_waitcnt lgkmcnt(3)
    v_fmaak_f32 v81, v81, v111, 0xc0135761
    v_fmaak_f32 v82, v82, v111, 0xc0135761
    v_mfma_f32_16x16x32_bf16 v[28:31], v[44:47], v[128:131], v[28:31]
    ds_read_b128 v[64:67], v107 offset:26624
    v_fmaak_f32 v83, v83, v111, 0xc0135761
    v_mul_f32 v80, v80, v12
    v_mfma_f32_16x16x32_bf16 v[36:39], v[44:47], v[132:135], v[36:39]
    s_add_u32 m0, s36, 25472
    s_nop 0
    buffer_load_dwordx4 v97, s[8:11], s37 offen offset:128 lds
    v_mul_f32 v81, v81, v13
    v_mul_f32 v82, v82, v14
    v_mul_f32 v83, v83, v15
    v_mfma_f32_16x16x32_bf16 v[32:35], v[48:51], v[128:131], v[32:35]
    ds_read_b128 v[68:71], v108 offset:26624
    v_exp_f32 v80, v80
    v_mfma_f32_16x16x32_bf16 v[40:43], v[48:51], v[132:135], v[40:43]
    s_waitcnt lgkmcnt(3)
    v_exp_f32 v81, v81
    v_mfma_f32_16x16x32_bf16 v[28:31], v[52:55], v[136:139], v[28:31]
    ds_read_b128 v[44:47], v109 offset:26624
    v_exp_f32 v82, v82
    v_mfma_f32_16x16x32_bf16 v[36:39], v[52:55], v[140:143], v[36:39]
    v_exp_f32 v83, v83
    v_add_f32 v80, 1.0, v80
    v_mfma_f32_16x16x32_bf16 v[32:35], v[56:59], v[136:139], v[32:35]
    s_waitcnt vmcnt(10)
    s_barrier
    ds_read_b128 v[48:51], v102 offset:24576
    v_add_f32 v81, 1.0, v81
    v_add_f32 v82, 1.0, v82
    v_mfma_f32_16x16x32_bf16 v[40:43], v[56:59], v[140:143], v[40:43]
    s_waitcnt lgkmcnt(3)
    v_add_f32 v83, 1.0, v83
    v_rcp_f32 v80, v80
    v_mfma_f32_16x16x32_bf16 v[28:31], v[60:63], v[144:147], v[28:31]
    ds_read_b128 v[52:55], v103 offset:24576
    v_rcp_f32 v81, v81
    v_mfma_f32_16x16x32_bf16 v[36:39], v[60:63], v[148:151], v[36:39]
    s_add_u32 m0, s36, 26368
    s_nop 0
    buffer_load_dwordx4 v97, s[8:11], s37 offen offset:256 lds
    v_rcp_f32 v82, v82
    v_mfma_f32_16x16x32_bf16 v[32:35], v[64:67], v[144:147], v[32:35]
    ds_read_b128 v[56:59], v104 offset:24576
    v_rcp_f32 v83, v83
    v_mfma_f32_16x16x32_bf16 v[40:43], v[64:67], v[148:151], v[40:43]
    s_waitcnt lgkmcnt(3)
    v_mul_f32 v80, v80, v12
    v_mul_f32 v81, v81, v13
    v_mul_f32 v82, v82, v14
    v_mfma_f32_16x16x32_bf16 v[28:31], v[68:71], v[152:155], v[28:31]
    ds_read_b128 v[60:63], v105 offset:24576
    v_mul_f32 v83, v83, v15
    v_cvt_pk_bf16_f32 v88, v80, v81
    v_mfma_f32_16x16x32_bf16 v[36:39], v[68:71], v[156:159], v[36:39]
    v_cvt_pk_bf16_f32 v89, v82, v83
    v_mul_f32 v84, v16, v16
    v_mfma_f32_16x16x32_bf16 v[32:35], v[44:47], v[152:155], v[32:35]
    ds_read_b128 v[64:67], v102 offset:25600
    v_mul_f32 v85, v17, v17
    v_mul_f32 v86, v18, v18
    v_mul_f32 v87, v19, v19
    v_mfma_f32_16x16x32_bf16 v[40:43], v[44:47], v[156:159], v[40:43]
    s_waitcnt lgkmcnt(3)
    v_fmaak_f32 v84, v84, v111, 0xc0135761
    v_fmaak_f32 v85, v85, v111, 0xc0135761
    v_mfma_f32_16x16x32_bf16 v[28:31], v[48:51], v[160:163], v[28:31]
    ds_read_b128 v[68:71], v103 offset:25600
    v_fmaak_f32 v86, v86, v111, 0xc0135761
    v_fmaak_f32 v87, v87, v111, 0xc0135761
    v_mfma_f32_16x16x32_bf16 v[36:39], v[48:51], v[164:167], v[36:39]
    s_add_u32 s37, s35, 295680
    s_add_u32 m0, s36, 49152
    s_nop 0
    buffer_load_dwordx4 v97, s[8:11], s37 offen offset:0 lds
    v_mul_f32 v84, v84, v16
    v_mul_f32 v85, v85, v17
    v_mfma_f32_16x16x32_bf16 v[32:35], v[52:55], v[160:163], v[32:35]
    ds_read_b128 v[44:47], v104 offset:25600
    v_mul_f32 v86, v86, v18
    v_mul_f32 v87, v87, v19
    v_mfma_f32_16x16x32_bf16 v[40:43], v[52:55], v[164:167], v[40:43]
    s_waitcnt lgkmcnt(3)
    v_exp_f32 v84, v84
    v_exp_f32 v85, v85
    v_mfma_f32_16x16x32_bf16 v[28:31], v[56:59], v[168:171], v[28:31]
    ds_read_b128 v[48:51], v105 offset:25600
    v_exp_f32 v86, v86
    v_mfma_f32_16x16x32_bf16 v[36:39], v[56:59], v[172:175], v[36:39]
    v_exp_f32 v87, v87
    v_mfma_f32_16x16x32_bf16 v[32:35], v[60:63], v[168:171], v[32:35]
    ds_read_b128 v[52:55], v102 offset:26624
    v_add_f32 v84, 1.0, v84
    v_add_f32 v85, 1.0, v85
    v_mfma_f32_16x16x32_bf16 v[40:43], v[60:63], v[172:175], v[40:43]
    s_waitcnt lgkmcnt(3)
    v_add_f32 v86, 1.0, v86
    v_add_f32 v87, 1.0, v87
    v_mfma_f32_16x16x32_bf16 v[28:31], v[64:67], v[176:179], v[28:31]
    ds_read_b128 v[56:59], v103 offset:26624
    v_rcp_f32 v84, v84
    v_mfma_f32_16x16x32_bf16 v[36:39], v[64:67], v[180:183], v[36:39]
    s_add_u32 m0, s36, 50048
    s_nop 0
    buffer_load_dwordx4 v97, s[8:11], s37 offen offset:128 lds
    v_rcp_f32 v85, v85
    v_mfma_f32_16x16x32_bf16 v[32:35], v[68:71], v[176:179], v[32:35]
    ds_read_b128 v[60:63], v104 offset:26624
    v_rcp_f32 v86, v86
    v_rcp_f32 v87, v87
    v_mfma_f32_16x16x32_bf16 v[40:43], v[68:71], v[180:183], v[40:43]
    s_waitcnt lgkmcnt(3)
    v_mul_f32 v84, v84, v16
    v_mfma_f32_16x16x32_bf16 v[28:31], v[44:47], v[184:187], v[28:31]
    ds_read_b128 v[64:67], v105 offset:26624
    v_mul_f32 v85, v85, v17
    v_mul_f32 v86, v86, v18
    v_mul_f32 v87, v87, v19
    v_mfma_f32_16x16x32_bf16 v[36:39], v[44:47], v[188:191], v[36:39]
    v_cvt_pk_bf16_f32 v90, v84, v85
    v_cvt_pk_bf16_f32 v91, v86, v87
    v_mfma_f32_16x16x32_bf16 v[32:35], v[48:51], v[184:187], v[32:35]
    s_waitcnt vmcnt(9)
    s_barrier
    ds_read_b128 v[68:71], v106 offset:0
    buffer_store_dwordx4 v[88:91], v110, s[20:23], s45 offen sc1
    v_mul_f32 v80, v20, v20
    v_mfma_f32_16x16x32_bf16 v[40:43], v[48:51], v[188:191], v[40:43]
    s_waitcnt lgkmcnt(3)
    v_mul_f32 v81, v21, v21
    v_mul_f32 v82, v22, v22
    v_mul_f32 v83, v23, v23
    v_mfma_f32_16x16x32_bf16 v[28:31], v[52:55], v[192:195], v[28:31]
    ds_read_b128 v[44:47], v107 offset:0
    v_fmaak_f32 v80, v80, v111, 0xc0135761
    v_fmaak_f32 v81, v81, v111, 0xc0135761
    v_mfma_f32_16x16x32_bf16 v[36:39], v[52:55], v[196:199], v[36:39]
    s_add_u32 m0, s36, 50944
    s_nop 0
    buffer_load_dwordx4 v97, s[8:11], s37 offen offset:256 lds
    v_fmaak_f32 v82, v82, v111, 0xc0135761
    v_fmaak_f32 v83, v83, v111, 0xc0135761
    v_mfma_f32_16x16x32_bf16 v[32:35], v[56:59], v[192:195], v[32:35]
    ds_read_b128 v[48:51], v108 offset:0
    v_mul_f32 v80, v80, v20
    v_mul_f32 v81, v81, v21
    v_mfma_f32_16x16x32_bf16 v[40:43], v[56:59], v[196:199], v[40:43]
    s_waitcnt lgkmcnt(3)
    v_mul_f32 v82, v82, v22
    v_mul_f32 v83, v83, v23
    v_mfma_f32_16x16x32_bf16 v[28:31], v[60:63], v[200:203], v[28:31]
    ds_read_b128 v[52:55], v109 offset:0
    v_exp_f32 v80, v80
    v_exp_f32 v81, v81
    v_mfma_f32_16x16x32_bf16 v[36:39], v[60:63], v[204:207], v[36:39]
    v_exp_f32 v82, v82
    v_mfma_f32_16x16x32_bf16 v[32:35], v[64:67], v[200:203], v[32:35]
    ds_read_b128 v[56:59], v106 offset:1024
    v_exp_f32 v83, v83
    v_mfma_f32_16x16x32_bf16 v[40:43], v[64:67], v[204:207], v[40:43]
    s_waitcnt lgkmcnt(3)
    v_add_f32 v80, 1.0, v80
    v_add_f32 v81, 1.0, v81
    v_mfma_f32_16x16x32_bf16 v[28:31], v[68:71], v[208:211], v[28:31]
    ds_read_b128 v[60:63], v107 offset:1024
    v_add_f32 v82, 1.0, v82
    v_add_f32 v83, 1.0, v83
    v_mfma_f32_16x16x32_bf16 v[36:39], v[68:71], v[212:215], v[36:39]
    s_add_u32 s37, s35, 368640
    s_add_u32 m0, s36, 122880
    s_nop 0
    buffer_load_dwordx4 v97, s[8:11], s37 offen offset:0 lds
    v_rcp_f32 v80, v80
    v_mfma_f32_16x16x32_bf16 v[32:35], v[44:47], v[208:211], v[32:35]
    ds_read_b128 v[64:67], v108 offset:1024
    v_rcp_f32 v81, v81
    v_mfma_f32_16x16x32_bf16 v[40:43], v[44:47], v[212:215], v[40:43]
    s_waitcnt lgkmcnt(3)
    v_rcp_f32 v82, v82
    v_rcp_f32 v83, v83
    v_mfma_f32_16x16x32_bf16 v[28:31], v[48:51], v[216:219], v[28:31]
    ds_read_b128 v[68:71], v109 offset:1024
    v_mul_f32 v80, v80, v20
    v_mfma_f32_16x16x32_bf16 v[36:39], v[48:51], v[220:223], v[36:39]
    v_mul_f32 v81, v81, v21
    v_mul_f32 v82, v82, v22
    v_mul_f32 v83, v83, v23
    v_mfma_f32_16x16x32_bf16 v[32:35], v[52:55], v[216:219], v[32:35]
    ds_read_b128 v[44:47], v106 offset:2048
    v_cvt_pk_bf16_f32 v92, v80, v81
    v_cvt_pk_bf16_f32 v93, v82, v83
    v_mfma_f32_16x16x32_bf16 v[40:43], v[52:55], v[220:223], v[40:43]
    s_waitcnt lgkmcnt(3)
    v_mul_f32 v84, v24, v24
    v_mul_f32 v85, v25, v25
    v_mfma_f32_16x16x32_bf16 v[28:31], v[56:59], v[224:227], v[28:31]
    ds_read_b128 v[48:51], v107 offset:2048
    v_mul_f32 v86, v26, v26
    v_mul_f32 v87, v27, v27
    v_fmaak_f32 v84, v84, v111, 0xc0135761
    v_mfma_f32_16x16x32_bf16 v[36:39], v[56:59], v[228:231], v[36:39]
    s_add_u32 m0, s36, 123776
    s_nop 0
    buffer_load_dwordx4 v97, s[8:11], s37 offen offset:128 lds
    v_fmaak_f32 v85, v85, v111, 0xc0135761
    v_fmaak_f32 v86, v86, v111, 0xc0135761
    v_mfma_f32_16x16x32_bf16 v[32:35], v[60:63], v[224:227], v[32:35]
    ds_read_b128 v[52:55], v108 offset:2048
    v_fmaak_f32 v87, v87, v111, 0xc0135761
    v_mul_f32 v84, v84, v24
    v_mfma_f32_16x16x32_bf16 v[40:43], v[60:63], v[228:231], v[40:43]
    s_waitcnt lgkmcnt(3)
    v_mul_f32 v85, v85, v25
    v_mul_f32 v86, v86, v26
    v_mfma_f32_16x16x32_bf16 v[28:31], v[64:67], v[232:235], v[28:31]
    ds_read_b128 v[56:59], v109 offset:2048
    v_mul_f32 v87, v87, v27
    v_exp_f32 v84, v84
    v_mfma_f32_16x16x32_bf16 v[36:39], v[64:67], v[236:239], v[36:39]
    v_exp_f32 v85, v85
    v_mfma_f32_16x16x32_bf16 v[32:35], v[68:71], v[232:235], v[32:35]
    s_waitcnt vmcnt(10)
    s_barrier
    ds_read_b128 v[60:63], v98 offset:0
    v_exp_f32 v86, v86
    v_mfma_f32_16x16x32_bf16 v[40:43], v[68:71], v[236:239], v[40:43]
    s_waitcnt lgkmcnt(3)
    v_exp_f32 v87, v87
    v_add_f32 v84, 1.0, v84
    v_mfma_f32_16x16x32_bf16 v[28:31], v[44:47], v[240:243], v[28:31]
    ds_read_b128 v[64:67], v99 offset:0
    v_add_f32 v85, 1.0, v85
    v_add_f32 v86, 1.0, v86
    v_mfma_f32_16x16x32_bf16 v[36:39], v[44:47], v[244:247], v[36:39]
    s_add_u32 m0, s36, 124672
    s_nop 0
    buffer_load_dwordx4 v97, s[8:11], s37 offen offset:256 lds
    v_add_f32 v87, 1.0, v87
    v_rcp_f32 v84, v84
    v_mfma_f32_16x16x32_bf16 v[32:35], v[48:51], v[240:243], v[32:35]
    ds_read_b128 v[68:71], v100 offset:0
    v_rcp_f32 v85, v85
    v_mfma_f32_16x16x32_bf16 v[40:43], v[48:51], v[244:247], v[40:43]
    s_waitcnt lgkmcnt(3)
    v_rcp_f32 v86, v86
    v_mfma_f32_16x16x32_bf16 v[28:31], v[52:55], v[248:251], v[28:31]
    ds_read_b128 v[44:47], v101 offset:0
    v_rcp_f32 v87, v87
    v_mfma_f32_16x16x32_bf16 v[36:39], v[52:55], v[252:255], v[36:39]
    v_mul_f32 v84, v84, v24
    v_mul_f32 v85, v85, v25
    v_mfma_f32_16x16x32_bf16 v[32:35], v[56:59], v[248:251], v[32:35]
    ds_read_b128 v[48:51], v98 offset:1024
    v_mul_f32 v86, v86, v26
    v_mul_f32 v87, v87, v27
    v_cvt_pk_bf16_f32 v94, v84, v85
    v_mfma_f32_16x16x32_bf16 v[40:43], v[56:59], v[252:255], v[40:43]
    s_waitcnt lgkmcnt(3)
    v_cvt_pk_bf16_f32 v95, v86, v87
    buffer_store_dwordx4 v[92:95], v10, s[20:23], s45 offen sc1
    v_mfma_f32_16x16x32_bf16 v[12:15], v[60:63], v[112:115], 0
    ds_read_b128 v[52:55], v99 offset:1024
    v_mfma_f32_16x16x32_bf16 v[20:23], v[60:63], v[116:119], 0
    s_add_u32 s37, s35, 369024
    s_add_u32 m0, s36, 73728
    s_nop 0
    buffer_load_dwordx4 v97, s[8:11], s37 offen offset:0 lds
    v_mfma_f32_16x16x32_bf16 v[16:19], v[64:67], v[112:115], 0
    ds_read_b128 v[56:59], v100 offset:1024
    v_mfma_f32_16x16x32_bf16 v[24:27], v[64:67], v[116:119], 0
    s_waitcnt lgkmcnt(3)
    v_mfma_f32_16x16x32_bf16 v[12:15], v[68:71], v[120:123], v[12:15]
    ds_read_b128 v[60:63], v101 offset:1024
    s_add_u32 s45, s42, 6
    s_mul_i32 s45, s45, 147456
    v_mfma_f32_16x16x32_bf16 v[20:23], v[68:71], v[124:127], v[20:23]
    v_mul_f32 v80, v28, v28
    v_mul_f32 v81, v29, v29
    v_mul_f32 v82, v30, v30
    v_mfma_f32_16x16x32_bf16 v[16:19], v[44:47], v[120:123], v[16:19]
    ds_read_b128 v[64:67], v98 offset:2048
    v_mul_f32 v83, v31, v31
    v_fmaak_f32 v80, v80, v111, 0xc0135761
    v_mfma_f32_16x16x32_bf16 v[24:27], v[44:47], v[124:127], v[24:27]
    s_waitcnt lgkmcnt(3)
    v_fmaak_f32 v81, v81, v111, 0xc0135761
    v_fmaak_f32 v82, v82, v111, 0xc0135761
    v_mfma_f32_16x16x32_bf16 v[12:15], v[48:51], v[128:131], v[12:15]
    ds_read_b128 v[68:71], v99 offset:2048
    v_fmaak_f32 v83, v83, v111, 0xc0135761
    v_mul_f32 v80, v80, v28
    v_mfma_f32_16x16x32_bf16 v[20:23], v[48:51], v[132:135], v[20:23]
    s_add_u32 m0, s36, 74624
    s_nop 0
    buffer_load_dwordx4 v97, s[8:11], s37 offen offset:128 lds
    v_mul_f32 v81, v81, v29
    v_mul_f32 v82, v82, v30
    v_mul_f32 v83, v83, v31
    v_mfma_f32_16x16x32_bf16 v[16:19], v[52:55], v[128:131], v[16:19]
    ds_read_b128 v[44:47], v100 offset:2048
    v_exp_f32 v80, v80
    v_mfma_f32_16x16x32_bf16 v[24:27], v[52:55], v[132:135], v[24:27]
    s_waitcnt lgkmcnt(3)
    v_exp_f32 v81, v81
    v_mfma_f32_16x16x32_bf16 v[12:15], v[56:59], v[136:139], v[12:15]
    ds_read_b128 v[48:51], v101 offset:2048
    v_exp_f32 v82, v82
    v_mfma_f32_16x16x32_bf16 v[20:23], v[56:59], v[140:143], v[20:23]
    v_exp_f32 v83, v83
    v_add_f32 v80, 1.0, v80
    v_mfma_f32_16x16x32_bf16 v[16:19], v[60:63], v[136:139], v[16:19]
    s_waitcnt vmcnt(10)
    s_barrier
    ds_read_b128 v[52:55], v98 offset:24576
    v_add_f32 v81, 1.0, v81
    v_add_f32 v82, 1.0, v82
    v_mfma_f32_16x16x32_bf16 v[24:27], v[60:63], v[140:143], v[24:27]
    s_waitcnt lgkmcnt(3)
    v_add_f32 v83, 1.0, v83
    v_rcp_f32 v80, v80
    v_mfma_f32_16x16x32_bf16 v[12:15], v[64:67], v[144:147], v[12:15]
    ds_read_b128 v[56:59], v99 offset:24576
    v_rcp_f32 v81, v81
    v_mfma_f32_16x16x32_bf16 v[20:23], v[64:67], v[148:151], v[20:23]
    s_add_u32 m0, s36, 75520
    s_nop 0
    buffer_load_dwordx4 v97, s[8:11], s37 offen offset:256 lds
    v_rcp_f32 v82, v82
    v_mfma_f32_16x16x32_bf16 v[16:19], v[68:71], v[144:147], v[16:19]
    ds_read_b128 v[60:63], v100 offset:24576
    v_rcp_f32 v83, v83
    v_mfma_f32_16x16x32_bf16 v[24:27], v[68:71], v[148:151], v[24:27]
    s_waitcnt lgkmcnt(3)
    v_mul_f32 v80, v80, v28
    v_mul_f32 v81, v81, v29
    v_mul_f32 v82, v82, v30
    v_mfma_f32_16x16x32_bf16 v[12:15], v[44:47], v[152:155], v[12:15]
    ds_read_b128 v[64:67], v101 offset:24576
    v_mul_f32 v83, v83, v31
    v_cvt_pk_bf16_f32 v88, v80, v81
    v_mfma_f32_16x16x32_bf16 v[20:23], v[44:47], v[156:159], v[20:23]
    v_cvt_pk_bf16_f32 v89, v82, v83
    v_mul_f32 v84, v32, v32
    v_mfma_f32_16x16x32_bf16 v[16:19], v[48:51], v[152:155], v[16:19]
    ds_read_b128 v[68:71], v98 offset:25600
    v_mul_f32 v85, v33, v33
    v_mul_f32 v86, v34, v34
    v_mul_f32 v87, v35, v35
    v_mfma_f32_16x16x32_bf16 v[24:27], v[48:51], v[156:159], v[24:27]
    s_waitcnt lgkmcnt(3)
    v_fmaak_f32 v84, v84, v111, 0xc0135761
    v_fmaak_f32 v85, v85, v111, 0xc0135761
    v_mfma_f32_16x16x32_bf16 v[12:15], v[52:55], v[160:163], v[12:15]
    ds_read_b128 v[44:47], v99 offset:25600
    v_fmaak_f32 v86, v86, v111, 0xc0135761
    v_fmaak_f32 v87, v87, v111, 0xc0135761
    v_mfma_f32_16x16x32_bf16 v[20:23], v[52:55], v[164:167], v[20:23]
    s_add_u32 s37, s35, 369408
    s_add_u32 m0, s36, 98304
    s_nop 0
    buffer_load_dwordx4 v97, s[8:11], s37 offen offset:0 lds
    v_mul_f32 v84, v84, v32
    v_mul_f32 v85, v85, v33
    v_mfma_f32_16x16x32_bf16 v[16:19], v[56:59], v[160:163], v[16:19]
    ds_read_b128 v[48:51], v100 offset:25600
    v_mul_f32 v86, v86, v34
    v_mul_f32 v87, v87, v35
    v_mfma_f32_16x16x32_bf16 v[24:27], v[56:59], v[164:167], v[24:27]
    s_waitcnt lgkmcnt(3)
    v_exp_f32 v84, v84
    v_exp_f32 v85, v85
    v_mfma_f32_16x16x32_bf16 v[12:15], v[60:63], v[168:171], v[12:15]
    ds_read_b128 v[52:55], v101 offset:25600
    v_exp_f32 v86, v86
    v_mfma_f32_16x16x32_bf16 v[20:23], v[60:63], v[172:175], v[20:23]
    v_exp_f32 v87, v87
    v_mfma_f32_16x16x32_bf16 v[16:19], v[64:67], v[168:171], v[16:19]
    ds_read_b128 v[56:59], v98 offset:26624
    v_add_f32 v84, 1.0, v84
    v_add_f32 v85, 1.0, v85
    v_mfma_f32_16x16x32_bf16 v[24:27], v[64:67], v[172:175], v[24:27]
    s_waitcnt lgkmcnt(3)
    v_add_f32 v86, 1.0, v86
    v_add_f32 v87, 1.0, v87
    v_mfma_f32_16x16x32_bf16 v[12:15], v[68:71], v[176:179], v[12:15]
    ds_read_b128 v[60:63], v99 offset:26624
    v_rcp_f32 v84, v84
    v_mfma_f32_16x16x32_bf16 v[20:23], v[68:71], v[180:183], v[20:23]
    s_add_u32 m0, s36, 99200
    s_nop 0
    buffer_load_dwordx4 v97, s[8:11], s37 offen offset:128 lds
    v_rcp_f32 v85, v85
    v_mfma_f32_16x16x32_bf16 v[16:19], v[44:47], v[176:179], v[16:19]
    ds_read_b128 v[64:67], v100 offset:26624
    v_rcp_f32 v86, v86
    v_rcp_f32 v87, v87
    v_mfma_f32_16x16x32_bf16 v[24:27], v[44:47], v[180:183], v[24:27]
    s_waitcnt lgkmcnt(3)
    v_mul_f32 v84, v84, v32
    v_mfma_f32_16x16x32_bf16 v[12:15], v[48:51], v[184:187], v[12:15]
    ds_read_b128 v[68:71], v101 offset:26624
    v_mul_f32 v85, v85, v33
    v_mul_f32 v86, v86, v34
    v_mul_f32 v87, v87, v35
    v_mfma_f32_16x16x32_bf16 v[20:23], v[48:51], v[188:191], v[20:23]
    v_cvt_pk_bf16_f32 v90, v84, v85
    v_cvt_pk_bf16_f32 v91, v86, v87
    v_mfma_f32_16x16x32_bf16 v[16:19], v[52:55], v[184:187], v[16:19]
    s_waitcnt vmcnt(9)
    s_barrier
    ds_read_b128 v[44:47], v102 offset:0
    buffer_store_dwordx4 v[88:91], v110, s[20:23], s45 offen sc1
    v_mul_f32 v80, v36, v36
    v_mfma_f32_16x16x32_bf16 v[24:27], v[52:55], v[188:191], v[24:27]
    s_waitcnt lgkmcnt(3)
    v_mul_f32 v81, v37, v37
    v_mul_f32 v82, v38, v38
    v_mul_f32 v83, v39, v39
    v_mfma_f32_16x16x32_bf16 v[12:15], v[56:59], v[192:195], v[12:15]
    ds_read_b128 v[48:51], v103 offset:0
    v_fmaak_f32 v80, v80, v111, 0xc0135761
    v_fmaak_f32 v81, v81, v111, 0xc0135761
    v_mfma_f32_16x16x32_bf16 v[20:23], v[56:59], v[196:199], v[20:23]
    s_add_u32 m0, s36, 100096
    s_nop 0
    buffer_load_dwordx4 v97, s[8:11], s37 offen offset:256 lds
    v_fmaak_f32 v82, v82, v111, 0xc0135761
    v_fmaak_f32 v83, v83, v111, 0xc0135761
    v_mfma_f32_16x16x32_bf16 v[16:19], v[60:63], v[192:195], v[16:19]
    ds_read_b128 v[52:55], v104 offset:0
    v_mul_f32 v80, v80, v36
    v_mul_f32 v81, v81, v37
    v_mfma_f32_16x16x32_bf16 v[24:27], v[60:63], v[196:199], v[24:27]
    s_waitcnt lgkmcnt(3)
    v_mul_f32 v82, v82, v38
    v_mul_f32 v83, v83, v39
    v_mfma_f32_16x16x32_bf16 v[12:15], v[64:67], v[200:203], v[12:15]
    ds_read_b128 v[56:59], v105 offset:0
    v_exp_f32 v80, v80
    v_exp_f32 v81, v81
    v_mfma_f32_16x16x32_bf16 v[20:23], v[64:67], v[204:207], v[20:23]
    v_exp_f32 v82, v82
    v_mfma_f32_16x16x32_bf16 v[16:19], v[68:71], v[200:203], v[16:19]
    ds_read_b128 v[60:63], v102 offset:1024
    v_exp_f32 v83, v83
    v_mfma_f32_16x16x32_bf16 v[24:27], v[68:71], v[204:207], v[24:27]
    s_waitcnt lgkmcnt(3)
    v_add_f32 v80, 1.0, v80
    v_add_f32 v81, 1.0, v81
    v_mfma_f32_16x16x32_bf16 v[12:15], v[44:47], v[208:211], v[12:15]
    ds_read_b128 v[64:67], v103 offset:1024
    v_add_f32 v82, 1.0, v82
    v_add_f32 v83, 1.0, v83
    v_mfma_f32_16x16x32_bf16 v[20:23], v[44:47], v[212:215], v[20:23]
    s_add_u32 s37, s33, 0
    s_add_u32 m0, s36, 0
    s_nop 0
    buffer_load_dwordx4 v97, s[8:11], s37 offen offset:0 lds
    v_rcp_f32 v80, v80
    v_mfma_f32_16x16x32_bf16 v[16:19], v[48:51], v[208:211], v[16:19]
    ds_read_b128 v[68:71], v104 offset:1024
    v_rcp_f32 v81, v81
    v_mfma_f32_16x16x32_bf16 v[24:27], v[48:51], v[212:215], v[24:27]
    s_waitcnt lgkmcnt(3)
    v_rcp_f32 v82, v82
    v_rcp_f32 v83, v83
    v_mfma_f32_16x16x32_bf16 v[12:15], v[52:55], v[216:219], v[12:15]
    ds_read_b128 v[44:47], v105 offset:1024
    v_mul_f32 v80, v80, v36
    v_mfma_f32_16x16x32_bf16 v[20:23], v[52:55], v[220:223], v[20:23]
    v_mul_f32 v81, v81, v37
    v_mul_f32 v82, v82, v38
    v_mul_f32 v83, v83, v39
    v_mfma_f32_16x16x32_bf16 v[16:19], v[56:59], v[216:219], v[16:19]
    ds_read_b128 v[48:51], v102 offset:2048
    v_cvt_pk_bf16_f32 v92, v80, v81
    v_cvt_pk_bf16_f32 v93, v82, v83
    v_mfma_f32_16x16x32_bf16 v[24:27], v[56:59], v[220:223], v[24:27]
    s_waitcnt lgkmcnt(3)
    v_mul_f32 v84, v40, v40
    v_mul_f32 v85, v41, v41
    v_mfma_f32_16x16x32_bf16 v[12:15], v[60:63], v[224:227], v[12:15]
    ds_read_b128 v[52:55], v103 offset:2048
    v_mul_f32 v86, v42, v42
    v_mul_f32 v87, v43, v43
    v_fmaak_f32 v84, v84, v111, 0xc0135761
    v_mfma_f32_16x16x32_bf16 v[20:23], v[60:63], v[228:231], v[20:23]
    s_add_u32 m0, s36, 896
    s_nop 0
    buffer_load_dwordx4 v97, s[8:11], s37 offen offset:128 lds
    v_fmaak_f32 v85, v85, v111, 0xc0135761
    v_fmaak_f32 v86, v86, v111, 0xc0135761
    v_mfma_f32_16x16x32_bf16 v[16:19], v[64:67], v[224:227], v[16:19]
    ds_read_b128 v[56:59], v104 offset:2048
    v_fmaak_f32 v87, v87, v111, 0xc0135761
    v_mul_f32 v84, v84, v40
    v_mfma_f32_16x16x32_bf16 v[24:27], v[64:67], v[228:231], v[24:27]
    s_waitcnt lgkmcnt(3)
    v_mul_f32 v85, v85, v41
    v_mul_f32 v86, v86, v42
    v_mfma_f32_16x16x32_bf16 v[12:15], v[68:71], v[232:235], v[12:15]
    ds_read_b128 v[60:63], v105 offset:2048
    v_mul_f32 v87, v87, v43
    v_exp_f32 v84, v84
    v_mfma_f32_16x16x32_bf16 v[20:23], v[68:71], v[236:239], v[20:23]
    v_exp_f32 v85, v85
    v_mfma_f32_16x16x32_bf16 v[16:19], v[44:47], v[232:235], v[16:19]
    s_waitcnt vmcnt(10)
    s_barrier
    ds_read_b128 v[64:67], v106 offset:24576
    v_exp_f32 v86, v86
    v_mfma_f32_16x16x32_bf16 v[24:27], v[44:47], v[236:239], v[24:27]
    s_waitcnt lgkmcnt(3)
    v_exp_f32 v87, v87
    v_add_f32 v84, 1.0, v84
    v_mfma_f32_16x16x32_bf16 v[12:15], v[48:51], v[240:243], v[12:15]
    ds_read_b128 v[68:71], v107 offset:24576
    v_add_f32 v85, 1.0, v85
    v_add_f32 v86, 1.0, v86
    v_mfma_f32_16x16x32_bf16 v[20:23], v[48:51], v[244:247], v[20:23]
    s_add_u32 m0, s36, 1792
    s_nop 0
    buffer_load_dwordx4 v97, s[8:11], s37 offen offset:256 lds
    v_add_f32 v87, 1.0, v87
    v_rcp_f32 v84, v84
    v_mfma_f32_16x16x32_bf16 v[16:19], v[52:55], v[240:243], v[16:19]
    ds_read_b128 v[44:47], v108 offset:24576
    v_rcp_f32 v85, v85
    v_mfma_f32_16x16x32_bf16 v[24:27], v[52:55], v[244:247], v[24:27]
    s_waitcnt lgkmcnt(3)
    v_rcp_f32 v86, v86
    v_mfma_f32_16x16x32_bf16 v[12:15], v[56:59], v[248:251], v[12:15]
    ds_read_b128 v[48:51], v109 offset:24576
    v_rcp_f32 v87, v87
    v_mfma_f32_16x16x32_bf16 v[20:23], v[56:59], v[252:255], v[20:23]
    v_mul_f32 v84, v84, v40
    v_mul_f32 v85, v85, v41
    v_mfma_f32_16x16x32_bf16 v[16:19], v[60:63], v[248:251], v[16:19]
    ds_read_b128 v[52:55], v106 offset:25600
    v_mul_f32 v86, v86, v42
    v_mul_f32 v87, v87, v43
    v_cvt_pk_bf16_f32 v94, v84, v85
    v_mfma_f32_16x16x32_bf16 v[24:27], v[60:63], v[252:255], v[24:27]
    s_waitcnt lgkmcnt(3)
    v_cvt_pk_bf16_f32 v95, v86, v87
    buffer_store_dwordx4 v[92:95], v10, s[20:23], s45 offen sc1
    v_mfma_f32_16x16x32_bf16 v[28:31], v[64:67], v[112:115], 0
    ds_read_b128 v[56:59], v107 offset:25600
    v_mfma_f32_16x16x32_bf16 v[36:39], v[64:67], v[116:119], 0
    s_add_u32 s37, s33, 384
    s_add_u32 m0, s36, 24576
    s_nop 0
    buffer_load_dwordx4 v97, s[8:11], s37 offen offset:0 lds
    v_mfma_f32_16x16x32_bf16 v[32:35], v[68:71], v[112:115], 0
    ds_read_b128 v[60:63], v108 offset:25600
    v_mfma_f32_16x16x32_bf16 v[40:43], v[68:71], v[116:119], 0
    s_add_u32 m0, s36, 25472
    s_nop 0
    buffer_load_dwordx4 v97, s[8:11], s37 offen offset:128 lds
    s_waitcnt lgkmcnt(4)
    v_mfma_f32_16x16x32_bf16 v[28:31], v[44:47], v[120:123], v[28:31]
    ds_read_b128 v[64:67], v109 offset:25600
    s_add_u32 s45, s42, 8
    s_mul_i32 s45, s45, 147456
    v_mfma_f32_16x16x32_bf16 v[36:39], v[44:47], v[124:127], v[36:39]
    s_add_u32 m0, s36, 26368
    s_nop 0
    buffer_load_dwordx4 v97, s[8:11], s37 offen offset:256 lds
    v_mul_f32 v80, v12, v12
    v_mul_f32 v81, v13, v13
    v_mul_f32 v82, v14, v14
    s_waitcnt lgkmcnt(4)
    v_mfma_f32_16x16x32_bf16 v[32:35], v[48:51], v[120:123], v[32:35]
    ds_read_b128 v[68:71], v106 offset:26624
    v_mul_f32 v83, v15, v15
    v_fmaak_f32 v80, v80, v111, 0xc0135761
    v_mfma_f32_16x16x32_bf16 v[40:43], v[48:51], v[124:127], v[40:43]
    s_waitcnt lgkmcnt(3)
    v_fmaak_f32 v81, v81, v111, 0xc0135761
    v_fmaak_f32 v82, v82, v111, 0xc0135761
    v_mfma_f32_16x16x32_bf16 v[28:31], v[52:55], v[128:131], v[28:31]
    ds_read_b128 v[44:47], v107 offset:26624
    v_fmaak_f32 v83, v83, v111, 0xc0135761
    v_mul_f32 v80, v80, v12
    v_mfma_f32_16x16x32_bf16 v[36:39], v[52:55], v[132:135], v[36:39]
    v_mul_f32 v81, v81, v13
    v_mul_f32 v82, v82, v14
    v_mul_f32 v83, v83, v15
    v_mfma_f32_16x16x32_bf16 v[32:35], v[56:59], v[128:131], v[32:35]
    ds_read_b128 v[48:51], v108 offset:26624
    v_exp_f32 v80, v80
    v_mfma_f32_16x16x32_bf16 v[40:43], v[56:59], v[132:135], v[40:43]
    s_waitcnt lgkmcnt(3)
    v_exp_f32 v81, v81
    v_mfma_f32_16x16x32_bf16 v[28:31], v[60:63], v[136:139], v[28:31]
    ds_read_b128 v[52:55], v109 offset:26624
    v_exp_f32 v82, v82
    v_mfma_f32_16x16x32_bf16 v[36:39], v[60:63], v[140:143], v[36:39]
    v_exp_f32 v83, v83
    v_add_f32 v80, 1.0, v80
    v_mfma_f32_16x16x32_bf16 v[32:35], v[64:67], v[136:139], v[32:35]
    s_waitcnt vmcnt(11)
    s_barrier
    ds_read_b128 v[56:59], v102 offset:24576
    v_add_f32 v81, 1.0, v81
    v_add_f32 v82, 1.0, v82
    v_mfma_f32_16x16x32_bf16 v[40:43], v[64:67], v[140:143], v[40:43]
    s_waitcnt lgkmcnt(3)
    v_add_f32 v83, 1.0, v83
    v_rcp_f32 v80, v80
    v_mfma_f32_16x16x32_bf16 v[28:31], v[68:71], v[144:147], v[28:31]
    ds_read_b128 v[60:63], v103 offset:24576
    v_rcp_f32 v81, v81
    v_mfma_f32_16x16x32_bf16 v[36:39], v[68:71], v[148:151], v[36:39]
    s_add_u32 s37, s33, 768
    s_add_u32 m0, s36, 49152
    s_nop 0
    buffer_load_dwordx4 v97, s[8:11], s37 offen offset:0 lds
    v_rcp_f32 v82, v82
    v_mfma_f32_16x16x32_bf16 v[32:35], v[44:47], v[144:147], v[32:35]
    ds_read_b128 v[64:67], v104 offset:24576
    v_rcp_f32 v83, v83
    v_mfma_f32_16x16x32_bf16 v[40:43], v[44:47], v[148:151], v[40:43]
    s_add_u32 m0, s36, 50048
    s_nop 0
    buffer_load_dwordx4 v97, s[8:11], s37 offen offset:128 lds
    v_mul_f32 v80, v80, v12
    v_mul_f32 v81, v81, v13
    v_mul_f32 v82, v82, v14
    s_waitcnt lgkmcnt(4)
    v_mfma_f32_16x16x32_bf16 v[28:31], v[48:51], v[152:155], v[28:31]
    ds_read_b128 v[68:71], v105 offset:24576
    v_mul_f32 v83, v83, v15
    v_cvt_pk_bf16_f32 v88, v80, v81
    v_mfma_f32_16x16x32_bf16 v[36:39], v[48:51], v[156:159], v[36:39]
    s_add_u32 m0, s36, 50944
    s_nop 0
    buffer_load_dwordx4 v97, s[8:11], s37 offen offset:256 lds
    v_cvt_pk_bf16_f32 v89, v82, v83
    v_mul_f32 v84, v16, v16
    s_waitcnt lgkmcnt(4)
    v_mfma_f32_16x16x32_bf16 v[32:35], v[52:55], v[152:155], v[32:35]
    ds_read_b128 v[44:47], v102 offset:25600
    v_mul_f32 v85, v17, v17
    v_mul_f32 v86, v18, v18
    v_mul_f32 v87, v19, v19
    v_mfma_f32_16x16x32_bf16 v[40:43], v[52:55], v[156:159], v[40:43]
    s_waitcnt lgkmcnt(3)
    v_fmaak_f32 v84, v84, v111, 0xc0135761
    v_fmaak_f32 v85, v85, v111, 0xc0135761
    v_mfma_f32_16x16x32_bf16 v[28:31], v[56:59], v[160:163], v[28:31]
    ds_read_b128 v[48:51], v103 offset:25600
    v_fmaak_f32 v86, v86, v111, 0xc0135761
    v_fmaak_f32 v87, v87, v111, 0xc0135761
    v_mfma_f32_16x16x32_bf16 v[36:39], v[56:59], v[164:167], v[36:39]
    v_mul_f32 v84, v84, v16
    v_mul_f32 v85, v85, v17
    v_mfma_f32_16x16x32_bf16 v[32:35], v[60:63], v[160:163], v[32:35]
    ds_read_b128 v[52:55], v104 offset:25600
    v_mul_f32 v86, v86, v18
    v_mul_f32 v87, v87, v19
    v_mfma_f32_16x16x32_bf16 v[40:43], v[60:63], v[164:167], v[40:43]
    s_waitcnt lgkmcnt(3)
    v_exp_f32 v84, v84
    v_exp_f32 v85, v85
    v_mfma_f32_16x16x32_bf16 v[28:31], v[64:67], v[168:171], v[28:31]
    ds_read_b128 v[56:59], v105 offset:25600
    v_exp_f32 v86, v86
    v_mfma_f32_16x16x32_bf16 v[36:39], v[64:67], v[172:175], v[36:39]
    v_exp_f32 v87, v87
    v_mfma_f32_16x16x32_bf16 v[32:35], v[68:71], v[168:171], v[32:35]
    ds_read_b128 v[60:63], v102 offset:26624
    v_add_f32 v84, 1.0, v84
    v_add_f32 v85, 1.0, v85
    v_mfma_f32_16x16x32_bf16 v[40:43], v[68:71], v[172:175], v[40:43]
    s_waitcnt lgkmcnt(3)
    v_add_f32 v86, 1.0, v86
    v_add_f32 v87, 1.0, v87
    v_mfma_f32_16x16x32_bf16 v[28:31], v[44:47], v[176:179], v[28:31]
    ds_read_b128 v[64:67], v103 offset:26624
    v_rcp_f32 v84, v84
    v_mfma_f32_16x16x32_bf16 v[36:39], v[44:47], v[180:183], v[36:39]
    v_rcp_f32 v85, v85
    v_mfma_f32_16x16x32_bf16 v[32:35], v[48:51], v[176:179], v[32:35]
    ds_read_b128 v[68:71], v104 offset:26624
    v_rcp_f32 v86, v86
    v_rcp_f32 v87, v87
    v_mfma_f32_16x16x32_bf16 v[40:43], v[48:51], v[180:183], v[40:43]
    s_waitcnt lgkmcnt(3)
    v_mul_f32 v84, v84, v16
    v_mfma_f32_16x16x32_bf16 v[28:31], v[52:55], v[184:187], v[28:31]
    ds_read_b128 v[44:47], v105 offset:26624
    v_mul_f32 v85, v85, v17
    v_mul_f32 v86, v86, v18
    v_mul_f32 v87, v87, v19
    v_mfma_f32_16x16x32_bf16 v[36:39], v[52:55], v[188:191], v[36:39]
    v_cvt_pk_bf16_f32 v90, v84, v85
    v_cvt_pk_bf16_f32 v91, v86, v87
    v_mfma_f32_16x16x32_bf16 v[32:35], v[56:59], v[184:187], v[32:35]
    s_waitcnt vmcnt(10)
    s_barrier
    ds_read_b128 v[48:51], v106 offset:0
    buffer_store_dwordx4 v[88:91], v110, s[20:23], s45 offen sc1
    v_mul_f32 v80, v20, v20
    v_mfma_f32_16x16x32_bf16 v[40:43], v[56:59], v[188:191], v[40:43]
    s_waitcnt lgkmcnt(3)
    v_mul_f32 v81, v21, v21
    v_mul_f32 v82, v22, v22
    v_mul_f32 v83, v23, v23
    v_mfma_f32_16x16x32_bf16 v[28:31], v[60:63], v[192:195], v[28:31]
    ds_read_b128 v[52:55], v107 offset:0
    v_fmaak_f32 v80, v80, v111, 0xc0135761
    v_fmaak_f32 v81, v81, v111, 0xc0135761
    v_mfma_f32_16x16x32_bf16 v[36:39], v[60:63], v[196:199], v[36:39]
    v_fmaak_f32 v82, v82, v111, 0xc0135761
    v_fmaak_f32 v83, v83, v111, 0xc0135761
    v_mfma_f32_16x16x32_bf16 v[32:35], v[64:67], v[192:195], v[32:35]
    ds_read_b128 v[56:59], v108 offset:0
    v_mul_f32 v80, v80, v20
    v_mul_f32 v81, v81, v21
    v_mfma_f32_16x16x32_bf16 v[40:43], v[64:67], v[196:199], v[40:43]
    s_waitcnt lgkmcnt(3)
    v_mul_f32 v82, v82, v22
    v_mul_f32 v83, v83, v23
    v_mfma_f32_16x16x32_bf16 v[28:31], v[68:71], v[200:203], v[28:31]
    ds_read_b128 v[60:63], v109 offset:0
    v_exp_f32 v80, v80
    v_exp_f32 v81, v81
    v_mfma_f32_16x16x32_bf16 v[36:39], v[68:71], v[204:207], v[36:39]
    v_exp_f32 v82, v82
    v_mfma_f32_16x16x32_bf16 v[32:35], v[44:47], v[200:203], v[32:35]
    ds_read_b128 v[64:67], v106 offset:1024
    v_exp_f32 v83, v83
    v_mfma_f32_16x16x32_bf16 v[40:43], v[44:47], v[204:207], v[40:43]
    s_waitcnt lgkmcnt(3)
    v_add_f32 v80, 1.0, v80
    v_add_f32 v81, 1.0, v81
    v_mfma_f32_16x16x32_bf16 v[28:31], v[48:51], v[208:211], v[28:31]
    ds_read_b128 v[68:71], v107 offset:1024
    v_add_f32 v82, 1.0, v82
    v_add_f32 v83, 1.0, v83
    v_mfma_f32_16x16x32_bf16 v[36:39], v[48:51], v[212:215], v[36:39]
    v_rcp_f32 v80, v80
    v_mfma_f32_16x16x32_bf16 v[32:35], v[52:55], v[208:211], v[32:35]
    ds_read_b128 v[44:47], v108 offset:1024
    v_rcp_f32 v81, v81
    v_mfma_f32_16x16x32_bf16 v[40:43], v[52:55], v[212:215], v[40:43]
    s_waitcnt lgkmcnt(3)
    v_rcp_f32 v82, v82
    v_rcp_f32 v83, v83
    v_mfma_f32_16x16x32_bf16 v[28:31], v[56:59], v[216:219], v[28:31]
    ds_read_b128 v[48:51], v109 offset:1024
    v_mul_f32 v80, v80, v20
    v_mfma_f32_16x16x32_bf16 v[36:39], v[56:59], v[220:223], v[36:39]
    v_mul_f32 v81, v81, v21
    v_mul_f32 v82, v82, v22
    v_mul_f32 v83, v83, v23
    v_mfma_f32_16x16x32_bf16 v[32:35], v[60:63], v[216:219], v[32:35]
    ds_read_b128 v[52:55], v106 offset:2048
    v_cvt_pk_bf16_f32 v92, v80, v81
    v_cvt_pk_bf16_f32 v93, v82, v83
    v_mfma_f32_16x16x32_bf16 v[40:43], v[60:63], v[220:223], v[40:43]
    s_waitcnt lgkmcnt(3)
    v_mul_f32 v84, v24, v24
    v_mul_f32 v85, v25, v25
    v_mfma_f32_16x16x32_bf16 v[28:31], v[64:67], v[224:227], v[28:31]
    ds_read_b128 v[56:59], v107 offset:2048
    v_mul_f32 v86, v26, v26
    v_mul_f32 v87, v27, v27
    v_fmaak_f32 v84, v84, v111, 0xc0135761
    v_mfma_f32_16x16x32_bf16 v[36:39], v[64:67], v[228:231], v[36:39]
    v_fmaak_f32 v85, v85, v111, 0xc0135761
    v_fmaak_f32 v86, v86, v111, 0xc0135761
    v_mfma_f32_16x16x32_bf16 v[32:35], v[68:71], v[224:227], v[32:35]
    ds_read_b128 v[60:63], v108 offset:2048
    v_fmaak_f32 v87, v87, v111, 0xc0135761
    v_mul_f32 v84, v84, v24
    v_mfma_f32_16x16x32_bf16 v[40:43], v[68:71], v[228:231], v[40:43]
    s_waitcnt lgkmcnt(3)
    v_mul_f32 v85, v85, v25
    v_mul_f32 v86, v86, v26
    v_mfma_f32_16x16x32_bf16 v[28:31], v[44:47], v[232:235], v[28:31]
    ds_read_b128 v[64:67], v109 offset:2048
    v_mul_f32 v87, v87, v27
    v_exp_f32 v84, v84
    v_mfma_f32_16x16x32_bf16 v[36:39], v[44:47], v[236:239], v[36:39]
    v_exp_f32 v85, v85
    v_mfma_f32_16x16x32_bf16 v[32:35], v[48:51], v[232:235], v[32:35]
    s_waitcnt vmcnt(1)
    s_barrier
    v_add_u32 v98, s49, v98
    v_add_u32 v99, s49, v99
    v_add_u32 v100, s49, v100
    v_add_u32 v101, s49, v101
    v_add_u32 v102, s49, v102
    v_add_u32 v103, s49, v103
    v_add_u32 v104, s49, v104
    v_add_u32 v105, s49, v105
    ds_read_b128 v[68:71], v98 offset:0
    v_exp_f32 v86, v86
    v_mfma_f32_16x16x32_bf16 v[40:43], v[48:51], v[236:239], v[40:43]
    s_waitcnt lgkmcnt(3)
    v_exp_f32 v87, v87
    v_add_f32 v84, 1.0, v84
    v_mfma_f32_16x16x32_bf16 v[28:31], v[52:55], v[240:243], v[28:31]
    ds_read_b128 v[44:47], v99 offset:0
    v_add_f32 v85, 1.0, v85
    v_add_f32 v86, 1.0, v86
    v_mfma_f32_16x16x32_bf16 v[36:39], v[52:55], v[244:247], v[36:39]
    v_add_f32 v87, 1.0, v87
    v_rcp_f32 v84, v84
    v_mfma_f32_16x16x32_bf16 v[32:35], v[56:59], v[240:243], v[32:35]
    ds_read_b128 v[48:51], v100 offset:0
    v_rcp_f32 v85, v85
    v_mfma_f32_16x16x32_bf16 v[40:43], v[56:59], v[244:247], v[40:43]
    s_waitcnt lgkmcnt(3)
    v_rcp_f32 v86, v86
    v_mfma_f32_16x16x32_bf16 v[28:31], v[60:63], v[248:251], v[28:31]
    ds_read_b128 v[52:55], v101 offset:0
    v_rcp_f32 v87, v87
    v_mfma_f32_16x16x32_bf16 v[36:39], v[60:63], v[252:255], v[36:39]
    v_mul_f32 v84, v84, v24
    v_mul_f32 v85, v85, v25
    v_mfma_f32_16x16x32_bf16 v[32:35], v[64:67], v[248:251], v[32:35]
    ds_read_b128 v[56:59], v98 offset:1024
    v_mul_f32 v86, v86, v26
    v_mul_f32 v87, v87, v27
    v_cvt_pk_bf16_f32 v94, v84, v85
    v_mfma_f32_16x16x32_bf16 v[40:43], v[64:67], v[252:255], v[40:43]
    s_waitcnt lgkmcnt(3)
    v_cvt_pk_bf16_f32 v95, v86, v87
    buffer_store_dwordx4 v[92:95], v10, s[20:23], s45 offen sc1
    s_cmp_eq_u32 s48, 0
    s_cbranch_scc1 K1_G_fin
    v_mfma_f32_16x16x32_bf16 v[12:15], v[68:71], v[112:115], 0
    ds_read_b128 v[60:63], v99 offset:1024
    v_mfma_f32_16x16x32_bf16 v[20:23], v[68:71], v[116:119], 0
    v_mfma_f32_16x16x32_bf16 v[16:19], v[44:47], v[112:115], 0
    ds_read_b128 v[64:67], v100 offset:1024
    v_mfma_f32_16x16x32_bf16 v[24:27], v[44:47], v[116:119], 0
    s_waitcnt lgkmcnt(3)
    v_mfma_f32_16x16x32_bf16 v[12:15], v[48:51], v[120:123], v[12:15]
    ds_read_b128 v[68:71], v101 offset:1024
    s_add_u32 s45, s42, 10
    s_mul_i32 s45, s45, 147456
    v_mfma_f32_16x16x32_bf16 v[20:23], v[48:51], v[124:127], v[20:23]
    v_mul_f32 v80, v28, v28
    v_mul_f32 v81, v29, v29
    v_mul_f32 v82, v30, v30
    v_mfma_f32_16x16x32_bf16 v[16:19], v[52:55], v[120:123], v[16:19]
    ds_read_b128 v[44:47], v98 offset:2048
    v_mul_f32 v83, v31, v31
    v_fmaak_f32 v80, v80, v111, 0xc0135761
    v_mfma_f32_16x16x32_bf16 v[24:27], v[52:55], v[124:127], v[24:27]
    s_waitcnt lgkmcnt(3)
    v_fmaak_f32 v81, v81, v111, 0xc0135761
    v_fmaak_f32 v82, v82, v111, 0xc0135761
    v_mfma_f32_16x16x32_bf16 v[12:15], v[56:59], v[128:131], v[12:15]
    ds_read_b128 v[48:51], v99 offset:2048
    v_fmaak_f32 v83, v83, v111, 0xc0135761
    v_mul_f32 v80, v80, v28
    v_mfma_f32_16x16x32_bf16 v[20:23], v[56:59], v[132:135], v[20:23]
    v_mul_f32 v81, v81, v29
    v_mul_f32 v82, v82, v30
    v_mul_f32 v83, v83, v31
    v_mfma_f32_16x16x32_bf16 v[16:19], v[60:63], v[128:131], v[16:19]
    ds_read_b128 v[52:55], v100 offset:2048
    v_exp_f32 v80, v80
    v_mfma_f32_16x16x32_bf16 v[24:27], v[60:63], v[132:135], v[24:27]
    s_waitcnt lgkmcnt(3)
    v_exp_f32 v81, v81
    v_mfma_f32_16x16x32_bf16 v[12:15], v[64:67], v[136:139], v[12:15]
    ds_read_b128 v[56:59], v101 offset:2048
    v_exp_f32 v82, v82
    v_mfma_f32_16x16x32_bf16 v[20:23], v[64:67], v[140:143], v[20:23]
    v_exp_f32 v83, v83
    v_add_f32 v80, 1.0, v80
    v_mfma_f32_16x16x32_bf16 v[16:19], v[68:71], v[136:139], v[16:19]
    ds_read_b128 v[60:63], v98 offset:24576
    v_add_f32 v81, 1.0, v81
    v_add_f32 v82, 1.0, v82
    v_mfma_f32_16x16x32_bf16 v[24:27], v[68:71], v[140:143], v[24:27]
    s_waitcnt lgkmcnt(3)
    v_add_f32 v83, 1.0, v83
    v_rcp_f32 v80, v80
    v_mfma_f32_16x16x32_bf16 v[12:15], v[44:47], v[144:147], v[12:15]
    ds_read_b128 v[64:67], v99 offset:24576
    v_rcp_f32 v81, v81
    v_mfma_f32_16x16x32_bf16 v[20:23], v[44:47], v[148:151], v[20:23]
    v_rcp_f32 v82, v82
    v_mfma_f32_16x16x32_bf16 v[16:19], v[48:51], v[144:147], v[16:19]
    ds_read_b128 v[68:71], v100 offset:24576
    v_rcp_f32 v83, v83
    v_mfma_f32_16x16x32_bf16 v[24:27], v[48:51], v[148:151], v[24:27]
    s_waitcnt lgkmcnt(3)
    v_mul_f32 v80, v80, v28
    v_mul_f32 v81, v81, v29
    v_mul_f32 v82, v82, v30
    v_mfma_f32_16x16x32_bf16 v[12:15], v[52:55], v[152:155], v[12:15]
    ds_read_b128 v[44:47], v101 offset:24576
    v_mul_f32 v83, v83, v31
    v_cvt_pk_bf16_f32 v88, v80, v81
    v_mfma_f32_16x16x32_bf16 v[20:23], v[52:55], v[156:159], v[20:23]
    v_cvt_pk_bf16_f32 v89, v82, v83
    v_mul_f32 v84, v32, v32
    v_mfma_f32_16x16x32_bf16 v[16:19], v[56:59], v[152:155], v[16:19]
    ds_read_b128 v[48:51], v98 offset:25600
    v_mul_f32 v85, v33, v33
    v_mul_f32 v86, v34, v34
    v_mul_f32 v87, v35, v35
    v_mfma_f32_16x16x32_bf16 v[24:27], v[56:59], v[156:159], v[24:27]
    s_waitcnt lgkmcnt(3)
    v_fmaak_f32 v84, v84, v111, 0xc0135761
    v_fmaak_f32 v85, v85, v111, 0xc0135761
    v_mfma_f32_16x16x32_bf16 v[12:15], v[60:63], v[160:163], v[12:15]
    ds_read_b128 v[52:55], v99 offset:25600
    v_fmaak_f32 v86, v86, v111, 0xc0135761
    v_fmaak_f32 v87, v87, v111, 0xc0135761
    v_mfma_f32_16x16x32_bf16 v[20:23], v[60:63], v[164:167], v[20:23]
    v_mul_f32 v84, v84, v32
    v_mul_f32 v85, v85, v33
    v_mfma_f32_16x16x32_bf16 v[16:19], v[64:67], v[160:163], v[16:19]
    ds_read_b128 v[56:59], v100 offset:25600
    v_mul_f32 v86, v86, v34
    v_mul_f32 v87, v87, v35
    v_mfma_f32_16x16x32_bf16 v[24:27], v[64:67], v[164:167], v[24:27]
    s_waitcnt lgkmcnt(3)
    v_exp_f32 v84, v84
    v_exp_f32 v85, v85
    v_mfma_f32_16x16x32_bf16 v[12:15], v[68:71], v[168:171], v[12:15]
    ds_read_b128 v[60:63], v101 offset:25600
    v_exp_f32 v86, v86
    v_mfma_f32_16x16x32_bf16 v[20:23], v[68:71], v[172:175], v[20:23]
    v_exp_f32 v87, v87
    v_mfma_f32_16x16x32_bf16 v[16:19], v[44:47], v[168:171], v[16:19]
    ds_read_b128 v[64:67], v98 offset:26624
    v_add_f32 v84, 1.0, v84
    v_add_f32 v85, 1.0, v85
    v_mfma_f32_16x16x32_bf16 v[24:27], v[44:47], v[172:175], v[24:27]
    s_waitcnt lgkmcnt(3)
    v_add_f32 v86, 1.0, v86
    v_add_f32 v87, 1.0, v87
    v_mfma_f32_16x16x32_bf16 v[12:15], v[48:51], v[176:179], v[12:15]
    ds_read_b128 v[68:71], v99 offset:26624
    v_rcp_f32 v84, v84
    v_mfma_f32_16x16x32_bf16 v[20:23], v[48:51], v[180:183], v[20:23]
    v_rcp_f32 v85, v85
    v_mfma_f32_16x16x32_bf16 v[16:19], v[52:55], v[176:179], v[16:19]
    ds_read_b128 v[44:47], v100 offset:26624
    v_rcp_f32 v86, v86
    v_rcp_f32 v87, v87
    v_mfma_f32_16x16x32_bf16 v[24:27], v[52:55], v[180:183], v[24:27]
    s_waitcnt lgkmcnt(3)
    v_mul_f32 v84, v84, v32
    v_mfma_f32_16x16x32_bf16 v[12:15], v[56:59], v[184:187], v[12:15]
    ds_read_b128 v[48:51], v101 offset:26624
    v_mul_f32 v85, v85, v33
    v_mul_f32 v86, v86, v34
    v_mul_f32 v87, v87, v35
    v_mfma_f32_16x16x32_bf16 v[20:23], v[56:59], v[188:191], v[20:23]
    v_cvt_pk_bf16_f32 v90, v84, v85
    v_cvt_pk_bf16_f32 v91, v86, v87
    v_mfma_f32_16x16x32_bf16 v[16:19], v[60:63], v[184:187], v[16:19]
    ds_read_b128 v[52:55], v102 offset:0
    buffer_store_dwordx4 v[88:91], v110, s[20:23], s45 offen sc1
    v_mul_f32 v80, v36, v36
    v_mfma_f32_16x16x32_bf16 v[24:27], v[60:63], v[188:191], v[24:27]
    s_waitcnt lgkmcnt(3)
    v_mul_f32 v81, v37, v37
    v_mul_f32 v82, v38, v38
    v_mul_f32 v83, v39, v39
    v_mfma_f32_16x16x32_bf16 v[12:15], v[64:67], v[192:195], v[12:15]
    ds_read_b128 v[56:59], v103 offset:0
    v_fmaak_f32 v80, v80, v111, 0xc0135761
    v_fmaak_f32 v81, v81, v111, 0xc0135761
    v_mfma_f32_16x16x32_bf16 v[20:23], v[64:67], v[196:199], v[20:23]
    v_fmaak_f32 v82, v82, v111, 0xc0135761
    v_fmaak_f32 v83, v83, v111, 0xc0135761
    v_mfma_f32_16x16x32_bf16 v[16:19], v[68:71], v[192:195], v[16:19]
    ds_read_b128 v[60:63], v104 offset:0
    v_mul_f32 v80, v80, v36
    v_mul_f32 v81, v81, v37
    v_mfma_f32_16x16x32_bf16 v[24:27], v[68:71], v[196:199], v[24:27]
    s_waitcnt lgkmcnt(3)
    v_mul_f32 v82, v82, v38
    v_mul_f32 v83, v83, v39
    v_mfma_f32_16x16x32_bf16 v[12:15], v[44:47], v[200:203], v[12:15]
    ds_read_b128 v[64:67], v105 offset:0
    v_exp_f32 v80, v80
    v_exp_f32 v81, v81
    v_mfma_f32_16x16x32_bf16 v[20:23], v[44:47], v[204:207], v[20:23]
    v_exp_f32 v82, v82
    v_mfma_f32_16x16x32_bf16 v[16:19], v[48:51], v[200:203], v[16:19]
    ds_read_b128 v[68:71], v102 offset:1024
    v_exp_f32 v83, v83
    v_mfma_f32_16x16x32_bf16 v[24:27], v[48:51], v[204:207], v[24:27]
    s_waitcnt lgkmcnt(3)
    v_add_f32 v80, 1.0, v80
    v_add_f32 v81, 1.0, v81
    v_mfma_f32_16x16x32_bf16 v[12:15], v[52:55], v[208:211], v[12:15]
    ds_read_b128 v[44:47], v103 offset:1024
    v_add_f32 v82, 1.0, v82
    v_add_f32 v83, 1.0, v83
    v_mfma_f32_16x16x32_bf16 v[20:23], v[52:55], v[212:215], v[20:23]
    v_rcp_f32 v80, v80
    v_mfma_f32_16x16x32_bf16 v[16:19], v[56:59], v[208:211], v[16:19]
    ds_read_b128 v[48:51], v104 offset:1024
    v_rcp_f32 v81, v81
    v_mfma_f32_16x16x32_bf16 v[24:27], v[56:59], v[212:215], v[24:27]
    s_waitcnt lgkmcnt(3)
    v_rcp_f32 v82, v82
    v_rcp_f32 v83, v83
    v_mfma_f32_16x16x32_bf16 v[12:15], v[60:63], v[216:219], v[12:15]
    ds_read_b128 v[52:55], v105 offset:1024
    v_mul_f32 v80, v80, v36
    v_mfma_f32_16x16x32_bf16 v[20:23], v[60:63], v[220:223], v[20:23]
    v_mul_f32 v81, v81, v37
    v_mul_f32 v82, v82, v38
    v_mul_f32 v83, v83, v39
    v_mfma_f32_16x16x32_bf16 v[16:19], v[64:67], v[216:219], v[16:19]
    ds_read_b128 v[56:59], v102 offset:2048
    v_cvt_pk_bf16_f32 v92, v80, v81
    v_cvt_pk_bf16_f32 v93, v82, v83
    v_mfma_f32_16x16x32_bf16 v[24:27], v[64:67], v[220:223], v[24:27]
    s_waitcnt lgkmcnt(3)
    v_mul_f32 v84, v40, v40
    v_mul_f32 v85, v41, v41
    v_mfma_f32_16x16x32_bf16 v[12:15], v[68:71], v[224:227], v[12:15]
    ds_read_b128 v[60:63], v103 offset:2048
    v_mul_f32 v86, v42, v42
    v_mul_f32 v87, v43, v43
    v_fmaak_f32 v84, v84, v111, 0xc0135761
    v_mfma_f32_16x16x32_bf16 v[20:23], v[68:71], v[228:231], v[20:23]
    v_fmaak_f32 v85, v85, v111, 0xc0135761
    v_fmaak_f32 v86, v86, v111, 0xc0135761
    v_mfma_f32_16x16x32_bf16 v[16:19], v[44:47], v[224:227], v[16:19]
    ds_read_b128 v[64:67], v104 offset:2048
    v_fmaak_f32 v87, v87, v111, 0xc0135761
    v_mul_f32 v84, v84, v40
    v_mfma_f32_16x16x32_bf16 v[24:27], v[44:47], v[228:231], v[24:27]
    s_waitcnt lgkmcnt(3)
    v_mul_f32 v85, v85, v41
    v_mul_f32 v86, v86, v42
    v_mfma_f32_16x16x32_bf16 v[12:15], v[48:51], v[232:235], v[12:15]
    ds_read_b128 v[68:71], v105 offset:2048
    v_mul_f32 v87, v87, v43
    v_exp_f32 v84, v84
    v_mfma_f32_16x16x32_bf16 v[20:23], v[48:51], v[236:239], v[20:23]
    v_exp_f32 v85, v85
    v_mfma_f32_16x16x32_bf16 v[16:19], v[52:55], v[232:235], v[16:19]
    v_exp_f32 v86, v86
    v_mfma_f32_16x16x32_bf16 v[24:27], v[52:55], v[236:239], v[24:27]
    s_waitcnt lgkmcnt(2)
    v_exp_f32 v87, v87
    v_add_f32 v84, 1.0, v84
    v_mfma_f32_16x16x32_bf16 v[12:15], v[56:59], v[240:243], v[12:15]
    v_add_f32 v85, 1.0, v85
    v_add_f32 v86, 1.0, v86
    v_mfma_f32_16x16x32_bf16 v[20:23], v[56:59], v[244:247], v[20:23]
    v_add_f32 v87, 1.0, v87
    v_rcp_f32 v84, v84
    v_mfma_f32_16x16x32_bf16 v[16:19], v[60:63], v[240:243], v[16:19]
    v_rcp_f32 v85, v85
    v_mfma_f32_16x16x32_bf16 v[24:27], v[60:63], v[244:247], v[24:27]
    s_waitcnt lgkmcnt(0)
    v_rcp_f32 v86, v86
    v_mfma_f32_16x16x32_bf16 v[12:15], v[64:67], v[248:251], v[12:15]
    v_rcp_f32 v87, v87
    v_mfma_f32_16x16x32_bf16 v[20:23], v[64:67], v[252:255], v[20:23]
    v_mul_f32 v84, v84, v40
    v_mul_f32 v85, v85, v41
    v_mfma_f32_16x16x32_bf16 v[16:19], v[68:71], v[248:251], v[16:19]
    v_mul_f32 v86, v86, v42
    v_mul_f32 v87, v87, v43
    v_cvt_pk_bf16_f32 v94, v84, v85
    v_mfma_f32_16x16x32_bf16 v[24:27], v[68:71], v[252:255], v[24:27]
    v_cvt_pk_bf16_f32 v95, v86, v87
    buffer_store_dwordx4 v[92:95], v10, s[20:23], s45 offen sc1
    s_mul_i32 s45, s44, 147456
    v_mul_f32 v80, v12, v12
    v_mul_f32 v81, v13, v13
    v_mul_f32 v82, v14, v14
    v_mul_f32 v83, v15, v15
    v_fmaak_f32 v80, v80, v111, 0xc0135761
    v_fmaak_f32 v81, v81, v111, 0xc0135761
    v_fmaak_f32 v82, v82, v111, 0xc0135761
    v_fmaak_f32 v83, v83, v111, 0xc0135761
    v_mul_f32 v80, v80, v12
    v_mul_f32 v81, v81, v13
    v_mul_f32 v82, v82, v14
    v_mul_f32 v83, v83, v15
    v_exp_f32 v80, v80
    v_exp_f32 v81, v81
    v_exp_f32 v82, v82
    v_exp_f32 v83, v83
    v_add_f32 v80, 1.0, v80
    v_add_f32 v81, 1.0, v81
    v_add_f32 v82, 1.0, v82
    v_add_f32 v83, 1.0, v83
    v_rcp_f32 v80, v80
    v_rcp_f32 v81, v81
    v_rcp_f32 v82, v82
    v_rcp_f32 v83, v83
    v_mul_f32 v80, v80, v12
    v_mul_f32 v81, v81, v13
    v_mul_f32 v82, v82, v14
    v_mul_f32 v83, v83, v15
    v_cvt_pk_bf16_f32 v88, v80, v81
    v_cvt_pk_bf16_f32 v89, v82, v83
    v_mul_f32 v84, v16, v16
    v_mul_f32 v85, v17, v17
    v_mul_f32 v86, v18, v18
    v_mul_f32 v87, v19, v19
    v_fmaak_f32 v84, v84, v111, 0xc0135761
    v_fmaak_f32 v85, v85, v111, 0xc0135761
    v_fmaak_f32 v86, v86, v111, 0xc0135761
    v_fmaak_f32 v87, v87, v111, 0xc0135761
    v_mul_f32 v84, v84, v16
    v_mul_f32 v85, v85, v17
    v_mul_f32 v86, v86, v18
    v_mul_f32 v87, v87, v19
    v_exp_f32 v84, v84
    v_exp_f32 v85, v85
    v_exp_f32 v86, v86
    v_exp_f32 v87, v87
    v_add_f32 v84, 1.0, v84
    v_add_f32 v85, 1.0, v85
    v_add_f32 v86, 1.0, v86
    v_add_f32 v87, 1.0, v87
    v_rcp_f32 v84, v84
    v_rcp_f32 v85, v85
    v_rcp_f32 v86, v86
    v_rcp_f32 v87, v87
    v_mul_f32 v84, v84, v16
    v_mul_f32 v85, v85, v17
    v_mul_f32 v86, v86, v18
    v_mul_f32 v87, v87, v19
    v_cvt_pk_bf16_f32 v90, v84, v85
    v_cvt_pk_bf16_f32 v91, v86, v87
    buffer_store_dwordx4 v[88:91], v110, s[20:23], s45 offen sc1
    v_mul_f32 v80, v20, v20
    v_mul_f32 v81, v21, v21
    v_mul_f32 v82, v22, v22
    v_mul_f32 v83, v23, v23
    v_fmaak_f32 v80, v80, v111, 0xc0135761
    v_fmaak_f32 v81, v81, v111, 0xc0135761
    v_fmaak_f32 v82, v82, v111, 0xc0135761
    v_fmaak_f32 v83, v83, v111, 0xc0135761
    v_mul_f32 v80, v80, v20
    v_mul_f32 v81, v81, v21
    v_mul_f32 v82, v82, v22
    v_mul_f32 v83, v83, v23
    v_exp_f32 v80, v80
    v_exp_f32 v81, v81
    v_exp_f32 v82, v82
    v_exp_f32 v83, v83
    v_add_f32 v80, 1.0, v80
    v_add_f32 v81, 1.0, v81
    v_add_f32 v82, 1.0, v82
    v_add_f32 v83, 1.0, v83
    v_rcp_f32 v80, v80
    v_rcp_f32 v81, v81
    v_rcp_f32 v82, v82
    v_rcp_f32 v83, v83
    v_mul_f32 v80, v80, v20
    v_mul_f32 v81, v81, v21
    v_mul_f32 v82, v82, v22
    v_mul_f32 v83, v83, v23
    v_cvt_pk_bf16_f32 v92, v80, v81
    v_cvt_pk_bf16_f32 v93, v82, v83
    v_mul_f32 v84, v24, v24
    v_mul_f32 v85, v25, v25
    v_mul_f32 v86, v26, v26
    v_mul_f32 v87, v27, v27
    v_fmaak_f32 v84, v84, v111, 0xc0135761
    v_fmaak_f32 v85, v85, v111, 0xc0135761
    v_fmaak_f32 v86, v86, v111, 0xc0135761
    v_fmaak_f32 v87, v87, v111, 0xc0135761
    v_mul_f32 v84, v84, v24
    v_mul_f32 v85, v85, v25
    v_mul_f32 v86, v86, v26
    v_mul_f32 v87, v87, v27
    v_exp_f32 v84, v84
    v_exp_f32 v85, v85
    v_exp_f32 v86, v86
    v_exp_f32 v87, v87
    v_add_f32 v84, 1.0, v84
    v_add_f32 v85, 1.0, v85
    v_add_f32 v86, 1.0, v86
    v_add_f32 v87, 1.0, v87
    v_rcp_f32 v84, v84
    v_rcp_f32 v85, v85
    v_rcp_f32 v86, v86
    v_rcp_f32 v87, v87
    v_mul_f32 v84, v84, v24
    v_mul_f32 v85, v85, v25
    v_mul_f32 v86, v86, v26
    v_mul_f32 v87, v87, v27
    v_cvt_pk_bf16_f32 v94, v84, v85
    v_cvt_pk_bf16_f32 v95, v86, v87
    buffer_store_dwordx4 v[92:95], v10, s[20:23], s45 offen sc1
    s_endpgm
K1_G_fin:
    s_lshl_b32 s48, s2, 2
    s_and_b32 s47, s32, 3
    s_add_u32 s48, s48, s47
    s_cmp_eq_u32 s34, 1
    s_cselect_b32 s48, s48, 1000
    s_mul_i32 s49, s48, 4608
    s_lshl_b32 s50, s48, 4
    s_add_u32 s50, s50, 58720256
    s_cmp_lt_u32 s48, 512
    s_cselect_b32 s49, s49, 0x7f000000
    s_cselect_b32 s50, s50, 0x7f000000
    s_mov_b32 s24, s26
    s_mov_b32 s25, s27
    s_cselect_b32 s26, 1152, 0
    s_mov_b32 s27, 0x00020000
    v_and_b32 v4, 31, v1
    v_lshlrev_b32 v4, 4, v4
    v_mul_u32_u24 v5, 1152, v6
    v_add_u32 v5, v5, v4
    v_mov_b32 v7, 0x7f000000
    v_cmp_gt_u32 vcc, 128, v4
    s_nop 1
    v_cndmask_b32 v7, v7, v5, vcc
    buffer_load_dwordx4 v[136:139], v4, s[24:27], 0 offen offset:0
    buffer_load_dwordx4 v[140:143], v4, s[24:27], 0 offen offset:512
    buffer_load_dwordx4 v[144:147], v4, s[24:27], 0 offen offset:1024
    buffer_load_dwordx4 v[112:115], v5, s[8:11], s49 offen offset:0
    buffer_load_dwordx4 v[116:119], v5, s[8:11], s49 offen offset:512
    buffer_load_dwordx4 v[120:123], v7, s[8:11], s49 offen offset:1024
    buffer_load_dwordx4 v[124:127], v5, s[8:11], s49 offen offset:2304
    buffer_load_dwordx4 v[128:131], v5, s[8:11], s49 offen offset:2816
    buffer_load_dwordx4 v[132:135], v7, s[8:11], s49 offen offset:3328
    s_add_u32 s45, s42, 10
    s_mul_i32 s45, s45, 147456
    v_mul_f32 v80, v28, v28
    v_mul_f32 v81, v29, v29
    v_mul_f32 v82, v30, v30
    v_mul_f32 v83, v31, v31
    v_fmaak_f32 v80, v80, v111, 0xc0135761
    v_fmaak_f32 v81, v81, v111, 0xc0135761
    v_fmaak_f32 v82, v82, v111, 0xc0135761
    v_fmaak_f32 v83, v83, v111, 0xc0135761
    v_mul_f32 v80, v80, v28
    v_mul_f32 v81, v81, v29
    v_mul_f32 v82, v82, v30
    v_mul_f32 v83, v83, v31
    v_exp_f32 v80, v80
    v_exp_f32 v81, v81
    v_exp_f32 v82, v82
    v_exp_f32 v83, v83
    v_add_f32 v80, 1.0, v80
    v_add_f32 v81, 1.0, v81
    v_add_f32 v82, 1.0, v82
    v_add_f32 v83, 1.0, v83
    v_rcp_f32 v80, v80
    v_rcp_f32 v81, v81
    v_rcp_f32 v82, v82
    v_rcp_f32 v83, v83
    v_mul_f32 v80, v80, v28
    v_mul_f32 v81, v81, v29
    v_mul_f32 v82, v82, v30
    v_mul_f32 v83, v83, v31
    v_cvt_pk_bf16_f32 v88, v80, v81
    v_cvt_pk_bf16_f32 v89, v82, v83
    v_mul_f32 v84, v32, v32
    v_mul_f32 v85, v33, v33
    v_mul_f32 v86, v34, v34
    v_mul_f32 v87, v35, v35
    v_fmaak_f32 v84, v84, v111, 0xc0135761
    v_fmaak_f32 v85, v85, v111, 0xc0135761
    v_fmaak_f32 v86, v86, v111, 0xc0135761
    v_fmaak_f32 v87, v87, v111, 0xc0135761
    v_mul_f32 v84, v84, v32
    v_mul_f32 v85, v85, v33
    v_mul_f32 v86, v86, v34
    v_mul_f32 v87, v87, v35
    v_exp_f32 v84, v84
    v_exp_f32 v85, v85
    v_exp_f32 v86, v86
    v_exp_f32 v87, v87
    v_add_f32 v84, 1.0, v84
    v_add_f32 v85, 1.0, v85
    v_add_f32 v86, 1.0, v86
    v_add_f32 v87, 1.0, v87
    v_rcp_f32 v84, v84
    v_rcp_f32 v85, v85
    v_rcp_f32 v86, v86
    v_rcp_f32 v87, v87
    v_mul_f32 v84, v84, v32
    v_mul_f32 v85, v85, v33
    v_mul_f32 v86, v86, v34
    v_mul_f32 v87, v87, v35
    v_cvt_pk_bf16_f32 v90, v84, v85
    v_cvt_pk_bf16_f32 v91, v86, v87
    buffer_store_dwordx4 v[88:91], v110, s[20:23], s45 offen sc1
    v_mul_f32 v80, v36, v36
    v_mul_f32 v81, v37, v37
    v_mul_f32 v82, v38, v38
    v_mul_f32 v83, v39, v39
    v_fmaak_f32 v80, v80, v111, 0xc0135761
    v_fmaak_f32 v81, v81, v111, 0xc0135761
    v_fmaak_f32 v82, v82, v111, 0xc0135761
    v_fmaak_f32 v83, v83, v111, 0xc0135761
    v_mul_f32 v80, v80, v36
    v_mul_f32 v81, v81, v37
    v_mul_f32 v82, v82, v38
    v_mul_f32 v83, v83, v39
    v_exp_f32 v80, v80
    v_exp_f32 v81, v81
    v_exp_f32 v82, v82
    v_exp_f32 v83, v83
    v_add_f32 v80, 1.0, v80
    v_add_f32 v81, 1.0, v81
    v_add_f32 v82, 1.0, v82
    v_add_f32 v83, 1.0, v83
    v_rcp_f32 v80, v80
    v_rcp_f32 v81, v81
    v_rcp_f32 v82, v82
    v_rcp_f32 v83, v83
    v_mul_f32 v80, v80, v36
    v_mul_f32 v81, v81, v37
    v_mul_f32 v82, v82, v38
    v_mul_f32 v83, v83, v39
    v_cvt_pk_bf16_f32 v92, v80, v81
    v_cvt_pk_bf16_f32 v93, v82, v83
    v_mul_f32 v84, v40, v40
    v_mul_f32 v85, v41, v41
    v_mul_f32 v86, v42, v42
    v_mul_f32 v87, v43, v43
    v_fmaak_f32 v84, v84, v111, 0xc0135761
    v_fmaak_f32 v85, v85, v111, 0xc0135761
    v_fmaak_f32 v86, v86, v111, 0xc0135761
    v_fmaak_f32 v87, v87, v111, 0xc0135761
    v_mul_f32 v84, v84, v40
    v_mul_f32 v85, v85, v41
    v_mul_f32 v86, v86, v42
    v_mul_f32 v87, v87, v43
    v_exp_f32 v84, v84
    v_exp_f32 v85, v85
    v_exp_f32 v86, v86
    v_exp_f32 v87, v87
    v_add_f32 v84, 1.0, v84
    v_add_f32 v85, 1.0, v85
    v_add_f32 v86, 1.0, v86
    v_add_f32 v87, 1.0, v87
    v_rcp_f32 v84, v84
    v_rcp_f32 v85, v85
    v_rcp_f32 v86, v86
    v_rcp_f32 v87, v87
    v_mul_f32 v84, v84, v40
    v_mul_f32 v85, v85, v41
    v_mul_f32 v86, v86, v42
    v_mul_f32 v87, v87, v43
    v_cvt_pk_bf16_f32 v94, v84, v85
    v_cvt_pk_bf16_f32 v95, v86, v87
    buffer_store_dwordx4 v[92:95], v10, s[20:23], s45 offen sc1
    v_mov_b32 v152, 0
    v_mov_b32 v153, 0
    v_mov_b32 v154, 0
    v_mov_b32 v155, 0
    s_waitcnt vmcnt(10)
    v_lshlrev_b32 v156, 16, v136
    v_and_b32 v157, 0xffff0000, v136
    s_waitcnt vmcnt(7)
    v_lshlrev_b32 v158, 16, v112
    v_and_b32 v159, 0xffff0000, v112
    v_fmac_f32 v152, v156, v158
    v_fmac_f32 v153, v157, v159
    s_waitcnt vmcnt(4)
    v_lshlrev_b32 v158, 16, v124
    v_and_b32 v159, 0xffff0000, v124
    v_fmac_f32 v154, v156, v158
    v_fmac_f32 v155, v157, v159
    v_lshlrev_b32 v156, 16, v137
    v_and_b32 v157, 0xffff0000, v137
    v_lshlrev_b32 v158, 16, v113
    v_and_b32 v159, 0xffff0000, v113
    v_fmac_f32 v152, v156, v158
    v_fmac_f32 v153, v157, v159
    v_lshlrev_b32 v158, 16, v125
    v_and_b32 v159, 0xffff0000, v125
    v_fmac_f32 v154, v156, v158
    v_fmac_f32 v155, v157, v159
    v_lshlrev_b32 v156, 16, v138
    v_and_b32 v157, 0xffff0000, v138
    v_lshlrev_b32 v158, 16, v114
    v_and_b32 v159, 0xffff0000, v114
    v_fmac_f32 v152, v156, v158
    v_fmac_f32 v153, v157, v159
    v_lshlrev_b32 v158, 16, v126
    v_and_b32 v159, 0xffff0000, v126
    v_fmac_f32 v154, v156, v158
    v_fmac_f32 v155, v157, v159
    v_lshlrev_b32 v156, 16, v139
    v_and_b32 v157, 0xffff0000, v139
    v_lshlrev_b32 v158, 16, v115
    v_and_b32 v159, 0xffff0000, v115
    v_fmac_f32 v152, v156, v158
    v_fmac_f32 v153, v157, v159
    v_lshlrev_b32 v158, 16, v127
    v_and_b32 v159, 0xffff0000, v127
    v_fmac_f32 v154, v156, v158
    v_fmac_f32 v155, v157, v159
    v_lshlrev_b32 v156, 16, v140
    v_and_b32 v157, 0xffff0000, v140
    v_lshlrev_b32 v158, 16, v116
    v_and_b32 v159, 0xffff0000, v116
    v_fmac_f32 v152, v156, v158
    v_fmac_f32 v153, v157, v159
    s_waitcnt vmcnt(3)
    v_lshlrev_b32 v158, 16, v128
    v_and_b32 v159, 0xffff0000, v128
    v_fmac_f32 v154, v156, v158
    v_fmac_f32 v155, v157, v159
    v_lshlrev_b32 v156, 16, v141
    v_and_b32 v157, 0xffff0000, v141
    v_lshlrev_b32 v158, 16, v117
    v_and_b32 v159, 0xffff0000, v117
    v_fmac_f32 v152, v156, v158
    v_fmac_f32 v153, v157, v159
    v_lshlrev_b32 v158, 16, v129
    v_and_b32 v159, 0xffff0000, v129
    v_fmac_f32 v154, v156, v158
    v_fmac_f32 v155, v157, v159
    v_lshlrev_b32 v156, 16, v142
    v_and_b32 v157, 0xffff0000, v142
    v_lshlrev_b32 v158, 16, v118
    v_and_b32 v159, 0xffff0000, v118
    v_fmac_f32 v152, v156, v158
    v_fmac_f32 v153, v157, v159
    v_lshlrev_b32 v158, 16, v130
    v_and_b32 v159, 0xffff0000, v130
    v_fmac_f32 v154, v156, v158
    v_fmac_f32 v155, v157, v159
    v_lshlrev_b32 v156, 16, v143
    v_and_b32 v157, 0xffff0000, v143
    v_lshlrev_b32 v158, 16, v119
    v_and_b32 v159, 0xffff0000, v119
    v_fmac_f32 v152, v156, v158
    v_fmac_f32 v153, v157, v159
    v_lshlrev_b32 v158, 16, v131
    v_and_b32 v159, 0xffff0000, v131
    v_fmac_f32 v154, v156, v158
    v_fmac_f32 v155, v157, v159
    v_lshlrev_b32 v156, 16, v144
    v_and_b32 v157, 0xffff0000, v144
    v_lshlrev_b32 v158, 16, v120
    v_and_b32 v159, 0xffff0000, v120
    v_fmac_f32 v152, v156, v158
    v_fmac_f32 v153, v157, v159
    s_waitcnt vmcnt(2)
    v_lshlrev_b32 v158, 16, v132
    v_and_b32 v159, 0xffff0000, v132
    v_fmac_f32 v154, v156, v158
    v_fmac_f32 v155, v157, v159
    v_lshlrev_b32 v156, 16, v145
    v_and_b32 v157, 0xffff0000, v145
    v_lshlrev_b32 v158, 16, v121
    v_and_b32 v159, 0xffff0000, v121
    v_fmac_f32 v152, v156, v158
    v_fmac_f32 v153, v157, v159
    v_lshlrev_b32 v158, 16, v133
    v_and_b32 v159, 0xffff0000, v133
    v_fmac_f32 v154, v156, v158
    v_fmac_f32 v155, v157, v159
    v_lshlrev_b32 v156, 16, v146
    v_and_b32 v157, 0xffff0000, v146
    v_lshlrev_b32 v158, 16, v122
    v_and_b32 v159, 0xffff0000, v122
    v_fmac_f32 v152, v156, v158
    v_fmac_f32 v153, v157, v159
    v_lshlrev_b32 v158, 16, v134
    v_and_b32 v159, 0xffff0000, v134
    v_fmac_f32 v154, v156, v158
    v_fmac_f32 v155, v157, v159
    v_lshlrev_b32 v156, 16, v147
    v_and_b32 v157, 0xffff0000, v147
    v_lshlrev_b32 v158, 16, v123
    v_and_b32 v159, 0xffff0000, v123
    v_fmac_f32 v152, v156, v158
    v_fmac_f32 v153, v157, v159
    v_lshlrev_b32 v158, 16, v135
    v_and_b32 v159, 0xffff0000, v135
    v_fmac_f32 v154, v156, v158
    v_fmac_f32 v155, v157, v159
    v_add_f32 v152, v152, v153
    v_add_f32 v154, v154, v155
    s_nop 0
    v_add_f32_dpp v152, v152, v152 row_shr:1 bound_ctrl:0
    v_add_f32_dpp v154, v154, v154 row_shr:1 bound_ctrl:0
    s_nop 0
    v_add_f32_dpp v152, v152, v152 row_shr:2 bound_ctrl:0
    v_add_f32_dpp v154, v154, v154 row_shr:2 bound_ctrl:0
    s_nop 0
    v_add_f32_dpp v152, v152, v152 row_shr:4 bound_ctrl:0
    v_add_f32_dpp v154, v154, v154 row_shr:4 bound_ctrl:0
    s_nop 0
    v_add_f32_dpp v152, v152, v152 row_shr:8 bound_ctrl:0
    v_add_f32_dpp v154, v154, v154 row_shr:8 bound_ctrl:0
    s_nop 0
    v_add_f32_dpp v152, v152, v152 row_bcast:15 row_mask:0xa
    v_add_f32_dpp v154, v154, v154 row_bcast:15 row_mask:0xa
    v_mul_f32 v152, 0xbfb8aa3b, v152
    v_exp_f32 v152, v152
    s_nop 0
    v_add_f32 v152, 1.0, v152
    v_rcp_f32 v152, v152
    v_mul_f32 v154, 0xbfb8aa3b, v154
    v_exp_f32 v154, v154
    s_nop 0
    v_add_f32 v154, 1.0, v154
    v_rcp_f32 v154, v154
    v_lshlrev_b32 v4, 2, v6
    s_mov_b32 exec_lo, 0x80000000
    s_mov_b32 exec_hi, 0x80000000
    buffer_store_dword v152, v4, s[20:23], s50 offen
    buffer_store_dword v154, v4, s[20:23], s50 offen offset:8
    s_mov_b64 exec, -1
    s_and_b32 s47, s32, 3
    s_getpc_b64 s[16:17]
    s_add_u32 s16, s16, k23_fused_kernel-.
    s_addc_u32 s17, s17, 0
    s_mul_i32 s18, s47, 6144
    v_lshlrev_b32 v2, 7, v1
    v_add_u32 v2, s18, v2
    s_mov_b32 exec_lo, 0xffffffff
    s_mov_b32 exec_hi, 0xffff
    global_load_dword v3, v2, s[16:17]
    s_mov_b64 exec, -1
    s_endpgm
K1_N:
K1_N_body:
    v_and_b32 v2, 15, v1
    v_lshrrev_b32 v3, 4, v1
    v_add_u32 v4, 0, v2
    v_bfe_u32 v5, v4, 1, 3
    v_lshrrev_b32 v7, 3, v4
    v_and_b32 v11, 2, v7
    v_xor_b32 v5, v5, v11
    v_xor_b32 v5, v5, v3
    v_lshlrev_b32 v5, 4, v5
    v_and_b32 v11, 7, v4
    v_lshl_add_u32 v5, v11, 7, v5
    v_mul_u32_u24 v7, 3072, v7
    v_add3_u32 v98, s59, v5, v7
    v_xor_b32 v100, 64, v98
    v_add_u32 v4, 16, v2
    v_bfe_u32 v5, v4, 1, 3
    v_lshrrev_b32 v7, 3, v4
    v_and_b32 v11, 2, v7
    v_xor_b32 v5, v5, v11
    v_xor_b32 v5, v5, v3
    v_lshlrev_b32 v5, 4, v5
    v_and_b32 v11, 7, v4
    v_lshl_add_u32 v5, v11, 7, v5
    v_mul_u32_u24 v7, 3072, v7
    v_add3_u32 v99, s59, v5, v7
    v_xor_b32 v101, 64, v99
    v_add_u32 v102, 49152, v98
    v_add_u32 v106, 98304, v98
    v_add_u32 v103, 49152, v99
    v_add_u32 v107, 98304, v99
    v_add_u32 v104, 49152, v100
    v_add_u32 v108, 98304, v100
    v_add_u32 v105, 49152, v101
    v_add_u32 v109, 98304, v101
    v_bfe_u32 v4, v1, 2, 2
    v_lshl_add_u32 v5, v3, 3, v4
    v_lshlrev_b32 v5, 8, v5
    s_and_b32 s47, s32, 3
    v_xor_b32 v4, s47, v4
    v_lshl_add_u32 v5, v4, 6, v5
    v_and_b32 v4, 3, v1
    v_lshl_add_u32 v5, v4, 3, v5
    v_and_b32 v4, 2, v1
    v_lshl_add_u32 v5, v4, 3, v5
    v_and_b32 v4, 1, v3
    v_lshl_add_u32 v5, v4, 4, v5
    v_xor_b32 v4, 16, v5
    v_add_u32 v72, 49152, v5
    v_add_u32 v73, 49152, v4
    v_add_u32 v74, 106496, v5
    v_add_u32 v75, 106496, v4
    v_add_u32 v76, 73728, v5
    v_add_u32 v77, 73728, v4
    v_lshlrev_b32 v4, 4, v1
    s_lshl_b32 s47, s46, 10
    s_add_u32 s47, s47, 41961472
    v_add_u32 v110, s47, v4
    v_add_u32 v10, 92160, v110
    v_mov_b32 v111, 0xbdd2d3e8
    s_cmp_eq_u32 s34, 1
    s_cselect_b64 vcc, -1, 0
    s_waitcnt vmcnt(5)
    s_barrier
    ds_read_b64_tr_b16 v[112:113], v72 offset:0
    ds_read_b64_tr_b16 v[114:115], v72 offset:1024
    ds_read_b64_tr_b16 v[116:117], v73 offset:0
    ds_read_b64_tr_b16 v[118:119], v73 offset:1024
    ds_read_b128 v[44:47], v98 offset:0
    ds_read_b128 v[48:51], v99 offset:0
    ds_read_b128 v[52:55], v100 offset:0
    ds_read_b128 v[56:59], v101 offset:0
    ds_read_b128 v[60:63], v98 offset:1024
    ds_read_b64_tr_b16 v[120:121], v72 offset:8192
    ds_read_b64_tr_b16 v[122:123], v72 offset:9216
    ds_read_b64_tr_b16 v[124:125], v73 offset:8192
    ds_read_b64_tr_b16 v[126:127], v73 offset:9216
    ds_read_b64_tr_b16 v[128:129], v72 offset:16384
    ds_read_b64_tr_b16 v[130:131], v72 offset:17408
    ds_read_b64_tr_b16 v[132:133], v73 offset:16384
    ds_read_b64_tr_b16 v[134:135], v73 offset:17408
    ds_read_b64_tr_b16 v[136:137], v72 offset:24576
    ds_read_b64_tr_b16 v[138:139], v72 offset:25600
    ds_read_b64_tr_b16 v[140:141], v73 offset:24576
    ds_read_b64_tr_b16 v[142:143], v73 offset:25600
    ds_read_b64_tr_b16 v[144:145], v72 offset:32768
    ds_read_b64_tr_b16 v[146:147], v72 offset:33792
    ds_read_b64_tr_b16 v[148:149], v73 offset:32768
    ds_read_b64_tr_b16 v[150:151], v73 offset:33792
    ds_read_b64_tr_b16 v[152:153], v72 offset:40960
    ds_read_b64_tr_b16 v[154:155], v72 offset:41984
    ds_read_b64_tr_b16 v[156:157], v73 offset:40960
    ds_read_b64_tr_b16 v[158:159], v73 offset:41984
    ds_read_b64_tr_b16 v[160:161], v72 offset:49152
    ds_read_b64_tr_b16 v[162:163], v72 offset:50176
    ds_read_b64_tr_b16 v[164:165], v73 offset:49152
    ds_read_b64_tr_b16 v[166:167], v73 offset:50176
    s_waitcnt lgkmcnt(0)
    s_barrier
    v_mfma_f32_16x16x32_bf16 v[12:15], v[112:115], v[44:47], 0
    ds_read_b128 v[64:67], v99 offset:1024
    v_mfma_f32_16x16x32_bf16 v[16:19], v[116:119], v[44:47], 0
    s_add_u32 m0, s40, 106496
    s_nop 0
    buffer_load_dwordx4 v96, s[12:15], s39 offen lds
    s_add_u32 s39, s39, s38
    v_mfma_f32_16x16x32_bf16 v[20:23], v[112:115], v[48:51], 0
    ds_read_b128 v[68:71], v100 offset:1024
    v_mfma_f32_16x16x32_bf16 v[24:27], v[116:119], v[48:51], 0
    s_add_u32 m0, s40, 114688
    s_nop 0
    buffer_load_dwordx4 v96, s[12:15], s39 offen lds
    s_add_u32 s39, s39, s38
    v_mfma_f32_16x16x32_bf16 v[12:15], v[120:123], v[52:55], v[12:15]
    ds_read_b128 v[44:47], v101 offset:1024
    v_mfma_f32_16x16x32_bf16 v[16:19], v[124:127], v[52:55], v[16:19]
    s_add_u32 m0, s40, 122880
    s_nop 0
    buffer_load_dwordx4 v96, s[12:15], s39 offen lds
    s_add_u32 s39, s39, s38
    v_mfma_f32_16x16x32_bf16 v[20:23], v[120:123], v[56:59], v[20:23]
    ds_read_b128 v[48:51], v98 offset:2048
    v_mfma_f32_16x16x32_bf16 v[24:27], v[124:127], v[56:59], v[24:27]
    s_add_u32 m0, s40, 131072
    s_nop 0
    buffer_load_dwordx4 v96, s[12:15], s39 offen lds
    s_add_u32 s39, s39, s38
    v_mfma_f32_16x16x32_bf16 v[12:15], v[128:131], v[60:63], v[12:15]
    ds_read_b128 v[52:55], v99 offset:2048
    v_mfma_f32_16x16x32_bf16 v[16:19], v[132:135], v[60:63], v[16:19]
    s_add_u32 m0, s40, 139264
    s_nop 0
    buffer_load_dwordx4 v96, s[12:15], s39 offen lds
    s_add_u32 s39, s39, s38
    s_waitcnt lgkmcnt(4)
    v_mfma_f32_16x16x32_bf16 v[20:23], v[128:131], v[64:67], v[20:23]
    ds_read_b128 v[56:59], v100 offset:2048
    v_mfma_f32_16x16x32_bf16 v[24:27], v[132:135], v[64:67], v[24:27]
    s_add_u32 m0, s40, 147456
    s_nop 0
    buffer_load_dwordx4 v96, s[12:15], s39 offen lds
    s_add_u32 s39, s39, s38
    s_waitcnt lgkmcnt(4)
    v_mfma_f32_16x16x32_bf16 v[12:15], v[136:139], v[68:71], v[12:15]
    ds_read_b128 v[60:63], v101 offset:2048
    v_mfma_f32_16x16x32_bf16 v[16:19], v[140:143], v[68:71], v[16:19]
    s_add_u32 m0, s40, 155648
    s_nop 0
    buffer_load_dwordx4 v96, s[12:15], s39 offen lds
    s_add_u32 s39, s39, s38
    s_waitcnt lgkmcnt(4)
    v_mfma_f32_16x16x32_bf16 v[20:23], v[136:139], v[44:47], v[20:23]
    s_add_u32 s37, s35, 768
    s_add_u32 m0, s36, 49152
    s_nop 0
    buffer_load_dwordx4 v97, s[8:11], s37 offen offset:0 lds
    s_add_u32 m0, s36, 50048
    s_nop 0
    buffer_load_dwordx4 v97, s[8:11], s37 offen offset:128 lds
    s_add_u32 m0, s36, 50944
    s_nop 0
    buffer_load_dwordx4 v97, s[8:11], s37 offen offset:256 lds
    s_add_u32 m0, s40, 73728
    s_nop 0
    buffer_load_dwordx4 v96, s[12:15], s39 offen lds
    s_add_u32 s39, s39, s38
    s_add_u32 m0, s40, 81920
    s_nop 0
    buffer_load_dwordx4 v96, s[12:15], s39 offen lds
    s_add_u32 s39, s39, s38
    s_add_u32 m0, s40, 90112
    s_nop 0
    buffer_load_dwordx4 v96, s[12:15], s39 offen lds
    s_add_u32 s39, s39, s38
    s_add_u32 m0, s40, 98304
    s_nop 0
    buffer_load_dwordx4 v96, s[12:15], s39 offen lds
    s_add_u32 s39, s39, s38
    s_waitcnt vmcnt(7)
    s_barrier
    ds_read_b64_tr_b16 v[168:169], v74 offset:0
    ds_read_b64_tr_b16 v[170:171], v74 offset:1024
    ds_read_b64_tr_b16 v[172:173], v75 offset:0
    ds_read_b64_tr_b16 v[174:175], v75 offset:1024
    ds_read_b64_tr_b16 v[176:177], v74 offset:8192
    ds_read_b64_tr_b16 v[178:179], v74 offset:9216
    ds_read_b64_tr_b16 v[180:181], v75 offset:8192
    ds_read_b64_tr_b16 v[182:183], v75 offset:9216
    ds_read_b64_tr_b16 v[184:185], v74 offset:16384
    ds_read_b64_tr_b16 v[186:187], v74 offset:17408
    ds_read_b64_tr_b16 v[188:189], v75 offset:16384
    ds_read_b64_tr_b16 v[190:191], v75 offset:17408
    ds_read_b64_tr_b16 v[192:193], v74 offset:24576
    ds_read_b64_tr_b16 v[194:195], v74 offset:25600
    ds_read_b64_tr_b16 v[196:197], v75 offset:24576
    ds_read_b64_tr_b16 v[198:199], v75 offset:25600
    ds_read_b64_tr_b16 v[200:201], v74 offset:32768
    ds_read_b64_tr_b16 v[202:203], v74 offset:33792
    ds_read_b64_tr_b16 v[204:205], v75 offset:32768
    ds_read_b64_tr_b16 v[206:207], v75 offset:33792
    ds_read_b64_tr_b16 v[208:209], v74 offset:40960
    ds_read_b64_tr_b16 v[210:211], v74 offset:41984
    ds_read_b64_tr_b16 v[212:213], v75 offset:40960
    ds_read_b64_tr_b16 v[214:215], v75 offset:41984
    ds_read_b64_tr_b16 v[216:217], v74 offset:49152
    ds_read_b64_tr_b16 v[218:219], v74 offset:50176
    ds_read_b64_tr_b16 v[220:221], v75 offset:49152
    ds_read_b64_tr_b16 v[222:223], v75 offset:50176
    s_waitcnt lgkmcnt(0)
    s_barrier
    ds_read_b128 v[64:67], v98 offset:24576
    v_mfma_f32_16x16x32_bf16 v[24:27], v[140:143], v[44:47], v[24:27]
    v_mfma_f32_16x16x32_bf16 v[12:15], v[144:147], v[48:51], v[12:15]
    ds_read_b128 v[68:71], v99 offset:24576
    v_mfma_f32_16x16x32_bf16 v[16:19], v[148:151], v[48:51], v[16:19]
    s_add_u32 s37, s35, 73728
    s_add_u32 m0, s36, 122880
    s_nop 0
    buffer_load_dwordx4 v97, s[8:11], s37 offen offset:0 lds
    v_mfma_f32_16x16x32_bf16 v[20:23], v[144:147], v[52:55], v[20:23]
    ds_read_b128 v[44:47], v100 offset:24576
    v_mfma_f32_16x16x32_bf16 v[24:27], v[148:151], v[52:55], v[24:27]
    s_add_u32 m0, s36, 123776
    s_nop 0
    buffer_load_dwordx4 v97, s[8:11], s37 offen offset:128 lds
    v_mfma_f32_16x16x32_bf16 v[12:15], v[152:155], v[56:59], v[12:15]
    ds_read_b128 v[48:51], v101 offset:24576
    v_mfma_f32_16x16x32_bf16 v[16:19], v[156:159], v[56:59], v[16:19]
    s_add_u32 m0, s36, 124672
    s_nop 0
    buffer_load_dwordx4 v97, s[8:11], s37 offen offset:256 lds
    v_mfma_f32_16x16x32_bf16 v[20:23], v[152:155], v[60:63], v[20:23]
    ds_read_b128 v[52:55], v98 offset:25600
    v_mfma_f32_16x16x32_bf16 v[24:27], v[156:159], v[60:63], v[24:27]
    s_waitcnt lgkmcnt(3)
    v_mfma_f32_16x16x32_bf16 v[12:15], v[160:163], v[64:67], v[12:15]
    ds_read_b128 v[56:59], v99 offset:25600
    v_mfma_f32_16x16x32_bf16 v[16:19], v[164:167], v[64:67], v[16:19]
    v_mfma_f32_16x16x32_bf16 v[20:23], v[160:163], v[68:71], v[20:23]
    ds_read_b128 v[60:63], v100 offset:25600
    v_mfma_f32_16x16x32_bf16 v[24:27], v[164:167], v[68:71], v[24:27]
    s_waitcnt lgkmcnt(3)
    v_mfma_f32_16x16x32_bf16 v[12:15], v[168:171], v[44:47], v[12:15]
    ds_read_b128 v[64:67], v101 offset:25600
    v_mfma_f32_16x16x32_bf16 v[16:19], v[172:175], v[44:47], v[16:19]
    v_mfma_f32_16x16x32_bf16 v[20:23], v[168:171], v[48:51], v[20:23]
    ds_read_b128 v[68:71], v98 offset:26624
    v_mfma_f32_16x16x32_bf16 v[24:27], v[172:175], v[48:51], v[24:27]
    s_waitcnt lgkmcnt(3)
    v_mfma_f32_16x16x32_bf16 v[12:15], v[176:179], v[52:55], v[12:15]
    ds_read_b128 v[44:47], v99 offset:26624
    v_mfma_f32_16x16x32_bf16 v[16:19], v[180:183], v[52:55], v[16:19]
    v_mfma_f32_16x16x32_bf16 v[20:23], v[176:179], v[56:59], v[20:23]
    ds_read_b128 v[48:51], v100 offset:26624
    v_mfma_f32_16x16x32_bf16 v[24:27], v[180:183], v[56:59], v[24:27]
    s_waitcnt lgkmcnt(3)
    v_mfma_f32_16x16x32_bf16 v[12:15], v[184:187], v[60:63], v[12:15]
    ds_read_b128 v[52:55], v101 offset:26624
    v_mfma_f32_16x16x32_bf16 v[16:19], v[188:191], v[60:63], v[16:19]
    v_mfma_f32_16x16x32_bf16 v[20:23], v[184:187], v[64:67], v[20:23]
    s_waitcnt vmcnt(3)
    s_barrier
    ds_read_b64_tr_b16 v[224:225], v76 offset:0
    ds_read_b64_tr_b16 v[226:227], v76 offset:1024
    ds_read_b64_tr_b16 v[228:229], v77 offset:0
    ds_read_b64_tr_b16 v[230:231], v77 offset:1024
    ds_read_b64_tr_b16 v[232:233], v76 offset:8192
    ds_read_b64_tr_b16 v[234:235], v76 offset:9216
    ds_read_b64_tr_b16 v[236:237], v77 offset:8192
    ds_read_b64_tr_b16 v[238:239], v77 offset:9216
    ds_read_b64_tr_b16 v[240:241], v76 offset:16384
    ds_read_b64_tr_b16 v[242:243], v76 offset:17408
    ds_read_b64_tr_b16 v[244:245], v77 offset:16384
    ds_read_b64_tr_b16 v[246:247], v77 offset:17408
    ds_read_b64_tr_b16 v[248:249], v76 offset:24576
    ds_read_b64_tr_b16 v[250:251], v76 offset:25600
    ds_read_b64_tr_b16 v[252:253], v77 offset:24576
    ds_read_b64_tr_b16 v[254:255], v77 offset:25600
    s_waitcnt lgkmcnt(0)
    s_barrier
    ds_read_b128 v[56:59], v102 offset:0
    v_mfma_f32_16x16x32_bf16 v[24:27], v[188:191], v[64:67], v[24:27]
    v_mfma_f32_16x16x32_bf16 v[12:15], v[192:195], v[68:71], v[12:15]
    ds_read_b128 v[60:63], v103 offset:0
    v_mfma_f32_16x16x32_bf16 v[16:19], v[196:199], v[68:71], v[16:19]
    s_add_u32 s37, s35, 74112
    s_add_u32 m0, s36, 73728
    s_nop 0
    buffer_load_dwordx4 v97, s[8:11], s37 offen offset:0 lds
    v_mfma_f32_16x16x32_bf16 v[20:23], v[192:195], v[44:47], v[20:23]
    ds_read_b128 v[64:67], v104 offset:0
    v_mfma_f32_16x16x32_bf16 v[24:27], v[196:199], v[44:47], v[24:27]
    s_add_u32 m0, s36, 74624
    s_nop 0
    buffer_load_dwordx4 v97, s[8:11], s37 offen offset:128 lds
    v_mfma_f32_16x16x32_bf16 v[12:15], v[200:203], v[48:51], v[12:15]
    ds_read_b128 v[68:71], v105 offset:0
    v_mfma_f32_16x16x32_bf16 v[16:19], v[204:207], v[48:51], v[16:19]
    s_add_u32 m0, s36, 75520
    s_nop 0
    buffer_load_dwordx4 v97, s[8:11], s37 offen offset:256 lds
    v_mfma_f32_16x16x32_bf16 v[20:23], v[200:203], v[52:55], v[20:23]
    ds_read_b128 v[44:47], v102 offset:1024
    v_mfma_f32_16x16x32_bf16 v[24:27], v[204:207], v[52:55], v[24:27]
    s_add_u32 s37, s35, 74496
    s_add_u32 m0, s36, 98304
    s_nop 0
    buffer_load_dwordx4 v97, s[8:11], s37 offen offset:0 lds
    s_waitcnt lgkmcnt(4)
    v_mfma_f32_16x16x32_bf16 v[12:15], v[208:211], v[56:59], v[12:15]
    ds_read_b128 v[48:51], v103 offset:1024
    v_mfma_f32_16x16x32_bf16 v[16:19], v[212:215], v[56:59], v[16:19]
    s_add_u32 m0, s36, 99200
    s_nop 0
    buffer_load_dwordx4 v97, s[8:11], s37 offen offset:128 lds
    s_waitcnt lgkmcnt(4)
    v_mfma_f32_16x16x32_bf16 v[20:23], v[208:211], v[60:63], v[20:23]
    ds_read_b128 v[52:55], v104 offset:1024
    v_mfma_f32_16x16x32_bf16 v[24:27], v[212:215], v[60:63], v[24:27]
    s_add_u32 m0, s36, 100096
    s_nop 0
    buffer_load_dwordx4 v97, s[8:11], s37 offen offset:256 lds
    s_waitcnt lgkmcnt(4)
    v_mfma_f32_16x16x32_bf16 v[12:15], v[216:219], v[64:67], v[12:15]
    ds_read_b128 v[56:59], v105 offset:1024
    v_mfma_f32_16x16x32_bf16 v[16:19], v[220:223], v[64:67], v[16:19]
    s_waitcnt lgkmcnt(4)
    v_mfma_f32_16x16x32_bf16 v[20:23], v[216:219], v[68:71], v[20:23]
    ds_read_b128 v[60:63], v102 offset:2048
    v_mfma_f32_16x16x32_bf16 v[24:27], v[220:223], v[68:71], v[24:27]
    s_waitcnt lgkmcnt(3)
    v_mfma_f32_16x16x32_bf16 v[12:15], v[224:227], v[44:47], v[12:15]
    ds_read_b128 v[64:67], v103 offset:2048
    v_mfma_f32_16x16x32_bf16 v[16:19], v[228:231], v[44:47], v[16:19]
    s_add_u32 s37, s35, 147456
    s_add_u32 m0, s36, 0
    s_nop 0
    buffer_load_dwordx4 v97, s[8:11], s37 offen offset:0 lds
    v_mfma_f32_16x16x32_bf16 v[20:23], v[224:227], v[48:51], v[20:23]
    ds_read_b128 v[68:71], v104 offset:2048
    v_mfma_f32_16x16x32_bf16 v[24:27], v[228:231], v[48:51], v[24:27]
    s_waitcnt lgkmcnt(3)
    v_mfma_f32_16x16x32_bf16 v[12:15], v[232:235], v[52:55], v[12:15]
    ds_read_b128 v[44:47], v105 offset:2048
    v_mfma_f32_16x16x32_bf16 v[16:19], v[236:239], v[52:55], v[16:19]
    v_mfma_f32_16x16x32_bf16 v[20:23], v[232:235], v[56:59], v[20:23]
    s_waitcnt vmcnt(7)
    s_barrier
    ds_read_b128 v[48:51], v106 offset:24576
    v_mfma_f32_16x16x32_bf16 v[24:27], v[236:239], v[56:59], v[24:27]
    s_waitcnt lgkmcnt(3)
    v_mfma_f32_16x16x32_bf16 v[12:15], v[240:243], v[60:63], v[12:15]
    ds_read_b128 v[52:55], v107 offset:24576
    v_mfma_f32_16x16x32_bf16 v[16:19], v[244:247], v[60:63], v[16:19]
    s_add_u32 m0, s36, 896
    s_nop 0
    buffer_load_dwordx4 v97, s[8:11], s37 offen offset:128 lds
    v_mfma_f32_16x16x32_bf16 v[20:23], v[240:243], v[64:67], v[20:23]
    ds_read_b128 v[56:59], v108 offset:24576
    v_mfma_f32_16x16x32_bf16 v[24:27], v[244:247], v[64:67], v[24:27]
    s_add_u32 m0, s36, 1792
    s_nop 0
    buffer_load_dwordx4 v97, s[8:11], s37 offen offset:256 lds
    s_waitcnt lgkmcnt(4)
    v_mfma_f32_16x16x32_bf16 v[12:15], v[248:251], v[68:71], v[12:15]
    ds_read_b128 v[60:63], v109 offset:24576
    v_mfma_f32_16x16x32_bf16 v[16:19], v[252:255], v[68:71], v[16:19]
    s_waitcnt lgkmcnt(4)
    v_mfma_f32_16x16x32_bf16 v[20:23], v[248:251], v[44:47], v[20:23]
    ds_read_b128 v[64:67], v106 offset:25600
    v_mfma_f32_16x16x32_bf16 v[24:27], v[252:255], v[44:47], v[24:27]
    s_waitcnt lgkmcnt(3)
    v_mfma_f32_16x16x32_bf16 v[28:31], v[112:115], v[48:51], 0
    ds_read_b128 v[68:71], v107 offset:25600
    v_mfma_f32_16x16x32_bf16 v[32:35], v[116:119], v[48:51], 0
    s_add_u32 s37, s35, 147840
    s_add_u32 m0, s36, 24576
    s_nop 0
    buffer_load_dwordx4 v97, s[8:11], s37 offen offset:0 lds
    v_mfma_f32_16x16x32_bf16 v[36:39], v[112:115], v[52:55], 0
    ds_read_b128 v[44:47], v108 offset:25600
    v_mfma_f32_16x16x32_bf16 v[40:43], v[116:119], v[52:55], 0
    s_waitcnt lgkmcnt(3)
    v_mfma_f32_16x16x32_bf16 v[28:31], v[120:123], v[56:59], v[28:31]
    ds_read_b128 v[48:51], v109 offset:25600
    s_add_u32 s45, s42, 0
    s_mul_i32 s45, s45, 184320
    v_mfma_f32_16x16x32_bf16 v[32:35], v[124:127], v[56:59], v[32:35]
    v_mul_f32 v80, v12, v12
    v_mul_f32 v81, v13, v13
    v_mul_f32 v82, v14, v14
    v_mfma_f32_16x16x32_bf16 v[36:39], v[120:123], v[60:63], v[36:39]
    ds_read_b128 v[52:55], v106 offset:26624
    v_mul_f32 v83, v15, v15
    v_fmaak_f32 v80, v80, v111, 0xc0135761
    v_mfma_f32_16x16x32_bf16 v[40:43], v[124:127], v[60:63], v[40:43]
    s_waitcnt lgkmcnt(3)
    v_fmaak_f32 v81, v81, v111, 0xc0135761
    v_fmaak_f32 v82, v82, v111, 0xc0135761
    v_mfma_f32_16x16x32_bf16 v[28:31], v[128:131], v[64:67], v[28:31]
    ds_read_b128 v[56:59], v107 offset:26624
    v_fmaak_f32 v83, v83, v111, 0xc0135761
    v_mul_f32 v80, v80, v12
    v_mfma_f32_16x16x32_bf16 v[32:35], v[132:135], v[64:67], v[32:35]
    s_add_u32 m0, s36, 25472
    s_nop 0
    buffer_load_dwordx4 v97, s[8:11], s37 offen offset:128 lds
    v_mul_f32 v81, v81, v13
    v_mul_f32 v82, v82, v14
    v_mul_f32 v83, v83, v15
    v_mfma_f32_16x16x32_bf16 v[36:39], v[128:131], v[68:71], v[36:39]
    ds_read_b128 v[60:63], v108 offset:26624
    v_exp_f32 v80, v80
    v_mfma_f32_16x16x32_bf16 v[40:43], v[132:135], v[68:71], v[40:43]
    s_waitcnt lgkmcnt(3)
    v_exp_f32 v81, v81
    v_mfma_f32_16x16x32_bf16 v[28:31], v[136:139], v[44:47], v[28:31]
    ds_read_b128 v[64:67], v109 offset:26624
    v_exp_f32 v82, v82
    v_mfma_f32_16x16x32_bf16 v[32:35], v[140:143], v[44:47], v[32:35]
    v_exp_f32 v83, v83
    v_add_f32 v80, 1.0, v80
    v_mfma_f32_16x16x32_bf16 v[36:39], v[136:139], v[48:51], v[36:39]
    s_waitcnt vmcnt(8)
    s_barrier
    ds_read_b128 v[68:71], v102 offset:24576
    v_add_f32 v81, 1.0, v81
    v_add_f32 v82, 1.0, v82
    v_mfma_f32_16x16x32_bf16 v[40:43], v[140:143], v[48:51], v[40:43]
    s_waitcnt lgkmcnt(3)
    v_add_f32 v83, 1.0, v83
    v_rcp_f32 v80, v80
    v_mfma_f32_16x16x32_bf16 v[28:31], v[144:147], v[52:55], v[28:31]
    ds_read_b128 v[44:47], v103 offset:24576
    v_rcp_f32 v81, v81
    v_mfma_f32_16x16x32_bf16 v[32:35], v[148:151], v[52:55], v[32:35]
    s_add_u32 m0, s36, 26368
    s_nop 0
    buffer_load_dwordx4 v97, s[8:11], s37 offen offset:256 lds
    v_rcp_f32 v82, v82
    v_mfma_f32_16x16x32_bf16 v[36:39], v[144:147], v[56:59], v[36:39]
    ds_read_b128 v[48:51], v104 offset:24576
    v_rcp_f32 v83, v83
    v_mfma_f32_16x16x32_bf16 v[40:43], v[148:151], v[56:59], v[40:43]
    s_waitcnt lgkmcnt(3)
    v_mul_f32 v80, v80, v12
    v_mul_f32 v81, v81, v13
    v_mul_f32 v82, v82, v14
    v_mfma_f32_16x16x32_bf16 v[28:31], v[152:155], v[60:63], v[28:31]
    ds_read_b128 v[52:55], v105 offset:24576
    v_mul_f32 v83, v83, v15
    v_cvt_pk_bf16_f32 v88, v80, v81
    v_mfma_f32_16x16x32_bf16 v[32:35], v[156:159], v[60:63], v[32:35]
    v_cvt_pk_bf16_f32 v89, v82, v83
    v_mul_f32 v84, v16, v16
    v_mfma_f32_16x16x32_bf16 v[36:39], v[152:155], v[64:67], v[36:39]
    ds_read_b128 v[56:59], v102 offset:25600
    v_mul_f32 v85, v17, v17
    v_mul_f32 v86, v18, v18
    v_mul_f32 v87, v19, v19
    v_mfma_f32_16x16x32_bf16 v[40:43], v[156:159], v[64:67], v[40:43]
    s_waitcnt lgkmcnt(3)
    v_fmaak_f32 v84, v84, v111, 0xc0135761
    v_fmaak_f32 v85, v85, v111, 0xc0135761
    v_mfma_f32_16x16x32_bf16 v[28:31], v[160:163], v[68:71], v[28:31]
    ds_read_b128 v[60:63], v103 offset:25600
    v_fmaak_f32 v86, v86, v111, 0xc0135761
    v_fmaak_f32 v87, v87, v111, 0xc0135761
    v_mfma_f32_16x16x32_bf16 v[32:35], v[164:167], v[68:71], v[32:35]
    s_add_u32 s37, s35, 148224
    s_add_u32 m0, s36, 49152
    s_nop 0
    buffer_load_dwordx4 v97, s[8:11], s37 offen offset:0 lds
    v_mul_f32 v84, v84, v16
    v_mul_f32 v85, v85, v17
    v_mfma_f32_16x16x32_bf16 v[36:39], v[160:163], v[44:47], v[36:39]
    ds_read_b128 v[64:67], v104 offset:25600
    v_mul_f32 v86, v86, v18
    v_mul_f32 v87, v87, v19
    v_mfma_f32_16x16x32_bf16 v[40:43], v[164:167], v[44:47], v[40:43]
    s_waitcnt lgkmcnt(3)
    v_exp_f32 v84, v84
    v_exp_f32 v85, v85
    v_mfma_f32_16x16x32_bf16 v[28:31], v[168:171], v[48:51], v[28:31]
    ds_read_b128 v[68:71], v105 offset:25600
    v_exp_f32 v86, v86
    v_mfma_f32_16x16x32_bf16 v[32:35], v[172:175], v[48:51], v[32:35]
    v_exp_f32 v87, v87
    v_mfma_f32_16x16x32_bf16 v[36:39], v[168:171], v[52:55], v[36:39]
    ds_read_b128 v[44:47], v102 offset:26624
    v_add_f32 v84, 1.0, v84
    v_add_f32 v85, 1.0, v85
    v_mfma_f32_16x16x32_bf16 v[40:43], v[172:175], v[52:55], v[40:43]
    s_waitcnt lgkmcnt(3)
    v_add_f32 v86, 1.0, v86
    v_add_f32 v87, 1.0, v87
    v_mfma_f32_16x16x32_bf16 v[28:31], v[176:179], v[56:59], v[28:31]
    ds_read_b128 v[48:51], v103 offset:26624
    v_rcp_f32 v84, v84
    v_mfma_f32_16x16x32_bf16 v[32:35], v[180:183], v[56:59], v[32:35]
    s_add_u32 m0, s36, 50048
    s_nop 0
    buffer_load_dwordx4 v97, s[8:11], s37 offen offset:128 lds
    v_rcp_f32 v85, v85
    v_mfma_f32_16x16x32_bf16 v[36:39], v[176:179], v[60:63], v[36:39]
    ds_read_b128 v[52:55], v104 offset:26624
    v_rcp_f32 v86, v86
    v_rcp_f32 v87, v87
    v_mfma_f32_16x16x32_bf16 v[40:43], v[180:183], v[60:63], v[40:43]
    s_waitcnt lgkmcnt(3)
    v_mul_f32 v84, v84, v16
    v_mfma_f32_16x16x32_bf16 v[28:31], v[184:187], v[64:67], v[28:31]
    ds_read_b128 v[56:59], v105 offset:26624
    v_mul_f32 v85, v85, v17
    v_mul_f32 v86, v86, v18
    v_mul_f32 v87, v87, v19
    v_mfma_f32_16x16x32_bf16 v[32:35], v[188:191], v[64:67], v[32:35]
    v_cvt_pk_bf16_f32 v90, v84, v85
    v_cvt_pk_bf16_f32 v91, v86, v87
    v_mfma_f32_16x16x32_bf16 v[36:39], v[184:187], v[68:71], v[36:39]
    s_waitcnt vmcnt(8)
    s_barrier
    ds_read_b128 v[60:63], v106 offset:0
    buffer_store_dwordx4 v[88:91], v110, s[20:23], s45 offen sc1
    v_mul_f32 v80, v20, v20
    v_mfma_f32_16x16x32_bf16 v[40:43], v[188:191], v[68:71], v[40:43]
    s_waitcnt lgkmcnt(3)
    v_mul_f32 v81, v21, v21
    v_mul_f32 v82, v22, v22
    v_mul_f32 v83, v23, v23
    v_mfma_f32_16x16x32_bf16 v[28:31], v[192:195], v[44:47], v[28:31]
    ds_read_b128 v[64:67], v107 offset:0
    v_fmaak_f32 v80, v80, v111, 0xc0135761
    v_fmaak_f32 v81, v81, v111, 0xc0135761
    v_mfma_f32_16x16x32_bf16 v[32:35], v[196:199], v[44:47], v[32:35]
    s_add_u32 m0, s36, 50944
    s_nop 0
    buffer_load_dwordx4 v97, s[8:11], s37 offen offset:256 lds
    v_fmaak_f32 v82, v82, v111, 0xc0135761
    v_fmaak_f32 v83, v83, v111, 0xc0135761
    v_mfma_f32_16x16x32_bf16 v[36:39], v[192:195], v[48:51], v[36:39]
    ds_read_b128 v[68:71], v108 offset:0
    v_mul_f32 v80, v80, v20
    v_mul_f32 v81, v81, v21
    v_mfma_f32_16x16x32_bf16 v[40:43], v[196:199], v[48:51], v[40:43]
    s_waitcnt lgkmcnt(3)
    v_mul_f32 v82, v82, v22
    v_mul_f32 v83, v83, v23
    v_mfma_f32_16x16x32_bf16 v[28:31], v[200:203], v[52:55], v[28:31]
    ds_read_b128 v[44:47], v109 offset:0
    v_exp_f32 v80, v80
    v_exp_f32 v81, v81
    v_mfma_f32_16x16x32_bf16 v[32:35], v[204:207], v[52:55], v[32:35]
    v_exp_f32 v82, v82
    v_mfma_f32_16x16x32_bf16 v[36:39], v[200:203], v[56:59], v[36:39]
    ds_read_b128 v[48:51], v106 offset:1024
    v_exp_f32 v83, v83
    v_mfma_f32_16x16x32_bf16 v[40:43], v[204:207], v[56:59], v[40:43]
    s_waitcnt lgkmcnt(3)
    v_add_f32 v80, 1.0, v80
    v_add_f32 v81, 1.0, v81
    v_mfma_f32_16x16x32_bf16 v[28:31], v[208:211], v[60:63], v[28:31]
    ds_read_b128 v[52:55], v107 offset:1024
    v_add_f32 v82, 1.0, v82
    v_add_f32 v83, 1.0, v83
    v_mfma_f32_16x16x32_bf16 v[32:35], v[212:215], v[60:63], v[32:35]
    s_add_u32 s37, s35, 221184
    s_add_u32 m0, s36, 122880
    s_nop 0
    buffer_load_dwordx4 v97, s[8:11], s37 offen offset:0 lds
    v_rcp_f32 v80, v80
    v_mfma_f32_16x16x32_bf16 v[36:39], v[208:211], v[64:67], v[36:39]
    ds_read_b128 v[56:59], v108 offset:1024
    v_rcp_f32 v81, v81
    v_mfma_f32_16x16x32_bf16 v[40:43], v[212:215], v[64:67], v[40:43]
    s_waitcnt lgkmcnt(3)
    v_rcp_f32 v82, v82
    v_rcp_f32 v83, v83
    v_mfma_f32_16x16x32_bf16 v[28:31], v[216:219], v[68:71], v[28:31]
    ds_read_b128 v[60:63], v109 offset:1024
    v_mul_f32 v80, v80, v20
    v_mfma_f32_16x16x32_bf16 v[32:35], v[220:223], v[68:71], v[32:35]
    v_mul_f32 v81, v81, v21
    v_mul_f32 v82, v82, v22
    v_mul_f32 v83, v83, v23
    v_mfma_f32_16x16x32_bf16 v[36:39], v[216:219], v[44:47], v[36:39]
    ds_read_b128 v[64:67], v106 offset:2048
    v_cvt_pk_bf16_f32 v92, v80, v81
    v_cvt_pk_bf16_f32 v93, v82, v83
    v_mfma_f32_16x16x32_bf16 v[40:43], v[220:223], v[44:47], v[40:43]
    s_waitcnt lgkmcnt(3)
    v_mul_f32 v84, v24, v24
    v_mul_f32 v85, v25, v25
    v_mfma_f32_16x16x32_bf16 v[28:31], v[224:227], v[48:51], v[28:31]
    ds_read_b128 v[68:71], v107 offset:2048
    v_mul_f32 v86, v26, v26
    v_mul_f32 v87, v27, v27
    v_fmaak_f32 v84, v84, v111, 0xc0135761
    v_mfma_f32_16x16x32_bf16 v[32:35], v[228:231], v[48:51], v[32:35]
    s_add_u32 m0, s36, 123776
    s_nop 0
    buffer_load_dwordx4 v97, s[8:11], s37 offen offset:128 lds
    v_fmaak_f32 v85, v85, v111, 0xc0135761
    v_fmaak_f32 v86, v86, v111, 0xc0135761
    v_mfma_f32_16x16x32_bf16 v[36:39], v[224:227], v[52:55], v[36:39]
    ds_read_b128 v[44:47], v108 offset:2048
    v_fmaak_f32 v87, v87, v111, 0xc0135761
    v_mul_f32 v84, v84, v24
    v_mfma_f32_16x16x32_bf16 v[40:43], v[228:231], v[52:55], v[40:43]
    s_waitcnt lgkmcnt(3)
    v_mul_f32 v85, v85, v25
    v_mul_f32 v86, v86, v26
    v_mfma_f32_16x16x32_bf16 v[28:31], v[232:235], v[56:59], v[28:31]
    ds_read_b128 v[48:51], v109 offset:2048
    v_mul_f32 v87, v87, v27
    v_exp_f32 v84, v84
    v_mfma_f32_16x16x32_bf16 v[32:35], v[236:239], v[56:59], v[32:35]
    v_exp_f32 v85, v85
    v_mfma_f32_16x16x32_bf16 v[36:39], v[232:235], v[60:63], v[36:39]
    s_waitcnt vmcnt(9)
    s_barrier
    ds_read_b128 v[52:55], v98 offset:0
    v_exp_f32 v86, v86
    v_mfma_f32_16x16x32_bf16 v[40:43], v[236:239], v[60:63], v[40:43]
    s_waitcnt lgkmcnt(3)
    v_exp_f32 v87, v87
    v_add_f32 v84, 1.0, v84
    v_mfma_f32_16x16x32_bf16 v[28:31], v[240:243], v[64:67], v[28:31]
    ds_read_b128 v[56:59], v99 offset:0
    v_add_f32 v85, 1.0, v85
    v_add_f32 v86, 1.0, v86
    v_mfma_f32_16x16x32_bf16 v[32:35], v[244:247], v[64:67], v[32:35]
    s_add_u32 m0, s36, 124672
    s_nop 0
    buffer_load_dwordx4 v97, s[8:11], s37 offen offset:256 lds
    v_add_f32 v87, 1.0, v87
    v_rcp_f32 v84, v84
    v_mfma_f32_16x16x32_bf16 v[36:39], v[240:243], v[68:71], v[36:39]
    ds_read_b128 v[60:63], v100 offset:0
    v_rcp_f32 v85, v85
    v_mfma_f32_16x16x32_bf16 v[40:43], v[244:247], v[68:71], v[40:43]
    s_waitcnt lgkmcnt(3)
    v_rcp_f32 v86, v86
    v_mfma_f32_16x16x32_bf16 v[28:31], v[248:251], v[44:47], v[28:31]
    ds_read_b128 v[64:67], v101 offset:0
    v_rcp_f32 v87, v87
    v_mfma_f32_16x16x32_bf16 v[32:35], v[252:255], v[44:47], v[32:35]
    v_mul_f32 v84, v84, v24
    v_mul_f32 v85, v85, v25
    v_mfma_f32_16x16x32_bf16 v[36:39], v[248:251], v[48:51], v[36:39]
    ds_read_b128 v[68:71], v98 offset:1024
    v_mul_f32 v86, v86, v26
    v_mul_f32 v87, v87, v27
    v_cvt_pk_bf16_f32 v94, v84, v85
    v_mfma_f32_16x16x32_bf16 v[40:43], v[252:255], v[48:51], v[40:43]
    s_waitcnt lgkmcnt(3)
    v_cvt_pk_bf16_f32 v95, v86, v87
    buffer_store_dwordx4 v[92:95], v10, s[20:23], s45 offen sc1
    v_mfma_f32_16x16x32_bf16 v[12:15], v[112:115], v[52:55], 0
    ds_read_b128 v[44:47], v99 offset:1024
    v_mfma_f32_16x16x32_bf16 v[16:19], v[116:119], v[52:55], 0
    s_add_u32 s37, s35, 221568
    s_add_u32 m0, s36, 73728
    s_nop 0
    buffer_load_dwordx4 v97, s[8:11], s37 offen offset:0 lds
    v_mfma_f32_16x16x32_bf16 v[20:23], v[112:115], v[56:59], 0
    ds_read_b128 v[48:51], v100 offset:1024
    v_mfma_f32_16x16x32_bf16 v[24:27], v[116:119], v[56:59], 0
    s_waitcnt lgkmcnt(3)
    v_mfma_f32_16x16x32_bf16 v[12:15], v[120:123], v[60:63], v[12:15]
    ds_read_b128 v[52:55], v101 offset:1024
    s_add_u32 s45, s42, 2
    s_mul_i32 s45, s45, 184320
    v_mfma_f32_16x16x32_bf16 v[16:19], v[124:127], v[60:63], v[16:19]
    v_mul_f32 v80, v28, v28
    v_mul_f32 v81, v29, v29
    v_mul_f32 v82, v30, v30
    v_mfma_f32_16x16x32_bf16 v[20:23], v[120:123], v[64:67], v[20:23]
    ds_read_b128 v[56:59], v98 offset:2048
    v_mul_f32 v83, v31, v31
    v_fmaak_f32 v80, v80, v111, 0xc0135761
    v_mfma_f32_16x16x32_bf16 v[24:27], v[124:127], v[64:67], v[24:27]
    s_waitcnt lgkmcnt(3)
    v_fmaak_f32 v81, v81, v111, 0xc0135761
    v_fmaak_f32 v82, v82, v111, 0xc0135761
    v_mfma_f32_16x16x32_bf16 v[12:15], v[128:131], v[68:71], v[12:15]
    ds_read_b128 v[60:63], v99 offset:2048
    v_fmaak_f32 v83, v83, v111, 0xc0135761
    v_mul_f32 v80, v80, v28
    v_mfma_f32_16x16x32_bf16 v[16:19], v[132:135], v[68:71], v[16:19]
    s_add_u32 m0, s36, 74624
    s_nop 0
    buffer_load_dwordx4 v97, s[8:11], s37 offen offset:128 lds
    v_mul_f32 v81, v81, v29
    v_mul_f32 v82, v82, v30
    v_mul_f32 v83, v83, v31
    v_mfma_f32_16x16x32_bf16 v[20:23], v[128:131], v[44:47], v[20:23]
    ds_read_b128 v[64:67], v100 offset:2048
    v_exp_f32 v80, v80
    v_mfma_f32_16x16x32_bf16 v[24:27], v[132:135], v[44:47], v[24:27]
    s_waitcnt lgkmcnt(3)
    v_exp_f32 v81, v81
    v_mfma_f32_16x16x32_bf16 v[12:15], v[136:139], v[48:51], v[12:15]
    ds_read_b128 v[68:71], v101 offset:2048
    v_exp_f32 v82, v82
    v_mfma_f32_16x16x32_bf16 v[16:19], v[140:143], v[48:51], v[16:19]
    v_exp_f32 v83, v83
    v_add_f32 v80, 1.0, v80
    v_mfma_f32_16x16x32_bf16 v[20:23], v[136:139], v[52:55], v[20:23]
    s_waitcnt vmcnt(10)
    s_barrier
    s_mov_b32 s16, s56
    s_mov_b32 s17, s57
    s_lshl_b32 s47, s41, 12
    s_add_u32 s18, s47, 1024
    buffer_load_dword v9, v8, s[16:19], s47 offen
    ds_read_b128 v[44:47], v98 offset:24576
    v_add_f32 v81, 1.0, v81
    v_add_f32 v82, 1.0, v82
    v_mfma_f32_16x16x32_bf16 v[24:27], v[140:143], v[52:55], v[24:27]
    s_waitcnt lgkmcnt(3)
    v_add_f32 v83, 1.0, v83
    v_rcp_f32 v80, v80
    v_mfma_f32_16x16x32_bf16 v[12:15], v[144:147], v[56:59], v[12:15]
    ds_read_b128 v[48:51], v99 offset:24576
    v_rcp_f32 v81, v81
    v_mfma_f32_16x16x32_bf16 v[16:19], v[148:151], v[56:59], v[16:19]
    s_add_u32 m0, s36, 75520
    s_nop 0
    buffer_load_dwordx4 v97, s[8:11], s37 offen offset:256 lds
    v_rcp_f32 v82, v82
    v_mfma_f32_16x16x32_bf16 v[20:23], v[144:147], v[60:63], v[20:23]
    ds_read_b128 v[52:55], v100 offset:24576
    v_rcp_f32 v83, v83
    v_mfma_f32_16x16x32_bf16 v[24:27], v[148:151], v[60:63], v[24:27]
    s_waitcnt lgkmcnt(3)
    v_mul_f32 v80, v80, v28
    v_mul_f32 v81, v81, v29
    v_mul_f32 v82, v82, v30
    v_mfma_f32_16x16x32_bf16 v[12:15], v[152:155], v[64:67], v[12:15]
    ds_read_b128 v[56:59], v101 offset:24576
    v_mul_f32 v83, v83, v31
    v_cvt_pk_bf16_f32 v88, v80, v81
    v_mfma_f32_16x16x32_bf16 v[16:19], v[156:159], v[64:67], v[16:19]
    v_cvt_pk_bf16_f32 v89, v82, v83
    v_mul_f32 v84, v32, v32
    v_mfma_f32_16x16x32_bf16 v[20:23], v[152:155], v[68:71], v[20:23]
    ds_read_b128 v[60:63], v98 offset:25600
    v_mul_f32 v85, v33, v33
    v_mul_f32 v86, v34, v34
    v_mul_f32 v87, v35, v35
    v_mfma_f32_16x16x32_bf16 v[24:27], v[156:159], v[68:71], v[24:27]
    s_waitcnt lgkmcnt(3)
    v_fmaak_f32 v84, v84, v111, 0xc0135761
    v_fmaak_f32 v85, v85, v111, 0xc0135761
    v_mfma_f32_16x16x32_bf16 v[12:15], v[160:163], v[44:47], v[12:15]
    ds_read_b128 v[64:67], v99 offset:25600
    v_fmaak_f32 v86, v86, v111, 0xc0135761
    v_fmaak_f32 v87, v87, v111, 0xc0135761
    v_mfma_f32_16x16x32_bf16 v[16:19], v[164:167], v[44:47], v[16:19]
    s_add_u32 s37, s35, 221952
    s_add_u32 m0, s36, 98304
    s_nop 0
    buffer_load_dwordx4 v97, s[8:11], s37 offen offset:0 lds
    v_mul_f32 v84, v84, v32
    v_mul_f32 v85, v85, v33
    v_mfma_f32_16x16x32_bf16 v[20:23], v[160:163], v[48:51], v[20:23]
    ds_read_b128 v[68:71], v100 offset:25600
    v_mul_f32 v86, v86, v34
    v_mul_f32 v87, v87, v35
    v_mfma_f32_16x16x32_bf16 v[24:27], v[164:167], v[48:51], v[24:27]
    s_waitcnt lgkmcnt(3)
    v_exp_f32 v84, v84
    v_exp_f32 v85, v85
    v_mfma_f32_16x16x32_bf16 v[12:15], v[168:171], v[52:55], v[12:15]
    ds_read_b128 v[44:47], v101 offset:25600
    v_exp_f32 v86, v86
    v_mfma_f32_16x16x32_bf16 v[16:19], v[172:175], v[52:55], v[16:19]
    v_exp_f32 v87, v87
    v_mfma_f32_16x16x32_bf16 v[20:23], v[168:171], v[56:59], v[20:23]
    ds_read_b128 v[48:51], v98 offset:26624
    v_add_f32 v84, 1.0, v84
    v_add_f32 v85, 1.0, v85
    v_mfma_f32_16x16x32_bf16 v[24:27], v[172:175], v[56:59], v[24:27]
    s_waitcnt lgkmcnt(3)
    v_add_f32 v86, 1.0, v86
    v_add_f32 v87, 1.0, v87
    v_mfma_f32_16x16x32_bf16 v[12:15], v[176:179], v[60:63], v[12:15]
    ds_read_b128 v[52:55], v99 offset:26624
    v_rcp_f32 v84, v84
    v_mfma_f32_16x16x32_bf16 v[16:19], v[180:183], v[60:63], v[16:19]
    s_add_u32 m0, s36, 99200
    s_nop 0
    buffer_load_dwordx4 v97, s[8:11], s37 offen offset:128 lds
    v_rcp_f32 v85, v85
    v_mfma_f32_16x16x32_bf16 v[20:23], v[176:179], v[64:67], v[20:23]
    ds_read_b128 v[56:59], v100 offset:26624
    v_rcp_f32 v86, v86
    v_rcp_f32 v87, v87
    v_mfma_f32_16x16x32_bf16 v[24:27], v[180:183], v[64:67], v[24:27]
    s_waitcnt lgkmcnt(3)
    v_mul_f32 v84, v84, v32
    v_mfma_f32_16x16x32_bf16 v[12:15], v[184:187], v[68:71], v[12:15]
    ds_read_b128 v[60:63], v101 offset:26624
    v_mul_f32 v85, v85, v33
    v_mul_f32 v86, v86, v34
    v_mul_f32 v87, v87, v35
    v_mfma_f32_16x16x32_bf16 v[16:19], v[188:191], v[68:71], v[16:19]
    v_cvt_pk_bf16_f32 v90, v84, v85
    v_cvt_pk_bf16_f32 v91, v86, v87
    v_mfma_f32_16x16x32_bf16 v[20:23], v[184:187], v[44:47], v[20:23]
    s_waitcnt vmcnt(10)
    s_barrier
    ds_read_b128 v[64:67], v102 offset:0
    buffer_store_dwordx4 v[88:91], v110, s[20:23], s45 offen sc1
    v_mul_f32 v80, v36, v36
    v_mfma_f32_16x16x32_bf16 v[24:27], v[188:191], v[44:47], v[24:27]
    s_waitcnt lgkmcnt(3)
    v_mul_f32 v81, v37, v37
    v_mul_f32 v82, v38, v38
    v_mul_f32 v83, v39, v39
    v_mfma_f32_16x16x32_bf16 v[12:15], v[192:195], v[48:51], v[12:15]
    ds_read_b128 v[68:71], v103 offset:0
    v_fmaak_f32 v80, v80, v111, 0xc0135761
    v_fmaak_f32 v81, v81, v111, 0xc0135761
    v_mfma_f32_16x16x32_bf16 v[16:19], v[196:199], v[48:51], v[16:19]
    s_add_u32 m0, s36, 100096
    s_nop 0
    buffer_load_dwordx4 v97, s[8:11], s37 offen offset:256 lds
    v_fmaak_f32 v82, v82, v111, 0xc0135761
    v_fmaak_f32 v83, v83, v111, 0xc0135761
    v_mfma_f32_16x16x32_bf16 v[20:23], v[192:195], v[52:55], v[20:23]
    ds_read_b128 v[44:47], v104 offset:0
    v_mul_f32 v80, v80, v36
    v_mul_f32 v81, v81, v37
    v_mfma_f32_16x16x32_bf16 v[24:27], v[196:199], v[52:55], v[24:27]
    s_waitcnt lgkmcnt(3)
    v_mul_f32 v82, v82, v38
    v_mul_f32 v83, v83, v39
    v_mfma_f32_16x16x32_bf16 v[12:15], v[200:203], v[56:59], v[12:15]
    ds_read_b128 v[48:51], v105 offset:0
    v_exp_f32 v80, v80
    v_exp_f32 v81, v81
    v_mfma_f32_16x16x32_bf16 v[16:19], v[204:207], v[56:59], v[16:19]
    v_exp_f32 v82, v82
    v_mfma_f32_16x16x32_bf16 v[20:23], v[200:203], v[60:63], v[20:23]
    ds_read_b128 v[52:55], v102 offset:1024
    v_exp_f32 v83, v83
    v_mfma_f32_16x16x32_bf16 v[24:27], v[204:207], v[60:63], v[24:27]
    s_waitcnt lgkmcnt(3)
    v_add_f32 v80, 1.0, v80
    v_add_f32 v81, 1.0, v81
    v_mfma_f32_16x16x32_bf16 v[12:15], v[208:211], v[64:67], v[12:15]
    ds_read_b128 v[56:59], v103 offset:1024
    v_add_f32 v82, 1.0, v82
    v_add_f32 v83, 1.0, v83
    v_mfma_f32_16x16x32_bf16 v[16:19], v[212:215], v[64:67], v[16:19]
    s_add_u32 s37, s35, 294912
    s_add_u32 m0, s36, 0
    s_nop 0
    buffer_load_dwordx4 v97, s[8:11], s37 offen offset:0 lds
    v_rcp_f32 v80, v80
    v_mfma_f32_16x16x32_bf16 v[20:23], v[208:211], v[68:71], v[20:23]
    ds_read_b128 v[60:63], v104 offset:1024
    v_rcp_f32 v81, v81
    v_mfma_f32_16x16x32_bf16 v[24:27], v[212:215], v[68:71], v[24:27]
    s_waitcnt lgkmcnt(3)
    v_rcp_f32 v82, v82
    v_rcp_f32 v83, v83
    v_mfma_f32_16x16x32_bf16 v[12:15], v[216:219], v[44:47], v[12:15]
    ds_read_b128 v[64:67], v105 offset:1024
    v_mul_f32 v80, v80, v36
    v_mfma_f32_16x16x32_bf16 v[16:19], v[220:223], v[44:47], v[16:19]
    v_mul_f32 v81, v81, v37
    v_mul_f32 v82, v82, v38
    v_mul_f32 v83, v83, v39
    v_mfma_f32_16x16x32_bf16 v[20:23], v[216:219], v[48:51], v[20:23]
    ds_read_b128 v[68:71], v102 offset:2048
    v_cvt_pk_bf16_f32 v92, v80, v81
    v_cvt_pk_bf16_f32 v93, v82, v83
    v_mfma_f32_16x16x32_bf16 v[24:27], v[220:223], v[48:51], v[24:27]
    s_waitcnt lgkmcnt(3)
    v_mul_f32 v84, v40, v40
    v_mul_f32 v85, v41, v41
    v_mfma_f32_16x16x32_bf16 v[12:15], v[224:227], v[52:55], v[12:15]
    ds_read_b128 v[44:47], v103 offset:2048
    v_mul_f32 v86, v42, v42
    v_mul_f32 v87, v43, v43
    v_fmaak_f32 v84, v84, v111, 0xc0135761
    v_mfma_f32_16x16x32_bf16 v[16:19], v[228:231], v[52:55], v[16:19]
    s_add_u32 m0, s36, 896
    s_nop 0
    buffer_load_dwordx4 v97, s[8:11], s37 offen offset:128 lds
    v_fmaak_f32 v85, v85, v111, 0xc0135761
    v_fmaak_f32 v86, v86, v111, 0xc0135761
    v_mfma_f32_16x16x32_bf16 v[20:23], v[224:227], v[56:59], v[20:23]
    ds_read_b128 v[48:51], v104 offset:2048
    v_fmaak_f32 v87, v87, v111, 0xc0135761
    v_mul_f32 v84, v84, v40
    v_mfma_f32_16x16x32_bf16 v[24:27], v[228:231], v[56:59], v[24:27]
    s_waitcnt lgkmcnt(3)
    v_mul_f32 v85, v85, v41
    v_mul_f32 v86, v86, v42
    v_mfma_f32_16x16x32_bf16 v[12:15], v[232:235], v[60:63], v[12:15]
    ds_read_b128 v[52:55], v105 offset:2048
    v_mul_f32 v87, v87, v43
    v_exp_f32 v84, v84
    v_mfma_f32_16x16x32_bf16 v[16:19], v[236:239], v[60:63], v[16:19]
    v_exp_f32 v85, v85
    v_mfma_f32_16x16x32_bf16 v[20:23], v[232:235], v[64:67], v[20:23]
    s_waitcnt vmcnt(11)
    s_barrier
    ds_read_b128 v[56:59], v106 offset:24576
    v_exp_f32 v86, v86
    v_mfma_f32_16x16x32_bf16 v[24:27], v[236:239], v[64:67], v[24:27]
    s_waitcnt lgkmcnt(3)
    v_exp_f32 v87, v87
    v_add_f32 v84, 1.0, v84
    v_mfma_f32_16x16x32_bf16 v[12:15], v[240:243], v[68:71], v[12:15]
    ds_read_b128 v[60:63], v107 offset:24576
    v_add_f32 v85, 1.0, v85
    v_add_f32 v86, 1.0, v86
    v_mfma_f32_16x16x32_bf16 v[16:19], v[244:247], v[68:71], v[16:19]
    s_add_u32 m0, s36, 1792
    s_nop 0
    buffer_load_dwordx4 v97, s[8:11], s37 offen offset:256 lds
    v_add_f32 v87, 1.0, v87
    v_rcp_f32 v84, v84
    v_mfma_f32_16x16x32_bf16 v[20:23], v[240:243], v[44:47], v[20:23]
    ds_read_b128 v[64:67], v108 offset:24576
    v_rcp_f32 v85, v85
    v_mfma_f32_16x16x32_bf16 v[24:27], v[244:247], v[44:47], v[24:27]
    s_waitcnt lgkmcnt(3)
    v_rcp_f32 v86, v86
    v_mfma_f32_16x16x32_bf16 v[12:15], v[248:251], v[48:51], v[12:15]
    ds_read_b128 v[68:71], v109 offset:24576
    v_rcp_f32 v87, v87
    v_mfma_f32_16x16x32_bf16 v[16:19], v[252:255], v[48:51], v[16:19]
    v_mul_f32 v84, v84, v40
    v_mul_f32 v85, v85, v41
    v_mfma_f32_16x16x32_bf16 v[20:23], v[248:251], v[52:55], v[20:23]
    ds_read_b128 v[44:47], v106 offset:25600
    v_mul_f32 v86, v86, v42
    v_mul_f32 v87, v87, v43
    v_cvt_pk_bf16_f32 v94, v84, v85
    v_mfma_f32_16x16x32_bf16 v[24:27], v[252:255], v[52:55], v[24:27]
    s_waitcnt lgkmcnt(3)
    v_cvt_pk_bf16_f32 v95, v86, v87
    buffer_store_dwordx4 v[92:95], v10, s[20:23], s45 offen sc1
    v_mfma_f32_16x16x32_bf16 v[28:31], v[112:115], v[56:59], 0
    ds_read_b128 v[48:51], v107 offset:25600
    v_mfma_f32_16x16x32_bf16 v[32:35], v[116:119], v[56:59], 0
    s_add_u32 s37, s35, 295296
    s_add_u32 m0, s36, 24576
    s_nop 0
    buffer_load_dwordx4 v97, s[8:11], s37 offen offset:0 lds
    v_mfma_f32_16x16x32_bf16 v[36:39], v[112:115], v[60:63], 0
    ds_read_b128 v[52:55], v108 offset:25600
    v_mfma_f32_16x16x32_bf16 v[40:43], v[116:119], v[60:63], 0
    s_waitcnt lgkmcnt(3)
    v_mfma_f32_16x16x32_bf16 v[28:31], v[120:123], v[64:67], v[28:31]
    ds_read_b128 v[56:59], v109 offset:25600
    s_add_u32 s45, s42, 4
    s_mul_i32 s45, s45, 184320
    v_mfma_f32_16x16x32_bf16 v[32:35], v[124:127], v[64:67], v[32:35]
    v_mul_f32 v80, v12, v12
    v_mul_f32 v81, v13, v13
    v_mul_f32 v82, v14, v14
    v_mfma_f32_16x16x32_bf16 v[36:39], v[120:123], v[68:71], v[36:39]
    ds_read_b128 v[60:63], v106 offset:26624
    v_mul_f32 v83, v15, v15
    v_fmaak_f32 v80, v80, v111, 0xc0135761
    v_mfma_f32_16x16x32_bf16 v[40:43], v[124:127], v[68:71], v[40:43]
    s_waitcnt lgkmcnt(3)
    v_fmaak_f32 v81, v81, v111, 0xc0135761
    v_fmaak_f32 v82, v82, v111, 0xc0135761
    v_mfma_f32_16x16x32_bf16 v[28:31], v[128:131], v[44:47], v[28:31]
    ds_read_b128 v[64:67], v107 offset:26624
    v_fmaak_f32 v83, v83, v111, 0xc0135761
    v_mul_f32 v80, v80, v12
    v_mfma_f32_16x16x32_bf16 v[32:35], v[132:135], v[44:47], v[32:35]
    s_add_u32 m0, s36, 25472
    s_nop 0
    buffer_load_dwordx4 v97, s[8:11], s37 offen offset:128 lds
    v_mul_f32 v81, v81, v13
    v_mul_f32 v82, v82, v14
    v_mul_f32 v83, v83, v15
    v_mfma_f32_16x16x32_bf16 v[36:39], v[128:131], v[48:51], v[36:39]
    ds_read_b128 v[68:71], v108 offset:26624
    v_exp_f32 v80, v80
    v_mfma_f32_16x16x32_bf16 v[40:43], v[132:135], v[48:51], v[40:43]
    s_waitcnt lgkmcnt(3)
    v_exp_f32 v81, v81
    v_mfma_f32_16x16x32_bf16 v[28:31], v[136:139], v[52:55], v[28:31]
    ds_read_b128 v[44:47], v109 offset:26624
    v_exp_f32 v82, v82
    v_mfma_f32_16x16x32_bf16 v[32:35], v[140:143], v[52:55], v[32:35]
    v_exp_f32 v83, v83
    v_add_f32 v80, 1.0, v80
    v_mfma_f32_16x16x32_bf16 v[36:39], v[136:139], v[56:59], v[36:39]
    s_waitcnt vmcnt(10)
    s_barrier
    ds_read_b128 v[48:51], v102 offset:24576
    v_add_f32 v81, 1.0, v81
    v_add_f32 v82, 1.0, v82
    v_mfma_f32_16x16x32_bf16 v[40:43], v[140:143], v[56:59], v[40:43]
    s_waitcnt lgkmcnt(3)
    v_add_f32 v83, 1.0, v83
    v_rcp_f32 v80, v80
    v_mfma_f32_16x16x32_bf16 v[28:31], v[144:147], v[60:63], v[28:31]
    ds_read_b128 v[52:55], v103 offset:24576
    v_rcp_f32 v81, v81
    v_mfma_f32_16x16x32_bf16 v[32:35], v[148:151], v[60:63], v[32:35]
    s_add_u32 m0, s36, 26368
    s_nop 0
    buffer_load_dwordx4 v97, s[8:11], s37 offen offset:256 lds
    v_rcp_f32 v82, v82
    v_mfma_f32_16x16x32_bf16 v[36:39], v[144:147], v[64:67], v[36:39]
    ds_read_b128 v[56:59], v104 offset:24576
    v_rcp_f32 v83, v83
    v_mfma_f32_16x16x32_bf16 v[40:43], v[148:151], v[64:67], v[40:43]
    s_waitcnt lgkmcnt(3)
    v_mul_f32 v80, v80, v12
    v_mul_f32 v81, v81, v13
    v_mul_f32 v82, v82, v14
    v_mfma_f32_16x16x32_bf16 v[28:31], v[152:155], v[68:71], v[28:31]
    ds_read_b128 v[60:63], v105 offset:24576
    v_mul_f32 v83, v83, v15
    v_cvt_pk_bf16_f32 v88, v80, v81
    v_mfma_f32_16x16x32_bf16 v[32:35], v[156:159], v[68:71], v[32:35]
    v_cvt_pk_bf16_f32 v89, v82, v83
    v_mul_f32 v84, v16, v16
    v_mfma_f32_16x16x32_bf16 v[36:39], v[152:155], v[44:47], v[36:39]
    ds_read_b128 v[64:67], v102 offset:25600
    v_mul_f32 v85, v17, v17
    v_mul_f32 v86, v18, v18
    v_mul_f32 v87, v19, v19
    v_mfma_f32_16x16x32_bf16 v[40:43], v[156:159], v[44:47], v[40:43]
    s_waitcnt lgkmcnt(3)
    v_fmaak_f32 v84, v84, v111, 0xc0135761
    v_fmaak_f32 v85, v85, v111, 0xc0135761
    v_mfma_f32_16x16x32_bf16 v[28:31], v[160:163], v[48:51], v[28:31]
    ds_read_b128 v[68:71], v103 offset:25600
    v_fmaak_f32 v86, v86, v111, 0xc0135761
    v_fmaak_f32 v87, v87, v111, 0xc0135761
    v_mfma_f32_16x16x32_bf16 v[32:35], v[164:167], v[48:51], v[32:35]
    s_add_u32 s37, s35, 295680
    s_add_u32 m0, s36, 49152
    s_nop 0
    buffer_load_dwordx4 v97, s[8:11], s37 offen offset:0 lds
    v_mul_f32 v84, v84, v16
    v_mul_f32 v85, v85, v17
    v_mfma_f32_16x16x32_bf16 v[36:39], v[160:163], v[52:55], v[36:39]
    ds_read_b128 v[44:47], v104 offset:25600
    v_mul_f32 v86, v86, v18
    v_mul_f32 v87, v87, v19
    v_mfma_f32_16x16x32_bf16 v[40:43], v[164:167], v[52:55], v[40:43]
    s_waitcnt lgkmcnt(3)
    v_exp_f32 v84, v84
    v_exp_f32 v85, v85
    v_mfma_f32_16x16x32_bf16 v[28:31], v[168:171], v[56:59], v[28:31]
    ds_read_b128 v[48:51], v105 offset:25600
    v_exp_f32 v86, v86
    v_mfma_f32_16x16x32_bf16 v[32:35], v[172:175], v[56:59], v[32:35]
    v_exp_f32 v87, v87
    v_mfma_f32_16x16x32_bf16 v[36:39], v[168:171], v[60:63], v[36:39]
    ds_read_b128 v[52:55], v102 offset:26624
    v_add_f32 v84, 1.0, v84
    v_add_f32 v85, 1.0, v85
    v_mfma_f32_16x16x32_bf16 v[40:43], v[172:175], v[60:63], v[40:43]
    s_waitcnt lgkmcnt(3)
    v_add_f32 v86, 1.0, v86
    v_add_f32 v87, 1.0, v87
    v_mfma_f32_16x16x32_bf16 v[28:31], v[176:179], v[64:67], v[28:31]
    ds_read_b128 v[56:59], v103 offset:26624
    v_rcp_f32 v84, v84
    v_mfma_f32_16x16x32_bf16 v[32:35], v[180:183], v[64:67], v[32:35]
    s_add_u32 m0, s36, 50048
    s_nop 0
    buffer_load_dwordx4 v97, s[8:11], s37 offen offset:128 lds
    v_rcp_f32 v85, v85
    v_mfma_f32_16x16x32_bf16 v[36:39], v[176:179], v[68:71], v[36:39]
    ds_read_b128 v[60:63], v104 offset:26624
    v_rcp_f32 v86, v86
    v_rcp_f32 v87, v87
    v_mfma_f32_16x16x32_bf16 v[40:43], v[180:183], v[68:71], v[40:43]
    s_waitcnt lgkmcnt(3)
    v_mul_f32 v84, v84, v16
    v_mfma_f32_16x16x32_bf16 v[28:31], v[184:187], v[44:47], v[28:31]
    ds_read_b128 v[64:67], v105 offset:26624
    v_mul_f32 v85, v85, v17
    v_mul_f32 v86, v86, v18
    v_mul_f32 v87, v87, v19
    v_mfma_f32_16x16x32_bf16 v[32:35], v[188:191], v[44:47], v[32:35]
    v_cvt_pk_bf16_f32 v90, v84, v85
    v_cvt_pk_bf16_f32 v91, v86, v87
    v_mfma_f32_16x16x32_bf16 v[36:39], v[184:187], v[48:51], v[36:39]
    s_waitcnt vmcnt(9)
    s_barrier
    ds_read_b128 v[68:71], v106 offset:0
    buffer_store_dwordx4 v[88:91], v110, s[20:23], s45 offen sc1
    v_mul_f32 v80, v20, v20
    v_mfma_f32_16x16x32_bf16 v[40:43], v[188:191], v[48:51], v[40:43]
    s_waitcnt lgkmcnt(3)
    v_mul_f32 v81, v21, v21
    v_mul_f32 v82, v22, v22
    v_mul_f32 v83, v23, v23
    v_mfma_f32_16x16x32_bf16 v[28:31], v[192:195], v[52:55], v[28:31]
    ds_read_b128 v[44:47], v107 offset:0
    v_fmaak_f32 v80, v80, v111, 0xc0135761
    v_fmaak_f32 v81, v81, v111, 0xc0135761
    v_mfma_f32_16x16x32_bf16 v[32:35], v[196:199], v[52:55], v[32:35]
    s_add_u32 m0, s36, 50944
    s_nop 0
    buffer_load_dwordx4 v97, s[8:11], s37 offen offset:256 lds
    v_fmaak_f32 v82, v82, v111, 0xc0135761
    v_fmaak_f32 v83, v83, v111, 0xc0135761
    v_mfma_f32_16x16x32_bf16 v[36:39], v[192:195], v[56:59], v[36:39]
    ds_read_b128 v[48:51], v108 offset:0
    v_mul_f32 v80, v80, v20
    v_mul_f32 v81, v81, v21
    v_mfma_f32_16x16x32_bf16 v[40:43], v[196:199], v[56:59], v[40:43]
    s_waitcnt lgkmcnt(3)
    v_mul_f32 v82, v82, v22
    v_mul_f32 v83, v83, v23
    v_mfma_f32_16x16x32_bf16 v[28:31], v[200:203], v[60:63], v[28:31]
    ds_read_b128 v[52:55], v109 offset:0
    v_exp_f32 v80, v80
    v_exp_f32 v81, v81
    v_mfma_f32_16x16x32_bf16 v[32:35], v[204:207], v[60:63], v[32:35]
    v_exp_f32 v82, v82
    v_mfma_f32_16x16x32_bf16 v[36:39], v[200:203], v[64:67], v[36:39]
    ds_read_b128 v[56:59], v106 offset:1024
    v_exp_f32 v83, v83
    v_mfma_f32_16x16x32_bf16 v[40:43], v[204:207], v[64:67], v[40:43]
    s_waitcnt lgkmcnt(3)
    v_add_f32 v80, 1.0, v80
    v_add_f32 v81, 1.0, v81
    v_mfma_f32_16x16x32_bf16 v[28:31], v[208:211], v[68:71], v[28:31]
    ds_read_b128 v[60:63], v107 offset:1024
    v_add_f32 v82, 1.0, v82
    v_add_f32 v83, 1.0, v83
    v_mfma_f32_16x16x32_bf16 v[32:35], v[212:215], v[68:71], v[32:35]
    s_add_u32 s37, s35, 368640
    s_add_u32 m0, s36, 122880
    s_nop 0
    buffer_load_dwordx4 v97, s[8:11], s37 offen offset:0 lds
    v_rcp_f32 v80, v80
    v_mfma_f32_16x16x32_bf16 v[36:39], v[208:211], v[44:47], v[36:39]
    ds_read_b128 v[64:67], v108 offset:1024
    v_rcp_f32 v81, v81
    v_mfma_f32_16x16x32_bf16 v[40:43], v[212:215], v[44:47], v[40:43]
    s_waitcnt lgkmcnt(3)
    v_rcp_f32 v82, v82
    v_rcp_f32 v83, v83
    v_mfma_f32_16x16x32_bf16 v[28:31], v[216:219], v[48:51], v[28:31]
    ds_read_b128 v[68:71], v109 offset:1024
    v_mul_f32 v80, v80, v20
    v_mfma_f32_16x16x32_bf16 v[32:35], v[220:223], v[48:51], v[32:35]
    v_mul_f32 v81, v81, v21
    v_mul_f32 v82, v82, v22
    v_mul_f32 v83, v83, v23
    v_mfma_f32_16x16x32_bf16 v[36:39], v[216:219], v[52:55], v[36:39]
    ds_read_b128 v[44:47], v106 offset:2048
    v_cvt_pk_bf16_f32 v92, v80, v81
    v_cvt_pk_bf16_f32 v93, v82, v83
    v_mfma_f32_16x16x32_bf16 v[40:43], v[220:223], v[52:55], v[40:43]
    s_waitcnt lgkmcnt(3)
    v_mul_f32 v84, v24, v24
    v_mul_f32 v85, v25, v25
    v_mfma_f32_16x16x32_bf16 v[28:31], v[224:227], v[56:59], v[28:31]
    ds_read_b128 v[48:51], v107 offset:2048
    v_mul_f32 v86, v26, v26
    v_mul_f32 v87, v27, v27
    v_fmaak_f32 v84, v84, v111, 0xc0135761
    v_mfma_f32_16x16x32_bf16 v[32:35], v[228:231], v[56:59], v[32:35]
    s_add_u32 m0, s36, 123776
    s_nop 0
    buffer_load_dwordx4 v97, s[8:11], s37 offen offset:128 lds
    v_fmaak_f32 v85, v85, v111, 0xc0135761
    v_fmaak_f32 v86, v86, v111, 0xc0135761
    v_mfma_f32_16x16x32_bf16 v[36:39], v[224:227], v[60:63], v[36:39]
    ds_read_b128 v[52:55], v108 offset:2048
    v_fmaak_f32 v87, v87, v111, 0xc0135761
    v_mul_f32 v84, v84, v24
    v_mfma_f32_16x16x32_bf16 v[40:43], v[228:231], v[60:63], v[40:43]
    s_waitcnt lgkmcnt(3)
    v_mul_f32 v85, v85, v25
    v_mul_f32 v86, v86, v26
    v_mfma_f32_16x16x32_bf16 v[28:31], v[232:235], v[64:67], v[28:31]
    ds_read_b128 v[56:59], v109 offset:2048
    v_mul_f32 v87, v87, v27
    v_exp_f32 v84, v84
    v_mfma_f32_16x16x32_bf16 v[32:35], v[236:239], v[64:67], v[32:35]
    v_exp_f32 v85, v85
    v_mfma_f32_16x16x32_bf16 v[36:39], v[232:235], v[68:71], v[36:39]
    s_waitcnt vmcnt(10)
    s_barrier
    ds_read_b128 v[60:63], v98 offset:0
    v_exp_f32 v86, v86
    v_mfma_f32_16x16x32_bf16 v[40:43], v[236:239], v[68:71], v[40:43]
    s_waitcnt lgkmcnt(3)
    v_exp_f32 v87, v87
    v_add_f32 v84, 1.0, v84
    v_mfma_f32_16x16x32_bf16 v[28:31], v[240:243], v[44:47], v[28:31]
    ds_read_b128 v[64:67], v99 offset:0
    v_add_f32 v85, 1.0, v85
    v_add_f32 v86, 1.0, v86
    v_mfma_f32_16x16x32_bf16 v[32:35], v[244:247], v[44:47], v[32:35]
    s_add_u32 m0, s36, 124672
    s_nop 0
    buffer_load_dwordx4 v97, s[8:11], s37 offen offset:256 lds
    v_add_f32 v87, 1.0, v87
    v_rcp_f32 v84, v84
    v_mfma_f32_16x16x32_bf16 v[36:39], v[240:243], v[48:51], v[36:39]
    ds_read_b128 v[68:71], v100 offset:0
    v_rcp_f32 v85, v85
    v_mfma_f32_16x16x32_bf16 v[40:43], v[244:247], v[48:51], v[40:43]
    s_waitcnt lgkmcnt(3)
    v_rcp_f32 v86, v86
    v_mfma_f32_16x16x32_bf16 v[28:31], v[248:251], v[52:55], v[28:31]
    ds_read_b128 v[44:47], v101 offset:0
    v_rcp_f32 v87, v87
    v_mfma_f32_16x16x32_bf16 v[32:35], v[252:255], v[52:55], v[32:35]
    v_mul_f32 v84, v84, v24
    v_mul_f32 v85, v85, v25
    v_mfma_f32_16x16x32_bf16 v[36:39], v[248:251], v[56:59], v[36:39]
    ds_read_b128 v[48:51], v98 offset:1024
    v_mul_f32 v86, v86, v26
    v_mul_f32 v87, v87, v27
    v_cvt_pk_bf16_f32 v94, v84, v85
    v_mfma_f32_16x16x32_bf16 v[40:43], v[252:255], v[56:59], v[40:43]
    s_waitcnt lgkmcnt(3)
    v_cvt_pk_bf16_f32 v95, v86, v87
    buffer_store_dwordx4 v[92:95], v10, s[20:23], s45 offen sc1
    v_mfma_f32_16x16x32_bf16 v[12:15], v[112:115], v[60:63], 0
    ds_read_b128 v[52:55], v99 offset:1024
    v_mfma_f32_16x16x32_bf16 v[16:19], v[116:119], v[60:63], 0
    s_add_u32 s37, s35, 369024
    s_add_u32 m0, s36, 73728
    s_nop 0
    buffer_load_dwordx4 v97, s[8:11], s37 offen offset:0 lds
    v_mfma_f32_16x16x32_bf16 v[20:23], v[112:115], v[64:67], 0
    ds_read_b128 v[56:59], v100 offset:1024
    v_mfma_f32_16x16x32_bf16 v[24:27], v[116:119], v[64:67], 0
    s_waitcnt lgkmcnt(3)
    v_mfma_f32_16x16x32_bf16 v[12:15], v[120:123], v[68:71], v[12:15]
    ds_read_b128 v[60:63], v101 offset:1024
    s_add_u32 s45, s42, 6
    s_mul_i32 s45, s45, 184320
    v_mfma_f32_16x16x32_bf16 v[16:19], v[124:127], v[68:71], v[16:19]
    v_mul_f32 v80, v28, v28
    v_mul_f32 v81, v29, v29
    v_mul_f32 v82, v30, v30
    v_mfma_f32_16x16x32_bf16 v[20:23], v[120:123], v[44:47], v[20:23]
    ds_read_b128 v[64:67], v98 offset:2048
    v_mul_f32 v83, v31, v31
    v_fmaak_f32 v80, v80, v111, 0xc0135761
    v_mfma_f32_16x16x32_bf16 v[24:27], v[124:127], v[44:47], v[24:27]
    s_waitcnt lgkmcnt(3)
    v_fmaak_f32 v81, v81, v111, 0xc0135761
    v_fmaak_f32 v82, v82, v111, 0xc0135761
    v_mfma_f32_16x16x32_bf16 v[12:15], v[128:131], v[48:51], v[12:15]
    ds_read_b128 v[68:71], v99 offset:2048
    v_fmaak_f32 v83, v83, v111, 0xc0135761
    v_mul_f32 v80, v80, v28
    v_mfma_f32_16x16x32_bf16 v[16:19], v[132:135], v[48:51], v[16:19]
    s_add_u32 m0, s36, 74624
    s_nop 0
    buffer_load_dwordx4 v97, s[8:11], s37 offen offset:128 lds
    v_mul_f32 v81, v81, v29
    v_mul_f32 v82, v82, v30
    v_mul_f32 v83, v83, v31
    v_mfma_f32_16x16x32_bf16 v[20:23], v[128:131], v[52:55], v[20:23]
    ds_read_b128 v[44:47], v100 offset:2048
    v_exp_f32 v80, v80
    v_mfma_f32_16x16x32_bf16 v[24:27], v[132:135], v[52:55], v[24:27]
    s_waitcnt lgkmcnt(3)
    v_exp_f32 v81, v81
    v_mfma_f32_16x16x32_bf16 v[12:15], v[136:139], v[56:59], v[12:15]
    ds_read_b128 v[48:51], v101 offset:2048
    v_exp_f32 v82, v82
    v_mfma_f32_16x16x32_bf16 v[16:19], v[140:143], v[56:59], v[16:19]
    v_exp_f32 v83, v83
    v_add_f32 v80, 1.0, v80
    v_mfma_f32_16x16x32_bf16 v[20:23], v[136:139], v[60:63], v[20:23]
    s_waitcnt vmcnt(10)
    s_barrier
    ds_read_b128 v[52:55], v98 offset:24576
    v_add_f32 v81, 1.0, v81
    v_add_f32 v82, 1.0, v82
    v_mfma_f32_16x16x32_bf16 v[24:27], v[140:143], v[60:63], v[24:27]
    s_waitcnt lgkmcnt(3)
    v_add_f32 v83, 1.0, v83
    v_rcp_f32 v80, v80
    v_mfma_f32_16x16x32_bf16 v[12:15], v[144:147], v[64:67], v[12:15]
    ds_read_b128 v[56:59], v99 offset:24576
    v_rcp_f32 v81, v81
    v_mfma_f32_16x16x32_bf16 v[16:19], v[148:151], v[64:67], v[16:19]
    s_add_u32 m0, s36, 75520
    s_nop 0
    buffer_load_dwordx4 v97, s[8:11], s37 offen offset:256 lds
    v_rcp_f32 v82, v82
    v_mfma_f32_16x16x32_bf16 v[20:23], v[144:147], v[68:71], v[20:23]
    ds_read_b128 v[60:63], v100 offset:24576
    v_rcp_f32 v83, v83
    v_mfma_f32_16x16x32_bf16 v[24:27], v[148:151], v[68:71], v[24:27]
    s_waitcnt lgkmcnt(3)
    v_mul_f32 v80, v80, v28
    v_mul_f32 v81, v81, v29
    v_mul_f32 v82, v82, v30
    v_mfma_f32_16x16x32_bf16 v[12:15], v[152:155], v[44:47], v[12:15]
    ds_read_b128 v[64:67], v101 offset:24576
    v_mul_f32 v83, v83, v31
    v_cvt_pk_bf16_f32 v88, v80, v81
    v_mfma_f32_16x16x32_bf16 v[16:19], v[156:159], v[44:47], v[16:19]
    v_cvt_pk_bf16_f32 v89, v82, v83
    v_mul_f32 v84, v32, v32
    v_mfma_f32_16x16x32_bf16 v[20:23], v[152:155], v[48:51], v[20:23]
    ds_read_b128 v[68:71], v98 offset:25600
    v_mul_f32 v85, v33, v33
    v_mul_f32 v86, v34, v34
    v_mul_f32 v87, v35, v35
    v_mfma_f32_16x16x32_bf16 v[24:27], v[156:159], v[48:51], v[24:27]
    s_waitcnt lgkmcnt(3)
    v_fmaak_f32 v84, v84, v111, 0xc0135761
    v_fmaak_f32 v85, v85, v111, 0xc0135761
    v_mfma_f32_16x16x32_bf16 v[12:15], v[160:163], v[52:55], v[12:15]
    ds_read_b128 v[44:47], v99 offset:25600
    v_fmaak_f32 v86, v86, v111, 0xc0135761
    v_fmaak_f32 v87, v87, v111, 0xc0135761
    v_mfma_f32_16x16x32_bf16 v[16:19], v[164:167], v[52:55], v[16:19]
    s_add_u32 s37, s35, 369408
    s_add_u32 m0, s36, 98304
    s_nop 0
    buffer_load_dwordx4 v97, s[8:11], s37 offen offset:0 lds
    v_mul_f32 v84, v84, v32
    v_mul_f32 v85, v85, v33
    v_mfma_f32_16x16x32_bf16 v[20:23], v[160:163], v[56:59], v[20:23]
    ds_read_b128 v[48:51], v100 offset:25600
    v_mul_f32 v86, v86, v34
    v_mul_f32 v87, v87, v35
    v_mfma_f32_16x16x32_bf16 v[24:27], v[164:167], v[56:59], v[24:27]
    s_waitcnt lgkmcnt(3)
    v_exp_f32 v84, v84
    v_exp_f32 v85, v85
    v_mfma_f32_16x16x32_bf16 v[12:15], v[168:171], v[60:63], v[12:15]
    ds_read_b128 v[52:55], v101 offset:25600
    v_exp_f32 v86, v86
    v_mfma_f32_16x16x32_bf16 v[16:19], v[172:175], v[60:63], v[16:19]
    v_exp_f32 v87, v87
    v_mfma_f32_16x16x32_bf16 v[20:23], v[168:171], v[64:67], v[20:23]
    ds_read_b128 v[56:59], v98 offset:26624
    v_add_f32 v84, 1.0, v84
    v_add_f32 v85, 1.0, v85
    v_mfma_f32_16x16x32_bf16 v[24:27], v[172:175], v[64:67], v[24:27]
    s_waitcnt lgkmcnt(3)
    v_add_f32 v86, 1.0, v86
    v_add_f32 v87, 1.0, v87
    v_mfma_f32_16x16x32_bf16 v[12:15], v[176:179], v[68:71], v[12:15]
    ds_read_b128 v[60:63], v99 offset:26624
    v_rcp_f32 v84, v84
    v_mfma_f32_16x16x32_bf16 v[16:19], v[180:183], v[68:71], v[16:19]
    s_add_u32 m0, s36, 99200
    s_nop 0
    buffer_load_dwordx4 v97, s[8:11], s37 offen offset:128 lds
    v_rcp_f32 v85, v85
    v_mfma_f32_16x16x32_bf16 v[20:23], v[176:179], v[44:47], v[20:23]
    ds_read_b128 v[64:67], v100 offset:26624
    v_rcp_f32 v86, v86
    v_rcp_f32 v87, v87
    v_mfma_f32_16x16x32_bf16 v[24:27], v[180:183], v[44:47], v[24:27]
    s_waitcnt lgkmcnt(3)
    v_mul_f32 v84, v84, v32
    v_mfma_f32_16x16x32_bf16 v[12:15], v[184:187], v[48:51], v[12:15]
    ds_read_b128 v[68:71], v101 offset:26624
    v_mul_f32 v85, v85, v33
    v_mul_f32 v86, v86, v34
    v_mul_f32 v87, v87, v35
    v_mfma_f32_16x16x32_bf16 v[16:19], v[188:191], v[48:51], v[16:19]
    v_cvt_pk_bf16_f32 v90, v84, v85
    v_cvt_pk_bf16_f32 v91, v86, v87
    v_mfma_f32_16x16x32_bf16 v[20:23], v[184:187], v[52:55], v[20:23]
    s_waitcnt vmcnt(9)
    s_barrier
    ds_read_b128 v[44:47], v102 offset:0
    buffer_store_dwordx4 v[88:91], v110, s[20:23], s45 offen sc1
    v_mul_f32 v80, v36, v36
    v_mfma_f32_16x16x32_bf16 v[24:27], v[188:191], v[52:55], v[24:27]
    s_waitcnt lgkmcnt(3)
    v_mul_f32 v81, v37, v37
    v_mul_f32 v82, v38, v38
    v_mul_f32 v83, v39, v39
    v_mfma_f32_16x16x32_bf16 v[12:15], v[192:195], v[56:59], v[12:15]
    ds_read_b128 v[48:51], v103 offset:0
    v_fmaak_f32 v80, v80, v111, 0xc0135761
    v_fmaak_f32 v81, v81, v111, 0xc0135761
    v_mfma_f32_16x16x32_bf16 v[16:19], v[196:199], v[56:59], v[16:19]
    s_add_u32 m0, s36, 100096
    s_nop 0
    buffer_load_dwordx4 v97, s[8:11], s37 offen offset:256 lds
    v_fmaak_f32 v82, v82, v111, 0xc0135761
    v_fmaak_f32 v83, v83, v111, 0xc0135761
    v_mfma_f32_16x16x32_bf16 v[20:23], v[192:195], v[60:63], v[20:23]
    ds_read_b128 v[52:55], v104 offset:0
    v_mul_f32 v80, v80, v36
    v_mul_f32 v81, v81, v37
    v_mfma_f32_16x16x32_bf16 v[24:27], v[196:199], v[60:63], v[24:27]
    s_waitcnt lgkmcnt(3)
    v_mul_f32 v82, v82, v38
    v_mul_f32 v83, v83, v39
    v_mfma_f32_16x16x32_bf16 v[12:15], v[200:203], v[64:67], v[12:15]
    ds_read_b128 v[56:59], v105 offset:0
    v_exp_f32 v80, v80
    v_exp_f32 v81, v81
    v_mfma_f32_16x16x32_bf16 v[16:19], v[204:207], v[64:67], v[16:19]
    v_exp_f32 v82, v82
    v_mfma_f32_16x16x32_bf16 v[20:23], v[200:203], v[68:71], v[20:23]
    ds_read_b128 v[60:63], v102 offset:1024
    v_exp_f32 v83, v83
    v_mfma_f32_16x16x32_bf16 v[24:27], v[204:207], v[68:71], v[24:27]
    s_waitcnt lgkmcnt(3)
    v_add_f32 v80, 1.0, v80
    v_add_f32 v81, 1.0, v81
    v_mfma_f32_16x16x32_bf16 v[12:15], v[208:211], v[44:47], v[12:15]
    ds_read_b128 v[64:67], v103 offset:1024
    v_add_f32 v82, 1.0, v82
    v_add_f32 v83, 1.0, v83
    v_mfma_f32_16x16x32_bf16 v[16:19], v[212:215], v[44:47], v[16:19]
    s_add_u32 s37, s33, 0
    s_add_u32 m0, s36, 0
    s_nop 0
    buffer_load_dwordx4 v97, s[8:11], s37 offen offset:0 lds
    v_rcp_f32 v80, v80
    v_mfma_f32_16x16x32_bf16 v[20:23], v[208:211], v[48:51], v[20:23]
    ds_read_b128 v[68:71], v104 offset:1024
    v_rcp_f32 v81, v81
    v_mfma_f32_16x16x32_bf16 v[24:27], v[212:215], v[48:51], v[24:27]
    s_waitcnt lgkmcnt(3)
    v_rcp_f32 v82, v82
    v_rcp_f32 v83, v83
    v_mfma_f32_16x16x32_bf16 v[12:15], v[216:219], v[52:55], v[12:15]
    ds_read_b128 v[44:47], v105 offset:1024
    v_mul_f32 v80, v80, v36
    v_mfma_f32_16x16x32_bf16 v[16:19], v[220:223], v[52:55], v[16:19]
    v_mul_f32 v81, v81, v37
    v_mul_f32 v82, v82, v38
    v_mul_f32 v83, v83, v39
    v_mfma_f32_16x16x32_bf16 v[20:23], v[216:219], v[56:59], v[20:23]
    ds_read_b128 v[48:51], v102 offset:2048
    v_cvt_pk_bf16_f32 v92, v80, v81
    v_cvt_pk_bf16_f32 v93, v82, v83
    v_mfma_f32_16x16x32_bf16 v[24:27], v[220:223], v[56:59], v[24:27]
    s_waitcnt lgkmcnt(3)
    v_mul_f32 v84, v40, v40
    v_mul_f32 v85, v41, v41
    v_mfma_f32_16x16x32_bf16 v[12:15], v[224:227], v[60:63], v[12:15]
    ds_read_b128 v[52:55], v103 offset:2048
    v_mul_f32 v86, v42, v42
    v_mul_f32 v87, v43, v43
    v_fmaak_f32 v84, v84, v111, 0xc0135761
    v_mfma_f32_16x16x32_bf16 v[16:19], v[228:231], v[60:63], v[16:19]
    s_add_u32 m0, s36, 896
    s_nop 0
    buffer_load_dwordx4 v97, s[8:11], s37 offen offset:128 lds
    v_fmaak_f32 v85, v85, v111, 0xc0135761
    v_fmaak_f32 v86, v86, v111, 0xc0135761
    v_mfma_f32_16x16x32_bf16 v[20:23], v[224:227], v[64:67], v[20:23]
    ds_read_b128 v[56:59], v104 offset:2048
    v_fmaak_f32 v87, v87, v111, 0xc0135761
    v_mul_f32 v84, v84, v40
    v_mfma_f32_16x16x32_bf16 v[24:27], v[228:231], v[64:67], v[24:27]
    s_waitcnt lgkmcnt(3)
    v_mul_f32 v85, v85, v41
    v_mul_f32 v86, v86, v42
    v_mfma_f32_16x16x32_bf16 v[12:15], v[232:235], v[68:71], v[12:15]
    ds_read_b128 v[60:63], v105 offset:2048
    v_mul_f32 v87, v87, v43
    v_exp_f32 v84, v84
    v_mfma_f32_16x16x32_bf16 v[16:19], v[236:239], v[68:71], v[16:19]
    v_exp_f32 v85, v85
    v_mfma_f32_16x16x32_bf16 v[20:23], v[232:235], v[44:47], v[20:23]
    s_waitcnt vmcnt(10)
    s_barrier
    ds_read_b128 v[64:67], v106 offset:24576
    v_exp_f32 v86, v86
    v_mfma_f32_16x16x32_bf16 v[24:27], v[236:239], v[44:47], v[24:27]
    s_waitcnt lgkmcnt(3)
    v_exp_f32 v87, v87
    v_add_f32 v84, 1.0, v84
    v_mfma_f32_16x16x32_bf16 v[12:15], v[240:243], v[48:51], v[12:15]
    ds_read_b128 v[68:71], v107 offset:24576
    v_add_f32 v85, 1.0, v85
    v_add_f32 v86, 1.0, v86
    v_mfma_f32_16x16x32_bf16 v[16:19], v[244:247], v[48:51], v[16:19]
    s_add_u32 m0, s36, 1792
    s_nop 0
    buffer_load_dwordx4 v97, s[8:11], s37 offen offset:256 lds
    v_add_f32 v87, 1.0, v87
    v_rcp_f32 v84, v84
    v_mfma_f32_16x16x32_bf16 v[20:23], v[240:243], v[52:55], v[20:23]
    ds_read_b128 v[44:47], v108 offset:24576
    v_rcp_f32 v85, v85
    v_mfma_f32_16x16x32_bf16 v[24:27], v[244:247], v[52:55], v[24:27]
    s_waitcnt lgkmcnt(3)
    v_rcp_f32 v86, v86
    v_mfma_f32_16x16x32_bf16 v[12:15], v[248:251], v[56:59], v[12:15]
    ds_read_b128 v[48:51], v109 offset:24576
    v_rcp_f32 v87, v87
    v_mfma_f32_16x16x32_bf16 v[16:19], v[252:255], v[56:59], v[16:19]
    v_mul_f32 v84, v84, v40
    v_mul_f32 v85, v85, v41
    v_mfma_f32_16x16x32_bf16 v[20:23], v[248:251], v[60:63], v[20:23]
    ds_read_b128 v[52:55], v106 offset:25600
    v_mul_f32 v86, v86, v42
    v_mul_f32 v87, v87, v43
    v_cvt_pk_bf16_f32 v94, v84, v85
    v_mfma_f32_16x16x32_bf16 v[24:27], v[252:255], v[60:63], v[24:27]
    s_waitcnt lgkmcnt(3)
    v_cvt_pk_bf16_f32 v95, v86, v87
    buffer_store_dwordx4 v[92:95], v10, s[20:23], s45 offen sc1
    v_mfma_f32_16x16x32_bf16 v[28:31], v[112:115], v[64:67], 0
    ds_read_b128 v[56:59], v107 offset:25600
    v_mfma_f32_16x16x32_bf16 v[32:35], v[116:119], v[64:67], 0
    s_add_u32 s37, s33, 384
    s_add_u32 m0, s36, 24576
    s_nop 0
    buffer_load_dwordx4 v97, s[8:11], s37 offen offset:0 lds
    v_mfma_f32_16x16x32_bf16 v[36:39], v[112:115], v[68:71], 0
    ds_read_b128 v[60:63], v108 offset:25600
    v_mfma_f32_16x16x32_bf16 v[40:43], v[116:119], v[68:71], 0
    s_add_u32 m0, s36, 25472
    s_nop 0
    buffer_load_dwordx4 v97, s[8:11], s37 offen offset:128 lds
    s_waitcnt lgkmcnt(4)
    v_mfma_f32_16x16x32_bf16 v[28:31], v[120:123], v[44:47], v[28:31]
    ds_read_b128 v[64:67], v109 offset:25600
    s_add_u32 s45, s42, 8
    s_mul_i32 s45, s45, 184320
    v_mfma_f32_16x16x32_bf16 v[32:35], v[124:127], v[44:47], v[32:35]
    s_add_u32 m0, s36, 26368
    s_nop 0
    buffer_load_dwordx4 v97, s[8:11], s37 offen offset:256 lds
    v_mul_f32 v80, v12, v12
    v_mul_f32 v81, v13, v13
    v_mul_f32 v82, v14, v14
    s_waitcnt lgkmcnt(4)
    v_mfma_f32_16x16x32_bf16 v[36:39], v[120:123], v[48:51], v[36:39]
    ds_read_b128 v[68:71], v106 offset:26624
    v_mul_f32 v83, v15, v15
    v_fmaak_f32 v80, v80, v111, 0xc0135761
    v_mfma_f32_16x16x32_bf16 v[40:43], v[124:127], v[48:51], v[40:43]
    s_waitcnt lgkmcnt(3)
    v_fmaak_f32 v81, v81, v111, 0xc0135761
    v_fmaak_f32 v82, v82, v111, 0xc0135761
    v_mfma_f32_16x16x32_bf16 v[28:31], v[128:131], v[52:55], v[28:31]
    ds_read_b128 v[44:47], v107 offset:26624
    v_fmaak_f32 v83, v83, v111, 0xc0135761
    v_mul_f32 v80, v80, v12
    v_mfma_f32_16x16x32_bf16 v[32:35], v[132:135], v[52:55], v[32:35]
    v_mul_f32 v81, v81, v13
    v_mul_f32 v82, v82, v14
    v_mul_f32 v83, v83, v15
    v_mfma_f32_16x16x32_bf16 v[36:39], v[128:131], v[56:59], v[36:39]
    ds_read_b128 v[48:51], v108 offset:26624
    v_exp_f32 v80, v80
    v_mfma_f32_16x16x32_bf16 v[40:43], v[132:135], v[56:59], v[40:43]
    s_waitcnt lgkmcnt(3)
    v_exp_f32 v81, v81
    v_mfma_f32_16x16x32_bf16 v[28:31], v[136:139], v[60:63], v[28:31]
    ds_read_b128 v[52:55], v109 offset:26624
    v_exp_f32 v82, v82
    v_mfma_f32_16x16x32_bf16 v[32:35], v[140:143], v[60:63], v[32:35]
    v_exp_f32 v83, v83
    v_add_f32 v80, 1.0, v80
    v_mfma_f32_16x16x32_bf16 v[36:39], v[136:139], v[64:67], v[36:39]
    s_waitcnt vmcnt(11)
    s_barrier
    ds_read_b128 v[56:59], v102 offset:24576
    v_add_f32 v81, 1.0, v81
    v_add_f32 v82, 1.0, v82
    v_mfma_f32_16x16x32_bf16 v[40:43], v[140:143], v[64:67], v[40:43]
    s_waitcnt lgkmcnt(3)
    v_add_f32 v83, 1.0, v83
    v_rcp_f32 v80, v80
    v_mfma_f32_16x16x32_bf16 v[28:31], v[144:147], v[68:71], v[28:31]
    ds_read_b128 v[60:63], v103 offset:24576
    v_rcp_f32 v81, v81
    v_mfma_f32_16x16x32_bf16 v[32:35], v[148:151], v[68:71], v[32:35]
    s_add_u32 s37, s33, 768
    s_add_u32 m0, s36, 49152
    s_nop 0
    buffer_load_dwordx4 v97, s[8:11], s37 offen offset:0 lds
    v_rcp_f32 v82, v82
    v_mfma_f32_16x16x32_bf16 v[36:39], v[144:147], v[44:47], v[36:39]
    ds_read_b128 v[64:67], v104 offset:24576
    v_rcp_f32 v83, v83
    v_mfma_f32_16x16x32_bf16 v[40:43], v[148:151], v[44:47], v[40:43]
    s_add_u32 m0, s36, 50048
    s_nop 0
    buffer_load_dwordx4 v97, s[8:11], s37 offen offset:128 lds
    v_mul_f32 v80, v80, v12
    v_mul_f32 v81, v81, v13
    v_mul_f32 v82, v82, v14
    s_waitcnt lgkmcnt(4)
    v_mfma_f32_16x16x32_bf16 v[28:31], v[152:155], v[48:51], v[28:31]
    ds_read_b128 v[68:71], v105 offset:24576
    v_mul_f32 v83, v83, v15
    v_cvt_pk_bf16_f32 v88, v80, v81
    v_mfma_f32_16x16x32_bf16 v[32:35], v[156:159], v[48:51], v[32:35]
    s_add_u32 m0, s36, 50944
    s_nop 0
    buffer_load_dwordx4 v97, s[8:11], s37 offen offset:256 lds
    v_cvt_pk_bf16_f32 v89, v82, v83
    v_mul_f32 v84, v16, v16
    s_waitcnt lgkmcnt(4)
    v_mfma_f32_16x16x32_bf16 v[36:39], v[152:155], v[52:55], v[36:39]
    ds_read_b128 v[44:47], v102 offset:25600
    v_mul_f32 v85, v17, v17
    v_mul_f32 v86, v18, v18
    v_mul_f32 v87, v19, v19
    v_mfma_f32_16x16x32_bf16 v[40:43], v[156:159], v[52:55], v[40:43]
    s_waitcnt lgkmcnt(3)
    v_fmaak_f32 v84, v84, v111, 0xc0135761
    v_fmaak_f32 v85, v85, v111, 0xc0135761
    v_mfma_f32_16x16x32_bf16 v[28:31], v[160:163], v[56:59], v[28:31]
    ds_read_b128 v[48:51], v103 offset:25600
    v_fmaak_f32 v86, v86, v111, 0xc0135761
    v_fmaak_f32 v87, v87, v111, 0xc0135761
    v_mfma_f32_16x16x32_bf16 v[32:35], v[164:167], v[56:59], v[32:35]
    v_mul_f32 v84, v84, v16
    v_mul_f32 v85, v85, v17
    v_mfma_f32_16x16x32_bf16 v[36:39], v[160:163], v[60:63], v[36:39]
    ds_read_b128 v[52:55], v104 offset:25600
    v_mul_f32 v86, v86, v18
    v_mul_f32 v87, v87, v19
    v_mfma_f32_16x16x32_bf16 v[40:43], v[164:167], v[60:63], v[40:43]
    s_waitcnt lgkmcnt(3)
    v_exp_f32 v84, v84
    v_exp_f32 v85, v85
    v_mfma_f32_16x16x32_bf16 v[28:31], v[168:171], v[64:67], v[28:31]
    ds_read_b128 v[56:59], v105 offset:25600
    v_exp_f32 v86, v86
    v_mfma_f32_16x16x32_bf16 v[32:35], v[172:175], v[64:67], v[32:35]
    v_exp_f32 v87, v87
    v_mfma_f32_16x16x32_bf16 v[36:39], v[168:171], v[68:71], v[36:39]
    ds_read_b128 v[60:63], v102 offset:26624
    v_add_f32 v84, 1.0, v84
    v_add_f32 v85, 1.0, v85
    v_mfma_f32_16x16x32_bf16 v[40:43], v[172:175], v[68:71], v[40:43]
    s_waitcnt lgkmcnt(3)
    v_add_f32 v86, 1.0, v86
    v_add_f32 v87, 1.0, v87
    v_mfma_f32_16x16x32_bf16 v[28:31], v[176:179], v[44:47], v[28:31]
    ds_read_b128 v[64:67], v103 offset:26624
    v_rcp_f32 v84, v84
    v_mfma_f32_16x16x32_bf16 v[32:35], v[180:183], v[44:47], v[32:35]
    v_rcp_f32 v85, v85
    v_mfma_f32_16x16x32_bf16 v[36:39], v[176:179], v[48:51], v[36:39]
    ds_read_b128 v[68:71], v104 offset:26624
    v_rcp_f32 v86, v86
    v_rcp_f32 v87, v87
    v_mfma_f32_16x16x32_bf16 v[40:43], v[180:183], v[48:51], v[40:43]
    s_waitcnt lgkmcnt(3)
    v_mul_f32 v84, v84, v16
    v_mfma_f32_16x16x32_bf16 v[28:31], v[184:187], v[52:55], v[28:31]
    ds_read_b128 v[44:47], v105 offset:26624
    v_mul_f32 v85, v85, v17
    v_mul_f32 v86, v86, v18
    v_mul_f32 v87, v87, v19
    v_mfma_f32_16x16x32_bf16 v[32:35], v[188:191], v[52:55], v[32:35]
    v_cvt_pk_bf16_f32 v90, v84, v85
    v_cvt_pk_bf16_f32 v91, v86, v87
    v_mfma_f32_16x16x32_bf16 v[36:39], v[184:187], v[56:59], v[36:39]
    s_waitcnt vmcnt(10)
    s_barrier
    ds_read_b128 v[48:51], v106 offset:0
    buffer_store_dwordx4 v[88:91], v110, s[20:23], s45 offen sc1
    v_mul_f32 v80, v20, v20
    v_mfma_f32_16x16x32_bf16 v[40:43], v[188:191], v[56:59], v[40:43]
    s_waitcnt lgkmcnt(3)
    v_mul_f32 v81, v21, v21
    v_mul_f32 v82, v22, v22
    v_mul_f32 v83, v23, v23
    v_mfma_f32_16x16x32_bf16 v[28:31], v[192:195], v[60:63], v[28:31]
    ds_read_b128 v[52:55], v107 offset:0
    v_fmaak_f32 v80, v80, v111, 0xc0135761
    v_fmaak_f32 v81, v81, v111, 0xc0135761
    v_mfma_f32_16x16x32_bf16 v[32:35], v[196:199], v[60:63], v[32:35]
    v_fmaak_f32 v82, v82, v111, 0xc0135761
    v_fmaak_f32 v83, v83, v111, 0xc0135761
    v_mfma_f32_16x16x32_bf16 v[36:39], v[192:195], v[64:67], v[36:39]
    ds_read_b128 v[56:59], v108 offset:0
    v_mul_f32 v80, v80, v20
    v_mul_f32 v81, v81, v21
    v_mfma_f32_16x16x32_bf16 v[40:43], v[196:199], v[64:67], v[40:43]
    s_waitcnt lgkmcnt(3)
    v_mul_f32 v82, v82, v22
    v_mul_f32 v83, v83, v23
    v_mfma_f32_16x16x32_bf16 v[28:31], v[200:203], v[68:71], v[28:31]
    ds_read_b128 v[60:63], v109 offset:0
    v_exp_f32 v80, v80
    v_exp_f32 v81, v81
    v_mfma_f32_16x16x32_bf16 v[32:35], v[204:207], v[68:71], v[32:35]
    v_exp_f32 v82, v82
    v_mfma_f32_16x16x32_bf16 v[36:39], v[200:203], v[44:47], v[36:39]
    ds_read_b128 v[64:67], v106 offset:1024
    v_exp_f32 v83, v83
    v_mfma_f32_16x16x32_bf16 v[40:43], v[204:207], v[44:47], v[40:43]
    s_waitcnt lgkmcnt(3)
    v_add_f32 v80, 1.0, v80
    v_add_f32 v81, 1.0, v81
    v_mfma_f32_16x16x32_bf16 v[28:31], v[208:211], v[48:51], v[28:31]
    ds_read_b128 v[68:71], v107 offset:1024
    v_add_f32 v82, 1.0, v82
    v_add_f32 v83, 1.0, v83
    v_mfma_f32_16x16x32_bf16 v[32:35], v[212:215], v[48:51], v[32:35]
    v_rcp_f32 v80, v80
    v_mfma_f32_16x16x32_bf16 v[36:39], v[208:211], v[52:55], v[36:39]
    ds_read_b128 v[44:47], v108 offset:1024
    v_rcp_f32 v81, v81
    v_mfma_f32_16x16x32_bf16 v[40:43], v[212:215], v[52:55], v[40:43]
    s_waitcnt lgkmcnt(3)
    v_rcp_f32 v82, v82
    v_rcp_f32 v83, v83
    v_mfma_f32_16x16x32_bf16 v[28:31], v[216:219], v[56:59], v[28:31]
    ds_read_b128 v[48:51], v109 offset:1024
    v_mul_f32 v80, v80, v20
    v_mfma_f32_16x16x32_bf16 v[32:35], v[220:223], v[56:59], v[32:35]
    v_mul_f32 v81, v81, v21
    v_mul_f32 v82, v82, v22
    v_mul_f32 v83, v83, v23
    v_mfma_f32_16x16x32_bf16 v[36:39], v[216:219], v[60:63], v[36:39]
    ds_read_b128 v[52:55], v106 offset:2048
    v_cvt_pk_bf16_f32 v92, v80, v81
    v_cvt_pk_bf16_f32 v93, v82, v83
    v_mfma_f32_16x16x32_bf16 v[40:43], v[220:223], v[60:63], v[40:43]
    s_waitcnt lgkmcnt(3)
    v_mul_f32 v84, v24, v24
    v_mul_f32 v85, v25, v25
    v_mfma_f32_16x16x32_bf16 v[28:31], v[224:227], v[64:67], v[28:31]
    ds_read_b128 v[56:59], v107 offset:2048
    v_mul_f32 v86, v26, v26
    v_mul_f32 v87, v27, v27
    v_fmaak_f32 v84, v84, v111, 0xc0135761
    v_mfma_f32_16x16x32_bf16 v[32:35], v[228:231], v[64:67], v[32:35]
    v_fmaak_f32 v85, v85, v111, 0xc0135761
    v_fmaak_f32 v86, v86, v111, 0xc0135761
    v_mfma_f32_16x16x32_bf16 v[36:39], v[224:227], v[68:71], v[36:39]
    ds_read_b128 v[60:63], v108 offset:2048
    v_fmaak_f32 v87, v87, v111, 0xc0135761
    v_mul_f32 v84, v84, v24
    v_mfma_f32_16x16x32_bf16 v[40:43], v[228:231], v[68:71], v[40:43]
    s_waitcnt lgkmcnt(3)
    v_mul_f32 v85, v85, v25
    v_mul_f32 v86, v86, v26
    v_mfma_f32_16x16x32_bf16 v[28:31], v[232:235], v[44:47], v[28:31]
    ds_read_b128 v[64:67], v109 offset:2048
    v_mul_f32 v87, v87, v27
    v_exp_f32 v84, v84
    v_mfma_f32_16x16x32_bf16 v[32:35], v[236:239], v[44:47], v[32:35]
    v_exp_f32 v85, v85
    v_mfma_f32_16x16x32_bf16 v[36:39], v[232:235], v[48:51], v[36:39]
    s_waitcnt vmcnt(1)
    s_barrier
    v_add_u32 v98, s49, v98
    v_add_u32 v99, s49, v99
    v_add_u32 v100, s49, v100
    v_add_u32 v101, s49, v101
    v_add_u32 v102, s49, v102
    v_add_u32 v103, s49, v103
    v_add_u32 v104, s49, v104
    v_add_u32 v105, s49, v105
    ds_read_b128 v[68:71], v98 offset:0
    v_exp_f32 v86, v86
    v_mfma_f32_16x16x32_bf16 v[40:43], v[236:239], v[48:51], v[40:43]
    s_waitcnt lgkmcnt(3)
    v_exp_f32 v87, v87
    v_add_f32 v84, 1.0, v84
    v_mfma_f32_16x16x32_bf16 v[28:31], v[240:243], v[52:55], v[28:31]
    ds_read_b128 v[44:47], v99 offset:0
    v_add_f32 v85, 1.0, v85
    v_add_f32 v86, 1.0, v86
    v_mfma_f32_16x16x32_bf16 v[32:35], v[244:247], v[52:55], v[32:35]
    v_add_f32 v87, 1.0, v87
    v_rcp_f32 v84, v84
    v_mfma_f32_16x16x32_bf16 v[36:39], v[240:243], v[56:59], v[36:39]
    ds_read_b128 v[48:51], v100 offset:0
    v_rcp_f32 v85, v85
    v_mfma_f32_16x16x32_bf16 v[40:43], v[244:247], v[56:59], v[40:43]
    s_waitcnt lgkmcnt(3)
    v_rcp_f32 v86, v86
    v_mfma_f32_16x16x32_bf16 v[28:31], v[248:251], v[60:63], v[28:31]
    ds_read_b128 v[52:55], v101 offset:0
    v_rcp_f32 v87, v87
    v_mfma_f32_16x16x32_bf16 v[32:35], v[252:255], v[60:63], v[32:35]
    v_mul_f32 v84, v84, v24
    v_mul_f32 v85, v85, v25
    v_mfma_f32_16x16x32_bf16 v[36:39], v[248:251], v[64:67], v[36:39]
    ds_read_b128 v[56:59], v98 offset:1024
    v_mul_f32 v86, v86, v26
    v_mul_f32 v87, v87, v27
    v_cvt_pk_bf16_f32 v94, v84, v85
    v_mfma_f32_16x16x32_bf16 v[40:43], v[252:255], v[64:67], v[40:43]
    s_waitcnt lgkmcnt(3)
    v_cvt_pk_bf16_f32 v95, v86, v87
    buffer_store_dwordx4 v[92:95], v10, s[20:23], s45 offen sc1
    s_cmp_eq_u32 s48, 0
    s_cbranch_scc1 K1_N_fin
    v_mfma_f32_16x16x32_bf16 v[12:15], v[112:115], v[68:71], 0
    ds_read_b128 v[60:63], v99 offset:1024
    v_mfma_f32_16x16x32_bf16 v[16:19], v[116:119], v[68:71], 0
    v_mfma_f32_16x16x32_bf16 v[20:23], v[112:115], v[44:47], 0
    ds_read_b128 v[64:67], v100 offset:1024
    v_mfma_f32_16x16x32_bf16 v[24:27], v[116:119], v[44:47], 0
    s_waitcnt lgkmcnt(3)
    v_mfma_f32_16x16x32_bf16 v[12:15], v[120:123], v[48:51], v[12:15]
    ds_read_b128 v[68:71], v101 offset:1024
    s_add_u32 s45, s42, 10
    s_mul_i32 s45, s45, 184320
    v_mfma_f32_16x16x32_bf16 v[16:19], v[124:127], v[48:51], v[16:19]
    v_mul_f32 v80, v28, v28
    v_mul_f32 v81, v29, v29
    v_mul_f32 v82, v30, v30
    v_mfma_f32_16x16x32_bf16 v[20:23], v[120:123], v[52:55], v[20:23]
    ds_read_b128 v[44:47], v98 offset:2048
    v_mul_f32 v83, v31, v31
    v_fmaak_f32 v80, v80, v111, 0xc0135761
    v_mfma_f32_16x16x32_bf16 v[24:27], v[124:127], v[52:55], v[24:27]
    s_waitcnt lgkmcnt(3)
    v_fmaak_f32 v81, v81, v111, 0xc0135761
    v_fmaak_f32 v82, v82, v111, 0xc0135761
    v_mfma_f32_16x16x32_bf16 v[12:15], v[128:131], v[56:59], v[12:15]
    ds_read_b128 v[48:51], v99 offset:2048
    v_fmaak_f32 v83, v83, v111, 0xc0135761
    v_mul_f32 v80, v80, v28
    v_mfma_f32_16x16x32_bf16 v[16:19], v[132:135], v[56:59], v[16:19]
    v_mul_f32 v81, v81, v29
    v_mul_f32 v82, v82, v30
    v_mul_f32 v83, v83, v31
    v_mfma_f32_16x16x32_bf16 v[20:23], v[128:131], v[60:63], v[20:23]
    ds_read_b128 v[52:55], v100 offset:2048
    v_exp_f32 v80, v80
    v_mfma_f32_16x16x32_bf16 v[24:27], v[132:135], v[60:63], v[24:27]
    s_waitcnt lgkmcnt(3)
    v_exp_f32 v81, v81
    v_mfma_f32_16x16x32_bf16 v[12:15], v[136:139], v[64:67], v[12:15]
    ds_read_b128 v[56:59], v101 offset:2048
    v_exp_f32 v82, v82
    v_mfma_f32_16x16x32_bf16 v[16:19], v[140:143], v[64:67], v[16:19]
    v_exp_f32 v83, v83
    v_add_f32 v80, 1.0, v80
    v_mfma_f32_16x16x32_bf16 v[20:23], v[136:139], v[68:71], v[20:23]
    ds_read_b128 v[60:63], v98 offset:24576
    v_add_f32 v81, 1.0, v81
    v_add_f32 v82, 1.0, v82
    v_mfma_f32_16x16x32_bf16 v[24:27], v[140:143], v[68:71], v[24:27]
    s_waitcnt lgkmcnt(3)
    v_add_f32 v83, 1.0, v83
    v_rcp_f32 v80, v80
    v_mfma_f32_16x16x32_bf16 v[12:15], v[144:147], v[44:47], v[12:15]
    ds_read_b128 v[64:67], v99 offset:24576
    v_rcp_f32 v81, v81
    v_mfma_f32_16x16x32_bf16 v[16:19], v[148:151], v[44:47], v[16:19]
    v_rcp_f32 v82, v82
    v_mfma_f32_16x16x32_bf16 v[20:23], v[144:147], v[48:51], v[20:23]
    ds_read_b128 v[68:71], v100 offset:24576
    v_rcp_f32 v83, v83
    v_mfma_f32_16x16x32_bf16 v[24:27], v[148:151], v[48:51], v[24:27]
    s_waitcnt lgkmcnt(3)
    v_mul_f32 v80, v80, v28
    v_mul_f32 v81, v81, v29
    v_mul_f32 v82, v82, v30
    v_mfma_f32_16x16x32_bf16 v[12:15], v[152:155], v[52:55], v[12:15]
    ds_read_b128 v[44:47], v101 offset:24576
    v_mul_f32 v83, v83, v31
    v_cvt_pk_bf16_f32 v88, v80, v81
    v_mfma_f32_16x16x32_bf16 v[16:19], v[156:159], v[52:55], v[16:19]
    v_cvt_pk_bf16_f32 v89, v82, v83
    v_mul_f32 v84, v32, v32
    v_mfma_f32_16x16x32_bf16 v[20:23], v[152:155], v[56:59], v[20:23]
    ds_read_b128 v[48:51], v98 offset:25600
    v_mul_f32 v85, v33, v33
    v_mul_f32 v86, v34, v34
    v_mul_f32 v87, v35, v35
    v_mfma_f32_16x16x32_bf16 v[24:27], v[156:159], v[56:59], v[24:27]
    s_waitcnt lgkmcnt(3)
    v_fmaak_f32 v84, v84, v111, 0xc0135761
    v_fmaak_f32 v85, v85, v111, 0xc0135761
    v_mfma_f32_16x16x32_bf16 v[12:15], v[160:163], v[60:63], v[12:15]
    ds_read_b128 v[52:55], v99 offset:25600
    v_fmaak_f32 v86, v86, v111, 0xc0135761
    v_fmaak_f32 v87, v87, v111, 0xc0135761
    v_mfma_f32_16x16x32_bf16 v[16:19], v[164:167], v[60:63], v[16:19]
    v_mul_f32 v84, v84, v32
    v_mul_f32 v85, v85, v33
    v_mfma_f32_16x16x32_bf16 v[20:23], v[160:163], v[64:67], v[20:23]
    ds_read_b128 v[56:59], v100 offset:25600
    v_mul_f32 v86, v86, v34
    v_mul_f32 v87, v87, v35
    v_mfma_f32_16x16x32_bf16 v[24:27], v[164:167], v[64:67], v[24:27]
    s_waitcnt lgkmcnt(3)
    v_exp_f32 v84, v84
    v_exp_f32 v85, v85
    v_mfma_f32_16x16x32_bf16 v[12:15], v[168:171], v[68:71], v[12:15]
    ds_read_b128 v[60:63], v101 offset:25600
    v_exp_f32 v86, v86
    v_mfma_f32_16x16x32_bf16 v[16:19], v[172:175], v[68:71], v[16:19]
    v_exp_f32 v87, v87
    v_mfma_f32_16x16x32_bf16 v[20:23], v[168:171], v[44:47], v[20:23]
    ds_read_b128 v[64:67], v98 offset:26624
    v_add_f32 v84, 1.0, v84
    v_add_f32 v85, 1.0, v85
    v_mfma_f32_16x16x32_bf16 v[24:27], v[172:175], v[44:47], v[24:27]
    s_waitcnt lgkmcnt(3)
    v_add_f32 v86, 1.0, v86
    v_add_f32 v87, 1.0, v87
    v_mfma_f32_16x16x32_bf16 v[12:15], v[176:179], v[48:51], v[12:15]
    ds_read_b128 v[68:71], v99 offset:26624
    v_rcp_f32 v84, v84
    v_mfma_f32_16x16x32_bf16 v[16:19], v[180:183], v[48:51], v[16:19]
    v_rcp_f32 v85, v85
    v_mfma_f32_16x16x32_bf16 v[20:23], v[176:179], v[52:55], v[20:23]
    ds_read_b128 v[44:47], v100 offset:26624
    v_rcp_f32 v86, v86
    v_rcp_f32 v87, v87
    v_mfma_f32_16x16x32_bf16 v[24:27], v[180:183], v[52:55], v[24:27]
    s_waitcnt lgkmcnt(3)
    v_mul_f32 v84, v84, v32
    v_mfma_f32_16x16x32_bf16 v[12:15], v[184:187], v[56:59], v[12:15]
    ds_read_b128 v[48:51], v101 offset:26624
    v_mul_f32 v85, v85, v33
    v_mul_f32 v86, v86, v34
    v_mul_f32 v87, v87, v35
    v_mfma_f32_16x16x32_bf16 v[16:19], v[188:191], v[56:59], v[16:19]
    v_cvt_pk_bf16_f32 v90, v84, v85
    v_cvt_pk_bf16_f32 v91, v86, v87
    v_mfma_f32_16x16x32_bf16 v[20:23], v[184:187], v[60:63], v[20:23]
    ds_read_b128 v[52:55], v102 offset:0
    buffer_store_dwordx4 v[88:91], v110, s[20:23], s45 offen sc1
    v_mul_f32 v80, v36, v36
    v_mfma_f32_16x16x32_bf16 v[24:27], v[188:191], v[60:63], v[24:27]
    s_waitcnt lgkmcnt(3)
    v_mul_f32 v81, v37, v37
    v_mul_f32 v82, v38, v38
    v_mul_f32 v83, v39, v39
    v_mfma_f32_16x16x32_bf16 v[12:15], v[192:195], v[64:67], v[12:15]
    ds_read_b128 v[56:59], v103 offset:0
    v_fmaak_f32 v80, v80, v111, 0xc0135761
    v_fmaak_f32 v81, v81, v111, 0xc0135761
    v_mfma_f32_16x16x32_bf16 v[16:19], v[196:199], v[64:67], v[16:19]
    v_fmaak_f32 v82, v82, v111, 0xc0135761
    v_fmaak_f32 v83, v83, v111, 0xc0135761
    v_mfma_f32_16x16x32_bf16 v[20:23], v[192:195], v[68:71], v[20:23]
    ds_read_b128 v[60:63], v104 offset:0
    v_mul_f32 v80, v80, v36
    v_mul_f32 v81, v81, v37
    v_mfma_f32_16x16x32_bf16 v[24:27], v[196:199], v[68:71], v[24:27]
    s_waitcnt lgkmcnt(3)
    v_mul_f32 v82, v82, v38
    v_mul_f32 v83, v83, v39
    v_mfma_f32_16x16x32_bf16 v[12:15], v[200:203], v[44:47], v[12:15]
    ds_read_b128 v[64:67], v105 offset:0
    v_exp_f32 v80, v80
    v_exp_f32 v81, v81
    v_mfma_f32_16x16x32_bf16 v[16:19], v[204:207], v[44:47], v[16:19]
    v_exp_f32 v82, v82
    v_mfma_f32_16x16x32_bf16 v[20:23], v[200:203], v[48:51], v[20:23]
    ds_read_b128 v[68:71], v102 offset:1024
    v_exp_f32 v83, v83
    v_mfma_f32_16x16x32_bf16 v[24:27], v[204:207], v[48:51], v[24:27]
    s_waitcnt lgkmcnt(3)
    v_add_f32 v80, 1.0, v80
    v_add_f32 v81, 1.0, v81
    v_mfma_f32_16x16x32_bf16 v[12:15], v[208:211], v[52:55], v[12:15]
    ds_read_b128 v[44:47], v103 offset:1024
    v_add_f32 v82, 1.0, v82
    v_add_f32 v83, 1.0, v83
    v_mfma_f32_16x16x32_bf16 v[16:19], v[212:215], v[52:55], v[16:19]
    v_rcp_f32 v80, v80
    v_mfma_f32_16x16x32_bf16 v[20:23], v[208:211], v[56:59], v[20:23]
    ds_read_b128 v[48:51], v104 offset:1024
    v_rcp_f32 v81, v81
    v_mfma_f32_16x16x32_bf16 v[24:27], v[212:215], v[56:59], v[24:27]
    s_waitcnt lgkmcnt(3)
    v_rcp_f32 v82, v82
    v_rcp_f32 v83, v83
    v_mfma_f32_16x16x32_bf16 v[12:15], v[216:219], v[60:63], v[12:15]
    ds_read_b128 v[52:55], v105 offset:1024
    v_mul_f32 v80, v80, v36
    v_mfma_f32_16x16x32_bf16 v[16:19], v[220:223], v[60:63], v[16:19]
    v_mul_f32 v81, v81, v37
    v_mul_f32 v82, v82, v38
    v_mul_f32 v83, v83, v39
    v_mfma_f32_16x16x32_bf16 v[20:23], v[216:219], v[64:67], v[20:23]
    ds_read_b128 v[56:59], v102 offset:2048
    v_cvt_pk_bf16_f32 v92, v80, v81
    v_cvt_pk_bf16_f32 v93, v82, v83
    v_mfma_f32_16x16x32_bf16 v[24:27], v[220:223], v[64:67], v[24:27]
    s_waitcnt lgkmcnt(3)
    v_mul_f32 v84, v40, v40
    v_mul_f32 v85, v41, v41
    v_mfma_f32_16x16x32_bf16 v[12:15], v[224:227], v[68:71], v[12:15]
    ds_read_b128 v[60:63], v103 offset:2048
    v_mul_f32 v86, v42, v42
    v_mul_f32 v87, v43, v43
    v_fmaak_f32 v84, v84, v111, 0xc0135761
    v_mfma_f32_16x16x32_bf16 v[16:19], v[228:231], v[68:71], v[16:19]
    v_fmaak_f32 v85, v85, v111, 0xc0135761
    v_fmaak_f32 v86, v86, v111, 0xc0135761
    v_mfma_f32_16x16x32_bf16 v[20:23], v[224:227], v[44:47], v[20:23]
    ds_read_b128 v[64:67], v104 offset:2048
    v_fmaak_f32 v87, v87, v111, 0xc0135761
    v_mul_f32 v84, v84, v40
    v_mfma_f32_16x16x32_bf16 v[24:27], v[228:231], v[44:47], v[24:27]
    s_waitcnt lgkmcnt(3)
    v_mul_f32 v85, v85, v41
    v_mul_f32 v86, v86, v42
    v_mfma_f32_16x16x32_bf16 v[12:15], v[232:235], v[48:51], v[12:15]
    ds_read_b128 v[68:71], v105 offset:2048
    v_mul_f32 v87, v87, v43
    v_exp_f32 v84, v84
    v_mfma_f32_16x16x32_bf16 v[16:19], v[236:239], v[48:51], v[16:19]
    v_exp_f32 v85, v85
    v_mfma_f32_16x16x32_bf16 v[20:23], v[232:235], v[52:55], v[20:23]
    v_exp_f32 v86, v86
    v_mfma_f32_16x16x32_bf16 v[24:27], v[236:239], v[52:55], v[24:27]
    s_waitcnt lgkmcnt(2)
    v_exp_f32 v87, v87
    v_add_f32 v84, 1.0, v84
    v_mfma_f32_16x16x32_bf16 v[12:15], v[240:243], v[56:59], v[12:15]
    v_add_f32 v85, 1.0, v85
    v_add_f32 v86, 1.0, v86
    v_mfma_f32_16x16x32_bf16 v[16:19], v[244:247], v[56:59], v[16:19]
    v_add_f32 v87, 1.0, v87
    v_rcp_f32 v84, v84
    v_mfma_f32_16x16x32_bf16 v[20:23], v[240:243], v[60:63], v[20:23]
    v_rcp_f32 v85, v85
    v_mfma_f32_16x16x32_bf16 v[24:27], v[244:247], v[60:63], v[24:27]
    s_waitcnt lgkmcnt(0)
    v_rcp_f32 v86, v86
    v_mfma_f32_16x16x32_bf16 v[12:15], v[248:251], v[64:67], v[12:15]
    v_rcp_f32 v87, v87
    v_mfma_f32_16x16x32_bf16 v[16:19], v[252:255], v[64:67], v[16:19]
    v_mul_f32 v84, v84, v40
    v_mul_f32 v85, v85, v41
    v_mfma_f32_16x16x32_bf16 v[20:23], v[248:251], v[68:71], v[20:23]
    v_mul_f32 v86, v86, v42
    v_mul_f32 v87, v87, v43
    v_cvt_pk_bf16_f32 v94, v84, v85
    v_mfma_f32_16x16x32_bf16 v[24:27], v[252:255], v[68:71], v[24:27]
    v_cvt_pk_bf16_f32 v95, v86, v87
    buffer_store_dwordx4 v[92:95], v10, s[20:23], s45 offen sc1
    s_mul_i32 s45, s44, 184320
    v_mul_f32 v80, v12, v12
    v_mul_f32 v81, v13, v13
    v_mul_f32 v82, v14, v14
    v_mul_f32 v83, v15, v15
    v_fmaak_f32 v80, v80, v111, 0xc0135761
    v_fmaak_f32 v81, v81, v111, 0xc0135761
    v_fmaak_f32 v82, v82, v111, 0xc0135761
    v_fmaak_f32 v83, v83, v111, 0xc0135761
    v_mul_f32 v80, v80, v12
    v_mul_f32 v81, v81, v13
    v_mul_f32 v82, v82, v14
    v_mul_f32 v83, v83, v15
    v_exp_f32 v80, v80
    v_exp_f32 v81, v81
    v_exp_f32 v82, v82
    v_exp_f32 v83, v83
    v_add_f32 v80, 1.0, v80
    v_add_f32 v81, 1.0, v81
    v_add_f32 v82, 1.0, v82
    v_add_f32 v83, 1.0, v83
    v_rcp_f32 v80, v80
    v_rcp_f32 v81, v81
    v_rcp_f32 v82, v82
    v_rcp_f32 v83, v83
    v_mul_f32 v80, v80, v12
    v_mul_f32 v81, v81, v13
    v_mul_f32 v82, v82, v14
    v_mul_f32 v83, v83, v15
    v_cvt_pk_bf16_f32 v88, v80, v81
    v_cvt_pk_bf16_f32 v89, v82, v83
    v_mul_f32 v84, v16, v16
    v_mul_f32 v85, v17, v17
    v_mul_f32 v86, v18, v18
    v_mul_f32 v87, v19, v19
    v_fmaak_f32 v84, v84, v111, 0xc0135761
    v_fmaak_f32 v85, v85, v111, 0xc0135761
    v_fmaak_f32 v86, v86, v111, 0xc0135761
    v_fmaak_f32 v87, v87, v111, 0xc0135761
    v_mul_f32 v84, v84, v16
    v_mul_f32 v85, v85, v17
    v_mul_f32 v86, v86, v18
    v_mul_f32 v87, v87, v19
    v_exp_f32 v84, v84
    v_exp_f32 v85, v85
    v_exp_f32 v86, v86
    v_exp_f32 v87, v87
    v_add_f32 v84, 1.0, v84
    v_add_f32 v85, 1.0, v85
    v_add_f32 v86, 1.0, v86
    v_add_f32 v87, 1.0, v87
    v_rcp_f32 v84, v84
    v_rcp_f32 v85, v85
    v_rcp_f32 v86, v86
    v_rcp_f32 v87, v87
    v_mul_f32 v84, v84, v16
    v_mul_f32 v85, v85, v17
    v_mul_f32 v86, v86, v18
    v_mul_f32 v87, v87, v19
    v_cvt_pk_bf16_f32 v90, v84, v85
    v_cvt_pk_bf16_f32 v91, v86, v87
    buffer_store_dwordx4 v[88:91], v110, s[20:23], s45 offen sc1
    v_mul_f32 v80, v20, v20
    v_mul_f32 v81, v21, v21
    v_mul_f32 v82, v22, v22
    v_mul_f32 v83, v23, v23
    v_fmaak_f32 v80, v80, v111, 0xc0135761
    v_fmaak_f32 v81, v81, v111, 0xc0135761
    v_fmaak_f32 v82, v82, v111, 0xc0135761
    v_fmaak_f32 v83, v83, v111, 0xc0135761
    v_mul_f32 v80, v80, v20
    v_mul_f32 v81, v81, v21
    v_mul_f32 v82, v82, v22
    v_mul_f32 v83, v83, v23
    v_exp_f32 v80, v80
    v_exp_f32 v81, v81
    v_exp_f32 v82, v82
    v_exp_f32 v83, v83
    v_add_f32 v80, 1.0, v80
    v_add_f32 v81, 1.0, v81
    v_add_f32 v82, 1.0, v82
    v_add_f32 v83, 1.0, v83
    v_rcp_f32 v80, v80
    v_rcp_f32 v81, v81
    v_rcp_f32 v82, v82
    v_rcp_f32 v83, v83
    v_mul_f32 v80, v80, v20
    v_mul_f32 v81, v81, v21
    v_mul_f32 v82, v82, v22
    v_mul_f32 v83, v83, v23
    v_cvt_pk_bf16_f32 v92, v80, v81
    v_cvt_pk_bf16_f32 v93, v82, v83
    v_mul_f32 v84, v24, v24
    v_mul_f32 v85, v25, v25
    v_mul_f32 v86, v26, v26
    v_mul_f32 v87, v27, v27
    v_fmaak_f32 v84, v84, v111, 0xc0135761
    v_fmaak_f32 v85, v85, v111, 0xc0135761
    v_fmaak_f32 v86, v86, v111, 0xc0135761
    v_fmaak_f32 v87, v87, v111, 0xc0135761
    v_mul_f32 v84, v84, v24
    v_mul_f32 v85, v85, v25
    v_mul_f32 v86, v86, v26
    v_mul_f32 v87, v87, v27
    v_exp_f32 v84, v84
    v_exp_f32 v85, v85
    v_exp_f32 v86, v86
    v_exp_f32 v87, v87
    v_add_f32 v84, 1.0, v84
    v_add_f32 v85, 1.0, v85
    v_add_f32 v86, 1.0, v86
    v_add_f32 v87, 1.0, v87
    v_rcp_f32 v84, v84
    v_rcp_f32 v85, v85
    v_rcp_f32 v86, v86
    v_rcp_f32 v87, v87
    v_mul_f32 v84, v84, v24
    v_mul_f32 v85, v85, v25
    v_mul_f32 v86, v86, v26
    v_mul_f32 v87, v87, v27
    v_cvt_pk_bf16_f32 v94, v84, v85
    v_cvt_pk_bf16_f32 v95, v86, v87
    buffer_store_dwordx4 v[92:95], v10, s[20:23], s45 offen sc1
    s_endpgm
K1_N_fin:
    s_lshl_b32 s48, s2, 2
    s_and_b32 s47, s32, 3
    s_add_u32 s48, s48, s47
    s_cmp_eq_u32 s34, 1
    s_cselect_b32 s48, s48, 1000
    s_mul_i32 s49, s48, 4608
    s_lshl_b32 s50, s48, 4
    s_add_u32 s50, s50, 58720256
    s_cmp_lt_u32 s48, 512
    s_cselect_b32 s49, s49, 0x7f000000
    s_cselect_b32 s50, s50, 0x7f000000
    s_mov_b32 s24, s26
    s_mov_b32 s25, s27
    s_cselect_b32 s26, 1152, 0
    s_mov_b32 s27, 0x00020000
    v_and_b32 v4, 31, v1
    v_lshlrev_b32 v4, 4, v4
    v_mul_u32_u24 v5, 1152, v6
    v_add_u32 v5, v5, v4
    v_mov_b32 v7, 0x7f000000
    v_cmp_gt_u32 vcc, 128, v4
    s_nop 1
    v_cndmask_b32 v7, v7, v5, vcc
    buffer_load_dwordx4 v[136:139], v4, s[24:27], 0 offen offset:0
    buffer_load_dwordx4 v[140:143], v4, s[24:27], 0 offen offset:512
    buffer_load_dwordx4 v[144:147], v4, s[24:27], 0 offen offset:1024
    buffer_load_dwordx4 v[112:115], v5, s[8:11], s49 offen offset:0
    buffer_load_dwordx4 v[116:119], v5, s[8:11], s49 offen offset:512
    buffer_load_dwordx4 v[120:123], v7, s[8:11], s49 offen offset:1024
    buffer_load_dwordx4 v[124:127], v5, s[8:11], s49 offen offset:2304
    buffer_load_dwordx4 v[128:131], v5, s[8:11], s49 offen offset:2816
    buffer_load_dwordx4 v[132:135], v7, s[8:11], s49 offen offset:3328
    s_add_u32 s45, s42, 10
    s_mul_i32 s45, s45, 184320
    v_mul_f32 v80, v28, v28
    v_mul_f32 v81, v29, v29
    v_mul_f32 v82, v30, v30
    v_mul_f32 v83, v31, v31
    v_fmaak_f32 v80, v80, v111, 0xc0135761
    v_fmaak_f32 v81, v81, v111, 0xc0135761
    v_fmaak_f32 v82, v82, v111, 0xc0135761
    v_fmaak_f32 v83, v83, v111, 0xc0135761
    v_mul_f32 v80, v80, v28
    v_mul_f32 v81, v81, v29
    v_mul_f32 v82, v82, v30
    v_mul_f32 v83, v83, v31
    v_exp_f32 v80, v80
    v_exp_f32 v81, v81
    v_exp_f32 v82, v82
    v_exp_f32 v83, v83
    v_add_f32 v80, 1.0, v80
    v_add_f32 v81, 1.0, v81
    v_add_f32 v82, 1.0, v82
    v_add_f32 v83, 1.0, v83
    v_rcp_f32 v80, v80
    v_rcp_f32 v81, v81
    v_rcp_f32 v82, v82
    v_rcp_f32 v83, v83
    v_mul_f32 v80, v80, v28
    v_mul_f32 v81, v81, v29
    v_mul_f32 v82, v82, v30
    v_mul_f32 v83, v83, v31
    v_cvt_pk_bf16_f32 v88, v80, v81
    v_cvt_pk_bf16_f32 v89, v82, v83
    v_mul_f32 v84, v32, v32
    v_mul_f32 v85, v33, v33
    v_mul_f32 v86, v34, v34
    v_mul_f32 v87, v35, v35
    v_fmaak_f32 v84, v84, v111, 0xc0135761
    v_fmaak_f32 v85, v85, v111, 0xc0135761
    v_fmaak_f32 v86, v86, v111, 0xc0135761
    v_fmaak_f32 v87, v87, v111, 0xc0135761
    v_mul_f32 v84, v84, v32
    v_mul_f32 v85, v85, v33
    v_mul_f32 v86, v86, v34
    v_mul_f32 v87, v87, v35
    v_exp_f32 v84, v84
    v_exp_f32 v85, v85
    v_exp_f32 v86, v86
    v_exp_f32 v87, v87
    v_add_f32 v84, 1.0, v84
    v_add_f32 v85, 1.0, v85
    v_add_f32 v86, 1.0, v86
    v_add_f32 v87, 1.0, v87
    v_rcp_f32 v84, v84
    v_rcp_f32 v85, v85
    v_rcp_f32 v86, v86
    v_rcp_f32 v87, v87
    v_mul_f32 v84, v84, v32
    v_mul_f32 v85, v85, v33
    v_mul_f32 v86, v86, v34
    v_mul_f32 v87, v87, v35
    v_cvt_pk_bf16_f32 v90, v84, v85
    v_cvt_pk_bf16_f32 v91, v86, v87
    buffer_store_dwordx4 v[88:91], v110, s[20:23], s45 offen sc1
    v_mul_f32 v80, v36, v36
    v_mul_f32 v81, v37, v37
    v_mul_f32 v82, v38, v38
    v_mul_f32 v83, v39, v39
    v_fmaak_f32 v80, v80, v111, 0xc0135761
    v_fmaak_f32 v81, v81, v111, 0xc0135761
    v_fmaak_f32 v82, v82, v111, 0xc0135761
    v_fmaak_f32 v83, v83, v111, 0xc0135761
    v_mul_f32 v80, v80, v36
    v_mul_f32 v81, v81, v37
    v_mul_f32 v82, v82, v38
    v_mul_f32 v83, v83, v39
    v_exp_f32 v80, v80
    v_exp_f32 v81, v81
    v_exp_f32 v82, v82
    v_exp_f32 v83, v83
    v_add_f32 v80, 1.0, v80
    v_add_f32 v81, 1.0, v81
    v_add_f32 v82, 1.0, v82
    v_add_f32 v83, 1.0, v83
    v_rcp_f32 v80, v80
    v_rcp_f32 v81, v81
    v_rcp_f32 v82, v82
    v_rcp_f32 v83, v83
    v_mul_f32 v80, v80, v36
    v_mul_f32 v81, v81, v37
    v_mul_f32 v82, v82, v38
    v_mul_f32 v83, v83, v39
    v_cvt_pk_bf16_f32 v92, v80, v81
    v_cvt_pk_bf16_f32 v93, v82, v83
    v_mul_f32 v84, v40, v40
    v_mul_f32 v85, v41, v41
    v_mul_f32 v86, v42, v42
    v_mul_f32 v87, v43, v43
    v_fmaak_f32 v84, v84, v111, 0xc0135761
    v_fmaak_f32 v85, v85, v111, 0xc0135761
    v_fmaak_f32 v86, v86, v111, 0xc0135761
    v_fmaak_f32 v87, v87, v111, 0xc0135761
    v_mul_f32 v84, v84, v40
    v_mul_f32 v85, v85, v41
    v_mul_f32 v86, v86, v42
    v_mul_f32 v87, v87, v43
    v_exp_f32 v84, v84
    v_exp_f32 v85, v85
    v_exp_f32 v86, v86
    v_exp_f32 v87, v87
    v_add_f32 v84, 1.0, v84
    v_add_f32 v85, 1.0, v85
    v_add_f32 v86, 1.0, v86
    v_add_f32 v87, 1.0, v87
    v_rcp_f32 v84, v84
    v_rcp_f32 v85, v85
    v_rcp_f32 v86, v86
    v_rcp_f32 v87, v87
    v_mul_f32 v84, v84, v40
    v_mul_f32 v85, v85, v41
    v_mul_f32 v86, v86, v42
    v_mul_f32 v87, v87, v43
    v_cvt_pk_bf16_f32 v94, v84, v85
    v_cvt_pk_bf16_f32 v95, v86, v87
    buffer_store_dwordx4 v[92:95], v10, s[20:23], s45 offen sc1
    v_mov_b32 v152, 0
    v_mov_b32 v153, 0
    v_mov_b32 v154, 0
    v_mov_b32 v155, 0
    s_waitcnt vmcnt(10)
    v_lshlrev_b32 v156, 16, v136
    v_and_b32 v157, 0xffff0000, v136
    s_waitcnt vmcnt(7)
    v_lshlrev_b32 v158, 16, v112
    v_and_b32 v159, 0xffff0000, v112
    v_fmac_f32 v152, v156, v158
    v_fmac_f32 v153, v157, v159
    s_waitcnt vmcnt(4)
    v_lshlrev_b32 v158, 16, v124
    v_and_b32 v159, 0xffff0000, v124
    v_fmac_f32 v154, v156, v158
    v_fmac_f32 v155, v157, v159
    v_lshlrev_b32 v156, 16, v137
    v_and_b32 v157, 0xffff0000, v137
    v_lshlrev_b32 v158, 16, v113
    v_and_b32 v159, 0xffff0000, v113
    v_fmac_f32 v152, v156, v158
    v_fmac_f32 v153, v157, v159
    v_lshlrev_b32 v158, 16, v125
    v_and_b32 v159, 0xffff0000, v125
    v_fmac_f32 v154, v156, v158
    v_fmac_f32 v155, v157, v159
    v_lshlrev_b32 v156, 16, v138
    v_and_b32 v157, 0xffff0000, v138
    v_lshlrev_b32 v158, 16, v114
    v_and_b32 v159, 0xffff0000, v114
    v_fmac_f32 v152, v156, v158
    v_fmac_f32 v153, v157, v159
    v_lshlrev_b32 v158, 16, v126
    v_and_b32 v159, 0xffff0000, v126
    v_fmac_f32 v154, v156, v158
    v_fmac_f32 v155, v157, v159
    v_lshlrev_b32 v156, 16, v139
    v_and_b32 v157, 0xffff0000, v139
    v_lshlrev_b32 v158, 16, v115
    v_and_b32 v159, 0xffff0000, v115
    v_fmac_f32 v152, v156, v158
    v_fmac_f32 v153, v157, v159
    v_lshlrev_b32 v158, 16, v127
    v_and_b32 v159, 0xffff0000, v127
    v_fmac_f32 v154, v156, v158
    v_fmac_f32 v155, v157, v159
    v_lshlrev_b32 v156, 16, v140
    v_and_b32 v157, 0xffff0000, v140
    v_lshlrev_b32 v158, 16, v116
    v_and_b32 v159, 0xffff0000, v116
    v_fmac_f32 v152, v156, v158
    v_fmac_f32 v153, v157, v159
    s_waitcnt vmcnt(3)
    v_lshlrev_b32 v158, 16, v128
    v_and_b32 v159, 0xffff0000, v128
    v_fmac_f32 v154, v156, v158
    v_fmac_f32 v155, v157, v159
    v_lshlrev_b32 v156, 16, v141
    v_and_b32 v157, 0xffff0000, v141
    v_lshlrev_b32 v158, 16, v117
    v_and_b32 v159, 0xffff0000, v117
    v_fmac_f32 v152, v156, v158
    v_fmac_f32 v153, v157, v159
    v_lshlrev_b32 v158, 16, v129
    v_and_b32 v159, 0xffff0000, v129
    v_fmac_f32 v154, v156, v158
    v_fmac_f32 v155, v157, v159
    v_lshlrev_b32 v156, 16, v142
    v_and_b32 v157, 0xffff0000, v142
    v_lshlrev_b32 v158, 16, v118
    v_and_b32 v159, 0xffff0000, v118
    v_fmac_f32 v152, v156, v158
    v_fmac_f32 v153, v157, v159
    v_lshlrev_b32 v158, 16, v130
    v_and_b32 v159, 0xffff0000, v130
    v_fmac_f32 v154, v156, v158
    v_fmac_f32 v155, v157, v159
    v_lshlrev_b32 v156, 16, v143
    v_and_b32 v157, 0xffff0000, v143
    v_lshlrev_b32 v158, 16, v119
    v_and_b32 v159, 0xffff0000, v119
    v_fmac_f32 v152, v156, v158
    v_fmac_f32 v153, v157, v159
    v_lshlrev_b32 v158, 16, v131
    v_and_b32 v159, 0xffff0000, v131
    v_fmac_f32 v154, v156, v158
    v_fmac_f32 v155, v157, v159
    v_lshlrev_b32 v156, 16, v144
    v_and_b32 v157, 0xffff0000, v144
    v_lshlrev_b32 v158, 16, v120
    v_and_b32 v159, 0xffff0000, v120
    v_fmac_f32 v152, v156, v158
    v_fmac_f32 v153, v157, v159
    s_waitcnt vmcnt(2)
    v_lshlrev_b32 v158, 16, v132
    v_and_b32 v159, 0xffff0000, v132
    v_fmac_f32 v154, v156, v158
    v_fmac_f32 v155, v157, v159
    v_lshlrev_b32 v156, 16, v145
    v_and_b32 v157, 0xffff0000, v145
    v_lshlrev_b32 v158, 16, v121
    v_and_b32 v159, 0xffff0000, v121
    v_fmac_f32 v152, v156, v158
    v_fmac_f32 v153, v157, v159
    v_lshlrev_b32 v158, 16, v133
    v_and_b32 v159, 0xffff0000, v133
    v_fmac_f32 v154, v156, v158
    v_fmac_f32 v155, v157, v159
    v_lshlrev_b32 v156, 16, v146
    v_and_b32 v157, 0xffff0000, v146
    v_lshlrev_b32 v158, 16, v122
    v_and_b32 v159, 0xffff0000, v122
    v_fmac_f32 v152, v156, v158
    v_fmac_f32 v153, v157, v159
    v_lshlrev_b32 v158, 16, v134
    v_and_b32 v159, 0xffff0000, v134
    v_fmac_f32 v154, v156, v158
    v_fmac_f32 v155, v157, v159
    v_lshlrev_b32 v156, 16, v147
    v_and_b32 v157, 0xffff0000, v147
    v_lshlrev_b32 v158, 16, v123
    v_and_b32 v159, 0xffff0000, v123
    v_fmac_f32 v152, v156, v158
    v_fmac_f32 v153, v157, v159
    v_lshlrev_b32 v158, 16, v135
    v_and_b32 v159, 0xffff0000, v135
    v_fmac_f32 v154, v156, v158
    v_fmac_f32 v155, v157, v159
    v_add_f32 v152, v152, v153
    v_add_f32 v154, v154, v155
    s_nop 0
    v_add_f32_dpp v152, v152, v152 row_shr:1 bound_ctrl:0
    v_add_f32_dpp v154, v154, v154 row_shr:1 bound_ctrl:0
    s_nop 0
    v_add_f32_dpp v152, v152, v152 row_shr:2 bound_ctrl:0
    v_add_f32_dpp v154, v154, v154 row_shr:2 bound_ctrl:0
    s_nop 0
    v_add_f32_dpp v152, v152, v152 row_shr:4 bound_ctrl:0
    v_add_f32_dpp v154, v154, v154 row_shr:4 bound_ctrl:0
    s_nop 0
    v_add_f32_dpp v152, v152, v152 row_shr:8 bound_ctrl:0
    v_add_f32_dpp v154, v154, v154 row_shr:8 bound_ctrl:0
    s_nop 0
    v_add_f32_dpp v152, v152, v152 row_bcast:15 row_mask:0xa
    v_add_f32_dpp v154, v154, v154 row_bcast:15 row_mask:0xa
    v_mul_f32 v152, 0xbfb8aa3b, v152
    v_exp_f32 v152, v152
    s_nop 0
    v_add_f32 v152, 1.0, v152
    v_rcp_f32 v152, v152
    v_mul_f32 v154, 0xbfb8aa3b, v154
    v_exp_f32 v154, v154
    s_nop 0
    v_add_f32 v154, 1.0, v154
    v_rcp_f32 v154, v154
    v_lshlrev_b32 v4, 2, v6
    s_mov_b32 exec_lo, 0x80000000
    s_mov_b32 exec_hi, 0x80000000
    buffer_store_dword v152, v4, s[20:23], s50 offen
    buffer_store_dword v154, v4, s[20:23], s50 offen offset:8
    s_mov_b64 exec, -1
    s_and_b32 s47, s32, 3
    s_getpc_b64 s[16:17]
    s_add_u32 s16, s16, k23_fused_kernel-.
    s_addc_u32 s17, s17, 0
    s_mul_i32 s18, s47, 6144
    v_lshlrev_b32 v2, 7, v1
    v_add_u32 v2, s18, v2
    s_mov_b32 exec_lo, 0xffffffff
    s_mov_b32 exec_hi, 0xffff
    global_load_dword v3, v2, s[16:17]
    s_mov_b64 exec, -1
    s_endpgm
K1_LT:
K1_L_body:
    v_and_b32 v2, 15, v1
    v_lshrrev_b32 v3, 4, v1
    v_lshrrev_b32 v4, 2, v2
    v_lshlrev_b32 v4, 3, v4
    v_and_b32 v5, 3, v2
    v_add3_u32 v4, v4, v5, 0
    v_bfe_u32 v5, v4, 1, 3
    v_lshrrev_b32 v7, 3, v4
    v_and_b32 v11, 2, v7
    v_xor_b32 v5, v5, v11
    v_xor_b32 v5, v5, v3
    v_lshlrev_b32 v5, 4, v5
    v_and_b32 v11, 7, v4
    v_lshl_add_u32 v5, v11, 7, v5
    v_mul_u32_u24 v7, 3072, v7
    v_add3_u32 v98, s59, v5, v7
    v_xor_b32 v100, 64, v98
    v_lshrrev_b32 v4, 2, v2
    v_lshlrev_b32 v4, 3, v4
    v_and_b32 v5, 3, v2
    v_add3_u32 v4, v4, v5, 4
    v_bfe_u32 v5, v4, 1, 3
    v_lshrrev_b32 v7, 3, v4
    v_and_b32 v11, 2, v7
    v_xor_b32 v5, v5, v11
    v_xor_b32 v5, v5, v3
    v_lshlrev_b32 v5, 4, v5
    v_and_b32 v11, 7, v4
    v_lshl_add_u32 v5, v11, 7, v5
    v_mul_u32_u24 v7, 3072, v7
    v_add3_u32 v99, s59, v5, v7
    v_xor_b32 v101, 64, v99
    v_add_u32 v102, 49152, v98
    v_add_u32 v106, 98304, v98
    v_add_u32 v103, 49152, v99
    v_add_u32 v107, 98304, v99
    v_add_u32 v104, 49152, v100
    v_add_u32 v108, 98304, v100
    v_add_u32 v105, 49152, v101
    v_add_u32 v109, 98304, v101
    v_bfe_u32 v4, v1, 2, 2
    v_lshl_add_u32 v5, v3, 3, v4
    v_lshlrev_b32 v5, 8, v5
    s_and_b32 s47, s32, 3
    v_xor_b32 v4, s47, v4
    v_lshl_add_u32 v5, v4, 6, v5
    v_and_b32 v4, 3, v1
    v_lshl_add_u32 v5, v4, 3, v5
    v_and_b32 v4, 1, v3
    v_lshl_add_u32 v5, v4, 5, v5
    v_xor_b32 v4, 32, v5
    v_add_u32 v72, 49152, v5
    v_add_u32 v73, 49152, v4
    v_add_u32 v74, 106496, v5
    v_add_u32 v75, 106496, v4
    v_add_u32 v76, 73728, v5
    v_add_u32 v77, 73728, v4
    v_mul_u32_u24 v4, 9344, v3
    v_lshl_add_u32 v4, v2, 4, v4
    s_mul_i32 s47, s46, 57
    s_lshr_b32 s47, s47, 10
    s_mul_i32 s47, s47, 2382848
    s_lshl_b32 s43, s46, 9
    s_add_u32 s47, s47, s43
    s_cmp_lt_u32 s46, 54
    s_cselect_b32 s47, s47, 0x7f000000
    v_add_u32 v110, s47, v4
    v_add_u32 v10, 256, v110
    s_cmp_lt_u32 s46, 18
    s_cselect_b32 s43, 0x3eae1a93, 1.0
    s_cmp_eq_u32 s34, 1
    s_cselect_b64 vcc, -1, 0
    s_waitcnt vmcnt(5)
    s_barrier
    ds_read_b64_tr_b16 v[112:113], v72 offset:0
    ds_read_b64_tr_b16 v[114:115], v72 offset:1024
    ds_read_b64_tr_b16 v[116:117], v73 offset:0
    ds_read_b64_tr_b16 v[118:119], v73 offset:1024
    ds_read_b128 v[44:47], v98 offset:0
    ds_read_b128 v[48:51], v99 offset:0
    ds_read_b128 v[52:55], v100 offset:0
    ds_read_b128 v[56:59], v101 offset:0
    ds_read_b128 v[60:63], v98 offset:1024
    ds_read_b64_tr_b16 v[120:121], v72 offset:8192
    ds_read_b64_tr_b16 v[122:123], v72 offset:9216
    ds_read_b64_tr_b16 v[124:125], v73 offset:8192
    ds_read_b64_tr_b16 v[126:127], v73 offset:9216
    ds_read_b64_tr_b16 v[128:129], v72 offset:16384
    ds_read_b64_tr_b16 v[130:131], v72 offset:17408
    ds_read_b64_tr_b16 v[132:133], v73 offset:16384
    ds_read_b64_tr_b16 v[134:135], v73 offset:17408
    ds_read_b64_tr_b16 v[136:137], v72 offset:24576
    ds_read_b64_tr_b16 v[138:139], v72 offset:25600
    ds_read_b64_tr_b16 v[140:141], v73 offset:24576
    ds_read_b64_tr_b16 v[142:143], v73 offset:25600
    ds_read_b64_tr_b16 v[144:145], v72 offset:32768
    ds_read_b64_tr_b16 v[146:147], v72 offset:33792
    ds_read_b64_tr_b16 v[148:149], v73 offset:32768
    ds_read_b64_tr_b16 v[150:151], v73 offset:33792
    ds_read_b64_tr_b16 v[152:153], v72 offset:40960
    ds_read_b64_tr_b16 v[154:155], v72 offset:41984
    ds_read_b64_tr_b16 v[156:157], v73 offset:40960
    ds_read_b64_tr_b16 v[158:159], v73 offset:41984
    ds_read_b64_tr_b16 v[160:161], v72 offset:49152
    ds_read_b64_tr_b16 v[162:163], v72 offset:50176
    ds_read_b64_tr_b16 v[164:165], v73 offset:49152
    ds_read_b64_tr_b16 v[166:167], v73 offset:50176
    s_waitcnt lgkmcnt(0)
    s_barrier
    v_mfma_f32_16x16x32_bf16 v[12:15], v[44:47], v[112:115], 0
    ds_read_b128 v[64:67], v99 offset:1024
    v_mfma_f32_16x16x32_bf16 v[20:23], v[44:47], v[116:119], 0
    s_add_u32 m0, s40, 106496
    s_nop 0
    buffer_load_dwordx4 v96, s[12:15], s39 offen lds
    s_add_u32 s39, s39, s38
    v_mfma_f32_16x16x32_bf16 v[16:19], v[48:51], v[112:115], 0
    ds_read_b128 v[68:71], v100 offset:1024
    v_mfma_f32_16x16x32_bf16 v[24:27], v[48:51], v[116:119], 0
    s_add_u32 m0, s40, 114688
    s_nop 0
    buffer_load_dwordx4 v96, s[12:15], s39 offen lds
    s_add_u32 s39, s39, s38
    v_mfma_f32_16x16x32_bf16 v[12:15], v[52:55], v[120:123], v[12:15]
    ds_read_b128 v[44:47], v101 offset:1024
    v_mfma_f32_16x16x32_bf16 v[20:23], v[52:55], v[124:127], v[20:23]
    s_add_u32 m0, s40, 122880
    s_nop 0
    buffer_load_dwordx4 v96, s[12:15], s39 offen lds
    s_add_u32 s39, s39, s38
    v_mfma_f32_16x16x32_bf16 v[16:19], v[56:59], v[120:123], v[16:19]
    ds_read_b128 v[48:51], v98 offset:2048
    v_mfma_f32_16x16x32_bf16 v[24:27], v[56:59], v[124:127], v[24:27]
    s_add_u32 m0, s40, 131072
    s_nop 0
    buffer_load_dwordx4 v96, s[12:15], s39 offen lds
    s_add_u32 s39, s39, s38
    v_mfma_f32_16x16x32_bf16 v[12:15], v[60:63], v[128:131], v[12:15]
    ds_read_b128 v[52:55], v99 offset:2048
    v_mfma_f32_16x16x32_bf16 v[20:23], v[60:63], v[132:135], v[20:23]
    s_add_u32 m0, s40, 139264
    s_nop 0
    buffer_load_dwordx4 v96, s[12:15], s39 offen lds
    s_add_u32 s39, s39, s38
    s_waitcnt lgkmcnt(4)
    v_mfma_f32_16x16x32_bf16 v[16:19], v[64:67], v[128:131], v[16:19]
    ds_read_b128 v[56:59], v100 offset:2048
    v_mfma_f32_16x16x32_bf16 v[24:27], v[64:67], v[132:135], v[24:27]
    s_add_u32 m0, s40, 147456
    s_nop 0
    buffer_load_dwordx4 v96, s[12:15], s39 offen lds
    s_add_u32 s39, s39, s38
    s_waitcnt lgkmcnt(4)
    v_mfma_f32_16x16x32_bf16 v[12:15], v[68:71], v[136:139], v[12:15]
    ds_read_b128 v[60:63], v101 offset:2048
    v_mfma_f32_16x16x32_bf16 v[20:23], v[68:71], v[140:143], v[20:23]
    s_add_u32 m0, s40, 155648
    s_nop 0
    buffer_load_dwordx4 v96, s[12:15], s39 offen lds
    s_add_u32 s39, s39, s38
    s_waitcnt lgkmcnt(4)
    v_mfma_f32_16x16x32_bf16 v[16:19], v[44:47], v[136:139], v[16:19]
    s_add_u32 s37, s35, 768
    s_add_u32 m0, s36, 49152
    s_nop 0
    buffer_load_dwordx4 v97, s[8:11], s37 offen offset:0 lds
    s_add_u32 m0, s36, 50048
    s_nop 0
    buffer_load_dwordx4 v97, s[8:11], s37 offen offset:128 lds
    s_add_u32 m0, s36, 50944
    s_nop 0
    buffer_load_dwordx4 v97, s[8:11], s37 offen offset:256 lds
    s_add_u32 m0, s40, 73728
    s_nop 0
    buffer_load_dwordx4 v96, s[12:15], s39 offen lds
    s_add_u32 s39, s39, s38
    s_add_u32 m0, s40, 81920
    s_nop 0
    buffer_load_dwordx4 v96, s[12:15], s39 offen lds
    s_add_u32 s39, s39, s38
    s_add_u32 m0, s40, 90112
    s_nop 0
    buffer_load_dwordx4 v96, s[12:15], s39 offen lds
    s_add_u32 s39, s39, s38
    s_add_u32 m0, s40, 98304
    s_nop 0
    buffer_load_dwordx4 v96, s[12:15], s39 offen lds
    s_add_u32 s39, s39, s38
    s_waitcnt vmcnt(7)
    s_barrier
    ds_read_b64_tr_b16 v[168:169], v74 offset:0
    ds_read_b64_tr_b16 v[170:171], v74 offset:1024
    ds_read_b64_tr_b16 v[172:173], v75 offset:0
    ds_read_b64_tr_b16 v[174:175], v75 offset:1024
    ds_read_b64_tr_b16 v[176:177], v74 offset:8192
    ds_read_b64_tr_b16 v[178:179], v74 offset:9216
    ds_read_b64_tr_b16 v[180:181], v75 offset:8192
    ds_read_b64_tr_b16 v[182:183], v75 offset:9216
    ds_read_b64_tr_b16 v[184:185], v74 offset:16384
    ds_read_b64_tr_b16 v[186:187], v74 offset:17408
    ds_read_b64_tr_b16 v[188:189], v75 offset:16384
    ds_read_b64_tr_b16 v[190:191], v75 offset:17408
    ds_read_b64_tr_b16 v[192:193], v74 offset:24576
    ds_read_b64_tr_b16 v[194:195], v74 offset:25600
    ds_read_b64_tr_b16 v[196:197], v75 offset:24576
    ds_read_b64_tr_b16 v[198:199], v75 offset:25600
    ds_read_b64_tr_b16 v[200:201], v74 offset:32768
    ds_read_b64_tr_b16 v[202:203], v74 offset:33792
    ds_read_b64_tr_b16 v[204:205], v75 offset:32768
    ds_read_b64_tr_b16 v[206:207], v75 offset:33792
    ds_read_b64_tr_b16 v[208:209], v74 offset:40960
    ds_read_b64_tr_b16 v[210:211], v74 offset:41984
    ds_read_b64_tr_b16 v[212:213], v75 offset:40960
    ds_read_b64_tr_b16 v[214:215], v75 offset:41984
    ds_read_b64_tr_b16 v[216:217], v74 offset:49152
    ds_read_b64_tr_b16 v[218:219], v74 offset:50176
    ds_read_b64_tr_b16 v[220:221], v75 offset:49152
    ds_read_b64_tr_b16 v[222:223], v75 offset:50176
    s_waitcnt lgkmcnt(0)
    s_barrier
    ds_read_b128 v[64:67], v98 offset:24576
    v_mfma_f32_16x16x32_bf16 v[24:27], v[44:47], v[140:143], v[24:27]
    v_mfma_f32_16x16x32_bf16 v[12:15], v[48:51], v[144:147], v[12:15]
    ds_read_b128 v[68:71], v99 offset:24576
    v_mfma_f32_16x16x32_bf16 v[20:23], v[48:51], v[148:151], v[20:23]
    s_add_u32 s37, s35, 73728
    s_add_u32 m0, s36, 122880
    s_nop 0
    buffer_load_dwordx4 v97, s[8:11], s37 offen offset:0 lds
    v_mfma_f32_16x16x32_bf16 v[16:19], v[52:55], v[144:147], v[16:19]
    ds_read_b128 v[44:47], v100 offset:24576
    v_mfma_f32_16x16x32_bf16 v[24:27], v[52:55], v[148:151], v[24:27]
    s_add_u32 m0, s36, 123776
    s_nop 0
    buffer_load_dwordx4 v97, s[8:11], s37 offen offset:128 lds
    v_mfma_f32_16x16x32_bf16 v[12:15], v[56:59], v[152:155], v[12:15]
    ds_read_b128 v[48:51], v101 offset:24576
    v_mfma_f32_16x16x32_bf16 v[20:23], v[56:59], v[156:159], v[20:23]
    s_add_u32 m0, s36, 124672
    s_nop 0
    buffer_load_dwordx4 v97, s[8:11], s37 offen offset:256 lds
    v_mfma_f32_16x16x32_bf16 v[16:19], v[60:63], v[152:155], v[16:19]
    ds_read_b128 v[52:55], v98 offset:25600
    v_mfma_f32_16x16x32_bf16 v[24:27], v[60:63], v[156:159], v[24:27]
    s_waitcnt lgkmcnt(3)
    v_mfma_f32_16x16x32_bf16 v[12:15], v[64:67], v[160:163], v[12:15]
    ds_read_b128 v[56:59], v99 offset:25600
    v_mfma_f32_16x16x32_bf16 v[20:23], v[64:67], v[164:167], v[20:23]
    v_mfma_f32_16x16x32_bf16 v[16:19], v[68:71], v[160:163], v[16:19]
    ds_read_b128 v[60:63], v100 offset:25600
    v_mfma_f32_16x16x32_bf16 v[24:27], v[68:71], v[164:167], v[24:27]
    s_waitcnt lgkmcnt(3)
    v_mfma_f32_16x16x32_bf16 v[12:15], v[44:47], v[168:171], v[12:15]
    ds_read_b128 v[64:67], v101 offset:25600
    v_mfma_f32_16x16x32_bf16 v[20:23], v[44:47], v[172:175], v[20:23]
    v_mfma_f32_16x16x32_bf16 v[16:19], v[48:51], v[168:171], v[16:19]
    ds_read_b128 v[68:71], v98 offset:26624
    v_mfma_f32_16x16x32_bf16 v[24:27], v[48:51], v[172:175], v[24:27]
    s_waitcnt lgkmcnt(3)
    v_mfma_f32_16x16x32_bf16 v[12:15], v[52:55], v[176:179], v[12:15]
    ds_read_b128 v[44:47], v99 offset:26624
    v_mfma_f32_16x16x32_bf16 v[20:23], v[52:55], v[180:183], v[20:23]
    v_mfma_f32_16x16x32_bf16 v[16:19], v[56:59], v[176:179], v[16:19]
    ds_read_b128 v[48:51], v100 offset:26624
    v_mfma_f32_16x16x32_bf16 v[24:27], v[56:59], v[180:183], v[24:27]
    s_waitcnt lgkmcnt(3)
    v_mfma_f32_16x16x32_bf16 v[12:15], v[60:63], v[184:187], v[12:15]
    ds_read_b128 v[52:55], v101 offset:26624
    v_mfma_f32_16x16x32_bf16 v[20:23], v[60:63], v[188:191], v[20:23]
    v_mfma_f32_16x16x32_bf16 v[16:19], v[64:67], v[184:187], v[16:19]
    s_waitcnt vmcnt(3)
    s_barrier
    ds_read_b64_tr_b16 v[224:225], v76 offset:0
    ds_read_b64_tr_b16 v[226:227], v76 offset:1024
    ds_read_b64_tr_b16 v[228:229], v77 offset:0
    ds_read_b64_tr_b16 v[230:231], v77 offset:1024
    ds_read_b64_tr_b16 v[232:233], v76 offset:8192
    ds_read_b64_tr_b16 v[234:235], v76 offset:9216
    ds_read_b64_tr_b16 v[236:237], v77 offset:8192
    ds_read_b64_tr_b16 v[238:239], v77 offset:9216
    ds_read_b64_tr_b16 v[240:241], v76 offset:16384
    ds_read_b64_tr_b16 v[242:243], v76 offset:17408
    ds_read_b64_tr_b16 v[244:245], v77 offset:16384
    ds_read_b64_tr_b16 v[246:247], v77 offset:17408
    ds_read_b64_tr_b16 v[248:249], v76 offset:24576
    ds_read_b64_tr_b16 v[250:251], v76 offset:25600
    ds_read_b64_tr_b16 v[252:253], v77 offset:24576
    ds_read_b64_tr_b16 v[254:255], v77 offset:25600
    s_waitcnt lgkmcnt(0)
    s_barrier
    ds_read_b128 v[56:59], v102 offset:0
    v_mfma_f32_16x16x32_bf16 v[24:27], v[64:67], v[188:191], v[24:27]
    v_mfma_f32_16x16x32_bf16 v[12:15], v[68:71], v[192:195], v[12:15]
    ds_read_b128 v[60:63], v103 offset:0
    v_mfma_f32_16x16x32_bf16 v[20:23], v[68:71], v[196:199], v[20:23]
    s_add_u32 s37, s35, 74112
    s_add_u32 m0, s36, 73728
    s_nop 0
    buffer_load_dwordx4 v97, s[8:11], s37 offen offset:0 lds
    v_mfma_f32_16x16x32_bf16 v[16:19], v[44:47], v[192:195], v[16:19]
    ds_read_b128 v[64:67], v104 offset:0
    v_mfma_f32_16x16x32_bf16 v[24:27], v[44:47], v[196:199], v[24:27]
    s_add_u32 m0, s36, 74624
    s_nop 0
    buffer_load_dwordx4 v97, s[8:11], s37 offen offset:128 lds
    v_mfma_f32_16x16x32_bf16 v[12:15], v[48:51], v[200:203], v[12:15]
    ds_read_b128 v[68:71], v105 offset:0
    v_mfma_f32_16x16x32_bf16 v[20:23], v[48:51], v[204:207], v[20:23]
    s_add_u32 m0, s36, 75520
    s_nop 0
    buffer_load_dwordx4 v97, s[8:11], s37 offen offset:256 lds
    v_mfma_f32_16x16x32_bf16 v[16:19], v[52:55], v[200:203], v[16:19]
    ds_read_b128 v[44:47], v102 offset:1024
    v_mfma_f32_16x16x32_bf16 v[24:27], v[52:55], v[204:207], v[24:27]
    s_add_u32 s37, s35, 74496
    s_add_u32 m0, s36, 98304
    s_nop 0
    buffer_load_dwordx4 v97, s[8:11], s37 offen offset:0 lds
    s_waitcnt lgkmcnt(4)
    v_mfma_f32_16x16x32_bf16 v[12:15], v[56:59], v[208:211], v[12:15]
    ds_read_b128 v[48:51], v103 offset:1024
    v_mfma_f32_16x16x32_bf16 v[20:23], v[56:59], v[212:215], v[20:23]
    s_add_u32 m0, s36, 99200
    s_nop 0
    buffer_load_dwordx4 v97, s[8:11], s37 offen offset:128 lds
    s_waitcnt lgkmcnt(4)
    v_mfma_f32_16x16x32_bf16 v[16:19], v[60:63], v[208:211], v[16:19]
    ds_read_b128 v[52:55], v104 offset:1024
    v_mfma_f32_16x16x32_bf16 v[24:27], v[60:63], v[212:215], v[24:27]
    s_add_u32 m0, s36, 100096
    s_nop 0
    buffer_load_dwordx4 v97, s[8:11], s37 offen offset:256 lds
    s_waitcnt lgkmcnt(4)
    v_mfma_f32_16x16x32_bf16 v[12:15], v[64:67], v[216:219], v[12:15]
    ds_read_b128 v[56:59], v105 offset:1024
    v_mfma_f32_16x16x32_bf16 v[20:23], v[64:67], v[220:223], v[20:23]
    s_waitcnt lgkmcnt(4)
    v_mfma_f32_16x16x32_bf16 v[16:19], v[68:71], v[216:219], v[16:19]
    ds_read_b128 v[60:63], v102 offset:2048
    v_mfma_f32_16x16x32_bf16 v[24:27], v[68:71], v[220:223], v[24:27]
    s_waitcnt lgkmcnt(3)
    v_mfma_f32_16x16x32_bf16 v[12:15], v[44:47], v[224:227], v[12:15]
    ds_read_b128 v[64:67], v103 offset:2048
    v_mfma_f32_16x16x32_bf16 v[20:23], v[44:47], v[228:231], v[20:23]
    s_add_u32 s37, s35, 147456
    s_add_u32 m0, s36, 0
    s_nop 0
    buffer_load_dwordx4 v97, s[8:11], s37 offen offset:0 lds
    v_mfma_f32_16x16x32_bf16 v[16:19], v[48:51], v[224:227], v[16:19]
    ds_read_b128 v[68:71], v104 offset:2048
    v_mfma_f32_16x16x32_bf16 v[24:27], v[48:51], v[228:231], v[24:27]
    s_waitcnt lgkmcnt(3)
    v_mfma_f32_16x16x32_bf16 v[12:15], v[52:55], v[232:235], v[12:15]
    ds_read_b128 v[44:47], v105 offset:2048
    v_mfma_f32_16x16x32_bf16 v[20:23], v[52:55], v[236:239], v[20:23]
    v_mfma_f32_16x16x32_bf16 v[16:19], v[56:59], v[232:235], v[16:19]
    s_waitcnt vmcnt(7)
    s_barrier
    ds_read_b128 v[48:51], v106 offset:24576
    v_mfma_f32_16x16x32_bf16 v[24:27], v[56:59], v[236:239], v[24:27]
    s_waitcnt lgkmcnt(3)
    v_mfma_f32_16x16x32_bf16 v[12:15], v[60:63], v[240:243], v[12:15]
    ds_read_b128 v[52:55], v107 offset:24576
    v_mfma_f32_16x16x32_bf16 v[20:23], v[60:63], v[244:247], v[20:23]
    s_add_u32 m0, s36, 896
    s_nop 0
    buffer_load_dwordx4 v97, s[8:11], s37 offen offset:128 lds
    v_mfma_f32_16x16x32_bf16 v[16:19], v[64:67], v[240:243], v[16:19]
    ds_read_b128 v[56:59], v108 offset:24576
    v_mfma_f32_16x16x32_bf16 v[24:27], v[64:67], v[244:247], v[24:27]
    s_add_u32 m0, s36, 1792
    s_nop 0
    buffer_load_dwordx4 v97, s[8:11], s37 offen offset:256 lds
    s_waitcnt lgkmcnt(4)
    v_mfma_f32_16x16x32_bf16 v[12:15], v[68:71], v[248:251], v[12:15]
    ds_read_b128 v[60:63], v109 offset:24576
    v_mfma_f32_16x16x32_bf16 v[20:23], v[68:71], v[252:255], v[20:23]
    s_waitcnt lgkmcnt(4)
    v_mfma_f32_16x16x32_bf16 v[16:19], v[44:47], v[248:251], v[16:19]
    ds_read_b128 v[64:67], v106 offset:25600
    v_mfma_f32_16x16x32_bf16 v[24:27], v[44:47], v[252:255], v[24:27]
    s_waitcnt lgkmcnt(3)
    v_mfma_f32_16x16x32_bf16 v[28:31], v[48:51], v[112:115], 0
    ds_read_b128 v[68:71], v107 offset:25600
    v_mfma_f32_16x16x32_bf16 v[36:39], v[48:51], v[116:119], 0
    s_add_u32 s37, s35, 147840
    s_add_u32 m0, s36, 24576
    s_nop 0
    buffer_load_dwordx4 v97, s[8:11], s37 offen offset:0 lds
    v_mfma_f32_16x16x32_bf16 v[32:35], v[52:55], v[112:115], 0
    ds_read_b128 v[44:47], v108 offset:25600
    v_mfma_f32_16x16x32_bf16 v[40:43], v[52:55], v[116:119], 0
    s_waitcnt lgkmcnt(3)
    v_mfma_f32_16x16x32_bf16 v[28:31], v[56:59], v[120:123], v[28:31]
    ds_read_b128 v[48:51], v109 offset:25600
    v_mfma_f32_16x16x32_bf16 v[36:39], v[56:59], v[124:127], v[36:39]
    s_add_u32 s45, s42, 0
    v_mfma_f32_16x16x32_bf16 v[32:35], v[60:63], v[120:123], v[32:35]
    ds_read_b128 v[52:55], v106 offset:26624
    v_mfma_f32_16x16x32_bf16 v[40:43], v[60:63], v[124:127], v[40:43]
    s_waitcnt lgkmcnt(3)
    s_mul_i32 s45, s45, 37376
    v_mfma_f32_16x16x32_bf16 v[28:31], v[64:67], v[128:131], v[28:31]
    ds_read_b128 v[56:59], v107 offset:26624
    v_mfma_f32_16x16x32_bf16 v[36:39], v[64:67], v[132:135], v[36:39]
    s_add_u32 m0, s36, 25472
    s_nop 0
    buffer_load_dwordx4 v97, s[8:11], s37 offen offset:128 lds
    v_mfma_f32_16x16x32_bf16 v[32:35], v[68:71], v[128:131], v[32:35]
    ds_read_b128 v[60:63], v108 offset:26624
    v_mul_f32 v80, s43, v12
    v_mfma_f32_16x16x32_bf16 v[40:43], v[68:71], v[132:135], v[40:43]
    s_waitcnt lgkmcnt(3)
    v_mfma_f32_16x16x32_bf16 v[28:31], v[44:47], v[136:139], v[28:31]
    ds_read_b128 v[64:67], v109 offset:26624
    v_mul_f32 v81, s43, v13
    v_mfma_f32_16x16x32_bf16 v[36:39], v[44:47], v[140:143], v[36:39]
    v_mfma_f32_16x16x32_bf16 v[32:35], v[48:51], v[136:139], v[32:35]
    s_waitcnt vmcnt(8)
    s_barrier
    ds_read_b128 v[68:71], v102 offset:24576
    v_cvt_pk_bf16_f32 v88, v80, v81
    v_mfma_f32_16x16x32_bf16 v[40:43], v[48:51], v[140:143], v[40:43]
    s_waitcnt lgkmcnt(3)
    v_mfma_f32_16x16x32_bf16 v[28:31], v[52:55], v[144:147], v[28:31]
    ds_read_b128 v[44:47], v103 offset:24576
    v_mfma_f32_16x16x32_bf16 v[36:39], v[52:55], v[148:151], v[36:39]
    s_add_u32 m0, s36, 26368
    s_nop 0
    buffer_load_dwordx4 v97, s[8:11], s37 offen offset:256 lds
    v_mul_f32 v82, s43, v14
    v_mfma_f32_16x16x32_bf16 v[32:35], v[56:59], v[144:147], v[32:35]
    ds_read_b128 v[48:51], v104 offset:24576
    v_mfma_f32_16x16x32_bf16 v[40:43], v[56:59], v[148:151], v[40:43]
    s_waitcnt lgkmcnt(3)
    v_mul_f32 v83, s43, v15
    v_mfma_f32_16x16x32_bf16 v[28:31], v[60:63], v[152:155], v[28:31]
    ds_read_b128 v[52:55], v105 offset:24576
    v_mfma_f32_16x16x32_bf16 v[36:39], v[60:63], v[156:159], v[36:39]
    v_mfma_f32_16x16x32_bf16 v[32:35], v[64:67], v[152:155], v[32:35]
    ds_read_b128 v[56:59], v102 offset:25600
    v_cvt_pk_bf16_f32 v89, v82, v83
    v_mfma_f32_16x16x32_bf16 v[40:43], v[64:67], v[156:159], v[40:43]
    s_waitcnt lgkmcnt(3)
    v_mfma_f32_16x16x32_bf16 v[28:31], v[68:71], v[160:163], v[28:31]
    ds_read_b128 v[60:63], v103 offset:25600
    v_mul_f32 v80, s43, v16
    v_mfma_f32_16x16x32_bf16 v[36:39], v[68:71], v[164:167], v[36:39]
    s_add_u32 s37, s35, 148224
    s_add_u32 m0, s36, 49152
    s_nop 0
    buffer_load_dwordx4 v97, s[8:11], s37 offen offset:0 lds
    v_mfma_f32_16x16x32_bf16 v[32:35], v[44:47], v[160:163], v[32:35]
    ds_read_b128 v[64:67], v104 offset:25600
    v_mfma_f32_16x16x32_bf16 v[40:43], v[44:47], v[164:167], v[40:43]
    s_waitcnt lgkmcnt(3)
    v_mul_f32 v81, s43, v17
    v_mfma_f32_16x16x32_bf16 v[28:31], v[48:51], v[168:171], v[28:31]
    ds_read_b128 v[68:71], v105 offset:25600
    v_mfma_f32_16x16x32_bf16 v[36:39], v[48:51], v[172:175], v[36:39]
    v_cvt_pk_bf16_f32 v90, v80, v81
    v_mfma_f32_16x16x32_bf16 v[32:35], v[52:55], v[168:171], v[32:35]
    ds_read_b128 v[44:47], v102 offset:26624
    v_mfma_f32_16x16x32_bf16 v[40:43], v[52:55], v[172:175], v[40:43]
    s_waitcnt lgkmcnt(3)
    v_mul_f32 v82, s43, v18
    v_mfma_f32_16x16x32_bf16 v[28:31], v[56:59], v[176:179], v[28:31]
    ds_read_b128 v[48:51], v103 offset:26624
    v_mfma_f32_16x16x32_bf16 v[36:39], v[56:59], v[180:183], v[36:39]
    s_add_u32 m0, s36, 50048
    s_nop 0
    buffer_load_dwordx4 v97, s[8:11], s37 offen offset:128 lds
    v_mfma_f32_16x16x32_bf16 v[32:35], v[60:63], v[176:179], v[32:35]
    ds_read_b128 v[52:55], v104 offset:26624
    v_mul_f32 v83, s43, v19
    v_mfma_f32_16x16x32_bf16 v[40:43], v[60:63], v[180:183], v[40:43]
    s_waitcnt lgkmcnt(3)
    v_mfma_f32_16x16x32_bf16 v[28:31], v[64:67], v[184:187], v[28:31]
    ds_read_b128 v[56:59], v105 offset:26624
    v_cvt_pk_bf16_f32 v91, v82, v83
    v_mfma_f32_16x16x32_bf16 v[36:39], v[64:67], v[188:191], v[36:39]
    v_mfma_f32_16x16x32_bf16 v[32:35], v[68:71], v[184:187], v[32:35]
    s_waitcnt vmcnt(8)
    s_barrier
    ds_read_b128 v[60:63], v106 offset:0
    v_mfma_f32_16x16x32_bf16 v[40:43], v[68:71], v[188:191], v[40:43]
    s_waitcnt lgkmcnt(3)
    buffer_store_dwordx4 v[88:91], v110, s[20:23], s45 offen sc1
    v_mfma_f32_16x16x32_bf16 v[28:31], v[44:47], v[192:195], v[28:31]
    ds_read_b128 v[64:67], v107 offset:0
    v_mfma_f32_16x16x32_bf16 v[36:39], v[44:47], v[196:199], v[36:39]
    s_add_u32 m0, s36, 50944
    s_nop 0
    buffer_load_dwordx4 v97, s[8:11], s37 offen offset:256 lds
    v_mul_f32 v80, s43, v20
    v_mfma_f32_16x16x32_bf16 v[32:35], v[48:51], v[192:195], v[32:35]
    ds_read_b128 v[68:71], v108 offset:0
    v_mfma_f32_16x16x32_bf16 v[40:43], v[48:51], v[196:199], v[40:43]
    s_waitcnt lgkmcnt(3)
    v_mfma_f32_16x16x32_bf16 v[28:31], v[52:55], v[200:203], v[28:31]
    ds_read_b128 v[44:47], v109 offset:0
    v_mul_f32 v81, s43, v21
    v_mfma_f32_16x16x32_bf16 v[36:39], v[52:55], v[204:207], v[36:39]
    v_mfma_f32_16x16x32_bf16 v[32:35], v[56:59], v[200:203], v[32:35]
    ds_read_b128 v[48:51], v106 offset:1024
    v_cvt_pk_bf16_f32 v92, v80, v81
    v_mfma_f32_16x16x32_bf16 v[40:43], v[56:59], v[204:207], v[40:43]
    s_waitcnt lgkmcnt(3)
    v_mfma_f32_16x16x32_bf16 v[28:31], v[60:63], v[208:211], v[28:31]
    ds_read_b128 v[52:55], v107 offset:1024
    v_mul_f32 v82, s43, v22
    v_mfma_f32_16x16x32_bf16 v[36:39], v[60:63], v[212:215], v[36:39]
    s_add_u32 s37, s35, 221184
    s_add_u32 m0, s36, 122880
    s_nop 0
    buffer_load_dwordx4 v97, s[8:11], s37 offen offset:0 lds
    v_mfma_f32_16x16x32_bf16 v[32:35], v[64:67], v[208:211], v[32:35]
    ds_read_b128 v[56:59], v108 offset:1024
    v_mfma_f32_16x16x32_bf16 v[40:43], v[64:67], v[212:215], v[40:43]
    s_waitcnt lgkmcnt(3)
    v_mul_f32 v83, s43, v23
    v_mfma_f32_16x16x32_bf16 v[28:31], v[68:71], v[216:219], v[28:31]
    ds_read_b128 v[60:63], v109 offset:1024
    v_mfma_f32_16x16x32_bf16 v[36:39], v[68:71], v[220:223], v[36:39]
    v_cvt_pk_bf16_f32 v93, v82, v83
    v_mfma_f32_16x16x32_bf16 v[32:35], v[44:47], v[216:219], v[32:35]
    ds_read_b128 v[64:67], v106 offset:2048
    v_mfma_f32_16x16x32_bf16 v[40:43], v[44:47], v[220:223], v[40:43]
    s_waitcnt lgkmcnt(3)
    v_mfma_f32_16x16x32_bf16 v[28:31], v[48:51], v[224:227], v[28:31]
    ds_read_b128 v[68:71], v107 offset:2048
    v_mul_f32 v80, s43, v24
    v_mfma_f32_16x16x32_bf16 v[36:39], v[48:51], v[228:231], v[36:39]
    s_add_u32 m0, s36, 123776
    s_nop 0
    buffer_load_dwordx4 v97, s[8:11], s37 offen offset:128 lds
    v_mfma_f32_16x16x32_bf16 v[32:35], v[52:55], v[224:227], v[32:35]
    ds_read_b128 v[44:47], v108 offset:2048
    v_mul_f32 v81, s43, v25
    v_mfma_f32_16x16x32_bf16 v[40:43], v[52:55], v[228:231], v[40:43]
    s_waitcnt lgkmcnt(3)
    v_mfma_f32_16x16x32_bf16 v[28:31], v[56:59], v[232:235], v[28:31]
    ds_read_b128 v[48:51], v109 offset:2048
    v_mfma_f32_16x16x32_bf16 v[36:39], v[56:59], v[236:239], v[36:39]
    v_cvt_pk_bf16_f32 v94, v80, v81
    v_mfma_f32_16x16x32_bf16 v[32:35], v[60:63], v[232:235], v[32:35]
    s_waitcnt vmcnt(9)
    s_barrier
    ds_read_b128 v[52:55], v98 offset:0
    v_mfma_f32_16x16x32_bf16 v[40:43], v[60:63], v[236:239], v[40:43]
    s_waitcnt lgkmcnt(3)
    v_mul_f32 v82, s43, v26
    v_mfma_f32_16x16x32_bf16 v[28:31], v[64:67], v[240:243], v[28:31]
    ds_read_b128 v[56:59], v99 offset:0
    v_mfma_f32_16x16x32_bf16 v[36:39], v[64:67], v[244:247], v[36:39]
    s_add_u32 m0, s36, 124672
    s_nop 0
    buffer_load_dwordx4 v97, s[8:11], s37 offen offset:256 lds
    v_mul_f32 v83, s43, v27
    v_mfma_f32_16x16x32_bf16 v[32:35], v[68:71], v[240:243], v[32:35]
    ds_read_b128 v[60:63], v100 offset:0
    v_mfma_f32_16x16x32_bf16 v[40:43], v[68:71], v[244:247], v[40:43]
    s_waitcnt lgkmcnt(3)
    v_mfma_f32_16x16x32_bf16 v[28:31], v[44:47], v[248:251], v[28:31]
    ds_read_b128 v[64:67], v101 offset:0
    v_cvt_pk_bf16_f32 v95, v82, v83
    v_mfma_f32_16x16x32_bf16 v[36:39], v[44:47], v[252:255], v[36:39]
    v_mfma_f32_16x16x32_bf16 v[32:35], v[48:51], v[248:251], v[32:35]
    ds_read_b128 v[68:71], v98 offset:1024
    buffer_store_dwordx4 v[92:95], v10, s[20:23], s45 offen sc1
    v_mfma_f32_16x16x32_bf16 v[40:43], v[48:51], v[252:255], v[40:43]
    s_waitcnt lgkmcnt(3)
    v_mfma_f32_16x16x32_bf16 v[12:15], v[52:55], v[112:115], 0
    ds_read_b128 v[44:47], v99 offset:1024
    v_mfma_f32_16x16x32_bf16 v[20:23], v[52:55], v[116:119], 0
    s_add_u32 s37, s35, 221568
    s_add_u32 m0, s36, 73728
    s_nop 0
    buffer_load_dwordx4 v97, s[8:11], s37 offen offset:0 lds
    v_mfma_f32_16x16x32_bf16 v[16:19], v[56:59], v[112:115], 0
    ds_read_b128 v[48:51], v100 offset:1024
    v_mfma_f32_16x16x32_bf16 v[24:27], v[56:59], v[116:119], 0
    s_waitcnt lgkmcnt(3)
    v_mfma_f32_16x16x32_bf16 v[12:15], v[60:63], v[120:123], v[12:15]
    ds_read_b128 v[52:55], v101 offset:1024
    v_mfma_f32_16x16x32_bf16 v[20:23], v[60:63], v[124:127], v[20:23]
    s_add_u32 s45, s42, 2
    v_mfma_f32_16x16x32_bf16 v[16:19], v[64:67], v[120:123], v[16:19]
    ds_read_b128 v[56:59], v98 offset:2048
    v_mfma_f32_16x16x32_bf16 v[24:27], v[64:67], v[124:127], v[24:27]
    s_waitcnt lgkmcnt(3)
    s_mul_i32 s45, s45, 37376
    v_mfma_f32_16x16x32_bf16 v[12:15], v[68:71], v[128:131], v[12:15]
    ds_read_b128 v[60:63], v99 offset:2048
    v_mfma_f32_16x16x32_bf16 v[20:23], v[68:71], v[132:135], v[20:23]
    s_add_u32 m0, s36, 74624
    s_nop 0
    buffer_load_dwordx4 v97, s[8:11], s37 offen offset:128 lds
    v_mfma_f32_16x16x32_bf16 v[16:19], v[44:47], v[128:131], v[16:19]
    ds_read_b128 v[64:67], v100 offset:2048
    v_mul_f32 v80, s43, v28
    v_mfma_f32_16x16x32_bf16 v[24:27], v[44:47], v[132:135], v[24:27]
    s_waitcnt lgkmcnt(3)
    v_mfma_f32_16x16x32_bf16 v[12:15], v[48:51], v[136:139], v[12:15]
    ds_read_b128 v[68:71], v101 offset:2048
    v_mul_f32 v81, s43, v29
    v_mfma_f32_16x16x32_bf16 v[20:23], v[48:51], v[140:143], v[20:23]
    v_mfma_f32_16x16x32_bf16 v[16:19], v[52:55], v[136:139], v[16:19]
    s_waitcnt vmcnt(10)
    s_barrier
    s_mov_b32 s16, s56
    s_mov_b32 s17, s57
    s_lshl_b32 s47, s41, 12
    s_add_u32 s18, s47, 1024
    buffer_load_dword v9, v8, s[16:19], s47 offen
    ds_read_b128 v[44:47], v98 offset:24576
    v_cvt_pk_bf16_f32 v88, v80, v81
    v_mfma_f32_16x16x32_bf16 v[24:27], v[52:55], v[140:143], v[24:27]
    s_waitcnt lgkmcnt(3)
    v_mfma_f32_16x16x32_bf16 v[12:15], v[56:59], v[144:147], v[12:15]
    ds_read_b128 v[48:51], v99 offset:24576
    v_mfma_f32_16x16x32_bf16 v[20:23], v[56:59], v[148:151], v[20:23]
    s_add_u32 m0, s36, 75520
    s_nop 0
    buffer_load_dwordx4 v97, s[8:11], s37 offen offset:256 lds
    v_mul_f32 v82, s43, v30
    v_mfma_f32_16x16x32_bf16 v[16:19], v[60:63], v[144:147], v[16:19]
    ds_read_b128 v[52:55], v100 offset:24576
    v_mfma_f32_16x16x32_bf16 v[24:27], v[60:63], v[148:151], v[24:27]
    s_waitcnt lgkmcnt(3)
    v_mul_f32 v83, s43, v31
    v_mfma_f32_16x16x32_bf16 v[12:15], v[64:67], v[152:155], v[12:15]
    ds_read_b128 v[56:59], v101 offset:24576
    v_mfma_f32_16x16x32_bf16 v[20:23], v[64:67], v[156:159], v[20:23]
    v_mfma_f32_16x16x32_bf16 v[16:19], v[68:71], v[152:155], v[16:19]
    ds_read_b128 v[60:63], v98 offset:25600
    v_cvt_pk_bf16_f32 v89, v82, v83
    v_mfma_f32_16x16x32_bf16 v[24:27], v[68:71], v[156:159], v[24:27]
    s_waitcnt lgkmcnt(3)
    v_mfma_f32_16x16x32_bf16 v[12:15], v[44:47], v[160:163], v[12:15]
    ds_read_b128 v[64:67], v99 offset:25600
    v_mul_f32 v80, s43, v32
    v_mfma_f32_16x16x32_bf16 v[20:23], v[44:47], v[164:167], v[20:23]
    s_add_u32 s37, s35, 221952
    s_add_u32 m0, s36, 98304
    s_nop 0
    buffer_load_dwordx4 v97, s[8:11], s37 offen offset:0 lds
    v_mfma_f32_16x16x32_bf16 v[16:19], v[48:51], v[160:163], v[16:19]
    ds_read_b128 v[68:71], v100 offset:25600
    v_mfma_f32_16x16x32_bf16 v[24:27], v[48:51], v[164:167], v[24:27]
    s_waitcnt lgkmcnt(3)
    v_mul_f32 v81, s43, v33
    v_mfma_f32_16x16x32_bf16 v[12:15], v[52:55], v[168:171], v[12:15]
    ds_read_b128 v[44:47], v101 offset:25600
    v_mfma_f32_16x16x32_bf16 v[20:23], v[52:55], v[172:175], v[20:23]
    v_cvt_pk_bf16_f32 v90, v80, v81
    v_mfma_f32_16x16x32_bf16 v[16:19], v[56:59], v[168:171], v[16:19]
    ds_read_b128 v[48:51], v98 offset:26624
    v_mfma_f32_16x16x32_bf16 v[24:27], v[56:59], v[172:175], v[24:27]
    s_waitcnt lgkmcnt(3)
    v_mul_f32 v82, s43, v34
    v_mfma_f32_16x16x32_bf16 v[12:15], v[60:63], v[176:179], v[12:15]
    ds_read_b128 v[52:55], v99 offset:26624
    v_mfma_f32_16x16x32_bf16 v[20:23], v[60:63], v[180:183], v[20:23]
    s_add_u32 m0, s36, 99200
    s_nop 0
    buffer_load_dwordx4 v97, s[8:11], s37 offen offset:128 lds
    v_mfma_f32_16x16x32_bf16 v[16:19], v[64:67], v[176:179], v[16:19]
    ds_read_b128 v[56:59], v100 offset:26624
    v_mul_f32 v83, s43, v35
    v_mfma_f32_16x16x32_bf16 v[24:27], v[64:67], v[180:183], v[24:27]
    s_waitcnt lgkmcnt(3)
    v_mfma_f32_16x16x32_bf16 v[12:15], v[68:71], v[184:187], v[12:15]
    ds_read_b128 v[60:63], v101 offset:26624
    v_cvt_pk_bf16_f32 v91, v82, v83
    v_mfma_f32_16x16x32_bf16 v[20:23], v[68:71], v[188:191], v[20:23]
    v_mfma_f32_16x16x32_bf16 v[16:19], v[44:47], v[184:187], v[16:19]
    s_waitcnt vmcnt(10)
    s_barrier
    ds_read_b128 v[64:67], v102 offset:0
    v_mfma_f32_16x16x32_bf16 v[24:27], v[44:47], v[188:191], v[24:27]
    s_waitcnt lgkmcnt(3)
    buffer_store_dwordx4 v[88:91], v110, s[20:23], s45 offen sc1
    v_mfma_f32_16x16x32_bf16 v[12:15], v[48:51], v[192:195], v[12:15]
    ds_read_b128 v[68:71], v103 offset:0
    v_mfma_f32_16x16x32_bf16 v[20:23], v[48:51], v[196:199], v[20:23]
    s_add_u32 m0, s36, 100096
    s_nop 0
    buffer_load_dwordx4 v97, s[8:11], s37 offen offset:256 lds
    v_mul_f32 v80, s43, v36
    v_mfma_f32_16x16x32_bf16 v[16:19], v[52:55], v[192:195], v[16:19]
    ds_read_b128 v[44:47], v104 offset:0
    v_mfma_f32_16x16x32_bf16 v[24:27], v[52:55], v[196:199], v[24:27]
    s_waitcnt lgkmcnt(3)
    v_mfma_f32_16x16x32_bf16 v[12:15], v[56:59], v[200:203], v[12:15]
    ds_read_b128 v[48:51], v105 offset:0
    v_mul_f32 v81, s43, v37
    v_mfma_f32_16x16x32_bf16 v[20:23], v[56:59], v[204:207], v[20:23]
    v_mfma_f32_16x16x32_bf16 v[16:19], v[60:63], v[200:203], v[16:19]
    ds_read_b128 v[52:55], v102 offset:1024
    v_cvt_pk_bf16_f32 v92, v80, v81
    v_mfma_f32_16x16x32_bf16 v[24:27], v[60:63], v[204:207], v[24:27]
    s_waitcnt lgkmcnt(3)
    v_mfma_f32_16x16x32_bf16 v[12:15], v[64:67], v[208:211], v[12:15]
    ds_read_b128 v[56:59], v103 offset:1024
    v_mul_f32 v82, s43, v38
    v_mfma_f32_16x16x32_bf16 v[20:23], v[64:67], v[212:215], v[20:23]
    s_add_u32 s37, s35, 294912
    s_add_u32 m0, s36, 0
    s_nop 0
    buffer_load_dwordx4 v97, s[8:11], s37 offen offset:0 lds
    v_mfma_f32_16x16x32_bf16 v[16:19], v[68:71], v[208:211], v[16:19]
    ds_read_b128 v[60:63], v104 offset:1024
    v_mfma_f32_16x16x32_bf16 v[24:27], v[68:71], v[212:215], v[24:27]
    s_waitcnt lgkmcnt(3)
    v_mul_f32 v83, s43, v39
    v_mfma_f32_16x16x32_bf16 v[12:15], v[44:47], v[216:219], v[12:15]
    ds_read_b128 v[64:67], v105 offset:1024
    v_mfma_f32_16x16x32_bf16 v[20:23], v[44:47], v[220:223], v[20:23]
    v_cvt_pk_bf16_f32 v93, v82, v83
    v_mfma_f32_16x16x32_bf16 v[16:19], v[48:51], v[216:219], v[16:19]
    ds_read_b128 v[68:71], v102 offset:2048
    v_mfma_f32_16x16x32_bf16 v[24:27], v[48:51], v[220:223], v[24:27]
    s_waitcnt lgkmcnt(3)
    v_mfma_f32_16x16x32_bf16 v[12:15], v[52:55], v[224:227], v[12:15]
    ds_read_b128 v[44:47], v103 offset:2048
    v_mul_f32 v80, s43, v40
    v_mfma_f32_16x16x32_bf16 v[20:23], v[52:55], v[228:231], v[20:23]
    s_add_u32 m0, s36, 896
    s_nop 0
    buffer_load_dwordx4 v97, s[8:11], s37 offen offset:128 lds
    v_mfma_f32_16x16x32_bf16 v[16:19], v[56:59], v[224:227], v[16:19]
    ds_read_b128 v[48:51], v104 offset:2048
    v_mul_f32 v81, s43, v41
    v_mfma_f32_16x16x32_bf16 v[24:27], v[56:59], v[228:231], v[24:27]
    s_waitcnt lgkmcnt(3)
    v_mfma_f32_16x16x32_bf16 v[12:15], v[60:63], v[232:235], v[12:15]
    ds_read_b128 v[52:55], v105 offset:2048
    v_mfma_f32_16x16x32_bf16 v[20:23], v[60:63], v[236:239], v[20:23]
    v_cvt_pk_bf16_f32 v94, v80, v81
    v_mfma_f32_16x16x32_bf16 v[16:19], v[64:67], v[232:235], v[16:19]
    s_waitcnt vmcnt(11)
    s_barrier
    ds_read_b128 v[56:59], v106 offset:24576
    v_mfma_f32_16x16x32_bf16 v[24:27], v[64:67], v[236:239], v[24:27]
    s_waitcnt lgkmcnt(3)
    v_mul_f32 v82, s43, v42
    v_mfma_f32_16x16x32_bf16 v[12:15], v[68:71], v[240:243], v[12:15]
    ds_read_b128 v[60:63], v107 offset:24576
    v_mfma_f32_16x16x32_bf16 v[20:23], v[68:71], v[244:247], v[20:23]
    s_add_u32 m0, s36, 1792
    s_nop 0
    buffer_load_dwordx4 v97, s[8:11], s37 offen offset:256 lds
    v_mul_f32 v83, s43, v43
    v_mfma_f32_16x16x32_bf16 v[16:19], v[44:47], v[240:243], v[16:19]
    ds_read_b128 v[64:67], v108 offset:24576
    v_mfma_f32_16x16x32_bf16 v[24:27], v[44:47], v[244:247], v[24:27]
    s_waitcnt lgkmcnt(3)
    v_mfma_f32_16x16x32_bf16 v[12:15], v[48:51], v[248:251], v[12:15]
    ds_read_b128 v[68:71], v109 offset:24576
    v_cvt_pk_bf16_f32 v95, v82, v83
    v_mfma_f32_16x16x32_bf16 v[20:23], v[48:51], v[252:255], v[20:23]
    v_mfma_f32_16x16x32_bf16 v[16:19], v[52:55], v[248:251], v[16:19]
    ds_read_b128 v[44:47], v106 offset:25600
    buffer_store_dwordx4 v[92:95], v10, s[20:23], s45 offen sc1
    v_mfma_f32_16x16x32_bf16 v[24:27], v[52:55], v[252:255], v[24:27]
    s_waitcnt lgkmcnt(3)
    v_mfma_f32_16x16x32_bf16 v[28:31], v[56:59], v[112:115], 0
    ds_read_b128 v[48:51], v107 offset:25600
    v_mfma_f32_16x16x32_bf16 v[36:39], v[56:59], v[116:119], 0
    s_add_u32 s37, s35, 295296
    s_add_u32 m0, s36, 24576
    s_nop 0
    buffer_load_dwordx4 v97, s[8:11], s37 offen offset:0 lds
    v_mfma_f32_16x16x32_bf16 v[32:35], v[60:63], v[112:115], 0
    ds_read_b128 v[52:55], v108 offset:25600
    v_mfma_f32_16x16x32_bf16 v[40:43], v[60:63], v[116:119], 0
    s_waitcnt lgkmcnt(3)
    v_mfma_f32_16x16x32_bf16 v[28:31], v[64:67], v[120:123], v[28:31]
    ds_read_b128 v[56:59], v109 offset:25600
    v_mfma_f32_16x16x32_bf16 v[36:39], v[64:67], v[124:127], v[36:39]
    s_add_u32 s45, s42, 4
    v_mfma_f32_16x16x32_bf16 v[32:35], v[68:71], v[120:123], v[32:35]
    ds_read_b128 v[60:63], v106 offset:26624
    v_mfma_f32_16x16x32_bf16 v[40:43], v[68:71], v[124:127], v[40:43]
    s_waitcnt lgkmcnt(3)
    s_mul_i32 s45, s45, 37376
    v_mfma_f32_16x16x32_bf16 v[28:31], v[44:47], v[128:131], v[28:31]
    ds_read_b128 v[64:67], v107 offset:26624
    v_mfma_f32_16x16x32_bf16 v[36:39], v[44:47], v[132:135], v[36:39]
    s_add_u32 m0, s36, 25472
    s_nop 0
    buffer_load_dwordx4 v97, s[8:11], s37 offen offset:128 lds
    v_mfma_f32_16x16x32_bf16 v[32:35], v[48:51], v[128:131], v[32:35]
    ds_read_b128 v[68:71], v108 offset:26624
    v_mul_f32 v80, s43, v12
    v_mfma_f32_16x16x32_bf16 v[40:43], v[48:51], v[132:135], v[40:43]
    s_waitcnt lgkmcnt(3)
    v_mfma_f32_16x16x32_bf16 v[28:31], v[52:55], v[136:139], v[28:31]
    ds_read_b128 v[44:47], v109 offset:26624
    v_mul_f32 v81, s43, v13
    v_mfma_f32_16x16x32_bf16 v[36:39], v[52:55], v[140:143], v[36:39]
    v_mfma_f32_16x16x32_bf16 v[32:35], v[56:59], v[136:139], v[32:35]
    s_waitcnt vmcnt(10)
    s_barrier
    ds_read_b128 v[48:51], v102 offset:24576
    v_cvt_pk_bf16_f32 v88, v80, v81
    v_mfma_f32_16x16x32_bf16 v[40:43], v[56:59], v[140:143], v[40:43]
    s_waitcnt lgkmcnt(3)
    v_mfma_f32_16x16x32_bf16 v[28:31], v[60:63], v[144:147], v[28:31]
    ds_read_b128 v[52:55], v103 offset:24576
    v_mfma_f32_16x16x32_bf16 v[36:39], v[60:63], v[148:151], v[36:39]
    s_add_u32 m0, s36, 26368
    s_nop 0
    buffer_load_dwordx4 v97, s[8:11], s37 offen offset:256 lds
    v_mul_f32 v82, s43, v14
    v_mfma_f32_16x16x32_bf16 v[32:35], v[64:67], v[144:147], v[32:35]
    ds_read_b128 v[56:59], v104 offset:24576
    v_mfma_f32_16x16x32_bf16 v[40:43], v[64:67], v[148:151], v[40:43]
    s_waitcnt lgkmcnt(3)
    v_mul_f32 v83, s43, v15
    v_mfma_f32_16x16x32_bf16 v[28:31], v[68:71], v[152:155], v[28:31]
    ds_read_b128 v[60:63], v105 offset:24576
    v_mfma_f32_16x16x32_bf16 v[36:39], v[68:71], v[156:159], v[36:39]
    v_mfma_f32_16x16x32_bf16 v[32:35], v[44:47], v[152:155], v[32:35]
    ds_read_b128 v[64:67], v102 offset:25600
    v_cvt_pk_bf16_f32 v89, v82, v83
    v_mfma_f32_16x16x32_bf16 v[40:43], v[44:47], v[156:159], v[40:43]
    s_waitcnt lgkmcnt(3)
    v_mfma_f32_16x16x32_bf16 v[28:31], v[48:51], v[160:163], v[28:31]
    ds_read_b128 v[68:71], v103 offset:25600
    v_mul_f32 v80, s43, v16
    v_mfma_f32_16x16x32_bf16 v[36:39], v[48:51], v[164:167], v[36:39]
    s_add_u32 s37, s35, 295680
    s_add_u32 m0, s36, 49152
    s_nop 0
    buffer_load_dwordx4 v97, s[8:11], s37 offen offset:0 lds
    v_mfma_f32_16x16x32_bf16 v[32:35], v[52:55], v[160:163], v[32:35]
    ds_read_b128 v[44:47], v104 offset:25600
    v_mfma_f32_16x16x32_bf16 v[40:43], v[52:55], v[164:167], v[40:43]
    s_waitcnt lgkmcnt(3)
    v_mul_f32 v81, s43, v17
    v_mfma_f32_16x16x32_bf16 v[28:31], v[56:59], v[168:171], v[28:31]
    ds_read_b128 v[48:51], v105 offset:25600
    v_mfma_f32_16x16x32_bf16 v[36:39], v[56:59], v[172:175], v[36:39]
    v_cvt_pk_bf16_f32 v90, v80, v81
    v_mfma_f32_16x16x32_bf16 v[32:35], v[60:63], v[168:171], v[32:35]
    ds_read_b128 v[52:55], v102 offset:26624
    v_mfma_f32_16x16x32_bf16 v[40:43], v[60:63], v[172:175], v[40:43]
    s_waitcnt lgkmcnt(3)
    v_mul_f32 v82, s43, v18
    v_mfma_f32_16x16x32_bf16 v[28:31], v[64:67], v[176:179], v[28:31]
    ds_read_b128 v[56:59], v103 offset:26624
    v_mfma_f32_16x16x32_bf16 v[36:39], v[64:67], v[180:183], v[36:39]
    s_add_u32 m0, s36, 50048
    s_nop 0
    buffer_load_dwordx4 v97, s[8:11], s37 offen offset:128 lds
    v_mfma_f32_16x16x32_bf16 v[32:35], v[68:71], v[176:179], v[32:35]
    ds_read_b128 v[60:63], v104 offset:26624
    v_mul_f32 v83, s43, v19
    v_mfma_f32_16x16x32_bf16 v[40:43], v[68:71], v[180:183], v[40:43]
    s_waitcnt lgkmcnt(3)
    v_mfma_f32_16x16x32_bf16 v[28:31], v[44:47], v[184:187], v[28:31]
    ds_read_b128 v[64:67], v105 offset:26624
    v_cvt_pk_bf16_f32 v91, v82, v83
    v_mfma_f32_16x16x32_bf16 v[36:39], v[44:47], v[188:191], v[36:39]
    v_mfma_f32_16x16x32_bf16 v[32:35], v[48:51], v[184:187], v[32:35]
    s_waitcnt vmcnt(9)
    s_barrier
    ds_read_b128 v[68:71], v106 offset:0
    v_mfma_f32_16x16x32_bf16 v[40:43], v[48:51], v[188:191], v[40:43]
    s_waitcnt lgkmcnt(3)
    buffer_store_dwordx4 v[88:91], v110, s[20:23], s45 offen sc1
    v_mfma_f32_16x16x32_bf16 v[28:31], v[52:55], v[192:195], v[28:31]
    ds_read_b128 v[44:47], v107 offset:0
    v_mfma_f32_16x16x32_bf16 v[36:39], v[52:55], v[196:199], v[36:39]
    s_add_u32 m0, s36, 50944
    s_nop 0
    buffer_load_dwordx4 v97, s[8:11], s37 offen offset:256 lds
    v_mul_f32 v80, s43, v20
    v_mfma_f32_16x16x32_bf16 v[32:35], v[56:59], v[192:195], v[32:35]
    ds_read_b128 v[48:51], v108 offset:0
    v_mfma_f32_16x16x32_bf16 v[40:43], v[56:59], v[196:199], v[40:43]
    s_waitcnt lgkmcnt(3)
    v_mfma_f32_16x16x32_bf16 v[28:31], v[60:63], v[200:203], v[28:31]
    ds_read_b128 v[52:55], v109 offset:0
    v_mul_f32 v81, s43, v21
    v_mfma_f32_16x16x32_bf16 v[36:39], v[60:63], v[204:207], v[36:39]
    v_mfma_f32_16x16x32_bf16 v[32:35], v[64:67], v[200:203], v[32:35]
    ds_read_b128 v[56:59], v106 offset:1024
    v_cvt_pk_bf16_f32 v92, v80, v81
    v_mfma_f32_16x16x32_bf16 v[40:43], v[64:67], v[204:207], v[40:43]
    s_waitcnt lgkmcnt(3)
    v_mfma_f32_16x16x32_bf16 v[28:31], v[68:71], v[208:211], v[28:31]
    ds_read_b128 v[60:63], v107 offset:1024
    v_mul_f32 v82, s43, v22
    v_mfma_f32_16x16x32_bf16 v[36:39], v[68:71], v[212:215], v[36:39]
    s_add_u32 s37, s35, 368640
    s_add_u32 m0, s36, 122880
    s_nop 0
    buffer_load_dwordx4 v97, s[8:11], s37 offen offset:0 lds
    v_mfma_f32_16x16x32_bf16 v[32:35], v[44:47], v[208:211], v[32:35]
    ds_read_b128 v[64:67], v108 offset:1024
    v_mfma_f32_16x16x32_bf16 v[40:43], v[44:47], v[212:215], v[40:43]
    s_waitcnt lgkmcnt(3)
    v_mul_f32 v83, s43, v23
    v_mfma_f32_16x16x32_bf16 v[28:31], v[48:51], v[216:219], v[28:31]
    ds_read_b128 v[68:71], v109 offset:1024
    v_mfma_f32_16x16x32_bf16 v[36:39], v[48:51], v[220:223], v[36:39]
    v_cvt_pk_bf16_f32 v93, v82, v83
    v_mfma_f32_16x16x32_bf16 v[32:35], v[52:55], v[216:219], v[32:35]
    ds_read_b128 v[44:47], v106 offset:2048
    v_mfma_f32_16x16x32_bf16 v[40:43], v[52:55], v[220:223], v[40:43]
    s_waitcnt lgkmcnt(3)
    v_mfma_f32_16x16x32_bf16 v[28:31], v[56:59], v[224:227], v[28:31]
    ds_read_b128 v[48:51], v107 offset:2048
    v_mul_f32 v80, s43, v24
    v_mfma_f32_16x16x32_bf16 v[36:39], v[56:59], v[228:231], v[36:39]
    s_add_u32 m0, s36, 123776
    s_nop 0
    buffer_load_dwordx4 v97, s[8:11], s37 offen offset:128 lds
    v_mfma_f32_16x16x32_bf16 v[32:35], v[60:63], v[224:227], v[32:35]
    ds_read_b128 v[52:55], v108 offset:2048
    v_mul_f32 v81, s43, v25
    v_mfma_f32_16x16x32_bf16 v[40:43], v[60:63], v[228:231], v[40:43]
    s_waitcnt lgkmcnt(3)
    v_mfma_f32_16x16x32_bf16 v[28:31], v[64:67], v[232:235], v[28:31]
    ds_read_b128 v[56:59], v109 offset:2048
    v_mfma_f32_16x16x32_bf16 v[36:39], v[64:67], v[236:239], v[36:39]
    v_cvt_pk_bf16_f32 v94, v80, v81
    v_mfma_f32_16x16x32_bf16 v[32:35], v[68:71], v[232:235], v[32:35]
    s_waitcnt vmcnt(10)
    s_barrier
    ds_read_b128 v[60:63], v98 offset:0
    v_mfma_f32_16x16x32_bf16 v[40:43], v[68:71], v[236:239], v[40:43]
    s_waitcnt lgkmcnt(3)
    v_mul_f32 v82, s43, v26
    v_mfma_f32_16x16x32_bf16 v[28:31], v[44:47], v[240:243], v[28:31]
    ds_read_b128 v[64:67], v99 offset:0
    v_mfma_f32_16x16x32_bf16 v[36:39], v[44:47], v[244:247], v[36:39]
    s_add_u32 m0, s36, 124672
    s_nop 0
    buffer_load_dwordx4 v97, s[8:11], s37 offen offset:256 lds
    v_mul_f32 v83, s43, v27
    v_mfma_f32_16x16x32_bf16 v[32:35], v[48:51], v[240:243], v[32:35]
    ds_read_b128 v[68:71], v100 offset:0
    v_mfma_f32_16x16x32_bf16 v[40:43], v[48:51], v[244:247], v[40:43]
    s_waitcnt lgkmcnt(3)
    v_mfma_f32_16x16x32_bf16 v[28:31], v[52:55], v[248:251], v[28:31]
    ds_read_b128 v[44:47], v101 offset:0
    v_cvt_pk_bf16_f32 v95, v82, v83
    v_mfma_f32_16x16x32_bf16 v[36:39], v[52:55], v[252:255], v[36:39]
    v_mfma_f32_16x16x32_bf16 v[32:35], v[56:59], v[248:251], v[32:35]
    ds_read_b128 v[48:51], v98 offset:1024
    buffer_store_dwordx4 v[92:95], v10, s[20:23], s45 offen sc1
    v_mfma_f32_16x16x32_bf16 v[40:43], v[56:59], v[252:255], v[40:43]
    s_waitcnt lgkmcnt(3)
    v_mfma_f32_16x16x32_bf16 v[12:15], v[60:63], v[112:115], 0
    ds_read_b128 v[52:55], v99 offset:1024
    v_mfma_f32_16x16x32_bf16 v[20:23], v[60:63], v[116:119], 0
    s_add_u32 s37, s35, 369024
    s_add_u32 m0, s36, 73728
    s_nop 0
    buffer_load_dwordx4 v97, s[8:11], s37 offen offset:0 lds
    v_mfma_f32_16x16x32_bf16 v[16:19], v[64:67], v[112:115], 0
    ds_read_b128 v[56:59], v100 offset:1024
    v_mfma_f32_16x16x32_bf16 v[24:27], v[64:67], v[116:119], 0
    s_waitcnt lgkmcnt(3)
    v_mfma_f32_16x16x32_bf16 v[12:15], v[68:71], v[120:123], v[12:15]
    ds_read_b128 v[60:63], v101 offset:1024
    v_mfma_f32_16x16x32_bf16 v[20:23], v[68:71], v[124:127], v[20:23]
    s_add_u32 s45, s42, 6
    v_mfma_f32_16x16x32_bf16 v[16:19], v[44:47], v[120:123], v[16:19]
    ds_read_b128 v[64:67], v98 offset:2048
    v_mfma_f32_16x16x32_bf16 v[24:27], v[44:47], v[124:127], v[24:27]
    s_waitcnt lgkmcnt(3)
    s_mul_i32 s45, s45, 37376
    v_mfma_f32_16x16x32_bf16 v[12:15], v[48:51], v[128:131], v[12:15]
    ds_read_b128 v[68:71], v99 offset:2048
    v_mfma_f32_16x16x32_bf16 v[20:23], v[48:51], v[132:135], v[20:23]
    s_add_u32 m0, s36, 74624
    s_nop 0
    buffer_load_dwordx4 v97, s[8:11], s37 offen offset:128 lds
    v_mfma_f32_16x16x32_bf16 v[16:19], v[52:55], v[128:131], v[16:19]
    ds_read_b128 v[44:47], v100 offset:2048
    v_mul_f32 v80, s43, v28
    v_mfma_f32_16x16x32_bf16 v[24:27], v[52:55], v[132:135], v[24:27]
    s_waitcnt lgkmcnt(3)
    v_mfma_f32_16x16x32_bf16 v[12:15], v[56:59], v[136:139], v[12:15]
    ds_read_b128 v[48:51], v101 offset:2048
    v_mul_f32 v81, s43, v29
    v_mfma_f32_16x16x32_bf16 v[20:23], v[56:59], v[140:143], v[20:23]
    v_mfma_f32_16x16x32_bf16 v[16:19], v[60:63], v[136:139], v[16:19]
    s_waitcnt vmcnt(10)
    s_barrier
    ds_read_b128 v[52:55], v98 offset:24576
    v_cvt_pk_bf16_f32 v88, v80, v81
    v_mfma_f32_16x16x32_bf16 v[24:27], v[60:63], v[140:143], v[24:27]
    s_waitcnt lgkmcnt(3)
    v_mfma_f32_16x16x32_bf16 v[12:15], v[64:67], v[144:147], v[12:15]
    ds_read_b128 v[56:59], v99 offset:24576
    v_mfma_f32_16x16x32_bf16 v[20:23], v[64:67], v[148:151], v[20:23]
    s_add_u32 m0, s36, 75520
    s_nop 0
    buffer_load_dwordx4 v97, s[8:11], s37 offen offset:256 lds
    v_mul_f32 v82, s43, v30
    v_mfma_f32_16x16x32_bf16 v[16:19], v[68:71], v[144:147], v[16:19]
    ds_read_b128 v[60:63], v100 offset:24576
    v_mfma_f32_16x16x32_bf16 v[24:27], v[68:71], v[148:151], v[24:27]
    s_waitcnt lgkmcnt(3)
    v_mul_f32 v83, s43, v31
    v_mfma_f32_16x16x32_bf16 v[12:15], v[44:47], v[152:155], v[12:15]
    ds_read_b128 v[64:67], v101 offset:24576
    v_mfma_f32_16x16x32_bf16 v[20:23], v[44:47], v[156:159], v[20:23]
    v_mfma_f32_16x16x32_bf16 v[16:19], v[48:51], v[152:155], v[16:19]
    ds_read_b128 v[68:71], v98 offset:25600
    v_cvt_pk_bf16_f32 v89, v82, v83
    v_mfma_f32_16x16x32_bf16 v[24:27], v[48:51], v[156:159], v[24:27]
    s_waitcnt lgkmcnt(3)
    v_mfma_f32_16x16x32_bf16 v[12:15], v[52:55], v[160:163], v[12:15]
    ds_read_b128 v[44:47], v99 offset:25600
    v_mul_f32 v80, s43, v32
    v_mfma_f32_16x16x32_bf16 v[20:23], v[52:55], v[164:167], v[20:23]
    s_add_u32 s37, s35, 369408
    s_add_u32 m0, s36, 98304
    s_nop 0
    buffer_load_dwordx4 v97, s[8:11], s37 offen offset:0 lds
    v_mfma_f32_16x16x32_bf16 v[16:19], v[56:59], v[160:163], v[16:19]
    ds_read_b128 v[48:51], v100 offset:25600
    v_mfma_f32_16x16x32_bf16 v[24:27], v[56:59], v[164:167], v[24:27]
    s_waitcnt lgkmcnt(3)
    v_mul_f32 v81, s43, v33
    v_mfma_f32_16x16x32_bf16 v[12:15], v[60:63], v[168:171], v[12:15]
    ds_read_b128 v[52:55], v101 offset:25600
    v_mfma_f32_16x16x32_bf16 v[20:23], v[60:63], v[172:175], v[20:23]
    v_cvt_pk_bf16_f32 v90, v80, v81
    v_mfma_f32_16x16x32_bf16 v[16:19], v[64:67], v[168:171], v[16:19]
    ds_read_b128 v[56:59], v98 offset:26624
    v_mfma_f32_16x16x32_bf16 v[24:27], v[64:67], v[172:175], v[24:27]
    s_waitcnt lgkmcnt(3)
    v_mul_f32 v82, s43, v34
    v_mfma_f32_16x16x32_bf16 v[12:15], v[68:71], v[176:179], v[12:15]
    ds_read_b128 v[60:63], v99 offset:26624
    v_mfma_f32_16x16x32_bf16 v[20:23], v[68:71], v[180:183], v[20:23]
    s_add_u32 m0, s36, 99200
    s_nop 0
    buffer_load_dwordx4 v97, s[8:11], s37 offen offset:128 lds
    v_mfma_f32_16x16x32_bf16 v[16:19], v[44:47], v[176:179], v[16:19]
    ds_read_b128 v[64:67], v100 offset:26624
    v_mul_f32 v83, s43, v35
    v_mfma_f32_16x16x32_bf16 v[24:27], v[44:47], v[180:183], v[24:27]
    s_waitcnt lgkmcnt(3)
    v_mfma_f32_16x16x32_bf16 v[12:15], v[48:51], v[184:187], v[12:15]
    ds_read_b128 v[68:71], v101 offset:26624
    v_cvt_pk_bf16_f32 v91, v82, v83
    v_mfma_f32_16x16x32_bf16 v[20:23], v[48:51], v[188:191], v[20:23]
    v_mfma_f32_16x16x32_bf16 v[16:19], v[52:55], v[184:187], v[16:19]
    s_waitcnt vmcnt(9)
    s_barrier
    ds_read_b128 v[44:47], v102 offset:0
    v_mfma_f32_16x16x32_bf16 v[24:27], v[52:55], v[188:191], v[24:27]
    s_waitcnt lgkmcnt(3)
    buffer_store_dwordx4 v[88:91], v110, s[20:23], s45 offen sc1
    v_mfma_f32_16x16x32_bf16 v[12:15], v[56:59], v[192:195], v[12:15]
    ds_read_b128 v[48:51], v103 offset:0
    v_mfma_f32_16x16x32_bf16 v[20:23], v[56:59], v[196:199], v[20:23]
    s_add_u32 m0, s36, 100096
    s_nop 0
    buffer_load_dwordx4 v97, s[8:11], s37 offen offset:256 lds
    v_mul_f32 v80, s43, v36
    v_mfma_f32_16x16x32_bf16 v[16:19], v[60:63], v[192:195], v[16:19]
    ds_read_b128 v[52:55], v104 offset:0
    v_mfma_f32_16x16x32_bf16 v[24:27], v[60:63], v[196:199], v[24:27]
    s_waitcnt lgkmcnt(3)
    v_mfma_f32_16x16x32_bf16 v[12:15], v[64:67], v[200:203], v[12:15]
    ds_read_b128 v[56:59], v105 offset:0
    v_mul_f32 v81, s43, v37
    v_mfma_f32_16x16x32_bf16 v[20:23], v[64:67], v[204:207], v[20:23]
    v_mfma_f32_16x16x32_bf16 v[16:19], v[68:71], v[200:203], v[16:19]
    ds_read_b128 v[60:63], v102 offset:1024
    v_cvt_pk_bf16_f32 v92, v80, v81
    v_mfma_f32_16x16x32_bf16 v[24:27], v[68:71], v[204:207], v[24:27]
    s_waitcnt lgkmcnt(3)
    v_mfma_f32_16x16x32_bf16 v[12:15], v[44:47], v[208:211], v[12:15]
    ds_read_b128 v[64:67], v103 offset:1024
    v_mul_f32 v82, s43, v38
    v_mfma_f32_16x16x32_bf16 v[20:23], v[44:47], v[212:215], v[20:23]
    s_add_u32 s37, s33, 0
    s_add_u32 m0, s36, 0
    s_nop 0
    buffer_load_dwordx4 v97, s[8:11], s37 offen offset:0 lds
    v_mfma_f32_16x16x32_bf16 v[16:19], v[48:51], v[208:211], v[16:19]
    ds_read_b128 v[68:71], v104 offset:1024
    v_mfma_f32_16x16x32_bf16 v[24:27], v[48:51], v[212:215], v[24:27]
    s_waitcnt lgkmcnt(3)
    v_mul_f32 v83, s43, v39
    v_mfma_f32_16x16x32_bf16 v[12:15], v[52:55], v[216:219], v[12:15]
    ds_read_b128 v[44:47], v105 offset:1024
    v_mfma_f32_16x16x32_bf16 v[20:23], v[52:55], v[220:223], v[20:23]
    v_cvt_pk_bf16_f32 v93, v82, v83
    v_mfma_f32_16x16x32_bf16 v[16:19], v[56:59], v[216:219], v[16:19]
    ds_read_b128 v[48:51], v102 offset:2048
    v_mfma_f32_16x16x32_bf16 v[24:27], v[56:59], v[220:223], v[24:27]
    s_waitcnt lgkmcnt(3)
    v_mfma_f32_16x16x32_bf16 v[12:15], v[60:63], v[224:227], v[12:15]
    ds_read_b128 v[52:55], v103 offset:2048
    v_mul_f32 v80, s43, v40
    v_mfma_f32_16x16x32_bf16 v[20:23], v[60:63], v[228:231], v[20:23]
    s_add_u32 m0, s36, 896
    s_nop 0
    buffer_load_dwordx4 v97, s[8:11], s37 offen offset:128 lds
    v_mfma_f32_16x16x32_bf16 v[16:19], v[64:67], v[224:227], v[16:19]
    ds_read_b128 v[56:59], v104 offset:2048
    v_mul_f32 v81, s43, v41
    v_mfma_f32_16x16x32_bf16 v[24:27], v[64:67], v[228:231], v[24:27]
    s_waitcnt lgkmcnt(3)
    v_mfma_f32_16x16x32_bf16 v[12:15], v[68:71], v[232:235], v[12:15]
    ds_read_b128 v[60:63], v105 offset:2048
    v_mfma_f32_16x16x32_bf16 v[20:23], v[68:71], v[236:239], v[20:23]
    v_cvt_pk_bf16_f32 v94, v80, v81
    v_mfma_f32_16x16x32_bf16 v[16:19], v[44:47], v[232:235], v[16:19]
    s_waitcnt vmcnt(10)
    s_barrier
    ds_read_b128 v[64:67], v106 offset:24576
    v_mfma_f32_16x16x32_bf16 v[24:27], v[44:47], v[236:239], v[24:27]
    s_waitcnt lgkmcnt(3)
    v_mul_f32 v82, s43, v42
    v_mfma_f32_16x16x32_bf16 v[12:15], v[48:51], v[240:243], v[12:15]
    ds_read_b128 v[68:71], v107 offset:24576
    v_mfma_f32_16x16x32_bf16 v[20:23], v[48:51], v[244:247], v[20:23]
    s_add_u32 m0, s36, 1792
    s_nop 0
    buffer_load_dwordx4 v97, s[8:11], s37 offen offset:256 lds
    v_mul_f32 v83, s43, v43
    v_mfma_f32_16x16x32_bf16 v[16:19], v[52:55], v[240:243], v[16:19]
    ds_read_b128 v[44:47], v108 offset:24576
    v_mfma_f32_16x16x32_bf16 v[24:27], v[52:55], v[244:247], v[24:27]
    s_waitcnt lgkmcnt(3)
    v_mfma_f32_16x16x32_bf16 v[12:15], v[56:59], v[248:251], v[12:15]
    ds_read_b128 v[48:51], v109 offset:24576
    v_cvt_pk_bf16_f32 v95, v82, v83
    v_mfma_f32_16x16x32_bf16 v[20:23], v[56:59], v[252:255], v[20:23]
    v_mfma_f32_16x16x32_bf16 v[16:19], v[60:63], v[248:251], v[16:19]
    ds_read_b128 v[52:55], v106 offset:25600
    buffer_store_dwordx4 v[92:95], v10, s[20:23], s45 offen sc1
    v_mfma_f32_16x16x32_bf16 v[24:27], v[60:63], v[252:255], v[24:27]
    s_waitcnt lgkmcnt(3)
    v_mfma_f32_16x16x32_bf16 v[28:31], v[64:67], v[112:115], 0
    ds_read_b128 v[56:59], v107 offset:25600
    v_mfma_f32_16x16x32_bf16 v[36:39], v[64:67], v[116:119], 0
    s_add_u32 s37, s33, 384
    s_add_u32 m0, s36, 24576
    s_nop 0
    buffer_load_dwordx4 v97, s[8:11], s37 offen offset:0 lds
    v_mfma_f32_16x16x32_bf16 v[32:35], v[68:71], v[112:115], 0
    ds_read_b128 v[60:63], v108 offset:25600
    v_mfma_f32_16x16x32_bf16 v[40:43], v[68:71], v[116:119], 0
    s_add_u32 m0, s36, 25472
    s_nop 0
    buffer_load_dwordx4 v97, s[8:11], s37 offen offset:128 lds
    s_waitcnt lgkmcnt(4)
    v_mfma_f32_16x16x32_bf16 v[28:31], v[44:47], v[120:123], v[28:31]
    ds_read_b128 v[64:67], v109 offset:25600
    v_mfma_f32_16x16x32_bf16 v[36:39], v[44:47], v[124:127], v[36:39]
    s_add_u32 m0, s36, 26368
    s_nop 0
    buffer_load_dwordx4 v97, s[8:11], s37 offen offset:256 lds
    s_add_u32 s45, s42, 8
    s_waitcnt lgkmcnt(4)
    v_mfma_f32_16x16x32_bf16 v[32:35], v[48:51], v[120:123], v[32:35]
    ds_read_b128 v[68:71], v106 offset:26624
    v_mfma_f32_16x16x32_bf16 v[40:43], v[48:51], v[124:127], v[40:43]
    s_waitcnt lgkmcnt(3)
    s_mul_i32 s45, s45, 37376
    v_mfma_f32_16x16x32_bf16 v[28:31], v[52:55], v[128:131], v[28:31]
    ds_read_b128 v[44:47], v107 offset:26624
    v_mfma_f32_16x16x32_bf16 v[36:39], v[52:55], v[132:135], v[36:39]
    v_mfma_f32_16x16x32_bf16 v[32:35], v[56:59], v[128:131], v[32:35]
    ds_read_b128 v[48:51], v108 offset:26624
    v_mul_f32 v80, s43, v12
    v_mfma_f32_16x16x32_bf16 v[40:43], v[56:59], v[132:135], v[40:43]
    s_waitcnt lgkmcnt(3)
    v_mfma_f32_16x16x32_bf16 v[28:31], v[60:63], v[136:139], v[28:31]
    ds_read_b128 v[52:55], v109 offset:26624
    v_mul_f32 v81, s43, v13
    v_mfma_f32_16x16x32_bf16 v[36:39], v[60:63], v[140:143], v[36:39]
    v_mfma_f32_16x16x32_bf16 v[32:35], v[64:67], v[136:139], v[32:35]
    s_waitcnt vmcnt(11)
    s_barrier
    ds_read_b128 v[56:59], v102 offset:24576
    v_cvt_pk_bf16_f32 v88, v80, v81
    v_mfma_f32_16x16x32_bf16 v[40:43], v[64:67], v[140:143], v[40:43]
    s_waitcnt lgkmcnt(3)
    v_mfma_f32_16x16x32_bf16 v[28:31], v[68:71], v[144:147], v[28:31]
    ds_read_b128 v[60:63], v103 offset:24576
    v_mfma_f32_16x16x32_bf16 v[36:39], v[68:71], v[148:151], v[36:39]
    s_add_u32 s37, s33, 768
    s_add_u32 m0, s36, 49152
    s_nop 0
    buffer_load_dwordx4 v97, s[8:11], s37 offen offset:0 lds
    v_mul_f32 v82, s43, v14
    v_mfma_f32_16x16x32_bf16 v[32:35], v[44:47], v[144:147], v[32:35]
    ds_read_b128 v[64:67], v104 offset:24576
    v_mfma_f32_16x16x32_bf16 v[40:43], v[44:47], v[148:151], v[40:43]
    s_add_u32 m0, s36, 50048
    s_nop 0
    buffer_load_dwordx4 v97, s[8:11], s37 offen offset:128 lds
    v_mul_f32 v83, s43, v15
    s_waitcnt lgkmcnt(4)
    v_mfma_f32_16x16x32_bf16 v[28:31], v[48:51], v[152:155], v[28:31]
    ds_read_b128 v[68:71], v105 offset:24576
    v_mfma_f32_16x16x32_bf16 v[36:39], v[48:51], v[156:159], v[36:39]
    s_add_u32 m0, s36, 50944
    s_nop 0
    buffer_load_dwordx4 v97, s[8:11], s37 offen offset:256 lds
    s_waitcnt lgkmcnt(4)
    v_mfma_f32_16x16x32_bf16 v[32:35], v[52:55], v[152:155], v[32:35]
    ds_read_b128 v[44:47], v102 offset:25600
    v_cvt_pk_bf16_f32 v89, v82, v83
    v_mfma_f32_16x16x32_bf16 v[40:43], v[52:55], v[156:159], v[40:43]
    s_waitcnt lgkmcnt(3)
    v_mfma_f32_16x16x32_bf16 v[28:31], v[56:59], v[160:163], v[28:31]
    ds_read_b128 v[48:51], v103 offset:25600
    v_mul_f32 v80, s43, v16
    v_mfma_f32_16x16x32_bf16 v[36:39], v[56:59], v[164:167], v[36:39]
    v_mfma_f32_16x16x32_bf16 v[32:35], v[60:63], v[160:163], v[32:35]
    ds_read_b128 v[52:55], v104 offset:25600
    v_mfma_f32_16x16x32_bf16 v[40:43], v[60:63], v[164:167], v[40:43]
    s_waitcnt lgkmcnt(3)
    v_mul_f32 v81, s43, v17
    v_mfma_f32_16x16x32_bf16 v[28:31], v[64:67], v[168:171], v[28:31]
    ds_read_b128 v[56:59], v105 offset:25600
    v_mfma_f32_16x16x32_bf16 v[36:39], v[64:67], v[172:175], v[36:39]
    v_cvt_pk_bf16_f32 v90, v80, v81
    v_mfma_f32_16x16x32_bf16 v[32:35], v[68:71], v[168:171], v[32:35]
    ds_read_b128 v[60:63], v102 offset:26624
    v_mfma_f32_16x16x32_bf16 v[40:43], v[68:71], v[172:175], v[40:43]
    s_waitcnt lgkmcnt(3)
    v_mul_f32 v82, s43, v18
    v_mfma_f32_16x16x32_bf16 v[28:31], v[44:47], v[176:179], v[28:31]
    ds_read_b128 v[64:67], v103 offset:26624
    v_mfma_f32_16x16x32_bf16 v[36:39], v[44:47], v[180:183], v[36:39]
    v_mfma_f32_16x16x32_bf16 v[32:35], v[48:51], v[176:179], v[32:35]
    ds_read_b128 v[68:71], v104 offset:26624
    v_mul_f32 v83, s43, v19
    v_mfma_f32_16x16x32_bf16 v[40:43], v[48:51], v[180:183], v[40:43]
    s_waitcnt lgkmcnt(3)
    v_mfma_f32_16x16x32_bf16 v[28:31], v[52:55], v[184:187], v[28:31]
    ds_read_b128 v[44:47], v105 offset:26624
    v_cvt_pk_bf16_f32 v91, v82, v83
    v_mfma_f32_16x16x32_bf16 v[36:39], v[52:55], v[188:191], v[36:39]
    v_mfma_f32_16x16x32_bf16 v[32:35], v[56:59], v[184:187], v[32:35]
    s_waitcnt vmcnt(10)
    s_barrier
    ds_read_b128 v[48:51], v106 offset:0
    v_mfma_f32_16x16x32_bf16 v[40:43], v[56:59], v[188:191], v[40:43]
    s_waitcnt lgkmcnt(3)
    buffer_store_dwordx4 v[88:91], v110, s[20:23], s45 offen sc1
    v_mfma_f32_16x16x32_bf16 v[28:31], v[60:63], v[192:195], v[28:31]
    ds_read_b128 v[52:55], v107 offset:0
    v_mfma_f32_16x16x32_bf16 v[36:39], v[60:63], v[196:199], v[36:39]
    v_mul_f32 v80, s43, v20
    v_mfma_f32_16x16x32_bf16 v[32:35], v[64:67], v[192:195], v[32:35]
    ds_read_b128 v[56:59], v108 offset:0
    v_mfma_f32_16x16x32_bf16 v[40:43], v[64:67], v[196:199], v[40:43]
    s_waitcnt lgkmcnt(3)
    v_mfma_f32_16x16x32_bf16 v[28:31], v[68:71], v[200:203], v[28:31]
    ds_read_b128 v[60:63], v109 offset:0
    v_mul_f32 v81, s43, v21
    v_mfma_f32_16x16x32_bf16 v[36:39], v[68:71], v[204:207], v[36:39]
    v_mfma_f32_16x16x32_bf16 v[32:35], v[44:47], v[200:203], v[32:35]
    ds_read_b128 v[64:67], v106 offset:1024
    v_cvt_pk_bf16_f32 v92, v80, v81
    v_mfma_f32_16x16x32_bf16 v[40:43], v[44:47], v[204:207], v[40:43]
    s_waitcnt lgkmcnt(3)
    v_mfma_f32_16x16x32_bf16 v[28:31], v[48:51], v[208:211], v[28:31]
    ds_read_b128 v[68:71], v107 offset:1024
    v_mul_f32 v82, s43, v22
    v_mfma_f32_16x16x32_bf16 v[36:39], v[48:51], v[212:215], v[36:39]
    v_mfma_f32_16x16x32_bf16 v[32:35], v[52:55], v[208:211], v[32:35]
    ds_read_b128 v[44:47], v108 offset:1024
    v_mfma_f32_16x16x32_bf16 v[40:43], v[52:55], v[212:215], v[40:43]
    s_waitcnt lgkmcnt(3)
    v_mul_f32 v83, s43, v23
    v_mfma_f32_16x16x32_bf16 v[28:31], v[56:59], v[216:219], v[28:31]
    ds_read_b128 v[48:51], v109 offset:1024
    v_mfma_f32_16x16x32_bf16 v[36:39], v[56:59], v[220:223], v[36:39]
    v_cvt_pk_bf16_f32 v93, v82, v83
    v_mfma_f32_16x16x32_bf16 v[32:35], v[60:63], v[216:219], v[32:35]
    ds_read_b128 v[52:55], v106 offset:2048
    v_mfma_f32_16x16x32_bf16 v[40:43], v[60:63], v[220:223], v[40:43]
    s_waitcnt lgkmcnt(3)
    v_mfma_f32_16x16x32_bf16 v[28:31], v[64:67], v[224:227], v[28:31]
    ds_read_b128 v[56:59], v107 offset:2048
    v_mul_f32 v80, s43, v24
    v_mfma_f32_16x16x32_bf16 v[36:39], v[64:67], v[228:231], v[36:39]
    v_mfma_f32_16x16x32_bf16 v[32:35], v[68:71], v[224:227], v[32:35]
    ds_read_b128 v[60:63], v108 offset:2048
    v_mul_f32 v81, s43, v25
    v_mfma_f32_16x16x32_bf16 v[40:43], v[68:71], v[228:231], v[40:43]
    s_waitcnt lgkmcnt(3)
    v_mfma_f32_16x16x32_bf16 v[28:31], v[44:47], v[232:235], v[28:31]
    ds_read_b128 v[64:67], v109 offset:2048
    v_mfma_f32_16x16x32_bf16 v[36:39], v[44:47], v[236:239], v[36:39]
    v_cvt_pk_bf16_f32 v94, v80, v81
    v_mfma_f32_16x16x32_bf16 v[32:35], v[48:51], v[232:235], v[32:35]
    s_waitcnt vmcnt(1)
    s_barrier
    v_add_u32 v98, s49, v98
    v_add_u32 v99, s49, v99
    v_add_u32 v100, s49, v100
    v_add_u32 v101, s49, v101
    v_add_u32 v102, s49, v102
    v_add_u32 v103, s49, v103
    v_add_u32 v104, s49, v104
    v_add_u32 v105, s49, v105
    ds_read_b128 v[68:71], v98 offset:0
    v_mfma_f32_16x16x32_bf16 v[40:43], v[48:51], v[236:239], v[40:43]
    s_waitcnt lgkmcnt(3)
    v_mul_f32 v82, s43, v26
    v_mfma_f32_16x16x32_bf16 v[28:31], v[52:55], v[240:243], v[28:31]
    ds_read_b128 v[44:47], v99 offset:0
    v_mfma_f32_16x16x32_bf16 v[36:39], v[52:55], v[244:247], v[36:39]
    v_mul_f32 v83, s43, v27
    v_mfma_f32_16x16x32_bf16 v[32:35], v[56:59], v[240:243], v[32:35]
    ds_read_b128 v[48:51], v100 offset:0
    v_mfma_f32_16x16x32_bf16 v[40:43], v[56:59], v[244:247], v[40:43]
    s_waitcnt lgkmcnt(3)
    v_mfma_f32_16x16x32_bf16 v[28:31], v[60:63], v[248:251], v[28:31]
    ds_read_b128 v[52:55], v101 offset:0
    v_cvt_pk_bf16_f32 v95, v82, v83
    v_mfma_f32_16x16x32_bf16 v[36:39], v[60:63], v[252:255], v[36:39]
    v_mfma_f32_16x16x32_bf16 v[32:35], v[64:67], v[248:251], v[32:35]
    ds_read_b128 v[56:59], v98 offset:1024
    buffer_store_dwordx4 v[92:95], v10, s[20:23], s45 offen sc1
    v_mfma_f32_16x16x32_bf16 v[40:43], v[64:67], v[252:255], v[40:43]
    s_waitcnt lgkmcnt(3)
    s_cmp_eq_u32 s48, 0
    s_cbranch_scc1 K1_L_fin
    v_mfma_f32_16x16x32_bf16 v[12:15], v[68:71], v[112:115], 0
    ds_read_b128 v[60:63], v99 offset:1024
    v_mfma_f32_16x16x32_bf16 v[20:23], v[68:71], v[116:119], 0
    v_mfma_f32_16x16x32_bf16 v[16:19], v[44:47], v[112:115], 0
    ds_read_b128 v[64:67], v100 offset:1024
    v_mfma_f32_16x16x32_bf16 v[24:27], v[44:47], v[116:119], 0
    s_waitcnt lgkmcnt(3)
    v_mfma_f32_16x16x32_bf16 v[12:15], v[48:51], v[120:123], v[12:15]
    ds_read_b128 v[68:71], v101 offset:1024
    v_mfma_f32_16x16x32_bf16 v[20:23], v[48:51], v[124:127], v[20:23]
    s_add_u32 s45, s42, 10
    v_mfma_f32_16x16x32_bf16 v[16:19], v[52:55], v[120:123], v[16:19]
    ds_read_b128 v[44:47], v98 offset:2048
    v_mfma_f32_16x16x32_bf16 v[24:27], v[52:55], v[124:127], v[24:27]
    s_waitcnt lgkmcnt(3)
    s_mul_i32 s45, s45, 37376
    v_mfma_f32_16x16x32_bf16 v[12:15], v[56:59], v[128:131], v[12:15]
    ds_read_b128 v[48:51], v99 offset:2048
    v_mfma_f32_16x16x32_bf16 v[20:23], v[56:59], v[132:135], v[20:23]
    v_mfma_f32_16x16x32_bf16 v[16:19], v[60:63], v[128:131], v[16:19]
    ds_read_b128 v[52:55], v100 offset:2048
    v_mul_f32 v80, s43, v28
    v_mfma_f32_16x16x32_bf16 v[24:27], v[60:63], v[132:135], v[24:27]
    s_waitcnt lgkmcnt(3)
    v_mfma_f32_16x16x32_bf16 v[12:15], v[64:67], v[136:139], v[12:15]
    ds_read_b128 v[56:59], v101 offset:2048
    v_mul_f32 v81, s43, v29
    v_mfma_f32_16x16x32_bf16 v[20:23], v[64:67], v[140:143], v[20:23]
    v_mfma_f32_16x16x32_bf16 v[16:19], v[68:71], v[136:139], v[16:19]
    ds_read_b128 v[60:63], v98 offset:24576
    v_cvt_pk_bf16_f32 v88, v80, v81
    v_mfma_f32_16x16x32_bf16 v[24:27], v[68:71], v[140:143], v[24:27]
    s_waitcnt lgkmcnt(3)
    v_mfma_f32_16x16x32_bf16 v[12:15], v[44:47], v[144:147], v[12:15]
    ds_read_b128 v[64:67], v99 offset:24576
    v_mfma_f32_16x16x32_bf16 v[20:23], v[44:47], v[148:151], v[20:23]
    v_mul_f32 v82, s43, v30
    v_mfma_f32_16x16x32_bf16 v[16:19], v[48:51], v[144:147], v[16:19]
    ds_read_b128 v[68:71], v100 offset:24576
    v_mfma_f32_16x16x32_bf16 v[24:27], v[48:51], v[148:151], v[24:27]
    s_waitcnt lgkmcnt(3)
    v_mul_f32 v83, s43, v31
    v_mfma_f32_16x16x32_bf16 v[12:15], v[52:55], v[152:155], v[12:15]
    ds_read_b128 v[44:47], v101 offset:24576
    v_mfma_f32_16x16x32_bf16 v[20:23], v[52:55], v[156:159], v[20:23]
    v_mfma_f32_16x16x32_bf16 v[16:19], v[56:59], v[152:155], v[16:19]
    ds_read_b128 v[48:51], v98 offset:25600
    v_cvt_pk_bf16_f32 v89, v82, v83
    v_mfma_f32_16x16x32_bf16 v[24:27], v[56:59], v[156:159], v[24:27]
    s_waitcnt lgkmcnt(3)
    v_mfma_f32_16x16x32_bf16 v[12:15], v[60:63], v[160:163], v[12:15]
    ds_read_b128 v[52:55], v99 offset:25600
    v_mul_f32 v80, s43, v32
    v_mfma_f32_16x16x32_bf16 v[20:23], v[60:63], v[164:167], v[20:23]
    v_mfma_f32_16x16x32_bf16 v[16:19], v[64:67], v[160:163], v[16:19]
    ds_read_b128 v[56:59], v100 offset:25600
    v_mfma_f32_16x16x32_bf16 v[24:27], v[64:67], v[164:167], v[24:27]
    s_waitcnt lgkmcnt(3)
    v_mul_f32 v81, s43, v33
    v_mfma_f32_16x16x32_bf16 v[12:15], v[68:71], v[168:171], v[12:15]
    ds_read_b128 v[60:63], v101 offset:25600
    v_mfma_f32_16x16x32_bf16 v[20:23], v[68:71], v[172:175], v[20:23]
    v_cvt_pk_bf16_f32 v90, v80, v81
    v_mfma_f32_16x16x32_bf16 v[16:19], v[44:47], v[168:171], v[16:19]
    ds_read_b128 v[64:67], v98 offset:26624
    v_mfma_f32_16x16x32_bf16 v[24:27], v[44:47], v[172:175], v[24:27]
    s_waitcnt lgkmcnt(3)
    v_mul_f32 v82, s43, v34
    v_mfma_f32_16x16x32_bf16 v[12:15], v[48:51], v[176:179], v[12:15]
    ds_read_b128 v[68:71], v99 offset:26624
    v_mfma_f32_16x16x32_bf16 v[20:23], v[48:51], v[180:183], v[20:23]
    v_mfma_f32_16x16x32_bf16 v[16:19], v[52:55], v[176:179], v[16:19]
    ds_read_b128 v[44:47], v100 offset:26624
    v_mul_f32 v83, s43, v35
    v_mfma_f32_16x16x32_bf16 v[24:27], v[52:55], v[180:183], v[24:27]
    s_waitcnt lgkmcnt(3)
    v_mfma_f32_16x16x32_bf16 v[12:15], v[56:59], v[184:187], v[12:15]
    ds_read_b128 v[48:51], v101 offset:26624
    v_cvt_pk_bf16_f32 v91, v82, v83
    v_mfma_f32_16x16x32_bf16 v[20:23], v[56:59], v[188:191], v[20:23]
    v_mfma_f32_16x16x32_bf16 v[16:19], v[60:63], v[184:187], v[16:19]
    ds_read_b128 v[52:55], v102 offset:0
    v_mfma_f32_16x16x32_bf16 v[24:27], v[60:63], v[188:191], v[24:27]
    s_waitcnt lgkmcnt(3)
    buffer_store_dwordx4 v[88:91], v110, s[20:23], s45 offen sc1
    v_mfma_f32_16x16x32_bf16 v[12:15], v[64:67], v[192:195], v[12:15]
    ds_read_b128 v[56:59], v103 offset:0
    v_mfma_f32_16x16x32_bf16 v[20:23], v[64:67], v[196:199], v[20:23]
    v_mul_f32 v80, s43, v36
    v_mfma_f32_16x16x32_bf16 v[16:19], v[68:71], v[192:195], v[16:19]
    ds_read_b128 v[60:63], v104 offset:0
    v_mfma_f32_16x16x32_bf16 v[24:27], v[68:71], v[196:199], v[24:27]
    s_waitcnt lgkmcnt(3)
    v_mfma_f32_16x16x32_bf16 v[12:15], v[44:47], v[200:203], v[12:15]
    ds_read_b128 v[64:67], v105 offset:0
    v_mul_f32 v81, s43, v37
    v_mfma_f32_16x16x32_bf16 v[20:23], v[44:47], v[204:207], v[20:23]
    v_mfma_f32_16x16x32_bf16 v[16:19], v[48:51], v[200:203], v[16:19]
    ds_read_b128 v[68:71], v102 offset:1024
    v_cvt_pk_bf16_f32 v92, v80, v81
    v_mfma_f32_16x16x32_bf16 v[24:27], v[48:51], v[204:207], v[24:27]
    s_waitcnt lgkmcnt(3)
    v_mfma_f32_16x16x32_bf16 v[12:15], v[52:55], v[208:211], v[12:15]
    ds_read_b128 v[44:47], v103 offset:1024
    v_mul_f32 v82, s43, v38
    v_mfma_f32_16x16x32_bf16 v[20:23], v[52:55], v[212:215], v[20:23]
    v_mfma_f32_16x16x32_bf16 v[16:19], v[56:59], v[208:211], v[16:19]
    ds_read_b128 v[48:51], v104 offset:1024
    v_mfma_f32_16x16x32_bf16 v[24:27], v[56:59], v[212:215], v[24:27]
    s_waitcnt lgkmcnt(3)
    v_mul_f32 v83, s43, v39
    v_mfma_f32_16x16x32_bf16 v[12:15], v[60:63], v[216:219], v[12:15]
    ds_read_b128 v[52:55], v105 offset:1024
    v_mfma_f32_16x16x32_bf16 v[20:23], v[60:63], v[220:223], v[20:23]
    v_cvt_pk_bf16_f32 v93, v82, v83
    v_mfma_f32_16x16x32_bf16 v[16:19], v[64:67], v[216:219], v[16:19]
    ds_read_b128 v[56:59], v102 offset:2048
    v_mfma_f32_16x16x32_bf16 v[24:27], v[64:67], v[220:223], v[24:27]
    s_waitcnt lgkmcnt(3)
    v_mfma_f32_16x16x32_bf16 v[12:15], v[68:71], v[224:227], v[12:15]
    ds_read_b128 v[60:63], v103 offset:2048
    v_mul_f32 v80, s43, v40
    v_mfma_f32_16x16x32_bf16 v[20:23], v[68:71], v[228:231], v[20:23]
    v_mfma_f32_16x16x32_bf16 v[16:19], v[44:47], v[224:227], v[16:19]
    ds_read_b128 v[64:67], v104 offset:2048
    v_mul_f32 v81, s43, v41
    v_mfma_f32_16x16x32_bf16 v[24:27], v[44:47], v[228:231], v[24:27]
    s_waitcnt lgkmcnt(3)
    v_mfma_f32_16x16x32_bf16 v[12:15], v[48:51], v[232:235], v[12:15]
    ds_read_b128 v[68:71], v105 offset:2048
    v_mfma_f32_16x16x32_bf16 v[20:23], v[48:51], v[236:239], v[20:23]
    v_cvt_pk_bf16_f32 v94, v80, v81
    v_mfma_f32_16x16x32_bf16 v[16:19], v[52:55], v[232:235], v[16:19]
    v_mfma_f32_16x16x32_bf16 v[24:27], v[52:55], v[236:239], v[24:27]
    s_waitcnt lgkmcnt(2)
    v_mul_f32 v82, s43, v42
    v_mfma_f32_16x16x32_bf16 v[12:15], v[56:59], v[240:243], v[12:15]
    v_mfma_f32_16x16x32_bf16 v[20:23], v[56:59], v[244:247], v[20:23]
    v_mul_f32 v83, s43, v43
    v_mfma_f32_16x16x32_bf16 v[16:19], v[60:63], v[240:243], v[16:19]
    v_mfma_f32_16x16x32_bf16 v[24:27], v[60:63], v[244:247], v[24:27]
    s_waitcnt lgkmcnt(0)
    v_mfma_f32_16x16x32_bf16 v[12:15], v[64:67], v[248:251], v[12:15]
    v_cvt_pk_bf16_f32 v95, v82, v83
    v_mfma_f32_16x16x32_bf16 v[20:23], v[64:67], v[252:255], v[20:23]
    v_mfma_f32_16x16x32_bf16 v[16:19], v[68:71], v[248:251], v[16:19]
    buffer_store_dwordx4 v[92:95], v10, s[20:23], s45 offen sc1
    v_mfma_f32_16x16x32_bf16 v[24:27], v[68:71], v[252:255], v[24:27]
    s_mul_i32 s45, s44, 37376
    s_nop 1
    v_mul_f32 v80, s43, v12
    v_mul_f32 v81, s43, v13
    v_cvt_pk_bf16_f32 v88, v80, v81
    v_mul_f32 v82, s43, v14
    v_mul_f32 v83, s43, v15
    v_cvt_pk_bf16_f32 v89, v82, v83
    v_mul_f32 v80, s43, v16
    v_mul_f32 v81, s43, v17
    v_cvt_pk_bf16_f32 v90, v80, v81
    v_mul_f32 v82, s43, v18
    v_mul_f32 v83, s43, v19
    v_cvt_pk_bf16_f32 v91, v82, v83
    buffer_store_dwordx4 v[88:91], v110, s[20:23], s45 offen sc1
    v_mul_f32 v80, s43, v20
    v_mul_f32 v81, s43, v21
    v_cvt_pk_bf16_f32 v92, v80, v81
    v_mul_f32 v82, s43, v22
    v_mul_f32 v83, s43, v23
    v_cvt_pk_bf16_f32 v93, v82, v83
    v_mul_f32 v80, s43, v24
    v_mul_f32 v81, s43, v25
    v_cvt_pk_bf16_f32 v94, v80, v81
    v_mul_f32 v82, s43, v26
    v_mul_f32 v83, s43, v27
    v_cvt_pk_bf16_f32 v95, v82, v83
    buffer_store_dwordx4 v[92:95], v10, s[20:23], s45 offen sc1
    s_endpgm
K1_L_fin:
    s_lshl_b32 s48, s2, 2
    s_and_b32 s47, s32, 3
    s_add_u32 s48, s48, s47
    s_cmp_eq_u32 s34, 1
    s_cselect_b32 s48, s48, 1000
    s_mul_i32 s49, s48, 4608
    s_lshl_b32 s50, s48, 4
    s_add_u32 s50, s50, 58720256
    s_cmp_lt_u32 s48, 512
    s_cselect_b32 s49, s49, 0x7f000000
    s_cselect_b32 s50, s50, 0x7f000000
    s_mov_b32 s24, s26
    s_mov_b32 s25, s27
    s_cselect_b32 s26, 1152, 0
    s_mov_b32 s27, 0x00020000
    v_and_b32 v4, 31, v1
    v_lshlrev_b32 v4, 4, v4
    v_mul_u32_u24 v5, 1152, v6
    v_add_u32 v5, v5, v4
    v_mov_b32 v7, 0x7f000000
    v_cmp_gt_u32 vcc, 128, v4
    s_nop 1
    v_cndmask_b32 v7, v7, v5, vcc
    buffer_load_dwordx4 v[136:139], v4, s[24:27], 0 offen offset:0
    buffer_load_dwordx4 v[140:143], v4, s[24:27], 0 offen offset:512
    buffer_load_dwordx4 v[144:147], v4, s[24:27], 0 offen offset:1024
    buffer_load_dwordx4 v[112:115], v5, s[8:11], s49 offen offset:0
    buffer_load_dwordx4 v[116:119], v5, s[8:11], s49 offen offset:512
    buffer_load_dwordx4 v[120:123], v7, s[8:11], s49 offen offset:1024
    buffer_load_dwordx4 v[124:127], v5, s[8:11], s49 offen offset:2304
    buffer_load_dwordx4 v[128:131], v5, s[8:11], s49 offen offset:2816
    buffer_load_dwordx4 v[132:135], v7, s[8:11], s49 offen offset:3328
    s_add_u32 s45, s42, 10
    s_mul_i32 s45, s45, 37376
    v_mul_f32 v80, s43, v28
    v_mul_f32 v81, s43, v29
    v_cvt_pk_bf16_f32 v88, v80, v81
    v_mul_f32 v82, s43, v30
    v_mul_f32 v83, s43, v31
    v_cvt_pk_bf16_f32 v89, v82, v83
    v_mul_f32 v80, s43, v32
    v_mul_f32 v81, s43, v33
    v_cvt_pk_bf16_f32 v90, v80, v81
    v_mul_f32 v82, s43, v34
    v_mul_f32 v83, s43, v35
    v_cvt_pk_bf16_f32 v91, v82, v83
    buffer_store_dwordx4 v[88:91], v110, s[20:23], s45 offen sc1
    v_mul_f32 v80, s43, v36
    v_mul_f32 v81, s43, v37
    v_cvt_pk_bf16_f32 v92, v80, v81
    v_mul_f32 v82, s43, v38
    v_mul_f32 v83, s43, v39
    v_cvt_pk_bf16_f32 v93, v82, v83
    v_mul_f32 v80, s43, v40
    v_mul_f32 v81, s43, v41
    v_cvt_pk_bf16_f32 v94, v80, v81
    v_mul_f32 v82, s43, v42
    v_mul_f32 v83, s43, v43
    v_cvt_pk_bf16_f32 v95, v82, v83
    buffer_store_dwordx4 v[92:95], v10, s[20:23], s45 offen sc1
    v_mov_b32 v152, 0
    v_mov_b32 v153, 0
    v_mov_b32 v154, 0
    v_mov_b32 v155, 0
    s_waitcnt vmcnt(10)
    v_lshlrev_b32 v156, 16, v136
    v_and_b32 v157, 0xffff0000, v136
    s_waitcnt vmcnt(7)
    v_lshlrev_b32 v158, 16, v112
    v_and_b32 v159, 0xffff0000, v112
    v_fmac_f32 v152, v156, v158
    v_fmac_f32 v153, v157, v159
    s_waitcnt vmcnt(4)
    v_lshlrev_b32 v158, 16, v124
    v_and_b32 v159, 0xffff0000, v124
    v_fmac_f32 v154, v156, v158
    v_fmac_f32 v155, v157, v159
    v_lshlrev_b32 v156, 16, v137
    v_and_b32 v157, 0xffff0000, v137
    v_lshlrev_b32 v158, 16, v113
    v_and_b32 v159, 0xffff0000, v113
    v_fmac_f32 v152, v156, v158
    v_fmac_f32 v153, v157, v159
    v_lshlrev_b32 v158, 16, v125
    v_and_b32 v159, 0xffff0000, v125
    v_fmac_f32 v154, v156, v158
    v_fmac_f32 v155, v157, v159
    v_lshlrev_b32 v156, 16, v138
    v_and_b32 v157, 0xffff0000, v138
    v_lshlrev_b32 v158, 16, v114
    v_and_b32 v159, 0xffff0000, v114
    v_fmac_f32 v152, v156, v158
    v_fmac_f32 v153, v157, v159
    v_lshlrev_b32 v158, 16, v126
    v_and_b32 v159, 0xffff0000, v126
    v_fmac_f32 v154, v156, v158
    v_fmac_f32 v155, v157, v159
    v_lshlrev_b32 v156, 16, v139
    v_and_b32 v157, 0xffff0000, v139
    v_lshlrev_b32 v158, 16, v115
    v_and_b32 v159, 0xffff0000, v115
    v_fmac_f32 v152, v156, v158
    v_fmac_f32 v153, v157, v159
    v_lshlrev_b32 v158, 16, v127
    v_and_b32 v159, 0xffff0000, v127
    v_fmac_f32 v154, v156, v158
    v_fmac_f32 v155, v157, v159
    v_lshlrev_b32 v156, 16, v140
    v_and_b32 v157, 0xffff0000, v140
    v_lshlrev_b32 v158, 16, v116
    v_and_b32 v159, 0xffff0000, v116
    v_fmac_f32 v152, v156, v158
    v_fmac_f32 v153, v157, v159
    s_waitcnt vmcnt(3)
    v_lshlrev_b32 v158, 16, v128
    v_and_b32 v159, 0xffff0000, v128
    v_fmac_f32 v154, v156, v158
    v_fmac_f32 v155, v157, v159
    v_lshlrev_b32 v156, 16, v141
    v_and_b32 v157, 0xffff0000, v141
    v_lshlrev_b32 v158, 16, v117
    v_and_b32 v159, 0xffff0000, v117
    v_fmac_f32 v152, v156, v158
    v_fmac_f32 v153, v157, v159
    v_lshlrev_b32 v158, 16, v129
    v_and_b32 v159, 0xffff0000, v129
    v_fmac_f32 v154, v156, v158
    v_fmac_f32 v155, v157, v159
    v_lshlrev_b32 v156, 16, v142
    v_and_b32 v157, 0xffff0000, v142
    v_lshlrev_b32 v158, 16, v118
    v_and_b32 v159, 0xffff0000, v118
    v_fmac_f32 v152, v156, v158
    v_fmac_f32 v153, v157, v159
    v_lshlrev_b32 v158, 16, v130
    v_and_b32 v159, 0xffff0000, v130
    v_fmac_f32 v154, v156, v158
    v_fmac_f32 v155, v157, v159
    v_lshlrev_b32 v156, 16, v143
    v_and_b32 v157, 0xffff0000, v143
    v_lshlrev_b32 v158, 16, v119
    v_and_b32 v159, 0xffff0000, v119
    v_fmac_f32 v152, v156, v158
    v_fmac_f32 v153, v157, v159
    v_lshlrev_b32 v158, 16, v131
    v_and_b32 v159, 0xffff0000, v131
    v_fmac_f32 v154, v156, v158
    v_fmac_f32 v155, v157, v159
    v_lshlrev_b32 v156, 16, v144
    v_and_b32 v157, 0xffff0000, v144
    v_lshlrev_b32 v158, 16, v120
    v_and_b32 v159, 0xffff0000, v120
    v_fmac_f32 v152, v156, v158
    v_fmac_f32 v153, v157, v159
    s_waitcnt vmcnt(2)
    v_lshlrev_b32 v158, 16, v132
    v_and_b32 v159, 0xffff0000, v132
    v_fmac_f32 v154, v156, v158
    v_fmac_f32 v155, v157, v159
    v_lshlrev_b32 v156, 16, v145
    v_and_b32 v157, 0xffff0000, v145
    v_lshlrev_b32 v158, 16, v121
    v_and_b32 v159, 0xffff0000, v121
    v_fmac_f32 v152, v156, v158
    v_fmac_f32 v153, v157, v159
    v_lshlrev_b32 v158, 16, v133
    v_and_b32 v159, 0xffff0000, v133
    v_fmac_f32 v154, v156, v158
    v_fmac_f32 v155, v157, v159
    v_lshlrev_b32 v156, 16, v146
    v_and_b32 v157, 0xffff0000, v146
    v_lshlrev_b32 v158, 16, v122
    v_and_b32 v159, 0xffff0000, v122
    v_fmac_f32 v152, v156, v158
    v_fmac_f32 v153, v157, v159
    v_lshlrev_b32 v158, 16, v134
    v_and_b32 v159, 0xffff0000, v134
    v_fmac_f32 v154, v156, v158
    v_fmac_f32 v155, v157, v159
    v_lshlrev_b32 v156, 16, v147
    v_and_b32 v157, 0xffff0000, v147
    v_lshlrev_b32 v158, 16, v123
    v_and_b32 v159, 0xffff0000, v123
    v_fmac_f32 v152, v156, v158
    v_fmac_f32 v153, v157, v159
    v_lshlrev_b32 v158, 16, v135
    v_and_b32 v159, 0xffff0000, v135
    v_fmac_f32 v154, v156, v158
    v_fmac_f32 v155, v157, v159
    v_add_f32 v152, v152, v153
    v_add_f32 v154, v154, v155
    s_nop 0
    v_add_f32_dpp v152, v152, v152 row_shr:1 bound_ctrl:0
    v_add_f32_dpp v154, v154, v154 row_shr:1 bound_ctrl:0
    s_nop 0
    v_add_f32_dpp v152, v152, v152 row_shr:2 bound_ctrl:0
    v_add_f32_dpp v154, v154, v154 row_shr:2 bound_ctrl:0
    s_nop 0
    v_add_f32_dpp v152, v152, v152 row_shr:4 bound_ctrl:0
    v_add_f32_dpp v154, v154, v154 row_shr:4 bound_ctrl:0
    s_nop 0
    v_add_f32_dpp v152, v152, v152 row_shr:8 bound_ctrl:0
    v_add_f32_dpp v154, v154, v154 row_shr:8 bound_ctrl:0
    s_nop 0
    v_add_f32_dpp v152, v152, v152 row_bcast:15 row_mask:0xa
    v_add_f32_dpp v154, v154, v154 row_bcast:15 row_mask:0xa
    v_mul_f32 v152, 0xbfb8aa3b, v152
    v_exp_f32 v152, v152
    s_nop 0
    v_add_f32 v152, 1.0, v152
    v_rcp_f32 v152, v152
    v_mul_f32 v154, 0xbfb8aa3b, v154
    v_exp_f32 v154, v154
    s_nop 0
    v_add_f32 v154, 1.0, v154
    v_rcp_f32 v154, v154
    v_lshlrev_b32 v4, 2, v6
    s_mov_b32 exec_lo, 0x80000000
    s_mov_b32 exec_hi, 0x80000000
    buffer_store_dword v152, v4, s[20:23], s50 offen
    buffer_store_dword v154, v4, s[20:23], s50 offen offset:8
    s_mov_b64 exec, -1
    s_and_b32 s47, s32, 3
    s_getpc_b64 s[16:17]
    s_add_u32 s16, s16, k23_fused_kernel-.
    s_addc_u32 s17, s17, 0
    s_mul_i32 s18, s47, 6144
    v_lshlrev_b32 v2, 7, v1
    v_add_u32 v2, s18, v2
    s_mov_b32 exec_lo, 0xffffffff
    s_mov_b32 exec_hi, 0xffff
    global_load_dword v3, v2, s[16:17]
    s_mov_b64 exec, -1
    s_endpgm
K1_exit:

    s_endpgm
k1_gemm_kernel_end:
.section .rodata,"a"
.p2align 6
.amdhsa_kernel k1_gemm_kernel
  .amdhsa_next_free_vgpr 256
  .amdhsa_next_free_sgpr 96
  .amdhsa_accum_offset 256
  .amdhsa_group_segment_fixed_size 0
  .amdhsa_kernarg_size 96
  .amdhsa_user_sgpr_count 2
  .amdhsa_user_sgpr_kernarg_segment_ptr 1
  .amdhsa_system_sgpr_workgroup_id_x 1
.end_amdhsa_kernel
.text
.globl k23_fused_kernel
.p2align 8
.type k23_fused_kernel,@function
k23_fused_kernel:
    s_cmp_ge_u32 s2, 512
    s_cbranch_scc1 K23_exit
    s_load_dwordx2 s[4:5], s[0:1], 88
    s_load_dwordx4 s[24:27], s[0:1], 40
    v_and_b32 v1, 63, v0
    v_lshrrev_b32 v2, 6, v0
    s_nop 0
    v_readfirstlane_b32 s32, v2
    s_waitcnt lgkmcnt(0)
    s_mov_b32 s8, s4
    s_mov_b32 s9, s5
    s_mov_b32 s10, 59768832
    s_mov_b32 s11, 0x00020000
    s_cmp_ge_u32 s2, 256
    s_cbranch_scc1 K23_B
    s_setprio 2
    s_and_b32 s30, s2, 7
    s_lshl_b32 s30, s30, 2
    s_lshr_b32 s46, s2, 6
    s_add_u32 s30, s30, s46
    s_bfe_u32 s31, s2, 0x30003
    v_lshlrev_b32 v13, 4, v1
    v_add_u32 v14, 4096, v13
    s_lshr_b32 s46, s32, 1
    s_add_u32 s46, s46, 1
    s_mul_i32 s42, s46, 2392064
    s_and_b32 s46, s32, 1
    s_mul_i32 s46, s46, 149504
    s_add_u32 s42, s42, s46
    s_mul_i32 s47, s30, 288
    v_mov_b32 v5, 9216
    v_mov_b32 v7, 9344
    v_add_u32 v2, 0, v1
    v_mul_u32_u24 v3, 3277, v2
    v_lshrrev_b32 v3, 16, v3
    v_mul_u32_u24 v4, 20, v3
    v_sub_u32 v2, v2, v4
    v_cmp_gt_u32 vcc, 18, v2
    v_lshl_add_u32 v2, v2, 4, s47
    v_mad_u32_u24 v2, v3, v7, v2
    v_cndmask_b32 v220, v5, v2, vcc
    v_add_u32 v2, 64, v1
    v_mul_u32_u24 v3, 3277, v2
    v_lshrrev_b32 v3, 16, v3
    v_mul_u32_u24 v4, 20, v3
    v_sub_u32 v2, v2, v4
    v_cmp_gt_u32 vcc, 18, v2
    v_lshl_add_u32 v2, v2, 4, s47
    v_mad_u32_u24 v2, v3, v7, v2
    v_cndmask_b32 v221, v5, v2, vcc
    v_subrev_u32 v221, 1024, v221
    v_add_u32 v2, 128, v1
    v_mul_u32_u24 v3, 3277, v2
    v_lshrrev_b32 v3, 16, v3
    v_mul_u32_u24 v4, 20, v3
    v_sub_u32 v2, v2, v4
    v_cmp_gt_u32 vcc, 18, v2
    v_lshl_add_u32 v2, v2, 4, s47
    v_mad_u32_u24 v2, v3, v7, v2
    v_cndmask_b32 v222, v5, v2, vcc
    v_subrev_u32 v222, 2048, v222
    v_add_u32 v2, 192, v1
    v_mul_u32_u24 v3, 3277, v2
    v_lshrrev_b32 v3, 16, v3
    v_mul_u32_u24 v4, 20, v3
    v_sub_u32 v2, v2, v4
    v_cmp_gt_u32 vcc, 18, v2
    v_lshl_add_u32 v2, v2, 4, s47
    v_mad_u32_u24 v2, v3, v7, v2
    v_cndmask_b32 v223, v5, v2, vcc
    v_subrev_u32 v223, 3072, v223
    v_add_u32 v2, 256, v1
    v_mul_u32_u24 v3, 3277, v2
    v_lshrrev_b32 v3, 16, v3
    v_mul_u32_u24 v4, 20, v3
    v_sub_u32 v2, v2, v4
    v_cmp_gt_u32 vcc, 18, v2
    v_lshl_add_u32 v2, v2, 4, s47
    v_mad_u32_u24 v2, v3, v7, v2
    v_cndmask_b32 v224, v5, v2, vcc
    s_mul_i32 s43, s32, 5120
    s_mov_b32 s40, s43
    s_add_u32 s41, s42, 0
    s_mov_b32 m0, s40
    s_nop 0
    buffer_load_dwordx4 v220, s[8:11], s41 offen offset:0 lds
    buffer_load_dwordx4 v221, s[8:11], s41 offen offset:1024 lds
    buffer_load_dwordx4 v222, s[8:11], s41 offen offset:2048 lds
    buffer_load_dwordx4 v223, s[8:11], s41 offen offset:3072 lds
    s_add_u32 m0, s40, 4096
    s_nop 0
    buffer_load_dwordx4 v224, s[8:11], s41 offen lds
    s_lshl_b32 s53, s2, 2
    s_add_u32 s53, s53, s32
    s_mul_i32 s53, s53, 10240
    s_add_u32 s53, s53, 18350080
    s_add_u32 s54, s53, 8192
    s_lshl_b32 s46, s31, 2
    s_add_u32 s46, s46, s32
    s_mul_i32 s47, s46, 74752
    s_mul_i32 s33, s32, 3072
    s_add_u32 s33, s33, 61952
    s_mov_b32 m0, s33
    s_nop 0
    buffer_load_dwordx4 v220, s[8:11], s47 offen offset:0 lds
    buffer_load_dwordx4 v221, s[8:11], s47 offen offset:1024 lds
    buffer_load_dwordx4 v222, s[8:11], s47 offen offset:2048 lds
    s_add_u32 s40, s43, 20480
    s_add_u32 s41, s42, 299008
    s_mov_b32 m0, s40
    s_nop 0
    buffer_load_dwordx4 v220, s[8:11], s41 offen offset:0 lds
    buffer_load_dwordx4 v221, s[8:11], s41 offen offset:1024 lds
    buffer_load_dwordx4 v222, s[8:11], s41 offen offset:2048 lds
    buffer_load_dwordx4 v223, s[8:11], s41 offen offset:3072 lds
    s_add_u32 m0, s40, 4096
    s_nop 0
    buffer_load_dwordx4 v224, s[8:11], s41 offen lds
    s_add_u32 s40, s43, 40960
    s_add_u32 s41, s42, 598016
    s_mov_b32 m0, s40
    s_nop 0
    buffer_load_dwordx4 v220, s[8:11], s41 offen offset:0 lds
    buffer_load_dwordx4 v221, s[8:11], s41 offen offset:1024 lds
    buffer_load_dwordx4 v222, s[8:11], s41 offen offset:2048 lds
    buffer_load_dwordx4 v223, s[8:11], s41 offen offset:3072 lds
    s_add_u32 m0, s40, 4096
    s_nop 0
    buffer_load_dwordx4 v224, s[8:11], s41 offen lds
    v_bfe_u32 v2, v1, 4, 1
    v_lshlrev_b32 v2, 1, v2
    v_and_b32 v3, 1, v1
    v_add_u32 v3, v2, v3
    v_mul_u32_u24 v3, 320, v3
    v_bfe_u32 v4, v1, 1, 1
    v_lshl_add_u32 v3, v4, 3, v3
    v_bfe_u32 v5, v1, 2, 2
    v_lshlrev_b32 v5, 4, v5
    v_lshrrev_b32 v6, 5, v1
    v_add_u32 v11, v3, v5
    v_lshl_add_u32 v10, v6, 7, v11
    v_add_u32 v11, 256, v11
    v_mul_u32_u24 v7, 320, v6
    v_and_b32 v8, 31, v1
    v_lshl_add_u32 v7, v8, 4, v7
    v_add_u32 v12, 10240, v7
    v_cmp_gt_u32 s[44:45], 32, v1
    s_mov_b32 s56, 0xfffff
    s_mov_b32 s57, 0xfffff
    v_mov_b32 v38, 0x3f80
    v_mov_b32 v39, 0
    v_mov_b32 v46, 0x3f80
    v_mov_b32 v47, 0
    v_mov_b32 v48, 0
    v_mov_b32 v49, 0
    v_mov_b32 v50, 0
    v_mov_b32 v51, 0
    v_mov_b32 v52, 0
    v_mov_b32 v53, 0
    v_mov_b32 v54, 0
    v_mov_b32 v55, 0
    v_mov_b32 v56, 0
    v_mov_b32 v57, 0
    v_mov_b32 v58, 0
    v_mov_b32 v59, 0
    v_mov_b32 v60, 0
    v_mov_b32 v61, 0
    v_mov_b32 v62, 0
    v_mov_b32 v63, 0
    v_add_u32 v2, v2, v4
    v_mul_u32_u24 v2, 320, v2
    v_and_b32 v3, 1, v1
    v_lshl_add_u32 v2, v3, 3, v2
    v_add3_u32 v176, v2, v5, s33
    v_lshl_add_u32 v177, v6, 7, v176
    s_load_dwordx2 s[36:37], s[0:1], 16
    s_load_dwordx2 s[38:39], s[0:1], 56
    v_and_b32 v228, 7, v1
    v_lshlrev_b32 v228, 7, v228
    v_lshrrev_b32 v229, 3, v1
    v_lshl_add_u32 v228, v229, 12, v228
    v_mov_b32 v229, 0x7f000000
    v_cmp_gt_u32 vcc, 16, v1
    s_nop 1
    v_cndmask_b32 v228, v229, v228, vcc
    v_lshlrev_b32 v227, 7, v1
    v_cndmask_b32 v227, v229, v227, s[44:45]
    s_lshl_b32 s51, s2, 2
    s_add_u32 s51, s51, s32
    s_lshl_b32 s52, s51, 13
    s_sub_u32 s52, s52, 0
    s_mov_b32 s16, s24
    s_mov_b32 s17, s25
    s_mov_b32 s18, 8388608
    s_mov_b32 s19, 0x00020000
    s_sub_u32 s50, s51, 648
    s_mov_b32 s22, 663552
    s_mov_b32 s23, 0x00020000
    s_waitcnt lgkmcnt(0)
    s_cmp_lt_u32 s51, 648
    s_cselect_b32 s20, s38, s36
    s_cselect_b32 s21, s39, s37
    s_cselect_b32 s22, 2654208, s22
    s_cselect_b32 s50, s51, s50
    s_lshl_b32 s50, s50, 12
    v_mov_b32 v22, 0
    v_mov_b32 v23, 0
    v_mov_b32 v30, 0
    v_mov_b32 v31, 0
    v_mov_b32 v144, 0
    v_mov_b32 v145, 0
    v_mov_b32 v146, 0
    v_mov_b32 v147, 0
    v_mov_b32 v148, 0
    v_mov_b32 v149, 0
    v_mov_b32 v150, 0
    v_mov_b32 v151, 0
    v_mov_b32 v152, 0
    v_mov_b32 v153, 0
    v_mov_b32 v154, 0
    v_mov_b32 v155, 0
    v_mov_b32 v156, 0
    v_mov_b32 v157, 0
    v_mov_b32 v158, 0
    v_mov_b32 v159, 0
    v_mov_b32 v160, 0
    v_mov_b32 v161, 0
    v_mov_b32 v162, 0
    v_mov_b32 v163, 0
    v_mov_b32 v164, 0
    v_mov_b32 v165, 0
    v_mov_b32 v166, 0
    v_mov_b32 v167, 0
    v_mov_b32 v168, 0
    v_mov_b32 v169, 0
    v_mov_b32 v170, 0
    v_mov_b32 v171, 0
    v_mov_b32 v172, 0
    v_mov_b32 v173, 0
    v_mov_b32 v174, 0
    v_mov_b32 v175, 0
    v_mov_b32 v4, v10
    v_mov_b32 v5, v11
    s_waitcnt vmcnt(10)
    ds_read_b64_tr_b16 v[16:17], v177 offset:0
    ds_read_b64_tr_b16 v[18:19], v177 offset:64
    ds_read_b64_tr_b16 v[20:21], v176 offset:256
    ds_read_b64_tr_b16 v[24:25], v177 offset:1280
    ds_read_b64_tr_b16 v[26:27], v177 offset:1344
    ds_read_b64_tr_b16 v[28:29], v176 offset:1536
    s_barrier
    ds_read_b64_tr_b16 v[32:33], v4 offset:0
    ds_read_b64_tr_b16 v[34:35], v4 offset:64
    ds_read_b64_tr_b16 v[36:37], v5 offset:0
    s_waitcnt lgkmcnt(6)
    v_cndmask_b32 v20, 0, v20, s[44:45]
    v_mov_b32 v21, 0
    s_waitcnt lgkmcnt(3)
    v_cndmask_b32 v28, 0, v28, s[44:45]
    v_mov_b32 v29, 0
    s_waitcnt lgkmcnt(1)
    v_mfma_f32_32x32x16_bf16 v[64:79], v[32:35], v[16:19], 0
    s_waitcnt lgkmcnt(0)
    v_mfma_f32_32x32x16_bf16 v[64:79], v[36:39], v[20:23], v[64:79]
    v_mfma_f32_32x32x16_bf16 v[80:95], v[32:35], v[24:27], 0
    v_mfma_f32_32x32x16_bf16 v[80:95], v[36:39], v[28:31], v[80:95]
    s_nop 9
    v_max3_f32 v176, v64, v65, v66
    v_max3_f32 v176, v176, v67, v68
    v_max3_f32 v176, v176, v69, v70
    v_max3_f32 v176, v176, v71, v72
    v_max3_f32 v176, v176, v73, v74
    v_max3_f32 v176, v176, v75, v76
    v_max3_f32 v176, v176, v77, v78
    v_max_f32 v176, v176, v79
    v_max3_f32 v177, v80, v81, v82
    v_max3_f32 v177, v177, v83, v84
    v_max3_f32 v177, v177, v85, v86
    v_max3_f32 v177, v177, v87, v88
    v_max3_f32 v177, v177, v89, v90
    v_max3_f32 v177, v177, v91, v92
    v_max3_f32 v177, v177, v93, v94
    v_max_f32 v177, v177, v95
    v_mov_b32 v178, v176
    s_nop 1
    v_permlane32_swap_b32 v176, v178
    v_max_f32 v176, v176, v178
    v_mov_b32 v179, v177
    s_nop 1
    v_permlane32_swap_b32 v177, v179
    v_max_f32 v177, v177, v179
    v_and_b32 v180, 0xffff0000, v176
    v_sub_f32 v181, v176, v180
    v_and_b32 v182, 0xffff0000, v181
    v_sub_f32 v181, v181, v182
    v_lshrrev_b32 v180, 16, v180
    v_or_b32 v180, v180, v182
    v_xor_b32 v180, 0x80008000, v180
    v_lshrrev_b32 v181, 16, v181
    v_xor_b32 v181, 0x8000, v181
    v_cndmask_b32 v21, 0, v180, s[44:45]
    v_cndmask_b32 v22, 0, v181, s[44:45]
    v_and_b32 v184, 0xffff0000, v177
    v_sub_f32 v185, v177, v184
    v_and_b32 v186, 0xffff0000, v185
    v_sub_f32 v185, v185, v186
    v_lshrrev_b32 v184, 16, v184
    v_or_b32 v184, v184, v186
    v_xor_b32 v184, 0x80008000, v184
    v_lshrrev_b32 v185, 16, v185
    v_xor_b32 v185, 0x8000, v185
    v_cndmask_b32 v29, 0, v184, s[44:45]
    v_cndmask_b32 v30, 0, v185, s[44:45]
    s_mov_b32 s34, 0
    s_mov_b32 s55, 1
    s_mov_b32 s58, 5
    s_mov_b32 s33, 5
    v_mov_b32 v232, 0x7f000000
    v_mov_b32 v233, 0x7f000000
    v_mov_b32 v234, 0x7f000000
    v_mov_b32 v235, 0x7f000000
    s_mov_b32 s35, 0
    s_add_u32 s41, s42, 598016
    s_setprio 2
    s_nop 1
A1_main:
    v_mov_b32 v4, v10
    v_mov_b32 v5, v11
    v_mov_b32 v6, v12
    ds_read_b64_tr_b16 v[32:33], v4 offset:0
    ds_read_b64_tr_b16 v[34:35], v4 offset:64
    ds_read_b64_tr_b16 v[36:37], v5 offset:0
    ds_read_b64_tr_b16 v[40:41], v4 offset:1280
    ds_read_b64_tr_b16 v[42:43], v4 offset:1344
    ds_read_b64_tr_b16 v[44:45], v5 offset:1280
    s_mov_b64 exec, s[56:57]
    ds_read_b128 v[48:51], v6 offset:0
    ds_read_b128 v[52:55], v6 offset:640
    s_mov_b64 exec, -1
    v_add_u32 v7, 20480, v10
    v_add_u32 v8, 20480, v11
    v_add_u32 v9, 20480, v12
    s_mov_b32 s36, 40960
    v_mov_b32 v140, 0
    v_mov_b32 v60, 0
    v_mov_b32 v141, 0
    v_mov_b32 v61, 0
    v_mov_b32 v142, 0
    v_mov_b32 v62, 0
    v_mov_b32 v143, 0
    v_mov_b32 v63, 0
    s_waitcnt lgkmcnt(6)
    v_mfma_f32_32x32x16_bf16 v[64:79], v[32:35], v[16:19], 0
    s_waitcnt lgkmcnt(5)
    v_mfma_f32_32x32x16_bf16 v[64:79], v[36:39], v[20:23], v[64:79]
    v_mfma_f32_32x32x16_bf16 v[80:95], v[32:35], v[24:27], 0
    v_mfma_f32_32x32x16_bf16 v[80:95], v[36:39], v[28:31], v[80:95]
    s_nop 7
A1_loop:
    s_nop 1
    v_exp_f32 v64, v64
    v_exp_f32 v65, v65
    v_mfma_f32_32x32x16_bf16 v[160:175], v[60:63], v[140:143], v[160:175]
    s_waitcnt lgkmcnt(0)
    ds_read_b64_tr_b16 v[32:33], v4 offset:2560
    v_exp_f32 v66, v66
    v_exp_f32 v67, v67
    v_cvt_pk_bf16_f32 v128, v64, v65
    v_exp_f32 v68, v68
    v_exp_f32 v69, v69
    v_cvt_pk_bf16_f32 v129, v66, v67
    v_mfma_f32_32x32x16_bf16 v[96:111], v[40:43], v[16:19], 0
    ds_read_b64_tr_b16 v[34:35], v4 offset:2624
    v_exp_f32 v70, v70
    v_exp_f32 v71, v71
    v_cvt_pk_bf16_f32 v130, v68, v69
    v_cvt_pk_bf16_f32 v131, v70, v71
    v_exp_f32 v72, v72
    v_exp_f32 v73, v73
    v_mfma_f32_32x32x16_bf16 v[96:111], v[44:47], v[20:23], v[96:111]
    ds_read_b64_tr_b16 v[36:37], v5 offset:2560
    v_exp_f32 v74, v74
    v_exp_f32 v75, v75
    v_cvt_pk_bf16_f32 v132, v72, v73
    v_exp_f32 v76, v76
    v_exp_f32 v77, v77
    v_cvt_pk_bf16_f32 v133, v74, v75
    v_mfma_f32_32x32x16_bf16 v[144:159], v[48:51], v[128:131], v[144:159]
    s_mov_b64 exec, s[56:57]
    ds_read_b128 v[56:59], v6 offset:1280
    ds_read_b128 v[60:63], v6 offset:1920
    s_mov_b64 exec, -1
    v_exp_f32 v78, v78
    v_exp_f32 v79, v79
    v_cvt_pk_bf16_f32 v134, v76, v77
    v_cvt_pk_bf16_f32 v135, v78, v79
    v_exp_f32 v80, v80
    v_exp_f32 v81, v81
    v_mfma_f32_32x32x16_bf16 v[112:127], v[40:43], v[24:27], 0
    v_exp_f32 v82, v82
    v_exp_f32 v83, v83
    v_cvt_pk_bf16_f32 v136, v80, v81
    v_exp_f32 v84, v84
    v_exp_f32 v85, v85
    v_cvt_pk_bf16_f32 v137, v82, v83
    v_mfma_f32_32x32x16_bf16 v[144:159], v[52:55], v[132:135], v[144:159]
    v_exp_f32 v86, v86
    v_exp_f32 v87, v87
    v_cvt_pk_bf16_f32 v138, v84, v85
    v_cvt_pk_bf16_f32 v139, v86, v87
    v_exp_f32 v88, v88
    v_exp_f32 v89, v89
    v_mfma_f32_32x32x16_bf16 v[112:127], v[44:47], v[28:31], v[112:127]
    v_exp_f32 v90, v90
    v_exp_f32 v91, v91
    v_cvt_pk_bf16_f32 v140, v88, v89
    v_exp_f32 v92, v92
    v_exp_f32 v93, v93
    v_cvt_pk_bf16_f32 v141, v90, v91
    v_mfma_f32_32x32x16_bf16 v[160:175], v[48:51], v[136:139], v[160:175]
    v_exp_f32 v94, v94
    v_exp_f32 v95, v95
    v_cvt_pk_bf16_f32 v142, v92, v93
    v_cvt_pk_bf16_f32 v143, v94, v95
    v_exp_f32 v96, v96
    v_exp_f32 v97, v97
    v_mfma_f32_32x32x16_bf16 v[160:175], v[52:55], v[140:143], v[160:175]
    s_waitcnt lgkmcnt(0)
    ds_read_b64_tr_b16 v[40:41], v4 offset:3840
    v_exp_f32 v98, v98
    v_exp_f32 v99, v99
    v_cvt_pk_bf16_f32 v128, v96, v97
    v_exp_f32 v100, v100
    v_exp_f32 v101, v101
    v_cvt_pk_bf16_f32 v129, v98, v99
    v_mfma_f32_32x32x16_bf16 v[64:79], v[32:35], v[16:19], 0
    ds_read_b64_tr_b16 v[42:43], v4 offset:3904
    v_exp_f32 v102, v102
    v_exp_f32 v103, v103
    v_cvt_pk_bf16_f32 v130, v100, v101
    v_cvt_pk_bf16_f32 v131, v102, v103
    v_exp_f32 v104, v104
    v_exp_f32 v105, v105
    v_mfma_f32_32x32x16_bf16 v[64:79], v[36:39], v[20:23], v[64:79]
    ds_read_b64_tr_b16 v[44:45], v5 offset:3840
    v_exp_f32 v106, v106
    v_exp_f32 v107, v107
    v_cvt_pk_bf16_f32 v132, v104, v105
    v_exp_f32 v108, v108
    v_exp_f32 v109, v109
    v_cvt_pk_bf16_f32 v133, v106, v107
    v_mfma_f32_32x32x16_bf16 v[144:159], v[56:59], v[128:131], v[144:159]
    s_mov_b64 exec, s[56:57]
    ds_read_b128 v[48:51], v6 offset:2560
    ds_read_b128 v[52:55], v6 offset:3200
    s_mov_b64 exec, -1
    v_exp_f32 v110, v110
    v_exp_f32 v111, v111
    v_cvt_pk_bf16_f32 v134, v108, v109
    v_cvt_pk_bf16_f32 v135, v110, v111
    v_exp_f32 v112, v112
    v_exp_f32 v113, v113
    v_mfma_f32_32x32x16_bf16 v[80:95], v[32:35], v[24:27], 0
    s_sub_u32 s37, s35, 1
    v_exp_f32 v114, v114
    v_exp_f32 v115, v115
    v_cvt_pk_bf16_f32 v136, v112, v113
    v_exp_f32 v116, v116
    v_exp_f32 v117, v117
    v_cvt_pk_bf16_f32 v137, v114, v115
    v_mfma_f32_32x32x16_bf16 v[144:159], v[60:63], v[132:135], v[144:159]
    s_cmp_ge_u32 s37, 3
    v_exp_f32 v118, v118
    v_exp_f32 v119, v119
    v_cvt_pk_bf16_f32 v138, v116, v117
    v_cvt_pk_bf16_f32 v139, v118, v119
    v_exp_f32 v120, v120
    v_exp_f32 v121, v121
    v_mfma_f32_32x32x16_bf16 v[80:95], v[36:39], v[28:31], v[80:95]
    s_cbranch_scc1 A1_nt0
    buffer_load_dword v229, v228, s[16:19], s52 offen
A1_nt0:
    v_exp_f32 v122, v122
    v_exp_f32 v123, v123
    v_cvt_pk_bf16_f32 v140, v120, v121
    v_exp_f32 v124, v124
    v_exp_f32 v125, v125
    v_cvt_pk_bf16_f32 v141, v122, v123
    v_mfma_f32_32x32x16_bf16 v[160:175], v[56:59], v[136:139], v[160:175]
    s_add_u32 s52, s52, 1024
    v_exp_f32 v126, v126
    v_exp_f32 v127, v127
    v_cvt_pk_bf16_f32 v142, v124, v125
    v_cvt_pk_bf16_f32 v143, v126, v127
    v_exp_f32 v64, v64
    v_exp_f32 v65, v65
    v_mfma_f32_32x32x16_bf16 v[160:175], v[60:63], v[140:143], v[160:175]
    s_waitcnt lgkmcnt(0)
    ds_read_b64_tr_b16 v[32:33], v4 offset:5120
    v_exp_f32 v66, v66
    v_exp_f32 v67, v67
    v_cvt_pk_bf16_f32 v128, v64, v65
    v_exp_f32 v68, v68
    v_exp_f32 v69, v69
    v_cvt_pk_bf16_f32 v129, v66, v67
    v_mfma_f32_32x32x16_bf16 v[96:111], v[40:43], v[16:19], 0
    ds_read_b64_tr_b16 v[34:35], v4 offset:5184
    v_exp_f32 v70, v70
    v_exp_f32 v71, v71
    v_cvt_pk_bf16_f32 v130, v68, v69
    v_cvt_pk_bf16_f32 v131, v70, v71
    v_exp_f32 v72, v72
    v_exp_f32 v73, v73
    v_mfma_f32_32x32x16_bf16 v[96:111], v[44:47], v[20:23], v[96:111]
    ds_read_b64_tr_b16 v[36:37], v5 offset:5120
    v_exp_f32 v74, v74
    v_exp_f32 v75, v75
    v_cvt_pk_bf16_f32 v132, v72, v73
    v_exp_f32 v76, v76
    v_exp_f32 v77, v77
    v_cvt_pk_bf16_f32 v133, v74, v75
    v_mfma_f32_32x32x16_bf16 v[144:159], v[48:51], v[128:131], v[144:159]
    s_mov_b64 exec, s[56:57]
    ds_read_b128 v[56:59], v6 offset:3840
    ds_read_b128 v[60:63], v6 offset:4480
    s_mov_b64 exec, -1
    v_exp_f32 v78, v78
    v_exp_f32 v79, v79
    v_cvt_pk_bf16_f32 v134, v76, v77
    v_cvt_pk_bf16_f32 v135, v78, v79
    v_exp_f32 v80, v80
    v_exp_f32 v81, v81
    v_mfma_f32_32x32x16_bf16 v[112:127], v[40:43], v[24:27], 0
    v_exp_f32 v82, v82
    v_exp_f32 v83, v83
    v_cvt_pk_bf16_f32 v136, v80, v81
    v_exp_f32 v84, v84
    v_exp_f32 v85, v85
    v_cvt_pk_bf16_f32 v137, v82, v83
    v_mfma_f32_32x32x16_bf16 v[144:159], v[52:55], v[132:135], v[144:159]
    s_cmp_lg_u32 s35, 3
    v_exp_f32 v86, v86
    v_exp_f32 v87, v87
    v_cvt_pk_bf16_f32 v138, v84, v85
    v_cvt_pk_bf16_f32 v139, v86, v87
    v_exp_f32 v88, v88
    v_exp_f32 v89, v89
    v_mfma_f32_32x32x16_bf16 v[112:127], v[44:47], v[28:31], v[112:127]
    s_cbranch_scc1 A1_nt1
    buffer_load_dword v229, v227, s[20:23], s50 offen
A1_nt1:
    v_exp_f32 v90, v90
    v_exp_f32 v91, v91
    v_cvt_pk_bf16_f32 v140, v88, v89
    v_exp_f32 v92, v92
    v_exp_f32 v93, v93
    v_cvt_pk_bf16_f32 v141, v90, v91
    v_mfma_f32_32x32x16_bf16 v[160:175], v[48:51], v[136:139], v[160:175]
    v_exp_f32 v94, v94
    v_exp_f32 v95, v95
    v_cvt_pk_bf16_f32 v142, v92, v93
    v_cvt_pk_bf16_f32 v143, v94, v95
    v_exp_f32 v96, v96
    v_exp_f32 v97, v97
    v_mfma_f32_32x32x16_bf16 v[160:175], v[52:55], v[140:143], v[160:175]
    s_waitcnt lgkmcnt(0)
    ds_read_b64_tr_b16 v[40:41], v4 offset:6400
    v_exp_f32 v98, v98
    v_exp_f32 v99, v99
    v_cvt_pk_bf16_f32 v128, v96, v97
    v_exp_f32 v100, v100
    v_exp_f32 v101, v101
    v_cvt_pk_bf16_f32 v129, v98, v99
    v_mfma_f32_32x32x16_bf16 v[64:79], v[32:35], v[16:19], 0
    ds_read_b64_tr_b16 v[42:43], v4 offset:6464
    v_exp_f32 v102, v102
    v_exp_f32 v103, v103
    v_cvt_pk_bf16_f32 v130, v100, v101
    v_cvt_pk_bf16_f32 v131, v102, v103
    v_exp_f32 v104, v104
    v_exp_f32 v105, v105
    v_mfma_f32_32x32x16_bf16 v[64:79], v[36:39], v[20:23], v[64:79]
    ds_read_b64_tr_b16 v[44:45], v5 offset:6400
    v_exp_f32 v106, v106
    v_exp_f32 v107, v107
    v_cvt_pk_bf16_f32 v132, v104, v105
    v_exp_f32 v108, v108
    v_exp_f32 v109, v109
    v_cvt_pk_bf16_f32 v133, v106, v107
    v_mfma_f32_32x32x16_bf16 v[144:159], v[56:59], v[128:131], v[144:159]
    s_mov_b64 exec, s[56:57]
    ds_read_b128 v[48:51], v6 offset:5120
    ds_read_b128 v[52:55], v6 offset:5760
    s_mov_b64 exec, -1
    v_exp_f32 v110, v110
    v_exp_f32 v111, v111
    v_cvt_pk_bf16_f32 v134, v108, v109
    v_cvt_pk_bf16_f32 v135, v110, v111
    v_exp_f32 v112, v112
    v_exp_f32 v113, v113
    v_mfma_f32_32x32x16_bf16 v[80:95], v[32:35], v[24:27], 0
    v_exp_f32 v114, v114
    v_exp_f32 v115, v115
    v_cvt_pk_bf16_f32 v136, v112, v113
    v_exp_f32 v116, v116
    v_exp_f32 v117, v117
    v_cvt_pk_bf16_f32 v137, v114, v115
    v_mfma_f32_32x32x16_bf16 v[144:159], v[60:63], v[132:135], v[144:159]
    v_exp_f32 v118, v118
    v_exp_f32 v119, v119
    v_cvt_pk_bf16_f32 v138, v116, v117
    v_cvt_pk_bf16_f32 v139, v118, v119
    v_exp_f32 v120, v120
    v_exp_f32 v121, v121
    v_mfma_f32_32x32x16_bf16 v[80:95], v[36:39], v[28:31], v[80:95]
    v_exp_f32 v122, v122
    v_exp_f32 v123, v123
    v_cvt_pk_bf16_f32 v140, v120, v121
    v_exp_f32 v124, v124
    v_exp_f32 v125, v125
    v_cvt_pk_bf16_f32 v141, v122, v123
    v_mfma_f32_32x32x16_bf16 v[160:175], v[56:59], v[136:139], v[160:175]
    v_exp_f32 v126, v126
    v_exp_f32 v127, v127
    v_cvt_pk_bf16_f32 v142, v124, v125
    v_cvt_pk_bf16_f32 v143, v126, v127
    v_exp_f32 v64, v64
    v_exp_f32 v65, v65
    v_mfma_f32_32x32x16_bf16 v[160:175], v[60:63], v[140:143], v[160:175]
    s_waitcnt lgkmcnt(0)
    ds_read_b64_tr_b16 v[32:33], v4 offset:7680
    v_exp_f32 v66, v66
    v_exp_f32 v67, v67
    v_cvt_pk_bf16_f32 v128, v64, v65
    v_exp_f32 v68, v68
    v_exp_f32 v69, v69
    v_cvt_pk_bf16_f32 v129, v66, v67
    v_mfma_f32_32x32x16_bf16 v[96:111], v[40:43], v[16:19], 0
    ds_read_b64_tr_b16 v[34:35], v4 offset:7744
    v_exp_f32 v70, v70
    v_exp_f32 v71, v71
    v_cvt_pk_bf16_f32 v130, v68, v69
    v_cvt_pk_bf16_f32 v131, v70, v71
    v_exp_f32 v72, v72
    v_exp_f32 v73, v73
    v_mfma_f32_32x32x16_bf16 v[96:111], v[44:47], v[20:23], v[96:111]
    ds_read_b64_tr_b16 v[36:37], v5 offset:7680
    v_exp_f32 v74, v74
    v_exp_f32 v75, v75
    v_cvt_pk_bf16_f32 v132, v72, v73
    v_exp_f32 v76, v76
    v_exp_f32 v77, v77
    v_cvt_pk_bf16_f32 v133, v74, v75
    v_mfma_f32_32x32x16_bf16 v[144:159], v[48:51], v[128:131], v[144:159]
    s_mov_b64 exec, s[56:57]
    ds_read_b128 v[56:59], v6 offset:6400
    ds_read_b128 v[60:63], v6 offset:7040
    s_mov_b64 exec, -1
    v_exp_f32 v78, v78
    v_exp_f32 v79, v79
    v_cvt_pk_bf16_f32 v134, v76, v77
    v_cvt_pk_bf16_f32 v135, v78, v79
    v_exp_f32 v80, v80
    v_exp_f32 v81, v81
    v_mfma_f32_32x32x16_bf16 v[112:127], v[40:43], v[24:27], 0
    s_add_u32 s40, s43, s36
    v_exp_f32 v82, v82
    v_exp_f32 v83, v83
    v_cvt_pk_bf16_f32 v136, v80, v81
    v_exp_f32 v84, v84
    v_exp_f32 v85, v85
    v_cvt_pk_bf16_f32 v137, v82, v83
    v_mfma_f32_32x32x16_bf16 v[144:159], v[52:55], v[132:135], v[144:159]
    s_add_u32 s59, s40, 4096
    v_exp_f32 v86, v86
    v_exp_f32 v87, v87
    v_cvt_pk_bf16_f32 v138, v84, v85
    v_cvt_pk_bf16_f32 v139, v86, v87
    v_exp_f32 v88, v88
    v_exp_f32 v89, v89
    v_mfma_f32_32x32x16_bf16 v[112:127], v[44:47], v[28:31], v[112:127]
    s_waitcnt vmcnt(0)
    v_exp_f32 v90, v90
    v_exp_f32 v91, v91
    v_cvt_pk_bf16_f32 v140, v88, v89
    v_exp_f32 v92, v92
    v_exp_f32 v93, v93
    v_cvt_pk_bf16_f32 v141, v90, v91
    v_mfma_f32_32x32x16_bf16 v[160:175], v[48:51], v[136:139], v[160:175]
    s_barrier
    v_exp_f32 v94, v94
    v_exp_f32 v95, v95
    v_cvt_pk_bf16_f32 v142, v92, v93
    v_cvt_pk_bf16_f32 v143, v94, v95
    v_exp_f32 v96, v96
    v_exp_f32 v97, v97
    v_mfma_f32_32x32x16_bf16 v[160:175], v[52:55], v[140:143], v[160:175]
    s_waitcnt lgkmcnt(0)
    ds_read_b64_tr_b16 v[40:41], v4 offset:8960
    v_exp_f32 v98, v98
    v_exp_f32 v99, v99
    v_cvt_pk_bf16_f32 v128, v96, v97
    v_exp_f32 v100, v100
    v_exp_f32 v101, v101
    v_cvt_pk_bf16_f32 v129, v98, v99
    v_mfma_f32_32x32x16_bf16 v[64:79], v[32:35], v[16:19], 0
    ds_read_b64_tr_b16 v[42:43], v4 offset:9024
    v_exp_f32 v102, v102
    v_exp_f32 v103, v103
    v_cvt_pk_bf16_f32 v130, v100, v101
    v_cvt_pk_bf16_f32 v131, v102, v103
    v_exp_f32 v104, v104
    v_exp_f32 v105, v105
    v_mfma_f32_32x32x16_bf16 v[64:79], v[36:39], v[20:23], v[64:79]
    ds_read_b64_tr_b16 v[44:45], v5 offset:8960
    v_exp_f32 v106, v106
    v_exp_f32 v107, v107
    v_cvt_pk_bf16_f32 v132, v104, v105
    v_exp_f32 v108, v108
    v_exp_f32 v109, v109
    v_cvt_pk_bf16_f32 v133, v106, v107
    v_mfma_f32_32x32x16_bf16 v[144:159], v[56:59], v[128:131], v[144:159]
    s_mov_b64 exec, s[56:57]
    ds_read_b128 v[48:51], v6 offset:7680
    ds_read_b128 v[52:55], v6 offset:8320
    s_mov_b64 exec, -1
    v_exp_f32 v110, v110
    v_exp_f32 v111, v111
    v_cvt_pk_bf16_f32 v134, v108, v109
    v_cvt_pk_bf16_f32 v135, v110, v111
    v_exp_f32 v112, v112
    v_exp_f32 v113, v113
    v_mfma_f32_32x32x16_bf16 v[80:95], v[32:35], v[24:27], 0
    s_sub_u32 s37, s35, s55
    v_exp_f32 v114, v114
    v_exp_f32 v115, v115
    v_cvt_pk_bf16_f32 v136, v112, v113
    v_exp_f32 v116, v116
    v_exp_f32 v117, v117
    v_cvt_pk_bf16_f32 v137, v114, v115
    v_mfma_f32_32x32x16_bf16 v[144:159], v[60:63], v[132:135], v[144:159]
    s_cmp_ge_u32 s37, s58
    s_mov_b32 m0, s40
    v_exp_f32 v118, v118
    v_exp_f32 v119, v119
    v_cvt_pk_bf16_f32 v138, v116, v117
    v_cvt_pk_bf16_f32 v139, v118, v119
    v_exp_f32 v120, v120
    v_exp_f32 v121, v121
    v_mfma_f32_32x32x16_bf16 v[80:95], v[36:39], v[28:31], v[80:95]
    s_cbranch_scc1 A1_nd0
    buffer_load_dwordx4 v220, s[8:11], s41 offen lds
A1_nd0:
    v_exp_f32 v122, v122
    v_exp_f32 v123, v123
    v_cvt_pk_bf16_f32 v140, v120, v121
    v_exp_f32 v124, v124
    v_exp_f32 v125, v125
    v_cvt_pk_bf16_f32 v141, v122, v123
    v_mfma_f32_32x32x16_bf16 v[160:175], v[56:59], v[136:139], v[160:175]
    s_cbranch_scc1 A1_nd1
    buffer_load_dwordx4 v221, s[8:11], s41 offen offset:1024 lds
A1_nd1:
    v_exp_f32 v126, v126
    v_exp_f32 v127, v127
    v_cvt_pk_bf16_f32 v142, v124, v125
    v_cvt_pk_bf16_f32 v143, v126, v127
    v_exp_f32 v64, v64
    v_exp_f32 v65, v65
    v_mfma_f32_32x32x16_bf16 v[160:175], v[60:63], v[140:143], v[160:175]
    s_waitcnt lgkmcnt(0)
    ds_read_b64_tr_b16 v[32:33], v7 offset:0
    v_exp_f32 v66, v66
    v_exp_f32 v67, v67
    v_cvt_pk_bf16_f32 v128, v64, v65
    v_exp_f32 v68, v68
    v_exp_f32 v69, v69
    v_cvt_pk_bf16_f32 v129, v66, v67
    v_mfma_f32_32x32x16_bf16 v[96:111], v[40:43], v[16:19], 0
    ds_read_b64_tr_b16 v[34:35], v7 offset:64
    v_exp_f32 v70, v70
    v_exp_f32 v71, v71
    v_cvt_pk_bf16_f32 v130, v68, v69
    v_cvt_pk_bf16_f32 v131, v70, v71
    v_exp_f32 v72, v72
    v_exp_f32 v73, v73
    v_mfma_f32_32x32x16_bf16 v[96:111], v[44:47], v[20:23], v[96:111]
    ds_read_b64_tr_b16 v[36:37], v8 offset:0
    v_exp_f32 v74, v74
    v_exp_f32 v75, v75
    v_cvt_pk_bf16_f32 v132, v72, v73
    v_exp_f32 v76, v76
    v_exp_f32 v77, v77
    v_cvt_pk_bf16_f32 v133, v74, v75
    v_mfma_f32_32x32x16_bf16 v[144:159], v[48:51], v[128:131], v[144:159]
    s_mov_b64 exec, s[56:57]
    ds_read_b128 v[56:59], v6 offset:8960
    ds_read_b128 v[60:63], v6 offset:9600
    s_mov_b64 exec, -1
    v_exp_f32 v78, v78
    v_exp_f32 v79, v79
    v_cvt_pk_bf16_f32 v134, v76, v77
    v_cvt_pk_bf16_f32 v135, v78, v79
    v_exp_f32 v80, v80
    v_exp_f32 v81, v81
    v_mfma_f32_32x32x16_bf16 v[112:127], v[40:43], v[24:27], 0
    s_cbranch_scc1 A1_nd2
    buffer_load_dwordx4 v222, s[8:11], s41 offen offset:2048 lds
A1_nd2:
    v_exp_f32 v82, v82
    v_exp_f32 v83, v83
    v_cvt_pk_bf16_f32 v136, v80, v81
    v_exp_f32 v84, v84
    v_exp_f32 v85, v85
    v_cvt_pk_bf16_f32 v137, v82, v83
    v_mfma_f32_32x32x16_bf16 v[144:159], v[52:55], v[132:135], v[144:159]
    s_cbranch_scc1 A1_nd3
    buffer_load_dwordx4 v223, s[8:11], s41 offen offset:3072 lds
A1_nd3:
    v_exp_f32 v86, v86
    v_exp_f32 v87, v87
    v_cvt_pk_bf16_f32 v138, v84, v85
    v_cvt_pk_bf16_f32 v139, v86, v87
    v_exp_f32 v88, v88
    v_exp_f32 v89, v89
    v_mfma_f32_32x32x16_bf16 v[112:127], v[44:47], v[28:31], v[112:127]
    s_mov_b32 m0, s59
    v_exp_f32 v90, v90
    v_exp_f32 v91, v91
    v_cvt_pk_bf16_f32 v140, v88, v89
    v_exp_f32 v92, v92
    v_exp_f32 v93, v93
    v_cvt_pk_bf16_f32 v141, v90, v91
    v_mfma_f32_32x32x16_bf16 v[160:175], v[48:51], v[136:139], v[160:175]
    s_cbranch_scc1 A1_nd4
    buffer_load_dwordx4 v224, s[8:11], s41 offen lds
A1_nd4:
    v_exp_f32 v94, v94
    v_exp_f32 v95, v95
    v_cvt_pk_bf16_f32 v142, v92, v93
    v_cvt_pk_bf16_f32 v143, v94, v95
    v_exp_f32 v96, v96
    v_exp_f32 v97, v97
    v_mfma_f32_32x32x16_bf16 v[160:175], v[52:55], v[140:143], v[160:175]
    s_waitcnt lgkmcnt(0)
    ds_read_b64_tr_b16 v[40:41], v7 offset:1280
    v_exp_f32 v98, v98
    v_exp_f32 v99, v99
    v_cvt_pk_bf16_f32 v128, v96, v97
    v_exp_f32 v100, v100
    v_exp_f32 v101, v101
    v_cvt_pk_bf16_f32 v129, v98, v99
    v_mfma_f32_32x32x16_bf16 v[64:79], v[32:35], v[16:19], 0
    ds_read_b64_tr_b16 v[42:43], v7 offset:1344
    v_exp_f32 v102, v102
    v_exp_f32 v103, v103
    v_cvt_pk_bf16_f32 v130, v100, v101
    v_cvt_pk_bf16_f32 v131, v102, v103
    v_exp_f32 v104, v104
    v_exp_f32 v105, v105
    v_mfma_f32_32x32x16_bf16 v[64:79], v[36:39], v[20:23], v[64:79]
    ds_read_b64_tr_b16 v[44:45], v8 offset:1280
    v_exp_f32 v106, v106
    v_exp_f32 v107, v107
    v_cvt_pk_bf16_f32 v132, v104, v105
    v_exp_f32 v108, v108
    v_exp_f32 v109, v109
    v_cvt_pk_bf16_f32 v133, v106, v107
    v_mfma_f32_32x32x16_bf16 v[144:159], v[56:59], v[128:131], v[144:159]
    s_mov_b64 exec, s[56:57]
    ds_read_b128 v[48:51], v9 offset:0
    ds_read_b128 v[52:55], v9 offset:640
    s_mov_b64 exec, -1
    v_exp_f32 v110, v110
    v_exp_f32 v111, v111
    v_cvt_pk_bf16_f32 v134, v108, v109
    v_cvt_pk_bf16_f32 v135, v110, v111
    v_exp_f32 v112, v112
    v_exp_f32 v113, v113
    v_mfma_f32_32x32x16_bf16 v[80:95], v[32:35], v[24:27], 0
    s_add_u32 s41, s41, 299008
    v_mov_b32 v4, v7
    v_mov_b32 v5, v8
    v_mov_b32 v6, v9
    v_add_u32 v7, s36, v10
    v_add_u32 v8, s36, v11
    v_add_u32 v9, s36, v12
    v_exp_f32 v114, v114
    v_exp_f32 v115, v115
    v_cvt_pk_bf16_f32 v136, v112, v113
    v_exp_f32 v116, v116
    v_exp_f32 v117, v117
    v_cvt_pk_bf16_f32 v137, v114, v115
    v_mfma_f32_32x32x16_bf16 v[144:159], v[60:63], v[132:135], v[144:159]
    s_add_u32 s36, s36, 20480
    s_cmp_eq_u32 s36, 61440
    v_exp_f32 v118, v118
    v_exp_f32 v119, v119
    v_cvt_pk_bf16_f32 v138, v116, v117
    v_cvt_pk_bf16_f32 v139, v118, v119
    v_exp_f32 v120, v120
    v_exp_f32 v121, v121
    v_mfma_f32_32x32x16_bf16 v[80:95], v[36:39], v[28:31], v[80:95]
    s_cselect_b32 s36, 0, s36
    s_add_u32 s35, s35, 1
    v_exp_f32 v122, v122
    v_exp_f32 v123, v123
    v_cvt_pk_bf16_f32 v140, v120, v121
    v_exp_f32 v124, v124
    v_exp_f32 v125, v125
    v_cvt_pk_bf16_f32 v141, v122, v123
    v_mfma_f32_32x32x16_bf16 v[160:175], v[56:59], v[136:139], v[160:175]
    s_cmp_lt_u32 s35, s33
    v_exp_f32 v126, v126
    v_exp_f32 v127, v127
    v_cvt_pk_bf16_f32 v142, v124, v125
    v_cvt_pk_bf16_f32 v143, v126, v127
    s_cbranch_scc1 A1_loop
    s_cmp_eq_u32 s35, 8
    s_cbranch_scc1 A1_fin
    s_mov_b32 s33, 8
    s_lshl_b32 s46, s31, 2
    s_add_u32 s46, s46, s32
    s_lshl_b32 s47, s46, 8
    s_add_u32 s47, s47, 58720256
    v_and_b32 v3, 31, v1
    v_lshlrev_b32 v3, 2, v3
    buffer_load_dword v230, v3, s[8:11], s47 offen
    buffer_load_dword v231, v3, s[8:11], s47 offen offset:128
    v_lshrrev_b32 v236, 5, v1
    s_lshl_b32 s46, s46, 2
    s_mul_i32 s46, s46, 92160
    s_add_u32 s46, s46, 41943040
    s_lshr_b32 s50, s30, 1
    s_lshl_b32 s50, s50, 10
    s_and_b32 s49, s30, 1
    s_lshl_b32 s49, s49, 9
    s_add_u32 s50, s50, s49
    s_add_u32 s50, s50, s46
    s_lshr_b32 s51, s30, 4
    s_add_u32 s51, s51, 16
    s_lshl_b32 s51, s51, 10
    s_bfe_u32 s49, s30, 0x20002
    s_lshl_b32 s49, s49, 8
    s_add_u32 s51, s51, s49
    s_and_b32 s49, s30, 3
    s_lshl_b32 s49, s49, 2
    s_add_u32 s51, s51, s49
    s_add_u32 s51, s51, s46
    v_bfe_u32 v3, v1, 4, 1
    s_mov_b32 s49, 92160
    v_mul_lo_u32 v3, v3, s49
    v_and_b32 v237, 15, v1
    v_lshl_add_u32 v232, v237, 4, v3
    v_lshl_add_u32 v233, v236, 8, v232
    v_add_u32 v234, 184320, v232
    v_add_u32 v235, 184320, v233
    s_load_dwordx2 s[12:13], s[0:1], 16
    s_load_dwordx2 s[14:15], s[0:1], 56
    s_lshl_b32 s48, s2, 2
    s_add_u32 s48, s48, s32
    s_mov_b32 s23, 0x00020000
    s_mul_i32 s25, s48, 729
    s_lshr_b32 s25, s25, 16
    s_mul_i32 s26, s25, 90
    s_sub_u32 s26, s48, s26
    s_mul_i32 s25, s25, 144
    s_sub_u32 s27, s26, 18
    s_lshl_b32 s27, s27, 5
    s_mov_b32 s28, 8
    s_mov_b32 s29, 2
    s_mov_b32 s96, 16
    s_mov_b32 s97, 4
    s_sub_u32 s47, s26, 16
    s_mul_i32 s47, s47, 288
    s_add_u32 s47, s47, 16
    s_mov_b32 s22, 2654208
    s_waitcnt lgkmcnt(0)
    s_cmp_lt_u32 s26, 18
    s_cselect_b32 s20, s12, s14
    s_cselect_b32 s21, s13, s15
    s_cselect_b32 s22, 663552, s22
    s_cselect_b32 s27, s47, s27
    s_cselect_b32 s28, 36, s28
    s_cselect_b32 s29, 18, s29
    s_cselect_b32 s96, 144, s96
    s_cselect_b32 s97, 72, s97
    s_mul_i32 s47, s26, 36
    s_cmp_lt_u32 s26, 16
    s_cselect_b32 s27, s47, s27
    s_cselect_b32 s28, 8, s28
    s_cselect_b32 s29, 2, s29
    s_cselect_b32 s96, 18, s96
    s_cselect_b32 s97, 4, s97
    s_mulk_i32 s27, 1152
    s_mulk_i32 s28, 1152
    s_mulk_i32 s29, 1152
    s_mulk_i32 s96, 1152
    s_mulk_i32 s97, 1152
    s_add_u32 s27, s27, s25
    v_lshrrev_b32 v238, 5, v1
    v_mul_lo_u32 v238, v238, s29
    v_bfe_u32 v239, v1, 4, 1
    v_mul_u32_u24 v239, 1152, v239
    v_and_b32 v241, 15, v1
    v_cmp_lt_u32 vcc, 8, v241
    v_lshlrev_b32 v241, 4, v241
    v_add3_u32 v238, v238, v239, v241
    v_mov_b32 v239, 0x7f000000
    v_cndmask_b32 v240, v238, v239, vcc
    s_cmp_lt_u32 s48, 720
    s_cselect_b32 s22, s22, 0
    s_mul_i32 s98, s48, 5120
    s_add_u32 s98, s98, 54525952
    s_cmp_lt_u32 s48, 720
    s_cselect_b32 s98, s98, 0x7f000000
    s_add_u32 s24, s43, 20480
    s_mul_i32 s99, s32, 3072
    s_add_u32 s99, s99, 56832
    s_barrier
    s_add_u32 m0, s24, 0
    s_nop 0
    buffer_load_dwordx4 v240, s[20:23], s27 offen lds
    s_add_u32 m0, s24, 1024
    s_add_u32 s47, s27, s28
    buffer_load_dwordx4 v240, s[20:23], s47 offen lds
    s_add_u32 m0, s24, 2048
    s_add_u32 s47, s27, s97
    buffer_load_dwordx4 v240, s[20:23], s47 offen lds
    s_add_u32 m0, s24, 3072
    s_add_u32 s47, s27, s97
    s_add_u32 s47, s47, s28
    buffer_load_dwordx4 v240, s[20:23], s47 offen lds
    s_add_u32 m0, s24, 4096
    s_add_u32 s47, s27, s96
    buffer_load_dwordx4 v240, s[20:23], s47 offen lds
    s_add_u32 m0, s99, 5120
    s_add_u32 s47, s27, s96
    s_add_u32 s47, s47, s28
    buffer_load_dwordx4 v240, s[20:23], s47 offen lds
    s_add_u32 m0, s99, 6144
    s_add_u32 s47, s27, s96
    s_add_u32 s47, s47, s97
    buffer_load_dwordx4 v240, s[20:23], s47 offen lds
    s_add_u32 m0, s99, 7168
    s_add_u32 s47, s27, s96
    s_add_u32 s47, s47, s97
    s_add_u32 s47, s47, s28
    buffer_load_dwordx4 v240, s[20:23], s47 offen lds
    v_lshrrev_b32 v238, 4, v1
    v_lshlrev_b32 v238, 11, v238
    v_bfe_u32 v239, v1, 2, 2
    v_lshl_add_u32 v238, v239, 8, v238
    v_and_b32 v239, 3, v1
    v_lshl_add_u32 v238, v239, 3, v238
    v_mov_b32 v240, s24
    v_mov_b32 v241, s99
    v_cmp_gt_u32 vcc, 48, v1
    s_nop 1
    v_cndmask_b32 v242, v241, v240, vcc
    v_add_u32 v242, v242, v238
    v_cndmask_b32 v243, v241, v240, s[44:45]
    v_add_u32 v243, v243, v238
    v_lshl_add_u32 v244, v239, 3, v242
    v_lshl_add_u32 v245, v239, 3, v243
    s_waitcnt vmcnt(0)
    ds_read_b64_tr_b16 v[100:101], v244 offset:0
    ds_read_b64_tr_b16 v[102:103], v245 offset:1024
    ds_read_b64_tr_b16 v[104:105], v244 offset:8
    ds_read_b64_tr_b16 v[106:107], v245 offset:1032
    ds_read_b64_tr_b16 v[108:109], v244 offset:64
    ds_read_b64_tr_b16 v[110:111], v245 offset:1088
    ds_read_b64_tr_b16 v[112:113], v244 offset:72
    ds_read_b64_tr_b16 v[114:115], v245 offset:1096
    ds_read_b64_tr_b16 v[116:117], v242 offset:128
    ds_read_b64_tr_b16 v[118:119], v243 offset:1152
    s_waitcnt lgkmcnt(8)
    buffer_store_dwordx4 v[100:103], v13, s[8:11], s98 offen offset:0 sc1
    s_waitcnt lgkmcnt(6)
    buffer_store_dwordx4 v[104:107], v13, s[8:11], s98 offen offset:1024 sc1
    s_waitcnt lgkmcnt(4)
    buffer_store_dwordx4 v[108:111], v13, s[8:11], s98 offen offset:2048 sc1
    s_waitcnt lgkmcnt(2)
    buffer_store_dwordx4 v[112:115], v13, s[8:11], s98 offen offset:3072 sc1
    s_add_u32 s98, s98, 4096
    s_waitcnt lgkmcnt(0)
    buffer_store_dwordx4 v[116:119], v13, s[8:11], s98 offen offset:0 sc1
    s_lshr_b32 s46, s2, 4
    s_lshl_b32 s46, s46, 7
    s_add_u32 s46, s46, 58787840
    s_mov_b32 s47, 58789888
    v_mov_b32 v238, 0
    v_mov_b32 v239, 1
    v_mov_b32 v240, 0x100
    v_lshlrev_b32 v241, 7, v1
    s_waitcnt vmcnt(0)
    s_barrier
    s_cmp_lg_u32 s32, 0
    s_cbranch_scc1 A1_wfd
    s_mov_b64 exec, 1
    buffer_atomic_add v239, v238, s[8:11], s46 offen sc0 sc1
    s_waitcnt vmcnt(0)
    v_readfirstlane_b32 s48, v239
    s_mov_b64 exec, -1
    s_cmp_lg_u32 s48, 15
    s_cbranch_scc1 A1_wfd
    buffer_atomic_add v240, v241, s[8:11], s47 offen sc1
A1_wfd:
    s_branch A1_loop
A1_fin:
    s_nop 0
    v_mfma_f32_32x32x16_bf16 v[160:175], v[60:63], v[140:143], v[160:175]
    s_setprio 3
    v_mov_b32 v184, v154
    v_mov_b32 v185, v154
    v_add_f32 v176, abs(v144), abs(v145)
    s_nop 0
    v_permlane32_swap_b32 v184, v185
    v_add_f32 v176, v176, abs(v146)
    v_add_f32 v176, v176, abs(v147)
    v_add_f32 v176, v176, abs(v148)
    v_add_f32 v176, v176, abs(v149)
    v_add_f32 v176, v176, abs(v150)
    v_add_f32 v176, v176, abs(v151)
    v_add_f32 v176, v176, abs(v152)
    v_add_f32 v176, v176, abs(v153)
    v_add_f32 v176, v176, abs(v154)
    v_rcp_f32 v184, v184
    s_nop 0
    v_mul_f32 v184, v184, v230
    v_mul_f32 v144, v144, v184
    v_mul_f32 v145, v145, v184
    v_mul_f32 v146, v146, v184
    v_mul_f32 v147, v147, v184
    v_mul_f32 v148, v148, v184
    v_mul_f32 v149, v149, v184
    v_mul_f32 v150, v150, v184
    v_mul_f32 v151, v151, v184
    v_mul_f32 v152, v152, v184
    v_mul_f32 v153, v153, v184
    v_cvt_pk_bf16_f32 v188, v144, v145
    v_cvt_pk_bf16_f32 v189, v146, v147
    v_cvt_pk_bf16_f32 v190, v148, v149
    v_cvt_pk_bf16_f32 v191, v150, v151
    v_cvt_pk_bf16_f32 v192, v152, v153
    buffer_store_dwordx4 v[188:191], v233, s[8:11], s50 offen sc1
    s_mov_b64 exec, s[44:45]
    buffer_store_dword v192, v232, s[8:11], s51 offen sc1
    s_mov_b64 exec, -1
    v_mov_b32 v200, v170
    v_mov_b32 v201, v170
    v_add_f32 v177, abs(v160), abs(v161)
    s_nop 0
    v_permlane32_swap_b32 v200, v201
    v_add_f32 v177, v177, abs(v162)
    v_add_f32 v177, v177, abs(v163)
    v_add_f32 v177, v177, abs(v164)
    v_add_f32 v177, v177, abs(v165)
    v_add_f32 v177, v177, abs(v166)
    v_add_f32 v177, v177, abs(v167)
    v_add_f32 v177, v177, abs(v168)
    v_add_f32 v177, v177, abs(v169)
    v_add_f32 v177, v177, abs(v170)
    v_rcp_f32 v200, v200
    s_nop 0
    v_mul_f32 v200, v200, v231
    v_mul_f32 v160, v160, v200
    v_mul_f32 v161, v161, v200
    v_mul_f32 v162, v162, v200
    v_mul_f32 v163, v163, v200
    v_mul_f32 v164, v164, v200
    v_mul_f32 v165, v165, v200
    v_mul_f32 v166, v166, v200
    v_mul_f32 v167, v167, v200
    v_mul_f32 v168, v168, v200
    v_mul_f32 v169, v169, v200
    v_cvt_pk_bf16_f32 v204, v160, v161
    v_cvt_pk_bf16_f32 v205, v162, v163
    v_cvt_pk_bf16_f32 v206, v164, v165
    v_cvt_pk_bf16_f32 v207, v166, v167
    v_cvt_pk_bf16_f32 v208, v168, v169
    buffer_store_dwordx4 v[204:207], v235, s[8:11], s50 offen sc1
    s_mov_b64 exec, s[44:45]
    buffer_store_dword v208, v234, s[8:11], s51 offen sc1
    s_mov_b64 exec, -1
    v_add_f32 v176, v176, v177
    v_mov_b32 v178, 0x71800000
    v_cmp_nlt_f32 vcc, v176, v178
    s_nop 0
    s_cmp_lg_u64 vcc, 0
    s_cselect_b32 s48, 1, 0
    v_mov_b32 v179, s48
    s_lshl_b32 s49, s32, 2
    v_mov_b32 v4, s49
    ds_write_b32 v4, v179 offset:61696
    s_lshl_b32 s46, s31, 7
    s_add_u32 s46, s46, 58798080
    s_lshl_b32 s47, s31, 12
    s_add_u32 s47, s47, 58802176
    v_mov_b32 v2, 0
    v_mov_b32 v3, 1
    v_mov_b32 v5, 1
    v_lshlrev_b32 v4, 7, v1
    s_waitcnt vmcnt(0) lgkmcnt(0)
    s_barrier
    ds_read_b128 v[180:183], v2 offset:61696
    s_waitcnt lgkmcnt(0)
    v_or3_b32 v180, v180, v181, v182
    v_or_b32 v180, v180, v183
    s_nop 0
    v_readfirstlane_b32 s48, v180
    s_nop 0
    s_andn2_b32 s48, s48, s34
    s_cmp_lg_u32 s48, 0
    s_cbranch_scc1 A1_fallback
    s_cmp_lg_u32 s32, 0
    s_cbranch_scc1 A1_done
    s_mov_b64 exec, 1
    buffer_atomic_add v3, v2, s[8:11], s46 offen sc0 sc1
    s_waitcnt vmcnt(0)
    v_readfirstlane_b32 s48, v3
    s_cmp_lg_u32 s48, 31
    s_cbranch_scc1 A1_done
    s_mov_b32 exec_lo, -1
    buffer_store_dword v5, v4, s[8:11], s47 offen sc1
A1_done:
    s_endpgm
A1_fallback:
    s_waitcnt vmcnt(0) lgkmcnt(0)
    s_nop 15
    s_mov_b32 s18, 0
    s_mov_b32 s22, 0
    s_mov_b32 s34, 1
    s_mov_b32 s35, 0
    s_mov_b32 s41, s42
    s_mov_b32 s40, s43
    v_mov_b32 v176, 0xff7fffff
    v_mov_b32 v177, 0xff7fffff
    v_mov_b32 v21, 0
    v_mov_b32 v22, 0
    v_mov_b32 v29, 0
    v_mov_b32 v30, 0
A1_fb_chunk:
    s_barrier
    s_mov_b32 m0, s40
    s_nop 0
    buffer_load_dwordx4 v220, s[8:11], s41 offen offset:0 lds
    buffer_load_dwordx4 v221, s[8:11], s41 offen offset:1024 lds
    buffer_load_dwordx4 v222, s[8:11], s41 offen offset:2048 lds
    buffer_load_dwordx4 v223, s[8:11], s41 offen offset:3072 lds
    s_add_u32 m0, s40, 4096
    s_nop 0
    buffer_load_dwordx4 v224, s[8:11], s41 offen lds
    s_waitcnt vmcnt(0)
    s_barrier
    v_mov_b32 v4, v10
    v_mov_b32 v5, v11
    s_mov_b32 s36, 0
A1_fb_tile:
    ds_read_b64_tr_b16 v[32:33], v4 offset:0
    ds_read_b64_tr_b16 v[34:35], v4 offset:64
    ds_read_b64_tr_b16 v[36:37], v5 offset:0
    s_waitcnt lgkmcnt(1)
    v_mfma_f32_32x32x16_bf16 v[64:79], v[32:35], v[16:19], 0
    s_waitcnt lgkmcnt(0)
    v_mfma_f32_32x32x16_bf16 v[64:79], v[36:39], v[20:23], v[64:79]
    v_mfma_f32_32x32x16_bf16 v[80:95], v[32:35], v[24:27], 0
    v_mfma_f32_32x32x16_bf16 v[80:95], v[36:39], v[28:31], v[80:95]
    s_nop 9
    v_max3_f32 v176, v176, v64, v65
    v_max3_f32 v176, v176, v66, v67
    v_max3_f32 v176, v176, v68, v69
    v_max3_f32 v176, v176, v70, v71
    v_max3_f32 v176, v176, v72, v73
    v_max3_f32 v176, v176, v74, v75
    v_max3_f32 v176, v176, v76, v77
    v_max3_f32 v176, v176, v78, v79
    v_max3_f32 v177, v177, v80, v81
    v_max3_f32 v177, v177, v82, v83
    v_max3_f32 v177, v177, v84, v85
    v_max3_f32 v177, v177, v86, v87
    v_max3_f32 v177, v177, v88, v89
    v_max3_f32 v177, v177, v90, v91
    v_max3_f32 v177, v177, v92, v93
    v_max3_f32 v177, v177, v94, v95
    v_add_u32 v4, 1280, v4
    v_add_u32 v5, 1280, v5
    s_add_u32 s36, s36, 1
    s_cmp_lt_u32 s36, 8
    s_cbranch_scc1 A1_fb_tile
    s_add_u32 s41, s41, 299008
    s_add_u32 s35, s35, 1
    s_cmp_lt_u32 s35, 8
    s_cbranch_scc1 A1_fb_chunk
    v_mov_b32 v178, v176
    s_nop 1
    v_permlane32_swap_b32 v176, v178
    v_max_f32 v176, v176, v178
    v_mov_b32 v179, v177
    s_nop 1
    v_permlane32_swap_b32 v177, v179
    v_max_f32 v177, v177, v179
    v_and_b32 v180, 0xffff0000, v176
    v_sub_f32 v181, v176, v180
    v_and_b32 v182, 0xffff0000, v181
    v_sub_f32 v181, v181, v182
    v_lshrrev_b32 v180, 16, v180
    v_or_b32 v180, v180, v182
    v_xor_b32 v180, 0x80008000, v180
    v_lshrrev_b32 v181, 16, v181
    v_xor_b32 v181, 0x8000, v181
    v_cndmask_b32 v21, 0, v180, s[44:45]
    v_cndmask_b32 v22, 0, v181, s[44:45]
    v_and_b32 v184, 0xffff0000, v177
    v_sub_f32 v185, v177, v184
    v_and_b32 v186, 0xffff0000, v185
    v_sub_f32 v185, v185, v186
    v_lshrrev_b32 v184, 16, v184
    v_or_b32 v184, v184, v186
    v_xor_b32 v184, 0x80008000, v184
    v_lshrrev_b32 v185, 16, v185
    v_xor_b32 v185, 0x8000, v185
    v_cndmask_b32 v29, 0, v184, s[44:45]
    v_cndmask_b32 v30, 0, v185, s[44:45]
    v_mov_b32 v144, 0
    v_mov_b32 v145, 0
    v_mov_b32 v146, 0
    v_mov_b32 v147, 0
    v_mov_b32 v148, 0
    v_mov_b32 v149, 0
    v_mov_b32 v150, 0
    v_mov_b32 v151, 0
    v_mov_b32 v152, 0
    v_mov_b32 v153, 0
    v_mov_b32 v154, 0
    v_mov_b32 v155, 0
    v_mov_b32 v156, 0
    v_mov_b32 v157, 0
    v_mov_b32 v158, 0
    v_mov_b32 v159, 0
    v_mov_b32 v160, 0
    v_mov_b32 v161, 0
    v_mov_b32 v162, 0
    v_mov_b32 v163, 0
    v_mov_b32 v164, 0
    v_mov_b32 v165, 0
    v_mov_b32 v166, 0
    v_mov_b32 v167, 0
    v_mov_b32 v168, 0
    v_mov_b32 v169, 0
    v_mov_b32 v170, 0
    v_mov_b32 v171, 0
    v_mov_b32 v172, 0
    v_mov_b32 v173, 0
    v_mov_b32 v174, 0
    v_mov_b32 v175, 0
    s_barrier
    s_mov_b32 s41, s42
    s_mov_b32 m0, s40
    s_nop 0
    buffer_load_dwordx4 v220, s[8:11], s41 offen offset:0 lds
    buffer_load_dwordx4 v221, s[8:11], s41 offen offset:1024 lds
    buffer_load_dwordx4 v222, s[8:11], s41 offen offset:2048 lds
    buffer_load_dwordx4 v223, s[8:11], s41 offen offset:3072 lds
    s_add_u32 m0, s40, 4096
    s_nop 0
    buffer_load_dwordx4 v224, s[8:11], s41 offen lds
    s_add_u32 s40, s43, 20480
    s_add_u32 s41, s42, 299008
    s_mov_b32 m0, s40
    s_nop 0
    buffer_load_dwordx4 v220, s[8:11], s41 offen offset:0 lds
    buffer_load_dwordx4 v221, s[8:11], s41 offen offset:1024 lds
    buffer_load_dwordx4 v222, s[8:11], s41 offen offset:2048 lds
    buffer_load_dwordx4 v223, s[8:11], s41 offen offset:3072 lds
    s_add_u32 m0, s40, 4096
    s_nop 0
    buffer_load_dwordx4 v224, s[8:11], s41 offen lds
    s_mov_b32 s55, 0
    s_mov_b32 s58, 6
    s_mov_b32 s35, 0
    s_add_u32 s41, s42, 598016
    s_waitcnt vmcnt(0)
    s_barrier
    s_nop 7
    s_branch A1_main
K23_B:
    s_setprio 1
    s_sub_u32 s2, s2, 256
    s_and_b32 s30, s2, 1
    s_lshl_b32 s30, s30, 3
    s_bfe_u32 s46, s2, 0x30003
    s_add_u32 s30, s30, s46
    s_bfe_u32 s31, s2, 0x20001
    s_lshl_b32 s31, s31, 2
    s_lshr_b32 s46, s2, 6
    s_add_u32 s31, s31, s46
    s_lshl_b32 s33, s30, 2
    s_add_u32 s33, s33, s32
    s_lshl_b32 s42, s33, 17
    v_lshlrev_b32 v232, 4, v1
    s_lshl_b32 s40, s32, 12
    s_mul_i32 s41, s32, 2432
    s_add_u32 s41, s41, 32768
    s_mul_i32 s44, s32, 36864
    v_lshrrev_b32 v7, 3, v1
    v_lshrrev_b32 v3, 4, v1
    v_and_b32 v4, 7, v1
    v_xor_b32 v4, v4, v3
    v_lshlrev_b32 v4, 4, v4
    v_xor_b32 v8, 64, v4
    s_mov_b32 s12, s24
    s_mov_b32 s13, s25
    s_mov_b32 s14, 8388608
    s_mov_b32 s15, 0x00020000
    s_mov_b32 s16, s26
    s_mov_b32 s17, s27
    s_mov_b32 s18, 4096
    s_mov_b32 s19, 0x00020000
    s_mul_i32 s48, s31, 2304
    s_add_u32 s48, s48, 8388608
    s_add_u32 s43, s48, s44
    v_lshlrev_b32 v2, 12, v7
    v_add_u32 v228, v2, v4
    v_add_u32 v229, v2, v8
    v_add_u32 v229, 31744, v229
    v_add_u32 v230, 63488, v228
    v_add_u32 v231, 63488, v229
    v_and_b32 v2, 15, v1
    v_bfe_u32 v9, v1, 1, 3
    v_xor_b32 v4, v9, v3
    v_lshlrev_b32 v4, 4, v4
    v_lshl_add_u32 v4, v2, 7, v4
    v_add_u32 v233, s40, v4
    v_xor_b32 v234, 64, v233
    v_mul_u32_u24 v4, 2432, v3
    v_lshl_add_u32 v4, v2, 4, v4
    s_and_b32 s46, s31, 1
    s_lshl_b32 s47, s46, 11
    s_sub_u32 s47, 34816, s47
    v_add_u32 v252, s47, v4
    v_and_b32 v9, 8, v1
    v_lshl_add_u32 v4, v9, 4, v4
    s_lshl_b32 s47, s46, 8
    s_add_u32 s47, s47, 32768
    v_add_u32 v235, s47, v4
    v_lshlrev_b32 v10, 1, v2
    v_lshlrev_b32 v11, 2, v2
    s_lshr_b32 s44, s2, 4
    s_lshl_b32 s44, s44, 7
    s_add_u32 s44, s44, 58785792
    s_and_b32 s45, s2, 63
    s_lshl_b32 s45, s45, 7
    s_add_u32 s45, s45, 58789888
    v_lshlrev_b32 v253, 7, v1
    v_mov_b32 v236, 0
    v_mov_b32 v237, 1
    s_mul_i32 s46, s33, 184320
    s_add_u32 s46, s46, 41961472
    s_mul_i32 s34, s31, 9
    s_add_u32 s34, s34, 1
    s_lshr_b32 s34, s34, 1
    s_lshl_b32 s34, s34, 10
    s_add_u32 s34, s34, s46
    s_lshr_b32 s49, s31, 1
    s_mul_i32 s49, s49, 9216
    s_add_u32 s49, s49, 4096
    s_and_b32 s47, s31, 1
    s_lshl_b32 s47, s47, 9
    s_add_u32 s49, s49, s47
    s_add_u32 s49, s49, s46
    v_add_u32 v244, 92160, v232
    v_and_b32 v4, 31, v1
    v_lshlrev_b32 v4, 4, v4
    v_lshrrev_b32 v9, 5, v1
    v_lshl_add_u32 v245, v9, 3, v4
    v_add_u32 v246, 92160, v245
    v_lshlrev_b32 v15, 4, v0
    s_and_b32 s59, s2, 7
    s_lshl_b32 s59, s59, 5
    s_lshr_b32 s46, s2, 3
    s_add_u32 s59, s59, s46
    s_mul_i32 s58, s59, 36864
    s_add_u32 s58, s58, 8388608
    s_mov_b32 s46, s58
    buffer_load_dwordx4 v[64:67], v15, s[8:11], s46 offen
    s_add_u32 s46, s46, 4096
    buffer_load_dwordx4 v[68:71], v15, s[8:11], s46 offen
    s_add_u32 s46, s46, 4096
    buffer_load_dwordx4 v[72:75], v15, s[8:11], s46 offen
    s_add_u32 s46, s46, 4096
    buffer_load_dwordx4 v[76:79], v15, s[8:11], s46 offen
    s_add_u32 s46, s46, 4096
    buffer_load_dwordx4 v[80:83], v15, s[8:11], s46 offen
    s_add_u32 s46, s46, 4096
    buffer_load_dwordx4 v[84:87], v15, s[8:11], s46 offen
    s_add_u32 s46, s46, 4096
    buffer_load_dwordx4 v[88:91], v15, s[8:11], s46 offen
    s_add_u32 s46, s46, 4096
    buffer_load_dwordx4 v[92:95], v15, s[8:11], s46 offen
    s_add_u32 s46, s46, 4096
    buffer_load_dwordx4 v[96:99], v15, s[8:11], s46 offen
    s_setprio 3
    s_waitcnt vmcnt(8)
    v_lshlrev_b32 v100, 16, v64
    v_and_b32 v101, 0xffff0000, v64
    v_lshlrev_b32 v102, 16, v65
    v_and_b32 v103, 0xffff0000, v65
    v_lshlrev_b32 v104, 16, v66
    v_and_b32 v105, 0xffff0000, v66
    v_lshlrev_b32 v106, 16, v67
    v_and_b32 v107, 0xffff0000, v67
    v_mul_f32 v24, v100, v100
    v_mul_f32 v25, v101, v101
    v_mul_f32 v26, v102, v102
    v_mul_f32 v27, v103, v103
    v_mul_f32 v28, v104, v104
    v_mul_f32 v29, v105, v105
    v_mul_f32 v30, v106, v106
    v_mul_f32 v31, v107, v107
    s_waitcnt vmcnt(7)
    v_lshlrev_b32 v108, 16, v68
    v_and_b32 v109, 0xffff0000, v68
    v_lshlrev_b32 v110, 16, v69
    v_and_b32 v111, 0xffff0000, v69
    v_lshlrev_b32 v112, 16, v70
    v_and_b32 v113, 0xffff0000, v70
    v_lshlrev_b32 v114, 16, v71
    v_and_b32 v115, 0xffff0000, v71
    v_add_f32 v16, v100, v108
    v_add_f32 v17, v101, v109
    v_add_f32 v18, v102, v110
    v_add_f32 v19, v103, v111
    v_add_f32 v20, v104, v112
    v_add_f32 v21, v105, v113
    v_add_f32 v22, v106, v114
    v_add_f32 v23, v107, v115
    v_fmac_f32 v24, v108, v108
    v_fmac_f32 v25, v109, v109
    v_fmac_f32 v26, v110, v110
    v_fmac_f32 v27, v111, v111
    v_fmac_f32 v28, v112, v112
    v_fmac_f32 v29, v113, v113
    v_fmac_f32 v30, v114, v114
    v_fmac_f32 v31, v115, v115
    s_waitcnt vmcnt(6)
    v_lshlrev_b32 v116, 16, v72
    v_and_b32 v117, 0xffff0000, v72
    v_lshlrev_b32 v118, 16, v73
    v_and_b32 v119, 0xffff0000, v73
    v_lshlrev_b32 v120, 16, v74
    v_and_b32 v121, 0xffff0000, v74
    v_lshlrev_b32 v122, 16, v75
    v_and_b32 v123, 0xffff0000, v75
    v_add_f32 v16, v16, v116
    v_add_f32 v17, v17, v117
    v_add_f32 v18, v18, v118
    v_add_f32 v19, v19, v119
    v_add_f32 v20, v20, v120
    v_add_f32 v21, v21, v121
    v_add_f32 v22, v22, v122
    v_add_f32 v23, v23, v123
    v_fmac_f32 v24, v116, v116
    v_fmac_f32 v25, v117, v117
    v_fmac_f32 v26, v118, v118
    v_fmac_f32 v27, v119, v119
    v_fmac_f32 v28, v120, v120
    v_fmac_f32 v29, v121, v121
    v_fmac_f32 v30, v122, v122
    v_fmac_f32 v31, v123, v123
    s_waitcnt vmcnt(5)
    v_lshlrev_b32 v124, 16, v76
    v_and_b32 v125, 0xffff0000, v76
    v_lshlrev_b32 v126, 16, v77
    v_and_b32 v127, 0xffff0000, v77
    v_lshlrev_b32 v128, 16, v78
    v_and_b32 v129, 0xffff0000, v78
    v_lshlrev_b32 v130, 16, v79
    v_and_b32 v131, 0xffff0000, v79
    v_add_f32 v16, v16, v124
    v_add_f32 v17, v17, v125
    v_add_f32 v18, v18, v126
    v_add_f32 v19, v19, v127
    v_add_f32 v20, v20, v128
    v_add_f32 v21, v21, v129
    v_add_f32 v22, v22, v130
    v_add_f32 v23, v23, v131
    v_fmac_f32 v24, v124, v124
    v_fmac_f32 v25, v125, v125
    v_fmac_f32 v26, v126, v126
    v_fmac_f32 v27, v127, v127
    v_fmac_f32 v28, v128, v128
    v_fmac_f32 v29, v129, v129
    v_fmac_f32 v30, v130, v130
    v_fmac_f32 v31, v131, v131
    s_waitcnt vmcnt(4)
    v_lshlrev_b32 v132, 16, v80
    v_and_b32 v133, 0xffff0000, v80
    v_lshlrev_b32 v134, 16, v81
    v_and_b32 v135, 0xffff0000, v81
    v_lshlrev_b32 v136, 16, v82
    v_and_b32 v137, 0xffff0000, v82
    v_lshlrev_b32 v138, 16, v83
    v_and_b32 v139, 0xffff0000, v83
    v_add_f32 v16, v16, v132
    v_add_f32 v17, v17, v133
    v_add_f32 v18, v18, v134
    v_add_f32 v19, v19, v135
    v_add_f32 v20, v20, v136
    v_add_f32 v21, v21, v137
    v_add_f32 v22, v22, v138
    v_add_f32 v23, v23, v139
    v_fmac_f32 v24, v132, v132
    v_fmac_f32 v25, v133, v133
    v_fmac_f32 v26, v134, v134
    v_fmac_f32 v27, v135, v135
    v_fmac_f32 v28, v136, v136
    v_fmac_f32 v29, v137, v137
    v_fmac_f32 v30, v138, v138
    v_fmac_f32 v31, v139, v139
    s_waitcnt vmcnt(3)
    v_lshlrev_b32 v140, 16, v84
    v_and_b32 v141, 0xffff0000, v84
    v_lshlrev_b32 v142, 16, v85
    v_and_b32 v143, 0xffff0000, v85
    v_lshlrev_b32 v144, 16, v86
    v_and_b32 v145, 0xffff0000, v86
    v_lshlrev_b32 v146, 16, v87
    v_and_b32 v147, 0xffff0000, v87
    v_add_f32 v16, v16, v140
    v_add_f32 v17, v17, v141
    v_add_f32 v18, v18, v142
    v_add_f32 v19, v19, v143
    v_add_f32 v20, v20, v144
    v_add_f32 v21, v21, v145
    v_add_f32 v22, v22, v146
    v_add_f32 v23, v23, v147
    v_fmac_f32 v24, v140, v140
    v_fmac_f32 v25, v141, v141
    v_fmac_f32 v26, v142, v142
    v_fmac_f32 v27, v143, v143
    v_fmac_f32 v28, v144, v144
    v_fmac_f32 v29, v145, v145
    v_fmac_f32 v30, v146, v146
    v_fmac_f32 v31, v147, v147
    s_waitcnt vmcnt(2)
    v_lshlrev_b32 v148, 16, v88
    v_and_b32 v149, 0xffff0000, v88
    v_lshlrev_b32 v150, 16, v89
    v_and_b32 v151, 0xffff0000, v89
    v_lshlrev_b32 v152, 16, v90
    v_and_b32 v153, 0xffff0000, v90
    v_lshlrev_b32 v154, 16, v91
    v_and_b32 v155, 0xffff0000, v91
    v_add_f32 v16, v16, v148
    v_add_f32 v17, v17, v149
    v_add_f32 v18, v18, v150
    v_add_f32 v19, v19, v151
    v_add_f32 v20, v20, v152
    v_add_f32 v21, v21, v153
    v_add_f32 v22, v22, v154
    v_add_f32 v23, v23, v155
    v_fmac_f32 v24, v148, v148
    v_fmac_f32 v25, v149, v149
    v_fmac_f32 v26, v150, v150
    v_fmac_f32 v27, v151, v151
    v_fmac_f32 v28, v152, v152
    v_fmac_f32 v29, v153, v153
    v_fmac_f32 v30, v154, v154
    v_fmac_f32 v31, v155, v155
    s_waitcnt vmcnt(1)
    v_lshlrev_b32 v156, 16, v92
    v_and_b32 v157, 0xffff0000, v92
    v_lshlrev_b32 v158, 16, v93
    v_and_b32 v159, 0xffff0000, v93
    v_lshlrev_b32 v160, 16, v94
    v_and_b32 v161, 0xffff0000, v94
    v_lshlrev_b32 v162, 16, v95
    v_and_b32 v163, 0xffff0000, v95
    v_add_f32 v16, v16, v156
    v_add_f32 v17, v17, v157
    v_add_f32 v18, v18, v158
    v_add_f32 v19, v19, v159
    v_add_f32 v20, v20, v160
    v_add_f32 v21, v21, v161
    v_add_f32 v22, v22, v162
    v_add_f32 v23, v23, v163
    v_fmac_f32 v24, v156, v156
    v_fmac_f32 v25, v157, v157
    v_fmac_f32 v26, v158, v158
    v_fmac_f32 v27, v159, v159
    v_fmac_f32 v28, v160, v160
    v_fmac_f32 v29, v161, v161
    v_fmac_f32 v30, v162, v162
    v_fmac_f32 v31, v163, v163
    s_waitcnt vmcnt(0)
    v_lshlrev_b32 v164, 16, v96
    v_and_b32 v165, 0xffff0000, v96
    v_lshlrev_b32 v166, 16, v97
    v_and_b32 v167, 0xffff0000, v97
    v_lshlrev_b32 v168, 16, v98
    v_and_b32 v169, 0xffff0000, v98
    v_lshlrev_b32 v170, 16, v99
    v_and_b32 v171, 0xffff0000, v99
    v_add_f32 v16, v16, v164
    v_add_f32 v17, v17, v165
    v_add_f32 v18, v18, v166
    v_add_f32 v19, v19, v167
    v_add_f32 v20, v20, v168
    v_add_f32 v21, v21, v169
    v_add_f32 v22, v22, v170
    v_add_f32 v23, v23, v171
    v_fmac_f32 v24, v164, v164
    v_fmac_f32 v25, v165, v165
    v_fmac_f32 v26, v166, v166
    v_fmac_f32 v27, v167, v167
    v_fmac_f32 v28, v168, v168
    v_fmac_f32 v29, v169, v169
    v_fmac_f32 v30, v170, v170
    v_fmac_f32 v31, v171, v171
    v_and_b32 v2, 1, v1
    v_cmp_eq_u32 s[50:51], 0, v2
    v_and_b32 v2, 2, v1
    v_cmp_eq_u32 s[52:53], 0, v2
    v_and_b32 v2, 4, v1
    v_cmp_eq_u32 s[54:55], 0, v2
    v_and_b32 v2, 8, v1
    v_cmp_eq_u32 s[56:57], 0, v2
    s_nop 1
    v_cndmask_b32 v32, v16, v24, s[56:57]
    v_cndmask_b32 v33, v17, v25, s[56:57]
    v_cndmask_b32 v34, v18, v26, s[56:57]
    v_cndmask_b32 v35, v19, v27, s[56:57]
    v_cndmask_b32 v36, v20, v28, s[56:57]
    v_cndmask_b32 v37, v21, v29, s[56:57]
    v_cndmask_b32 v38, v22, v30, s[56:57]
    v_cndmask_b32 v39, v23, v31, s[56:57]
    v_cndmask_b32 v16, v24, v16, s[56:57]
    v_cndmask_b32 v17, v25, v17, s[56:57]
    v_cndmask_b32 v18, v26, v18, s[56:57]
    v_cndmask_b32 v19, v27, v19, s[56:57]
    v_cndmask_b32 v20, v28, v20, s[56:57]
    v_cndmask_b32 v21, v29, v21, s[56:57]
    v_cndmask_b32 v22, v30, v22, s[56:57]
    v_cndmask_b32 v23, v31, v23, s[56:57]
    v_add_f32_dpp v16, v32, v16 row_mirror row_mask:0xf bank_mask:0xf
    v_add_f32_dpp v17, v33, v17 row_mirror row_mask:0xf bank_mask:0xf
    v_add_f32_dpp v18, v34, v18 row_mirror row_mask:0xf bank_mask:0xf
    v_add_f32_dpp v19, v35, v19 row_mirror row_mask:0xf bank_mask:0xf
    v_add_f32_dpp v20, v36, v20 row_mirror row_mask:0xf bank_mask:0xf
    v_add_f32_dpp v21, v37, v21 row_mirror row_mask:0xf bank_mask:0xf
    v_add_f32_dpp v22, v38, v22 row_mirror row_mask:0xf bank_mask:0xf
    v_add_f32_dpp v23, v39, v23 row_mirror row_mask:0xf bank_mask:0xf
    v_cndmask_b32 v32, v16, v20, s[54:55]
    v_cndmask_b32 v33, v17, v21, s[54:55]
    v_cndmask_b32 v34, v18, v22, s[54:55]
    v_cndmask_b32 v35, v19, v23, s[54:55]
    v_cndmask_b32 v16, v20, v16, s[54:55]
    v_cndmask_b32 v17, v21, v17, s[54:55]
    v_cndmask_b32 v18, v22, v18, s[54:55]
    v_cndmask_b32 v19, v23, v19, s[54:55]
    v_add_f32_dpp v16, v32, v16 row_half_mirror row_mask:0xf bank_mask:0xf
    v_add_f32_dpp v17, v33, v17 row_half_mirror row_mask:0xf bank_mask:0xf
    v_add_f32_dpp v18, v34, v18 row_half_mirror row_mask:0xf bank_mask:0xf
    v_add_f32_dpp v19, v35, v19 row_half_mirror row_mask:0xf bank_mask:0xf
    v_cndmask_b32 v32, v16, v18, s[52:53]
    v_cndmask_b32 v33, v17, v19, s[52:53]
    v_cndmask_b32 v16, v18, v16, s[52:53]
    v_cndmask_b32 v17, v19, v17, s[52:53]
    s_nop 0
    v_add_f32_dpp v16, v32, v16 quad_perm:[2,3,0,1] row_mask:0xf bank_mask:0xf
    v_add_f32_dpp v17, v33, v17 quad_perm:[2,3,0,1] row_mask:0xf bank_mask:0xf
    v_cndmask_b32 v32, v16, v17, s[50:51]
    v_cndmask_b32 v16, v17, v16, s[50:51]
    s_nop 1
    v_add_f32_dpp v16, v32, v16 quad_perm:[1,0,3,2] row_mask:0xf bank_mask:0xf
    v_lshlrev_b32 v2, 2, v0
    v_add_u32 v2, 71680, v2
    ds_write_b32 v2, v16
    v_and_b32 v3, 15, v1
    v_lshlrev_b32 v3, 2, v3
    v_add_u32 v3, 71680, v3
    s_add_u32 m0, s40, 0
    s_nop 0
    buffer_load_dwordx4 v228, s[12:15], s42 offen offset:0 lds
    buffer_load_dwordx4 v229, s[12:15], s42 offen offset:1024 lds
    buffer_load_dwordx4 v230, s[12:15], s42 offen offset:2048 lds
    buffer_load_dwordx4 v231, s[12:15], s42 offen offset:3072 lds
    s_add_u32 s42, s42, 128
    s_add_u32 m0, s40, 16384
    s_nop 0
    buffer_load_dwordx4 v228, s[12:15], s42 offen offset:0 lds
    buffer_load_dwordx4 v229, s[12:15], s42 offen offset:1024 lds
    buffer_load_dwordx4 v230, s[12:15], s42 offen offset:2048 lds
    buffer_load_dwordx4 v231, s[12:15], s42 offen offset:3072 lds
    s_add_u32 s42, s42, 128
    s_lshl_b32 s46, s33, 6
    buffer_load_ushort v238, v10, s[16:19], s46 offen
    buffer_load_ushort v239, v10, s[16:19], s46 offen offset:32
    s_waitcnt lgkmcnt(0)
    s_barrier
    ds_read2_b32 v[32:33], v3 offset0:0 offset1:16
    ds_read2_b32 v[34:35], v3 offset0:32 offset1:48
    ds_read2_b32 v[36:37], v3 offset0:64 offset1:80
    ds_read2_b32 v[38:39], v3 offset0:96 offset1:112
    ds_read2_b32 v[40:41], v3 offset0:128 offset1:144
    ds_read2_b32 v[42:43], v3 offset0:160 offset1:176
    ds_read2_b32 v[44:45], v3 offset0:192 offset1:208
    ds_read2_b32 v[46:47], v3 offset0:224 offset1:240
    s_waitcnt lgkmcnt(3)
    v_add_f32 v32, v32, v40
    v_add_f32 v33, v33, v41
    s_waitcnt lgkmcnt(2)
    v_add_f32 v34, v34, v42
    v_add_f32 v35, v35, v43
    s_waitcnt lgkmcnt(1)
    v_add_f32 v36, v36, v44
    v_add_f32 v37, v37, v45
    s_waitcnt lgkmcnt(0)
    v_add_f32 v38, v38, v46
    v_add_f32 v39, v39, v47
    v_add_f32 v32, v32, v36
    v_add_f32 v33, v33, v37
    v_add_f32 v34, v34, v38
    v_add_f32 v35, v35, v39
    v_add_f32 v32, v32, v34
    v_add_f32 v33, v33, v35
    v_add_f32 v32, v32, v33
    v_mul_f32 v32, 0x39e38e39, v32
    s_nop 1
    v_mov_b32_dpp v33, v32 row_ror:8 row_mask:0xf bank_mask:0xf
    v_fma_f32 v33, -v32, v32, v33
    v_max_f32 v33, 0, v33
    v_add_f32 v33, 0x3727c5ac, v33
    v_rsq_f32 v33, v33
    s_nop 0
    v_mul_f32_e64 v32, -v32, v33
    s_nop 0
    v_readlane_b32 s50, v32, 0
    v_readlane_b32 s51, v32, 1
    v_readlane_b32 s52, v32, 2
    v_readlane_b32 s53, v32, 3
    v_readlane_b32 s54, v32, 4
    v_readlane_b32 s55, v32, 5
    v_readlane_b32 s56, v32, 6
    v_readlane_b32 s57, v32, 7
    v_mov_b32 v16, s50
    v_mov_b32 v17, s51
    v_mov_b32 v18, s52
    v_mov_b32 v19, s53
    v_mov_b32 v20, s54
    v_mov_b32 v21, s55
    v_mov_b32 v22, s56
    v_mov_b32 v23, s57
    v_readlane_b32 s50, v33, 0
    v_readlane_b32 s51, v33, 1
    v_readlane_b32 s52, v33, 2
    v_readlane_b32 s53, v33, 3
    v_readlane_b32 s54, v33, 4
    v_readlane_b32 s55, v33, 5
    v_readlane_b32 s56, v33, 6
    v_readlane_b32 s57, v33, 7
    v_fma_f32 v100, v100, s50, v16
    v_fma_f32 v101, v101, s51, v17
    v_fma_f32 v102, v102, s52, v18
    v_fma_f32 v103, v103, s53, v19
    v_fma_f32 v104, v104, s54, v20
    v_fma_f32 v105, v105, s55, v21
    v_fma_f32 v106, v106, s56, v22
    v_fma_f32 v107, v107, s57, v23
    v_cvt_pk_bf16_f32 v64, v100, v101
    v_cvt_pk_bf16_f32 v65, v102, v103
    v_cvt_pk_bf16_f32 v66, v104, v105
    v_cvt_pk_bf16_f32 v67, v106, v107
    buffer_store_dwordx4 v[64:67], v15, s[8:11], s58 offen sc1
    s_add_u32 s58, s58, 4096
    v_fma_f32 v108, v108, s50, v16
    v_fma_f32 v109, v109, s51, v17
    v_fma_f32 v110, v110, s52, v18
    v_fma_f32 v111, v111, s53, v19
    v_fma_f32 v112, v112, s54, v20
    v_fma_f32 v113, v113, s55, v21
    v_fma_f32 v114, v114, s56, v22
    v_fma_f32 v115, v115, s57, v23
    v_cvt_pk_bf16_f32 v68, v108, v109
    v_cvt_pk_bf16_f32 v69, v110, v111
    v_cvt_pk_bf16_f32 v70, v112, v113
    v_cvt_pk_bf16_f32 v71, v114, v115
    buffer_store_dwordx4 v[68:71], v15, s[8:11], s58 offen sc1
    s_add_u32 s58, s58, 4096
    v_fma_f32 v116, v116, s50, v16
    v_fma_f32 v117, v117, s51, v17
    v_fma_f32 v118, v118, s52, v18
    v_fma_f32 v119, v119, s53, v19
    v_fma_f32 v120, v120, s54, v20
    v_fma_f32 v121, v121, s55, v21
    v_fma_f32 v122, v122, s56, v22
    v_fma_f32 v123, v123, s57, v23
    v_cvt_pk_bf16_f32 v72, v116, v117
    v_cvt_pk_bf16_f32 v73, v118, v119
    v_cvt_pk_bf16_f32 v74, v120, v121
    v_cvt_pk_bf16_f32 v75, v122, v123
    buffer_store_dwordx4 v[72:75], v15, s[8:11], s58 offen sc1
    s_add_u32 s58, s58, 4096
    v_fma_f32 v124, v124, s50, v16
    v_fma_f32 v125, v125, s51, v17
    v_fma_f32 v126, v126, s52, v18
    v_fma_f32 v127, v127, s53, v19
    v_fma_f32 v128, v128, s54, v20
    v_fma_f32 v129, v129, s55, v21
    v_fma_f32 v130, v130, s56, v22
    v_fma_f32 v131, v131, s57, v23
    v_cvt_pk_bf16_f32 v76, v124, v125
    v_cvt_pk_bf16_f32 v77, v126, v127
    v_cvt_pk_bf16_f32 v78, v128, v129
    v_cvt_pk_bf16_f32 v79, v130, v131
    buffer_store_dwordx4 v[76:79], v15, s[8:11], s58 offen sc1
    s_add_u32 s58, s58, 4096
    v_fma_f32 v132, v132, s50, v16
    v_fma_f32 v133, v133, s51, v17
    v_fma_f32 v134, v134, s52, v18
    v_fma_f32 v135, v135, s53, v19
    v_fma_f32 v136, v136, s54, v20
    v_fma_f32 v137, v137, s55, v21
    v_fma_f32 v138, v138, s56, v22
    v_fma_f32 v139, v139, s57, v23
    v_cvt_pk_bf16_f32 v80, v132, v133
    v_cvt_pk_bf16_f32 v81, v134, v135
    v_cvt_pk_bf16_f32 v82, v136, v137
    v_cvt_pk_bf16_f32 v83, v138, v139
    buffer_store_dwordx4 v[80:83], v15, s[8:11], s58 offen sc1
    s_add_u32 s58, s58, 4096
    v_fma_f32 v140, v140, s50, v16
    v_fma_f32 v141, v141, s51, v17
    v_fma_f32 v142, v142, s52, v18
    v_fma_f32 v143, v143, s53, v19
    v_fma_f32 v144, v144, s54, v20
    v_fma_f32 v145, v145, s55, v21
    v_fma_f32 v146, v146, s56, v22
    v_fma_f32 v147, v147, s57, v23
    v_cvt_pk_bf16_f32 v84, v140, v141
    v_cvt_pk_bf16_f32 v85, v142, v143
    v_cvt_pk_bf16_f32 v86, v144, v145
    v_cvt_pk_bf16_f32 v87, v146, v147
    buffer_store_dwordx4 v[84:87], v15, s[8:11], s58 offen sc1
    s_add_u32 s58, s58, 4096
    v_fma_f32 v148, v148, s50, v16
    v_fma_f32 v149, v149, s51, v17
    v_fma_f32 v150, v150, s52, v18
    v_fma_f32 v151, v151, s53, v19
    v_fma_f32 v152, v152, s54, v20
    v_fma_f32 v153, v153, s55, v21
    v_fma_f32 v154, v154, s56, v22
    v_fma_f32 v155, v155, s57, v23
    v_cvt_pk_bf16_f32 v88, v148, v149
    v_cvt_pk_bf16_f32 v89, v150, v151
    v_cvt_pk_bf16_f32 v90, v152, v153
    v_cvt_pk_bf16_f32 v91, v154, v155
    buffer_store_dwordx4 v[88:91], v15, s[8:11], s58 offen sc1
    s_add_u32 s58, s58, 4096
    v_fma_f32 v156, v156, s50, v16
    v_fma_f32 v157, v157, s51, v17
    v_fma_f32 v158, v158, s52, v18
    v_fma_f32 v159, v159, s53, v19
    v_fma_f32 v160, v160, s54, v20
    v_fma_f32 v161, v161, s55, v21
    v_fma_f32 v162, v162, s56, v22
    v_fma_f32 v163, v163, s57, v23
    v_cvt_pk_bf16_f32 v92, v156, v157
    v_cvt_pk_bf16_f32 v93, v158, v159
    v_cvt_pk_bf16_f32 v94, v160, v161
    v_cvt_pk_bf16_f32 v95, v162, v163
    buffer_store_dwordx4 v[92:95], v15, s[8:11], s58 offen sc1
    s_add_u32 s58, s58, 4096
    v_fma_f32 v164, v164, s50, v16
    v_fma_f32 v165, v165, s51, v17
    v_fma_f32 v166, v166, s52, v18
    v_fma_f32 v167, v167, s53, v19
    v_fma_f32 v168, v168, s54, v20
    v_fma_f32 v169, v169, s55, v21
    v_fma_f32 v170, v170, s56, v22
    v_fma_f32 v171, v171, s57, v23
    v_cvt_pk_bf16_f32 v96, v164, v165
    v_cvt_pk_bf16_f32 v97, v166, v167
    v_cvt_pk_bf16_f32 v98, v168, v169
    v_cvt_pk_bf16_f32 v99, v170, v171
    buffer_store_dwordx4 v[96:99], v15, s[8:11], s58 offen sc1
    s_add_u32 s58, s58, 4096
    s_lshl_b32 s59, s33, 7
    s_add_u32 s59, s59, 58720256
    s_waitcnt vmcnt(0)
    s_barrier
    s_cmp_lg_u32 s32, 0
    s_cbranch_scc1 KB_pubd
    s_mov_b64 exec, 1
    v_mov_b32 v254, 1
    buffer_atomic_add v254, v236, s[8:11], s44 offen sc0 sc1
    s_waitcnt vmcnt(0)
    v_readfirstlane_b32 s47, v254
    s_cmp_lg_u32 s47, 15
    s_cbranch_scc1 KB_notlast
    s_mov_b64 exec, -1
    s_mov_b32 s47, 58789888
    buffer_atomic_add v237, v253, s[8:11], s47 offen sc1
    s_mov_b64 exec, 1
KB_notlast:
    s_mov_b64 exec, -1
KB_pubd:
    s_cmp_lg_u32 s32, 0
    s_cbranch_scc1 KB_polled
    s_mov_b64 exec, 1
    s_mov_b32 s47, 0
KB_poll:
    buffer_load_dword v254, v236, s[8:11], s45 offen sc1
    s_add_u32 s47, s47, 1
    s_waitcnt vmcnt(0)
    v_and_b32 v254, 0xff, v254
    v_cmp_ne_u32 vcc, 16, v254
    s_cmp_gt_u32 s47, 0x10000
    s_cbranch_scc1 KB_pdone
    s_cbranch_vccz KB_pdone
    s_sleep 1
    s_branch KB_poll
KB_pdone:
    s_mov_b64 exec, -1
KB_polled:
    s_barrier
    s_add_u32 m0, s41, 0
    s_nop 0
    buffer_load_dwordx4 v232, s[8:11], s43 offen sc1 lds
    buffer_load_dwordx4 v232, s[8:11], s43 offen offset:1024 sc1 lds
    s_mov_b64 exec, 0xffff
    buffer_load_dwordx4 v232, s[8:11], s43 offen offset:2048 sc1 lds
    s_mov_b64 exec, -1
    s_add_u32 s43, s43, 147456
    s_add_u32 m0, s41, 9728
    s_nop 0
    buffer_load_dwordx4 v232, s[8:11], s43 offen sc1 lds
    buffer_load_dwordx4 v232, s[8:11], s43 offen offset:1024 sc1 lds
    s_mov_b64 exec, 0xffff
    buffer_load_dwordx4 v232, s[8:11], s43 offen offset:2048 sc1 lds
    s_mov_b64 exec, -1
    s_add_u32 s43, s43, 147456
    s_add_u32 m0, s41, 19456
    s_nop 0
    buffer_load_dwordx4 v232, s[8:11], s43 offen sc1 lds
    buffer_load_dwordx4 v232, s[8:11], s43 offen offset:1024 sc1 lds
    s_mov_b64 exec, 0xffff
    buffer_load_dwordx4 v232, s[8:11], s43 offen offset:2048 sc1 lds
    s_mov_b64 exec, -1
    s_add_u32 s43, s43, 147456
    s_add_u32 m0, s41, 29184
    s_nop 0
    buffer_load_dwordx4 v232, s[8:11], s43 offen sc1 lds
    buffer_load_dwordx4 v232, s[8:11], s43 offen offset:1024 sc1 lds
    s_mov_b64 exec, 0xffff
    buffer_load_dwordx4 v232, s[8:11], s43 offen offset:2048 sc1 lds
    s_mov_b64 exec, -1
    s_add_u32 s43, s43, 147456
    buffer_load_dword v240, v11, s[8:11], s59 offen
    buffer_load_dword v241, v11, s[8:11], s59 offen offset:64
    s_waitcnt vmcnt(11)
    s_barrier
    ds_read_b128 v[160:163], v233 offset:0
    ds_read_b128 v[164:167], v233 offset:2048
    ds_read_b128 v[168:171], v234 offset:0
    ds_read_b128 v[172:175], v234 offset:2048
    ds_read_b128 v[88:91], v235 offset:0
    ds_read_b128 v[92:95], v235 offset:128
    ds_read_b128 v[96:99], v235 offset:512
    ds_read_b128 v[100:103], v235 offset:640
    ds_read_b128 v[104:107], v235 offset:1024
    ds_read_b128 v[108:111], v235 offset:1152
    ds_read_b128 v[112:115], v235 offset:1536
    ds_read_b128 v[116:119], v235 offset:1664
    ds_read_b128 v[120:123], v252 offset:0
    s_mov_b32 s35, 0
    s_waitcnt lgkmcnt(8)
    v_mfma_f32_16x16x32_bf16 v[16:19], v[88:91], v[160:163], 0
    v_mfma_f32_16x16x32_bf16 v[24:27], v[88:91], v[164:167], 0
    s_waitcnt lgkmcnt(7)
    v_mfma_f32_16x16x32_bf16 v[20:23], v[92:95], v[160:163], 0
    v_mfma_f32_16x16x32_bf16 v[28:31], v[92:95], v[164:167], 0
    s_waitcnt lgkmcnt(0)
    s_waitcnt vmcnt(8)
    s_barrier
    v_mfma_f32_16x16x32_bf16 v[32:35], v[96:99], v[160:163], 0
    s_add_u32 m0, s40, 0
    ds_read_b128 v[124:127], v235 offset:9728
    v_mfma_f32_16x16x32_bf16 v[40:43], v[96:99], v[164:167], 0
    buffer_load_dwordx4 v228, s[12:15], s42 offen offset:0 lds
    v_mfma_f32_16x16x32_bf16 v[36:39], v[100:103], v[160:163], 0
    ds_read_b128 v[128:131], v235 offset:9856
    v_mfma_f32_16x16x32_bf16 v[44:47], v[100:103], v[164:167], 0
    buffer_load_dwordx4 v229, s[12:15], s42 offen offset:1024 lds
    ds_read_b128 v[132:135], v235 offset:10240
    v_mfma_f32_16x16x32_bf16 v[48:51], v[104:107], v[160:163], 0
    buffer_load_dwordx4 v230, s[12:15], s42 offen offset:2048 lds
    v_mfma_f32_16x16x32_bf16 v[56:59], v[104:107], v[164:167], 0
    ds_read_b128 v[136:139], v235 offset:10368
    v_mfma_f32_16x16x32_bf16 v[52:55], v[108:111], v[160:163], 0
    buffer_load_dwordx4 v231, s[12:15], s42 offen offset:3072 lds
    s_add_u32 s42, s42, 128
    v_mfma_f32_16x16x32_bf16 v[60:63], v[108:111], v[164:167], 0
    ds_read_b128 v[140:143], v235 offset:10752
    s_add_u32 m0, s41, 0
    v_mfma_f32_16x16x32_bf16 v[64:67], v[112:115], v[160:163], 0
    ds_read_b128 v[144:147], v235 offset:10880
    v_mfma_f32_16x16x32_bf16 v[72:75], v[112:115], v[164:167], 0
    buffer_load_dwordx4 v232, s[8:11], s43 offen sc1 lds
    v_mfma_f32_16x16x32_bf16 v[68:71], v[116:119], v[160:163], 0
    ds_read_b128 v[148:151], v235 offset:11264
    buffer_load_dwordx4 v232, s[8:11], s43 offen offset:1024 sc1 lds
    v_mfma_f32_16x16x32_bf16 v[76:79], v[116:119], v[164:167], 0
    ds_read_b128 v[152:155], v235 offset:11392
    v_mfma_f32_16x16x32_bf16 v[80:83], v[120:123], v[160:163], 0
    s_mov_b64 exec, 0xffff
    buffer_load_dwordx4 v232, s[8:11], s43 offen offset:2048 sc1 lds
    s_mov_b64 exec, -1
    s_add_u32 s43, s43, 147456
    v_mfma_f32_16x16x32_bf16 v[84:87], v[120:123], v[164:167], 0
    ds_read_b128 v[156:159], v252 offset:9728
    s_waitcnt lgkmcnt(8)
    v_mfma_f32_16x16x32_bf16 v[16:19], v[124:127], v[168:171], v[16:19]
    v_mfma_f32_16x16x32_bf16 v[24:27], v[124:127], v[172:175], v[24:27]
    s_waitcnt lgkmcnt(7)
    v_mfma_f32_16x16x32_bf16 v[20:23], v[128:131], v[168:171], v[20:23]
    v_mfma_f32_16x16x32_bf16 v[28:31], v[128:131], v[172:175], v[28:31]
    s_waitcnt lgkmcnt(0)
    s_waitcnt vmcnt(12)
    s_barrier
    v_mfma_f32_16x16x32_bf16 v[32:35], v[132:135], v[168:171], v[32:35]
    s_add_u32 m0, s41, 9728
    ds_read_b128 v[176:179], v233 offset:16384
    v_mfma_f32_16x16x32_bf16 v[40:43], v[132:135], v[172:175], v[40:43]
    ds_read_b128 v[180:183], v233 offset:18432
    v_mfma_f32_16x16x32_bf16 v[36:39], v[136:139], v[168:171], v[36:39]
    buffer_load_dwordx4 v232, s[8:11], s43 offen sc1 lds
    v_mfma_f32_16x16x32_bf16 v[44:47], v[136:139], v[172:175], v[44:47]
    ds_read_b128 v[88:91], v235 offset:19456
    v_mfma_f32_16x16x32_bf16 v[48:51], v[140:143], v[168:171], v[48:51]
    ds_read_b128 v[92:95], v235 offset:19584
    buffer_load_dwordx4 v232, s[8:11], s43 offen offset:1024 sc1 lds
    v_mfma_f32_16x16x32_bf16 v[56:59], v[140:143], v[172:175], v[56:59]
    ds_read_b128 v[96:99], v235 offset:19968
    v_mfma_f32_16x16x32_bf16 v[52:55], v[144:147], v[168:171], v[52:55]
    ds_read_b128 v[100:103], v235 offset:20096
    v_mfma_f32_16x16x32_bf16 v[60:63], v[144:147], v[172:175], v[60:63]
    s_mov_b64 exec, 0xffff
    buffer_load_dwordx4 v232, s[8:11], s43 offen offset:2048 sc1 lds
    s_mov_b64 exec, -1
    s_add_u32 s43, s43, 147456
    v_mfma_f32_16x16x32_bf16 v[64:67], v[148:151], v[168:171], v[64:67]
    ds_read_b128 v[104:107], v235 offset:20480
    v_mfma_f32_16x16x32_bf16 v[72:75], v[148:151], v[172:175], v[72:75]
    ds_read_b128 v[108:111], v235 offset:20608
    ds_read_b128 v[112:115], v235 offset:20992
    v_mfma_f32_16x16x32_bf16 v[68:71], v[152:155], v[168:171], v[68:71]
    ds_read_b128 v[116:119], v235 offset:21120
    v_mfma_f32_16x16x32_bf16 v[76:79], v[152:155], v[172:175], v[76:79]
    ds_read_b128 v[120:123], v252 offset:19456
    v_mfma_f32_16x16x32_bf16 v[80:83], v[156:159], v[168:171], v[80:83]
    ds_read_b128 v[184:187], v234 offset:16384
    v_mfma_f32_16x16x32_bf16 v[84:87], v[156:159], v[172:175], v[84:87]
    ds_read_b128 v[188:191], v234 offset:18432
    s_waitcnt lgkmcnt(10)
    v_mfma_f32_16x16x32_bf16 v[16:19], v[88:91], v[176:179], v[16:19]
    v_mfma_f32_16x16x32_bf16 v[24:27], v[88:91], v[180:183], v[24:27]
    s_waitcnt lgkmcnt(9)
    v_mfma_f32_16x16x32_bf16 v[20:23], v[92:95], v[176:179], v[20:23]
    v_mfma_f32_16x16x32_bf16 v[28:31], v[92:95], v[180:183], v[28:31]
    s_waitcnt lgkmcnt(0)
    s_waitcnt vmcnt(12)
    s_barrier
    v_mfma_f32_16x16x32_bf16 v[32:35], v[96:99], v[176:179], v[32:35]
    s_add_u32 m0, s40, 16384
    ds_read_b128 v[124:127], v235 offset:29184
    v_mfma_f32_16x16x32_bf16 v[40:43], v[96:99], v[180:183], v[40:43]
    buffer_load_dwordx4 v228, s[12:15], s42 offen offset:0 lds
    v_mfma_f32_16x16x32_bf16 v[36:39], v[100:103], v[176:179], v[36:39]
    ds_read_b128 v[128:131], v235 offset:29312
    v_mfma_f32_16x16x32_bf16 v[44:47], v[100:103], v[180:183], v[44:47]
    buffer_load_dwordx4 v229, s[12:15], s42 offen offset:1024 lds
    ds_read_b128 v[132:135], v235 offset:29696
    v_mfma_f32_16x16x32_bf16 v[48:51], v[104:107], v[176:179], v[48:51]
    buffer_load_dwordx4 v230, s[12:15], s42 offen offset:2048 lds
    v_mfma_f32_16x16x32_bf16 v[56:59], v[104:107], v[180:183], v[56:59]
    ds_read_b128 v[136:139], v235 offset:29824
    v_mfma_f32_16x16x32_bf16 v[52:55], v[108:111], v[176:179], v[52:55]
    buffer_load_dwordx4 v231, s[12:15], s42 offen offset:3072 lds
    s_add_u32 s42, s42, 128
    v_mfma_f32_16x16x32_bf16 v[60:63], v[108:111], v[180:183], v[60:63]
    ds_read_b128 v[140:143], v235 offset:30208
    s_add_u32 m0, s41, 19456
    v_mfma_f32_16x16x32_bf16 v[64:67], v[112:115], v[176:179], v[64:67]
    ds_read_b128 v[144:147], v235 offset:30336
    v_mfma_f32_16x16x32_bf16 v[72:75], v[112:115], v[180:183], v[72:75]
    buffer_load_dwordx4 v232, s[8:11], s43 offen sc1 lds
    v_mfma_f32_16x16x32_bf16 v[68:71], v[116:119], v[176:179], v[68:71]
    ds_read_b128 v[148:151], v235 offset:30720
    buffer_load_dwordx4 v232, s[8:11], s43 offen offset:1024 sc1 lds
    v_mfma_f32_16x16x32_bf16 v[76:79], v[116:119], v[180:183], v[76:79]
    ds_read_b128 v[152:155], v235 offset:30848
    v_mfma_f32_16x16x32_bf16 v[80:83], v[120:123], v[176:179], v[80:83]
    s_mov_b64 exec, 0xffff
    buffer_load_dwordx4 v232, s[8:11], s43 offen offset:2048 sc1 lds
    s_mov_b64 exec, -1
    s_add_u32 s43, s43, 147456
    v_mfma_f32_16x16x32_bf16 v[84:87], v[120:123], v[180:183], v[84:87]
    ds_read_b128 v[156:159], v252 offset:29184
    s_waitcnt lgkmcnt(8)
    v_mfma_f32_16x16x32_bf16 v[16:19], v[124:127], v[184:187], v[16:19]
    v_mfma_f32_16x16x32_bf16 v[24:27], v[124:127], v[188:191], v[24:27]
    s_waitcnt lgkmcnt(7)
    v_mfma_f32_16x16x32_bf16 v[20:23], v[128:131], v[184:187], v[20:23]
    v_mfma_f32_16x16x32_bf16 v[28:31], v[128:131], v[188:191], v[28:31]
    s_waitcnt lgkmcnt(0)
    s_waitcnt vmcnt(10)
    s_barrier
    v_mfma_f32_16x16x32_bf16 v[32:35], v[132:135], v[184:187], v[32:35]
    s_add_u32 m0, s41, 29184
    ds_read_b128 v[160:163], v233 offset:0
    v_mfma_f32_16x16x32_bf16 v[40:43], v[132:135], v[188:191], v[40:43]
    ds_read_b128 v[164:167], v233 offset:2048
    v_mfma_f32_16x16x32_bf16 v[36:39], v[136:139], v[184:187], v[36:39]
    buffer_load_dwordx4 v232, s[8:11], s43 offen sc1 lds
    v_mfma_f32_16x16x32_bf16 v[44:47], v[136:139], v[188:191], v[44:47]
    ds_read_b128 v[88:91], v235 offset:0
    v_mfma_f32_16x16x32_bf16 v[48:51], v[140:143], v[184:187], v[48:51]
    ds_read_b128 v[92:95], v235 offset:128
    buffer_load_dwordx4 v232, s[8:11], s43 offen offset:1024 sc1 lds
    v_mfma_f32_16x16x32_bf16 v[56:59], v[140:143], v[188:191], v[56:59]
    ds_read_b128 v[96:99], v235 offset:512
    v_mfma_f32_16x16x32_bf16 v[52:55], v[144:147], v[184:187], v[52:55]
    ds_read_b128 v[100:103], v235 offset:640
    v_mfma_f32_16x16x32_bf16 v[60:63], v[144:147], v[188:191], v[60:63]
    s_mov_b64 exec, 0xffff
    buffer_load_dwordx4 v232, s[8:11], s43 offen offset:2048 sc1 lds
    s_mov_b64 exec, -1
    s_add_u32 s43, s43, 147456
    v_mfma_f32_16x16x32_bf16 v[64:67], v[148:151], v[184:187], v[64:67]
    ds_read_b128 v[104:107], v235 offset:1024
    v_mfma_f32_16x16x32_bf16 v[72:75], v[148:151], v[188:191], v[72:75]
    ds_read_b128 v[108:111], v235 offset:1152
    ds_read_b128 v[112:115], v235 offset:1536
    v_mfma_f32_16x16x32_bf16 v[68:71], v[152:155], v[184:187], v[68:71]
    ds_read_b128 v[116:119], v235 offset:1664
    v_mfma_f32_16x16x32_bf16 v[76:79], v[152:155], v[188:191], v[76:79]
    ds_read_b128 v[120:123], v252 offset:0
    v_mfma_f32_16x16x32_bf16 v[80:83], v[156:159], v[184:187], v[80:83]
    ds_read_b128 v[168:171], v234 offset:0
    v_mfma_f32_16x16x32_bf16 v[84:87], v[156:159], v[188:191], v[84:87]
    ds_read_b128 v[172:175], v234 offset:2048
KB_loop:
    s_waitcnt lgkmcnt(10)
    v_mfma_f32_16x16x32_bf16 v[16:19], v[88:91], v[160:163], v[16:19]
    v_mfma_f32_16x16x32_bf16 v[24:27], v[88:91], v[164:167], v[24:27]
    s_waitcnt lgkmcnt(9)
    v_mfma_f32_16x16x32_bf16 v[20:23], v[92:95], v[160:163], v[20:23]
    v_mfma_f32_16x16x32_bf16 v[28:31], v[92:95], v[164:167], v[28:31]
    s_waitcnt lgkmcnt(0)
    s_waitcnt vmcnt(10)
    s_barrier
    v_mfma_f32_16x16x32_bf16 v[32:35], v[96:99], v[160:163], v[32:35]
    s_add_u32 m0, s40, 0
    ds_read_b128 v[124:127], v235 offset:9728
    v_mfma_f32_16x16x32_bf16 v[40:43], v[96:99], v[164:167], v[40:43]
    buffer_load_dwordx4 v228, s[12:15], s42 offen offset:0 lds
    v_mfma_f32_16x16x32_bf16 v[36:39], v[100:103], v[160:163], v[36:39]
    ds_read_b128 v[128:131], v235 offset:9856
    v_mfma_f32_16x16x32_bf16 v[44:47], v[100:103], v[164:167], v[44:47]
    buffer_load_dwordx4 v229, s[12:15], s42 offen offset:1024 lds
    ds_read_b128 v[132:135], v235 offset:10240
    v_mfma_f32_16x16x32_bf16 v[48:51], v[104:107], v[160:163], v[48:51]
    buffer_load_dwordx4 v230, s[12:15], s42 offen offset:2048 lds
    v_mfma_f32_16x16x32_bf16 v[56:59], v[104:107], v[164:167], v[56:59]
    ds_read_b128 v[136:139], v235 offset:10368
    v_mfma_f32_16x16x32_bf16 v[52:55], v[108:111], v[160:163], v[52:55]
    buffer_load_dwordx4 v231, s[12:15], s42 offen offset:3072 lds
    s_add_u32 s42, s42, 128
    v_mfma_f32_16x16x32_bf16 v[60:63], v[108:111], v[164:167], v[60:63]
    ds_read_b128 v[140:143], v235 offset:10752
    s_add_u32 m0, s41, 0
    v_mfma_f32_16x16x32_bf16 v[64:67], v[112:115], v[160:163], v[64:67]
    ds_read_b128 v[144:147], v235 offset:10880
    v_mfma_f32_16x16x32_bf16 v[72:75], v[112:115], v[164:167], v[72:75]
    buffer_load_dwordx4 v232, s[8:11], s43 offen sc1 lds
    v_mfma_f32_16x16x32_bf16 v[68:71], v[116:119], v[160:163], v[68:71]
    ds_read_b128 v[148:151], v235 offset:11264
    buffer_load_dwordx4 v232, s[8:11], s43 offen offset:1024 sc1 lds
    v_mfma_f32_16x16x32_bf16 v[76:79], v[116:119], v[164:167], v[76:79]
    ds_read_b128 v[152:155], v235 offset:11392
    v_mfma_f32_16x16x32_bf16 v[80:83], v[120:123], v[160:163], v[80:83]
    s_mov_b64 exec, 0xffff
    buffer_load_dwordx4 v232, s[8:11], s43 offen offset:2048 sc1 lds
    s_mov_b64 exec, -1
    s_add_u32 s43, s43, 147456
    v_mfma_f32_16x16x32_bf16 v[84:87], v[120:123], v[164:167], v[84:87]
    ds_read_b128 v[156:159], v252 offset:9728
    s_waitcnt lgkmcnt(8)
    v_mfma_f32_16x16x32_bf16 v[16:19], v[124:127], v[168:171], v[16:19]
    v_mfma_f32_16x16x32_bf16 v[24:27], v[124:127], v[172:175], v[24:27]
    s_waitcnt lgkmcnt(7)
    v_mfma_f32_16x16x32_bf16 v[20:23], v[128:131], v[168:171], v[20:23]
    v_mfma_f32_16x16x32_bf16 v[28:31], v[128:131], v[172:175], v[28:31]
    s_waitcnt lgkmcnt(0)
    s_waitcnt vmcnt(10)
    s_barrier
    v_mfma_f32_16x16x32_bf16 v[32:35], v[132:135], v[168:171], v[32:35]
    s_add_u32 m0, s41, 9728
    ds_read_b128 v[176:179], v233 offset:16384
    v_mfma_f32_16x16x32_bf16 v[40:43], v[132:135], v[172:175], v[40:43]
    ds_read_b128 v[180:183], v233 offset:18432
    v_mfma_f32_16x16x32_bf16 v[36:39], v[136:139], v[168:171], v[36:39]
    buffer_load_dwordx4 v232, s[8:11], s43 offen sc1 lds
    v_mfma_f32_16x16x32_bf16 v[44:47], v[136:139], v[172:175], v[44:47]
    ds_read_b128 v[88:91], v235 offset:19456
    v_mfma_f32_16x16x32_bf16 v[48:51], v[140:143], v[168:171], v[48:51]
    ds_read_b128 v[92:95], v235 offset:19584
    buffer_load_dwordx4 v232, s[8:11], s43 offen offset:1024 sc1 lds
    v_mfma_f32_16x16x32_bf16 v[56:59], v[140:143], v[172:175], v[56:59]
    ds_read_b128 v[96:99], v235 offset:19968
    v_mfma_f32_16x16x32_bf16 v[52:55], v[144:147], v[168:171], v[52:55]
    ds_read_b128 v[100:103], v235 offset:20096
    v_mfma_f32_16x16x32_bf16 v[60:63], v[144:147], v[172:175], v[60:63]
    s_mov_b64 exec, 0xffff
    buffer_load_dwordx4 v232, s[8:11], s43 offen offset:2048 sc1 lds
    s_mov_b64 exec, -1
    s_add_u32 s43, s43, 147456
    v_mfma_f32_16x16x32_bf16 v[64:67], v[148:151], v[168:171], v[64:67]
    ds_read_b128 v[104:107], v235 offset:20480
    v_mfma_f32_16x16x32_bf16 v[72:75], v[148:151], v[172:175], v[72:75]
    ds_read_b128 v[108:111], v235 offset:20608
    ds_read_b128 v[112:115], v235 offset:20992
    v_mfma_f32_16x16x32_bf16 v[68:71], v[152:155], v[168:171], v[68:71]
    ds_read_b128 v[116:119], v235 offset:21120
    v_mfma_f32_16x16x32_bf16 v[76:79], v[152:155], v[172:175], v[76:79]
    ds_read_b128 v[120:123], v252 offset:19456
    v_mfma_f32_16x16x32_bf16 v[80:83], v[156:159], v[168:171], v[80:83]
    ds_read_b128 v[184:187], v234 offset:16384
    v_mfma_f32_16x16x32_bf16 v[84:87], v[156:159], v[172:175], v[84:87]
    ds_read_b128 v[188:191], v234 offset:18432
    s_waitcnt lgkmcnt(10)
    v_mfma_f32_16x16x32_bf16 v[16:19], v[88:91], v[176:179], v[16:19]
    v_mfma_f32_16x16x32_bf16 v[24:27], v[88:91], v[180:183], v[24:27]
    s_waitcnt lgkmcnt(9)
    v_mfma_f32_16x16x32_bf16 v[20:23], v[92:95], v[176:179], v[20:23]
    v_mfma_f32_16x16x32_bf16 v[28:31], v[92:95], v[180:183], v[28:31]
    s_waitcnt lgkmcnt(0)
    s_waitcnt vmcnt(10)
    s_barrier
    v_mfma_f32_16x16x32_bf16 v[32:35], v[96:99], v[176:179], v[32:35]
    s_add_u32 m0, s40, 16384
    ds_read_b128 v[124:127], v235 offset:29184
    v_mfma_f32_16x16x32_bf16 v[40:43], v[96:99], v[180:183], v[40:43]
    buffer_load_dwordx4 v228, s[12:15], s42 offen offset:0 lds
    v_mfma_f32_16x16x32_bf16 v[36:39], v[100:103], v[176:179], v[36:39]
    ds_read_b128 v[128:131], v235 offset:29312
    v_mfma_f32_16x16x32_bf16 v[44:47], v[100:103], v[180:183], v[44:47]
    buffer_load_dwordx4 v229, s[12:15], s42 offen offset:1024 lds
    ds_read_b128 v[132:135], v235 offset:29696
    v_mfma_f32_16x16x32_bf16 v[48:51], v[104:107], v[176:179], v[48:51]
    buffer_load_dwordx4 v230, s[12:15], s42 offen offset:2048 lds
    v_mfma_f32_16x16x32_bf16 v[56:59], v[104:107], v[180:183], v[56:59]
    ds_read_b128 v[136:139], v235 offset:29824
    v_mfma_f32_16x16x32_bf16 v[52:55], v[108:111], v[176:179], v[52:55]
    buffer_load_dwordx4 v231, s[12:15], s42 offen offset:3072 lds
    s_add_u32 s42, s42, 128
    v_mfma_f32_16x16x32_bf16 v[60:63], v[108:111], v[180:183], v[60:63]
    ds_read_b128 v[140:143], v235 offset:30208
    s_add_u32 m0, s41, 19456
    v_mfma_f32_16x16x32_bf16 v[64:67], v[112:115], v[176:179], v[64:67]
    ds_read_b128 v[144:147], v235 offset:30336
    v_mfma_f32_16x16x32_bf16 v[72:75], v[112:115], v[180:183], v[72:75]
    buffer_load_dwordx4 v232, s[8:11], s43 offen sc1 lds
    v_mfma_f32_16x16x32_bf16 v[68:71], v[116:119], v[176:179], v[68:71]
    ds_read_b128 v[148:151], v235 offset:30720
    buffer_load_dwordx4 v232, s[8:11], s43 offen offset:1024 sc1 lds
    v_mfma_f32_16x16x32_bf16 v[76:79], v[116:119], v[180:183], v[76:79]
    ds_read_b128 v[152:155], v235 offset:30848
    v_mfma_f32_16x16x32_bf16 v[80:83], v[120:123], v[176:179], v[80:83]
    s_mov_b64 exec, 0xffff
    buffer_load_dwordx4 v232, s[8:11], s43 offen offset:2048 sc1 lds
    s_mov_b64 exec, -1
    s_add_u32 s43, s43, 147456
    v_mfma_f32_16x16x32_bf16 v[84:87], v[120:123], v[180:183], v[84:87]
    ds_read_b128 v[156:159], v252 offset:29184
    s_waitcnt lgkmcnt(8)
    v_mfma_f32_16x16x32_bf16 v[16:19], v[124:127], v[184:187], v[16:19]
    v_mfma_f32_16x16x32_bf16 v[24:27], v[124:127], v[188:191], v[24:27]
    s_waitcnt lgkmcnt(7)
    v_mfma_f32_16x16x32_bf16 v[20:23], v[128:131], v[184:187], v[20:23]
    v_mfma_f32_16x16x32_bf16 v[28:31], v[128:131], v[188:191], v[28:31]
    s_waitcnt lgkmcnt(0)
    s_waitcnt vmcnt(10)
    s_barrier
    v_mfma_f32_16x16x32_bf16 v[32:35], v[132:135], v[184:187], v[32:35]
    s_add_u32 m0, s41, 29184
    ds_read_b128 v[160:163], v233 offset:0
    v_mfma_f32_16x16x32_bf16 v[40:43], v[132:135], v[188:191], v[40:43]
    ds_read_b128 v[164:167], v233 offset:2048
    v_mfma_f32_16x16x32_bf16 v[36:39], v[136:139], v[184:187], v[36:39]
    buffer_load_dwordx4 v232, s[8:11], s43 offen sc1 lds
    v_mfma_f32_16x16x32_bf16 v[44:47], v[136:139], v[188:191], v[44:47]
    ds_read_b128 v[88:91], v235 offset:0
    v_mfma_f32_16x16x32_bf16 v[48:51], v[140:143], v[184:187], v[48:51]
    ds_read_b128 v[92:95], v235 offset:128
    buffer_load_dwordx4 v232, s[8:11], s43 offen offset:1024 sc1 lds
    v_mfma_f32_16x16x32_bf16 v[56:59], v[140:143], v[188:191], v[56:59]
    ds_read_b128 v[96:99], v235 offset:512
    v_mfma_f32_16x16x32_bf16 v[52:55], v[144:147], v[184:187], v[52:55]
    ds_read_b128 v[100:103], v235 offset:640
    v_mfma_f32_16x16x32_bf16 v[60:63], v[144:147], v[188:191], v[60:63]
    s_mov_b64 exec, 0xffff
    buffer_load_dwordx4 v232, s[8:11], s43 offen offset:2048 sc1 lds
    s_mov_b64 exec, -1
    s_add_u32 s43, s43, 147456
    v_mfma_f32_16x16x32_bf16 v[64:67], v[148:151], v[184:187], v[64:67]
    ds_read_b128 v[104:107], v235 offset:1024
    v_mfma_f32_16x16x32_bf16 v[72:75], v[148:151], v[188:191], v[72:75]
    ds_read_b128 v[108:111], v235 offset:1152
    ds_read_b128 v[112:115], v235 offset:1536
    v_mfma_f32_16x16x32_bf16 v[68:71], v[152:155], v[184:187], v[68:71]
    ds_read_b128 v[116:119], v235 offset:1664
    v_mfma_f32_16x16x32_bf16 v[76:79], v[152:155], v[188:191], v[76:79]
    ds_read_b128 v[120:123], v252 offset:0
    v_mfma_f32_16x16x32_bf16 v[80:83], v[156:159], v[184:187], v[80:83]
    ds_read_b128 v[168:171], v234 offset:0
    v_mfma_f32_16x16x32_bf16 v[84:87], v[156:159], v[188:191], v[84:87]
    ds_read_b128 v[172:175], v234 offset:2048
    s_add_u32 s35, s35, 1
    s_cmp_lt_u32 s35, 14
    s_cbranch_scc1 KB_loop
    s_getpc_b64 s[50:51]
    s_add_u32 s50, s50, KB_tail-.
    s_addc_u32 s51, s51, 0
    s_mul_i32 s52, s32, 2560
    v_lshlrev_b32 v2, 7, v1
    v_add_u32 v2, s52, v2
    s_mov_b32 exec_lo, 0xfffff
    s_mov_b32 exec_hi, 0x0
    global_load_dword v3, v2, s[50:51]
    s_mov_b64 exec, -1
KB_tail:
    s_waitcnt lgkmcnt(10)
    v_mfma_f32_16x16x32_bf16 v[16:19], v[88:91], v[160:163], v[16:19]
    v_mfma_f32_16x16x32_bf16 v[24:27], v[88:91], v[164:167], v[24:27]
    s_waitcnt lgkmcnt(9)
    v_mfma_f32_16x16x32_bf16 v[20:23], v[92:95], v[160:163], v[20:23]
    v_mfma_f32_16x16x32_bf16 v[28:31], v[92:95], v[164:167], v[28:31]
    s_waitcnt lgkmcnt(0)
    s_waitcnt vmcnt(11)
    s_barrier
    v_mfma_f32_16x16x32_bf16 v[32:35], v[96:99], v[160:163], v[32:35]
    buffer_load_dwordx4 v[192:195], v232, s[8:11], s34 offen offset:0
    v_mfma_f32_16x16x32_bf16 v[40:43], v[96:99], v[164:167], v[40:43]
    ds_read_b128 v[124:127], v235 offset:9728
    v_mfma_f32_16x16x32_bf16 v[36:39], v[100:103], v[160:163], v[36:39]
    ds_read_b128 v[128:131], v235 offset:9856
    v_mfma_f32_16x16x32_bf16 v[44:47], v[100:103], v[164:167], v[44:47]
    buffer_load_dwordx4 v[196:199], v244, s[8:11], s34 offen offset:0
    v_mfma_f32_16x16x32_bf16 v[48:51], v[104:107], v[160:163], v[48:51]
    ds_read_b128 v[132:135], v235 offset:10240
    v_mfma_f32_16x16x32_bf16 v[56:59], v[104:107], v[164:167], v[56:59]
    ds_read_b128 v[136:139], v235 offset:10368
    v_mfma_f32_16x16x32_bf16 v[52:55], v[108:111], v[160:163], v[52:55]
    buffer_load_dwordx4 v[200:203], v232, s[8:11], s34 offen offset:1024
    v_mfma_f32_16x16x32_bf16 v[60:63], v[108:111], v[164:167], v[60:63]
    ds_read_b128 v[140:143], v235 offset:10752
    v_mfma_f32_16x16x32_bf16 v[64:67], v[112:115], v[160:163], v[64:67]
    ds_read_b128 v[144:147], v235 offset:10880
    v_mfma_f32_16x16x32_bf16 v[72:75], v[112:115], v[164:167], v[72:75]
    buffer_load_dwordx4 v[204:207], v244, s[8:11], s34 offen offset:1024
    v_mfma_f32_16x16x32_bf16 v[68:71], v[116:119], v[160:163], v[68:71]
    ds_read_b128 v[148:151], v235 offset:11264
    v_mfma_f32_16x16x32_bf16 v[76:79], v[116:119], v[164:167], v[76:79]
    ds_read_b128 v[152:155], v235 offset:11392
    v_mfma_f32_16x16x32_bf16 v[80:83], v[120:123], v[160:163], v[80:83]
    buffer_load_dwordx4 v[208:211], v232, s[8:11], s34 offen offset:2048
    v_mfma_f32_16x16x32_bf16 v[84:87], v[120:123], v[164:167], v[84:87]
    ds_read_b128 v[156:159], v252 offset:9728
    s_waitcnt lgkmcnt(8)
    v_mfma_f32_16x16x32_bf16 v[16:19], v[124:127], v[168:171], v[16:19]
    v_mfma_f32_16x16x32_bf16 v[24:27], v[124:127], v[172:175], v[24:27]
    s_waitcnt lgkmcnt(7)
    v_mfma_f32_16x16x32_bf16 v[20:23], v[128:131], v[168:171], v[20:23]
    v_mfma_f32_16x16x32_bf16 v[28:31], v[128:131], v[172:175], v[28:31]
    s_waitcnt lgkmcnt(0)
    s_waitcnt vmcnt(9)
    s_barrier
    v_mfma_f32_16x16x32_bf16 v[32:35], v[132:135], v[168:171], v[32:35]
    buffer_load_dwordx4 v[212:215], v244, s[8:11], s34 offen offset:2048
    ds_read_b128 v[176:179], v233 offset:16384
    v_mfma_f32_16x16x32_bf16 v[40:43], v[132:135], v[172:175], v[40:43]
    ds_read_b128 v[180:183], v233 offset:18432
    v_mfma_f32_16x16x32_bf16 v[36:39], v[136:139], v[168:171], v[36:39]
    buffer_load_dwordx4 v[216:219], v232, s[8:11], s34 offen offset:3072
    v_mfma_f32_16x16x32_bf16 v[44:47], v[136:139], v[172:175], v[44:47]
    ds_read_b128 v[88:91], v235 offset:19456
    ds_read_b128 v[92:95], v235 offset:19584
    v_mfma_f32_16x16x32_bf16 v[48:51], v[140:143], v[168:171], v[48:51]
    buffer_load_dwordx4 v[220:223], v244, s[8:11], s34 offen offset:3072
    v_mfma_f32_16x16x32_bf16 v[56:59], v[140:143], v[172:175], v[56:59]
    ds_read_b128 v[96:99], v235 offset:19968
    v_mfma_f32_16x16x32_bf16 v[52:55], v[144:147], v[168:171], v[52:55]
    ds_read_b128 v[100:103], v235 offset:20096
    v_mfma_f32_16x16x32_bf16 v[60:63], v[144:147], v[172:175], v[60:63]
    buffer_load_dwordx2 v[224:225], v245, s[8:11], s49 offen
    ds_read_b128 v[104:107], v235 offset:20480
    v_mfma_f32_16x16x32_bf16 v[64:67], v[148:151], v[168:171], v[64:67]
    ds_read_b128 v[108:111], v235 offset:20608
    v_mfma_f32_16x16x32_bf16 v[72:75], v[148:151], v[172:175], v[72:75]
    buffer_load_dwordx2 v[226:227], v246, s[8:11], s49 offen
    v_mfma_f32_16x16x32_bf16 v[68:71], v[152:155], v[168:171], v[68:71]
    ds_read_b128 v[112:115], v235 offset:20992
    ds_read_b128 v[116:119], v235 offset:21120
    v_mfma_f32_16x16x32_bf16 v[76:79], v[152:155], v[172:175], v[76:79]
    ds_read_b128 v[120:123], v252 offset:19456
    v_mfma_f32_16x16x32_bf16 v[80:83], v[156:159], v[168:171], v[80:83]
    ds_read_b128 v[184:187], v234 offset:16384
    v_mfma_f32_16x16x32_bf16 v[84:87], v[156:159], v[172:175], v[84:87]
    ds_read_b128 v[188:191], v234 offset:18432
    s_waitcnt lgkmcnt(10)
    v_mfma_f32_16x16x32_bf16 v[16:19], v[88:91], v[176:179], v[16:19]
    v_mfma_f32_16x16x32_bf16 v[24:27], v[88:91], v[180:183], v[24:27]
    s_waitcnt lgkmcnt(9)
    v_mfma_f32_16x16x32_bf16 v[20:23], v[92:95], v[176:179], v[20:23]
    v_mfma_f32_16x16x32_bf16 v[28:31], v[92:95], v[180:183], v[28:31]
    s_waitcnt lgkmcnt(0)
    s_waitcnt vmcnt(11)
    s_barrier
    v_mfma_f32_16x16x32_bf16 v[32:35], v[96:99], v[176:179], v[32:35]
    v_lshlrev_b32 v238, 16, v238
    ds_read_b128 v[124:127], v235 offset:29184
    v_mfma_f32_16x16x32_bf16 v[40:43], v[96:99], v[180:183], v[40:43]
    ds_read_b128 v[128:131], v235 offset:29312
    v_mfma_f32_16x16x32_bf16 v[36:39], v[100:103], v[176:179], v[36:39]
    v_lshlrev_b32 v239, 16, v239
    v_mfma_f32_16x16x32_bf16 v[44:47], v[100:103], v[180:183], v[44:47]
    ds_read_b128 v[132:135], v235 offset:29696
    v_mfma_f32_16x16x32_bf16 v[48:51], v[104:107], v[176:179], v[48:51]
    ds_read_b128 v[136:139], v235 offset:29824
    v_mfma_f32_16x16x32_bf16 v[56:59], v[104:107], v[180:183], v[56:59]
    v_sub_f32 v240, 1.0, v240
    v_mfma_f32_16x16x32_bf16 v[52:55], v[108:111], v[176:179], v[52:55]
    ds_read_b128 v[140:143], v235 offset:30208
    v_mfma_f32_16x16x32_bf16 v[60:63], v[108:111], v[180:183], v[60:63]
    ds_read_b128 v[144:147], v235 offset:30336
    v_mfma_f32_16x16x32_bf16 v[64:67], v[112:115], v[176:179], v[64:67]
    v_sub_f32 v241, 1.0, v241
    v_mfma_f32_16x16x32_bf16 v[72:75], v[112:115], v[180:183], v[72:75]
    ds_read_b128 v[148:151], v235 offset:30720
    v_mfma_f32_16x16x32_bf16 v[68:71], v[116:119], v[176:179], v[68:71]
    v_mul_f32 v238, v238, v240
    v_mfma_f32_16x16x32_bf16 v[76:79], v[116:119], v[180:183], v[76:79]
    ds_read_b128 v[152:155], v235 offset:30848
    v_mfma_f32_16x16x32_bf16 v[80:83], v[120:123], v[176:179], v[80:83]
    v_mul_f32 v239, v239, v241
    v_mfma_f32_16x16x32_bf16 v[84:87], v[120:123], v[180:183], v[84:87]
    ds_read_b128 v[156:159], v252 offset:29184
    s_setprio 3
    s_waitcnt lgkmcnt(8)
    v_mfma_f32_16x16x32_bf16 v[16:19], v[124:127], v[184:187], v[16:19]
    v_mfma_f32_16x16x32_bf16 v[24:27], v[124:127], v[188:191], v[24:27]
    s_waitcnt lgkmcnt(7)
    v_mfma_f32_16x16x32_bf16 v[20:23], v[128:131], v[184:187], v[20:23]
    v_mfma_f32_16x16x32_bf16 v[28:31], v[128:131], v[188:191], v[28:31]
    s_waitcnt lgkmcnt(6)
    v_mfma_f32_16x16x32_bf16 v[32:35], v[132:135], v[184:187], v[32:35]
    v_mfma_f32_16x16x32_bf16 v[40:43], v[132:135], v[188:191], v[40:43]
    s_waitcnt lgkmcnt(5)
    v_mfma_f32_16x16x32_bf16 v[36:39], v[136:139], v[184:187], v[36:39]
    s_waitcnt vmcnt(9)
    v_lshlrev_b32 v2, 16, v192
    v_and_b32 v3, 0xffff0000, v192
    v_mfma_f32_16x16x32_bf16 v[44:47], v[136:139], v[188:191], v[44:47]
    v_lshlrev_b32 v4, 16, v193
    v_and_b32 v5, 0xffff0000, v193
    s_waitcnt lgkmcnt(4)
    v_mfma_f32_16x16x32_bf16 v[48:51], v[140:143], v[184:187], v[48:51]
    v_fma_f32 v16, v16, v240, v238
    v_fma_f32 v17, v17, v240, v238
    v_mfma_f32_16x16x32_bf16 v[56:59], v[140:143], v[188:191], v[56:59]
    v_fma_f32 v18, v18, v240, v238
    v_fma_f32 v19, v19, v240, v238
    s_waitcnt lgkmcnt(3)
    v_mfma_f32_16x16x32_bf16 v[52:55], v[144:147], v[184:187], v[52:55]
    v_mul_f32 v16, v16, v2
    v_mul_f32 v17, v17, v3
    v_mfma_f32_16x16x32_bf16 v[60:63], v[144:147], v[188:191], v[60:63]
    v_mul_f32 v18, v18, v4
    v_mul_f32 v19, v19, v5
    s_waitcnt lgkmcnt(2)
    v_mfma_f32_16x16x32_bf16 v[64:67], v[148:151], v[184:187], v[64:67]
    v_cvt_pk_bf16_f32 v88, v16, v17
    v_cvt_pk_bf16_f32 v89, v18, v19
    v_mfma_f32_16x16x32_bf16 v[72:75], v[148:151], v[188:191], v[72:75]
    v_lshlrev_b32 v6, 16, v194
    v_and_b32 v7, 0xffff0000, v194
    s_waitcnt lgkmcnt(1)
    v_mfma_f32_16x16x32_bf16 v[68:71], v[152:155], v[184:187], v[68:71]
    v_lshlrev_b32 v8, 16, v195
    v_and_b32 v9, 0xffff0000, v195
    v_mfma_f32_16x16x32_bf16 v[76:79], v[152:155], v[188:191], v[76:79]
    v_fma_f32 v20, v20, v240, v238
    v_fma_f32 v21, v21, v240, v238
    s_waitcnt lgkmcnt(0)
    v_mfma_f32_16x16x32_bf16 v[80:83], v[156:159], v[184:187], v[80:83]
    v_fma_f32 v22, v22, v240, v238
    v_fma_f32 v23, v23, v240, v238
    v_mfma_f32_16x16x32_bf16 v[84:87], v[156:159], v[188:191], v[84:87]
    v_mul_f32 v20, v20, v6
    v_mul_f32 v21, v21, v7
    v_mul_f32 v22, v22, v8
    v_mul_f32 v23, v23, v9
    v_cvt_pk_bf16_f32 v90, v20, v21
    v_cvt_pk_bf16_f32 v91, v22, v23
    buffer_store_dwordx4 v[88:91], v232, s[8:11], s34 offen offset:0 sc1
    s_waitcnt vmcnt(9)
    v_lshlrev_b32 v2, 16, v196
    v_and_b32 v3, 0xffff0000, v196
    v_lshlrev_b32 v4, 16, v197
    v_and_b32 v5, 0xffff0000, v197
    v_fma_f32 v24, v24, v241, v239
    v_fma_f32 v25, v25, v241, v239
    v_fma_f32 v26, v26, v241, v239
    v_fma_f32 v27, v27, v241, v239
    v_mul_f32 v24, v24, v2
    v_mul_f32 v25, v25, v3
    v_mul_f32 v26, v26, v4
    v_mul_f32 v27, v27, v5
    v_cvt_pk_bf16_f32 v92, v24, v25
    v_cvt_pk_bf16_f32 v93, v26, v27
    v_lshlrev_b32 v6, 16, v198
    v_and_b32 v7, 0xffff0000, v198
    v_lshlrev_b32 v8, 16, v199
    v_and_b32 v9, 0xffff0000, v199
    v_fma_f32 v28, v28, v241, v239
    v_fma_f32 v29, v29, v241, v239
    v_fma_f32 v30, v30, v241, v239
    v_fma_f32 v31, v31, v241, v239
    v_mul_f32 v28, v28, v6
    v_mul_f32 v29, v29, v7
    v_mul_f32 v30, v30, v8
    v_mul_f32 v31, v31, v9
    v_cvt_pk_bf16_f32 v94, v28, v29
    v_cvt_pk_bf16_f32 v95, v30, v31
    buffer_store_dwordx4 v[92:95], v244, s[8:11], s34 offen offset:0 sc1
    s_waitcnt vmcnt(9)
    v_lshlrev_b32 v2, 16, v200
    v_and_b32 v3, 0xffff0000, v200
    v_lshlrev_b32 v4, 16, v201
    v_and_b32 v5, 0xffff0000, v201
    v_fma_f32 v32, v32, v240, v238
    v_fma_f32 v33, v33, v240, v238
    v_fma_f32 v34, v34, v240, v238
    v_fma_f32 v35, v35, v240, v238
    v_mul_f32 v32, v32, v2
    v_mul_f32 v33, v33, v3
    v_mul_f32 v34, v34, v4
    v_mul_f32 v35, v35, v5
    v_cvt_pk_bf16_f32 v96, v32, v33
    v_cvt_pk_bf16_f32 v97, v34, v35
    v_lshlrev_b32 v6, 16, v202
    v_and_b32 v7, 0xffff0000, v202
    v_lshlrev_b32 v8, 16, v203
    v_and_b32 v9, 0xffff0000, v203
    v_fma_f32 v36, v36, v240, v238
    v_fma_f32 v37, v37, v240, v238
    v_fma_f32 v38, v38, v240, v238
    v_fma_f32 v39, v39, v240, v238
    v_mul_f32 v36, v36, v6
    v_mul_f32 v37, v37, v7
    v_mul_f32 v38, v38, v8
    v_mul_f32 v39, v39, v9
    v_cvt_pk_bf16_f32 v98, v36, v37
    v_cvt_pk_bf16_f32 v99, v38, v39
    buffer_store_dwordx4 v[96:99], v232, s[8:11], s34 offen offset:1024 sc1
    s_waitcnt vmcnt(9)
    v_lshlrev_b32 v2, 16, v204
    v_and_b32 v3, 0xffff0000, v204
    v_lshlrev_b32 v4, 16, v205
    v_and_b32 v5, 0xffff0000, v205
    v_fma_f32 v40, v40, v241, v239
    v_fma_f32 v41, v41, v241, v239
    v_fma_f32 v42, v42, v241, v239
    v_fma_f32 v43, v43, v241, v239
    v_mul_f32 v40, v40, v2
    v_mul_f32 v41, v41, v3
    v_mul_f32 v42, v42, v4
    v_mul_f32 v43, v43, v5
    v_cvt_pk_bf16_f32 v100, v40, v41
    v_cvt_pk_bf16_f32 v101, v42, v43
    v_lshlrev_b32 v6, 16, v206
    v_and_b32 v7, 0xffff0000, v206
    v_lshlrev_b32 v8, 16, v207
    v_and_b32 v9, 0xffff0000, v207
    v_fma_f32 v44, v44, v241, v239
    v_fma_f32 v45, v45, v241, v239
    v_fma_f32 v46, v46, v241, v239
    v_fma_f32 v47, v47, v241, v239
    v_mul_f32 v44, v44, v6
    v_mul_f32 v45, v45, v7
    v_mul_f32 v46, v46, v8
    v_mul_f32 v47, v47, v9
    v_cvt_pk_bf16_f32 v102, v44, v45
    v_cvt_pk_bf16_f32 v103, v46, v47
    buffer_store_dwordx4 v[100:103], v244, s[8:11], s34 offen offset:1024 sc1
    s_waitcnt vmcnt(9)
    v_lshlrev_b32 v2, 16, v208
    v_and_b32 v3, 0xffff0000, v208
    v_lshlrev_b32 v4, 16, v209
    v_and_b32 v5, 0xffff0000, v209
    v_fma_f32 v48, v48, v240, v238
    v_fma_f32 v49, v49, v240, v238
    v_fma_f32 v50, v50, v240, v238
    v_fma_f32 v51, v51, v240, v238
    v_mul_f32 v48, v48, v2
    v_mul_f32 v49, v49, v3
    v_mul_f32 v50, v50, v4
    v_mul_f32 v51, v51, v5
    v_cvt_pk_bf16_f32 v104, v48, v49
    v_cvt_pk_bf16_f32 v105, v50, v51
    v_lshlrev_b32 v6, 16, v210
    v_and_b32 v7, 0xffff0000, v210
    v_lshlrev_b32 v8, 16, v211
    v_and_b32 v9, 0xffff0000, v211
    v_fma_f32 v52, v52, v240, v238
    v_fma_f32 v53, v53, v240, v238
    v_fma_f32 v54, v54, v240, v238
    v_fma_f32 v55, v55, v240, v238
    v_mul_f32 v52, v52, v6
    v_mul_f32 v53, v53, v7
    v_mul_f32 v54, v54, v8
    v_mul_f32 v55, v55, v9
    v_cvt_pk_bf16_f32 v106, v52, v53
    v_cvt_pk_bf16_f32 v107, v54, v55
    buffer_store_dwordx4 v[104:107], v232, s[8:11], s34 offen offset:2048 sc1
    s_waitcnt vmcnt(9)
    v_lshlrev_b32 v2, 16, v212
    v_and_b32 v3, 0xffff0000, v212
    v_lshlrev_b32 v4, 16, v213
    v_and_b32 v5, 0xffff0000, v213
    v_fma_f32 v56, v56, v241, v239
    v_fma_f32 v57, v57, v241, v239
    v_fma_f32 v58, v58, v241, v239
    v_fma_f32 v59, v59, v241, v239
    v_mul_f32 v56, v56, v2
    v_mul_f32 v57, v57, v3
    v_mul_f32 v58, v58, v4
    v_mul_f32 v59, v59, v5
    v_cvt_pk_bf16_f32 v108, v56, v57
    v_cvt_pk_bf16_f32 v109, v58, v59
    v_lshlrev_b32 v6, 16, v214
    v_and_b32 v7, 0xffff0000, v214
    v_lshlrev_b32 v8, 16, v215
    v_and_b32 v9, 0xffff0000, v215
    v_fma_f32 v60, v60, v241, v239
    v_fma_f32 v61, v61, v241, v239
    v_fma_f32 v62, v62, v241, v239
    v_fma_f32 v63, v63, v241, v239
    v_mul_f32 v60, v60, v6
    v_mul_f32 v61, v61, v7
    v_mul_f32 v62, v62, v8
    v_mul_f32 v63, v63, v9
    v_cvt_pk_bf16_f32 v110, v60, v61
    v_cvt_pk_bf16_f32 v111, v62, v63
    buffer_store_dwordx4 v[108:111], v244, s[8:11], s34 offen offset:2048 sc1
    s_waitcnt vmcnt(9)
    v_lshlrev_b32 v2, 16, v216
    v_and_b32 v3, 0xffff0000, v216
    v_lshlrev_b32 v4, 16, v217
    v_and_b32 v5, 0xffff0000, v217
    v_fma_f32 v64, v64, v240, v238
    v_fma_f32 v65, v65, v240, v238
    v_fma_f32 v66, v66, v240, v238
    v_fma_f32 v67, v67, v240, v238
    v_mul_f32 v64, v64, v2
    v_mul_f32 v65, v65, v3
    v_mul_f32 v66, v66, v4
    v_mul_f32 v67, v67, v5
    v_cvt_pk_bf16_f32 v112, v64, v65
    v_cvt_pk_bf16_f32 v113, v66, v67
    v_lshlrev_b32 v6, 16, v218
    v_and_b32 v7, 0xffff0000, v218
    v_lshlrev_b32 v8, 16, v219
    v_and_b32 v9, 0xffff0000, v219
    v_fma_f32 v68, v68, v240, v238
    v_fma_f32 v69, v69, v240, v238
    v_fma_f32 v70, v70, v240, v238
    v_fma_f32 v71, v71, v240, v238
    v_mul_f32 v68, v68, v6
    v_mul_f32 v69, v69, v7
    v_mul_f32 v70, v70, v8
    v_mul_f32 v71, v71, v9
    v_cvt_pk_bf16_f32 v114, v68, v69
    v_cvt_pk_bf16_f32 v115, v70, v71
    buffer_store_dwordx4 v[112:115], v232, s[8:11], s34 offen offset:3072 sc1
    s_waitcnt vmcnt(9)
    v_lshlrev_b32 v2, 16, v220
    v_and_b32 v3, 0xffff0000, v220
    v_lshlrev_b32 v4, 16, v221
    v_and_b32 v5, 0xffff0000, v221
    v_fma_f32 v72, v72, v241, v239
    v_fma_f32 v73, v73, v241, v239
    v_fma_f32 v74, v74, v241, v239
    v_fma_f32 v75, v75, v241, v239
    v_mul_f32 v72, v72, v2
    v_mul_f32 v73, v73, v3
    v_mul_f32 v74, v74, v4
    v_mul_f32 v75, v75, v5
    v_cvt_pk_bf16_f32 v116, v72, v73
    v_cvt_pk_bf16_f32 v117, v74, v75
    v_lshlrev_b32 v6, 16, v222
    v_and_b32 v7, 0xffff0000, v222
    v_lshlrev_b32 v8, 16, v223
    v_and_b32 v9, 0xffff0000, v223
    v_fma_f32 v76, v76, v241, v239
    v_fma_f32 v77, v77, v241, v239
    v_fma_f32 v78, v78, v241, v239
    v_fma_f32 v79, v79, v241, v239
    v_mul_f32 v76, v76, v6
    v_mul_f32 v77, v77, v7
    v_mul_f32 v78, v78, v8
    v_mul_f32 v79, v79, v9
    v_cvt_pk_bf16_f32 v118, v76, v77
    v_cvt_pk_bf16_f32 v119, v78, v79
    buffer_store_dwordx4 v[116:119], v244, s[8:11], s34 offen offset:3072 sc1
    s_waitcnt vmcnt(9)
    v_lshlrev_b32 v2, 16, v224
    v_and_b32 v3, 0xffff0000, v224
    v_lshlrev_b32 v4, 16, v225
    v_and_b32 v5, 0xffff0000, v225
    v_fma_f32 v80, v80, v240, v238
    v_fma_f32 v81, v81, v240, v238
    v_fma_f32 v82, v82, v240, v238
    v_fma_f32 v83, v83, v240, v238
    v_mul_f32 v80, v80, v2
    v_mul_f32 v81, v81, v3
    v_mul_f32 v82, v82, v4
    v_mul_f32 v83, v83, v5
    v_cvt_pk_bf16_f32 v120, v80, v81
    v_cvt_pk_bf16_f32 v121, v82, v83
    buffer_store_dwordx2 v[120:121], v245, s[8:11], s49 offen sc1
    s_waitcnt vmcnt(9)
    v_lshlrev_b32 v6, 16, v226
    v_and_b32 v7, 0xffff0000, v226
    v_lshlrev_b32 v8, 16, v227
    v_and_b32 v9, 0xffff0000, v227
    v_fma_f32 v84, v84, v241, v239
    v_fma_f32 v85, v85, v241, v239
    v_fma_f32 v86, v86, v241, v239
    v_fma_f32 v87, v87, v241, v239
    v_mul_f32 v84, v84, v6
    v_mul_f32 v85, v85, v7
    v_mul_f32 v86, v86, v8
    v_mul_f32 v87, v87, v9
    v_cvt_pk_bf16_f32 v122, v84, v85
    v_cvt_pk_bf16_f32 v123, v86, v87
    buffer_store_dwordx2 v[122:123], v246, s[8:11], s49 offen sc1
KC_start:
    s_load_dwordx2 s[6:7], s[0:1], 72
    v_lshlrev_b32 v8, 4, v1
    s_lshl_b32 s44, s30, 7
    s_add_u32 s44, s44, 58799104
    s_lshl_b32 s30, s30, 1
    s_and_b32 s46, s31, 1
    s_add_u32 s30, s30, s46
    s_lshr_b32 s31, s31, 1
    s_mul_i32 s42, s30, 368640
    s_lshl_b32 s46, s32, 10
    s_add_u32 s42, s42, s46
    s_add_u32 s42, s42, 41943040
    s_mul_i32 s43, s31, 460800
    s_mul_i32 s46, s32, 5120
    s_add_u32 s43, s43, s46
    s_add_u32 s43, s43, 54525952
    s_add_u32 s40, s42, 18432
    s_add_u32 s41, s43, 92160
    s_add_u32 s46, s32, 0
    s_and_b32 s46, s46, 3
    s_mul_i32 s50, s46, 15360
    s_mul_i32 s46, s46, 92160
    v_add_u32 v4, s46, v8
    s_add_u32 s46, s32, 1
    s_and_b32 s46, s46, 3
    s_mul_i32 s51, s46, 15360
    s_mul_i32 s46, s46, 92160
    v_add_u32 v5, s46, v8
    s_add_u32 s46, s32, 2
    s_and_b32 s46, s46, 3
    s_mul_i32 s52, s46, 15360
    s_mul_i32 s46, s46, 92160
    v_add_u32 v6, s46, v8
    s_add_u32 s46, s32, 3
    s_and_b32 s46, s46, 3
    s_mul_i32 s53, s46, 15360
    s_mul_i32 s46, s46, 92160
    v_add_u32 v7, s46, v8
    v_bfe_u32 v2, v1, 3, 1
    v_lshlrev_b32 v2, 30, v2
    v_add_u32 v9, v8, v2
    v_add_u32 v9, 4096, v9
    v_add_u32 v10, s51, v8
    v_add_u32 v11, s52, v8
    v_add_u32 v12, s53, v8
    v_add_u32 v13, s50, v8
    v_and_b32 v2, 15, v1
    v_mul_u32_u24 v2, 1152, v2
    v_lshrrev_b32 v3, 4, v1
    v_lshl_add_u32 v14, v3, 4, v2
    v_lshl_add_u32 v15, v3, 3, v2
    s_lshl_b32 s46, s30, 2
    s_add_u32 s46, s46, s32
    s_mul_i32 s46, s46, 18432
    s_mul_i32 s47, s31, 144
    s_add_u32 s46, s46, s47
    s_lshl_b32 s45, s30, 3
    s_add_u32 s45, s45, s31
    s_lshl_b32 s45, s45, 7
    s_add_u32 s45, s45, 58802176
    v_mov_b32 v2, 0
    v_mov_b32 v3, 1
    s_mov_b32 s35, 0
    s_waitcnt lgkmcnt(0)
    s_mov_b32 s12, s6
    s_mov_b32 s13, s7
    s_mov_b32 s14, 2359296
    s_mov_b32 s15, 0x00020000
    s_and_b32 s48, s2, 63
    s_lshl_b32 s48, s48, 7
    s_add_u32 s48, s48, 58789888
    s_mov_b32 s47, 0
    s_cmp_lg_u32 s32, 0
    s_cbranch_scc1 KC_wok
KC_wpoll:
    buffer_load_dword v240, v2, s[8:11], s48 offen sc1
    s_add_u32 s47, s47, 1
    s_waitcnt vmcnt(0)
    v_lshrrev_b32 v240, 8, v240
    v_cmp_ne_u32 vcc, 16, v240
    s_cmp_gt_u32 s47, 0x40000
    s_cbranch_scc1 KC_wok
    s_cbranch_vccz KC_wok
    s_sleep 2
    s_branch KC_wpoll
KC_wok:
    s_waitcnt vmcnt(0)
    s_barrier
    s_cmp_lg_u32 s32, 0
    s_cbranch_scc1 KC_arr
    s_mov_b64 exec, 1
    buffer_atomic_add v3, v2, s[8:11], s44 offen sc1
    s_mov_b32 s47, 0
KC_hpoll:
    buffer_load_dword v3, v2, s[8:11], s44 offen sc1
    s_add_u32 s47, s47, 1
    s_waitcnt vmcnt(0)
    v_cmp_ne_u32 vcc, 16, v3
    s_cmp_gt_u32 s47, 0x40000
    s_cbranch_scc1 KC_hok
    s_cbranch_vccz KC_hok
    s_sleep 1
    s_branch KC_hpoll
KC_hok:
    s_mov_b64 exec, -1
    s_barrier
    buffer_load_dwordx4 v[112:115], v8, s[8:11], s41 offen offset:0 sc1
    buffer_load_dwordx4 v[116:119], v8, s[8:11], s41 offen offset:1024 sc1
    buffer_load_dwordx4 v[120:123], v8, s[8:11], s41 offen offset:2048 sc1
    buffer_load_dwordx4 v[124:127], v8, s[8:11], s41 offen offset:3072 sc1
    buffer_load_dwordx4 v[128:131], v9, s[8:11], s41 offen sc1
    s_add_u32 s41, s41, 20480
    buffer_load_dwordx4 v[148:151], v8, s[8:11], s41 offen offset:0 sc1
    buffer_load_dwordx4 v[152:155], v8, s[8:11], s41 offen offset:1024 sc1
    buffer_load_dwordx4 v[156:159], v8, s[8:11], s41 offen offset:2048 sc1
    buffer_load_dwordx4 v[160:163], v8, s[8:11], s41 offen offset:3072 sc1
    buffer_load_dwordx4 v[164:167], v9, s[8:11], s41 offen sc1
    s_add_u32 s41, s41, 20480
    buffer_load_dwordx4 v[184:187], v8, s[8:11], s41 offen offset:0 sc1
    buffer_load_dwordx4 v[188:191], v8, s[8:11], s41 offen offset:1024 sc1
    buffer_load_dwordx4 v[192:195], v8, s[8:11], s41 offen offset:2048 sc1
    buffer_load_dwordx4 v[196:199], v8, s[8:11], s41 offen offset:3072 sc1
    buffer_load_dwordx4 v[200:203], v9, s[8:11], s41 offen sc1
    s_add_u32 s41, s41, 20480
    s_branch KC_go
KC_arr:
    buffer_load_dwordx4 v[112:115], v8, s[8:11], s41 offen offset:0 sc1
    buffer_load_dwordx4 v[116:119], v8, s[8:11], s41 offen offset:1024 sc1
    buffer_load_dwordx4 v[120:123], v8, s[8:11], s41 offen offset:2048 sc1
    buffer_load_dwordx4 v[124:127], v8, s[8:11], s41 offen offset:3072 sc1
    buffer_load_dwordx4 v[128:131], v9, s[8:11], s41 offen sc1
    s_add_u32 s41, s41, 20480
    buffer_load_dwordx4 v[148:151], v8, s[8:11], s41 offen offset:0 sc1
    buffer_load_dwordx4 v[152:155], v8, s[8:11], s41 offen offset:1024 sc1
    buffer_load_dwordx4 v[156:159], v8, s[8:11], s41 offen offset:2048 sc1
    buffer_load_dwordx4 v[160:163], v8, s[8:11], s41 offen offset:3072 sc1
    buffer_load_dwordx4 v[164:167], v9, s[8:11], s41 offen sc1
    s_add_u32 s41, s41, 20480
    buffer_load_dwordx4 v[184:187], v8, s[8:11], s41 offen offset:0 sc1
    buffer_load_dwordx4 v[188:191], v8, s[8:11], s41 offen offset:1024 sc1
    buffer_load_dwordx4 v[192:195], v8, s[8:11], s41 offen offset:2048 sc1
    buffer_load_dwordx4 v[196:199], v8, s[8:11], s41 offen offset:3072 sc1
    buffer_load_dwordx4 v[200:203], v9, s[8:11], s41 offen sc1
    s_add_u32 s41, s41, 20480
    s_barrier
KC_go:
    buffer_load_dwordx4 v[96:99], v4, s[8:11], s40 offen sc1
    buffer_load_dwordx4 v[100:103], v5, s[8:11], s40 offen sc1
    buffer_load_dwordx4 v[104:107], v6, s[8:11], s40 offen sc1
    buffer_load_dwordx4 v[108:111], v7, s[8:11], s40 offen sc1
    s_add_u32 s40, s40, 4096
    buffer_load_dwordx4 v[132:135], v4, s[8:11], s40 offen sc1
    buffer_load_dwordx4 v[136:139], v5, s[8:11], s40 offen sc1
    buffer_load_dwordx4 v[140:143], v6, s[8:11], s40 offen sc1
    buffer_load_dwordx4 v[144:147], v7, s[8:11], s40 offen sc1
    s_add_u32 s40, s40, 4096
    buffer_load_dwordx4 v[168:171], v4, s[8:11], s40 offen sc1
    buffer_load_dwordx4 v[172:175], v5, s[8:11], s40 offen sc1
    buffer_load_dwordx4 v[176:179], v6, s[8:11], s40 offen sc1
    buffer_load_dwordx4 v[180:183], v7, s[8:11], s40 offen sc1
    s_add_u32 s40, s40, 4096
    s_setprio 0
    s_waitcnt vmcnt(11)
    v_mfma_f32_16x16x32_bf16 v[16:19], v[112:115], v[96:99], 0
    s_waitcnt vmcnt(10)
    v_mfma_f32_16x16x32_bf16 v[20:23], v[112:115], v[100:103], 0
    v_mfma_f32_16x16x32_bf16 v[32:35], v[116:119], v[96:99], 0
    buffer_load_dwordx4 v[204:207], v4, s[8:11], s40 offen sc1
    v_mfma_f32_16x16x32_bf16 v[36:39], v[116:119], v[100:103], 0
    buffer_load_dwordx4 v[220:223], v8, s[8:11], s41 offen offset:0 sc1
    s_waitcnt vmcnt(11)
    v_mfma_f32_16x16x32_bf16 v[24:27], v[112:115], v[104:107], 0
    buffer_load_dwordx4 v[208:211], v5, s[8:11], s40 offen sc1
    v_mfma_f32_16x16x32_bf16 v[40:43], v[116:119], v[104:107], 0
    buffer_load_dwordx4 v[224:227], v8, s[8:11], s41 offen offset:1024 sc1
    v_mfma_f32_16x16x32_bf16 v[48:51], v[120:123], v[96:99], 0
    buffer_load_dwordx4 v[212:215], v6, s[8:11], s40 offen sc1
    v_mfma_f32_16x16x32_bf16 v[52:55], v[120:123], v[100:103], 0
    v_mfma_f32_16x16x32_bf16 v[56:59], v[120:123], v[104:107], 0
    buffer_load_dwordx4 v[228:231], v8, s[8:11], s41 offen offset:2048 sc1
    s_waitcnt vmcnt(14)
    v_mfma_f32_16x16x32_bf16 v[28:31], v[112:115], v[108:111], 0
    buffer_load_dwordx4 v[216:219], v7, s[8:11], s40 offen sc1
    v_mfma_f32_16x16x32_bf16 v[44:47], v[116:119], v[108:111], 0
    buffer_load_dwordx4 v[232:235], v8, s[8:11], s41 offen offset:3072 sc1
    v_mfma_f32_16x16x32_bf16 v[60:63], v[120:123], v[108:111], 0
    s_add_u32 s40, s40, 4096
    v_mfma_f32_16x16x32_bf16 v[64:67], v[124:127], v[96:99], 0
    buffer_load_dwordx4 v[236:239], v9, s[8:11], s41 offen sc1
    v_mfma_f32_16x16x32_bf16 v[68:71], v[124:127], v[100:103], 0
    s_add_u32 s41, s41, 20480
    v_mfma_f32_16x16x32_bf16 v[72:75], v[124:127], v[104:107], 0
    v_mfma_f32_16x16x32_bf16 v[76:79], v[124:127], v[108:111], 0
    v_mfma_f32_16x16x32_bf16 v[80:83], v[128:131], v[96:99], 0
    v_mfma_f32_16x16x32_bf16 v[84:87], v[128:131], v[100:103], 0
    v_mfma_f32_16x16x32_bf16 v[88:91], v[128:131], v[104:107], 0
    v_mfma_f32_16x16x32_bf16 v[92:95], v[128:131], v[108:111], 0
    s_waitcnt vmcnt(16)
    v_mfma_f32_16x16x32_bf16 v[16:19], v[148:151], v[132:135], v[16:19]
    s_waitcnt vmcnt(15)
    v_mfma_f32_16x16x32_bf16 v[20:23], v[148:151], v[136:139], v[20:23]
    v_mfma_f32_16x16x32_bf16 v[32:35], v[152:155], v[132:135], v[32:35]
    buffer_load_dwordx4 v[96:99], v4, s[8:11], s40 offen sc1
    v_mfma_f32_16x16x32_bf16 v[36:39], v[152:155], v[136:139], v[36:39]
    buffer_load_dwordx4 v[112:115], v8, s[8:11], s41 offen offset:0 sc1
    s_waitcnt vmcnt(16)
    v_mfma_f32_16x16x32_bf16 v[24:27], v[148:151], v[140:143], v[24:27]
    buffer_load_dwordx4 v[100:103], v5, s[8:11], s40 offen sc1
    v_mfma_f32_16x16x32_bf16 v[40:43], v[152:155], v[140:143], v[40:43]
    buffer_load_dwordx4 v[116:119], v8, s[8:11], s41 offen offset:1024 sc1
    v_mfma_f32_16x16x32_bf16 v[48:51], v[156:159], v[132:135], v[48:51]
    buffer_load_dwordx4 v[104:107], v6, s[8:11], s40 offen sc1
    v_mfma_f32_16x16x32_bf16 v[52:55], v[156:159], v[136:139], v[52:55]
    v_mfma_f32_16x16x32_bf16 v[56:59], v[156:159], v[140:143], v[56:59]
    buffer_load_dwordx4 v[120:123], v8, s[8:11], s41 offen offset:2048 sc1
    s_waitcnt vmcnt(19)
    v_mfma_f32_16x16x32_bf16 v[28:31], v[148:151], v[144:147], v[28:31]
    buffer_load_dwordx4 v[108:111], v7, s[8:11], s40 offen sc1
    v_mfma_f32_16x16x32_bf16 v[44:47], v[152:155], v[144:147], v[44:47]
    buffer_load_dwordx4 v[124:127], v8, s[8:11], s41 offen offset:3072 sc1
    v_mfma_f32_16x16x32_bf16 v[60:63], v[156:159], v[144:147], v[60:63]
    s_add_u32 s40, s40, 4096
    v_mfma_f32_16x16x32_bf16 v[64:67], v[160:163], v[132:135], v[64:67]
    buffer_load_dwordx4 v[128:131], v9, s[8:11], s41 offen sc1
    v_mfma_f32_16x16x32_bf16 v[68:71], v[160:163], v[136:139], v[68:71]
    s_add_u32 s41, s41, 20480
    v_mfma_f32_16x16x32_bf16 v[72:75], v[160:163], v[140:143], v[72:75]
    v_mfma_f32_16x16x32_bf16 v[76:79], v[160:163], v[144:147], v[76:79]
    v_mfma_f32_16x16x32_bf16 v[80:83], v[164:167], v[132:135], v[80:83]
    v_mfma_f32_16x16x32_bf16 v[84:87], v[164:167], v[136:139], v[84:87]
    v_mfma_f32_16x16x32_bf16 v[88:91], v[164:167], v[140:143], v[88:91]
    v_mfma_f32_16x16x32_bf16 v[92:95], v[164:167], v[144:147], v[92:95]
    s_waitcnt vmcnt(21)
    v_mfma_f32_16x16x32_bf16 v[16:19], v[184:187], v[168:171], v[16:19]
    s_waitcnt vmcnt(20)
    v_mfma_f32_16x16x32_bf16 v[20:23], v[184:187], v[172:175], v[20:23]
    v_mfma_f32_16x16x32_bf16 v[32:35], v[188:191], v[168:171], v[32:35]
    buffer_load_dwordx4 v[132:135], v4, s[8:11], s40 offen sc1
    v_mfma_f32_16x16x32_bf16 v[36:39], v[188:191], v[172:175], v[36:39]
    buffer_load_dwordx4 v[148:151], v8, s[8:11], s41 offen offset:0 sc1
    s_waitcnt vmcnt(21)
    v_mfma_f32_16x16x32_bf16 v[24:27], v[184:187], v[176:179], v[24:27]
    buffer_load_dwordx4 v[136:139], v5, s[8:11], s40 offen sc1
    v_mfma_f32_16x16x32_bf16 v[40:43], v[188:191], v[176:179], v[40:43]
    buffer_load_dwordx4 v[152:155], v8, s[8:11], s41 offen offset:1024 sc1
    v_mfma_f32_16x16x32_bf16 v[48:51], v[192:195], v[168:171], v[48:51]
    buffer_load_dwordx4 v[140:143], v6, s[8:11], s40 offen sc1
    v_mfma_f32_16x16x32_bf16 v[52:55], v[192:195], v[172:175], v[52:55]
    v_mfma_f32_16x16x32_bf16 v[56:59], v[192:195], v[176:179], v[56:59]
    buffer_load_dwordx4 v[156:159], v8, s[8:11], s41 offen offset:2048 sc1
    s_waitcnt vmcnt(24)
    v_mfma_f32_16x16x32_bf16 v[28:31], v[184:187], v[180:183], v[28:31]
    buffer_load_dwordx4 v[144:147], v7, s[8:11], s40 offen sc1
    v_mfma_f32_16x16x32_bf16 v[44:47], v[188:191], v[180:183], v[44:47]
    buffer_load_dwordx4 v[160:163], v8, s[8:11], s41 offen offset:3072 sc1
    v_mfma_f32_16x16x32_bf16 v[60:63], v[192:195], v[180:183], v[60:63]
    s_add_u32 s40, s40, 4096
    v_mfma_f32_16x16x32_bf16 v[64:67], v[196:199], v[168:171], v[64:67]
    buffer_load_dwordx4 v[164:167], v9, s[8:11], s41 offen sc1
    v_mfma_f32_16x16x32_bf16 v[68:71], v[196:199], v[172:175], v[68:71]
    s_add_u32 s41, s41, 20480
    v_mfma_f32_16x16x32_bf16 v[72:75], v[196:199], v[176:179], v[72:75]
    v_mfma_f32_16x16x32_bf16 v[76:79], v[196:199], v[180:183], v[76:79]
    v_mfma_f32_16x16x32_bf16 v[80:83], v[200:203], v[168:171], v[80:83]
    v_mfma_f32_16x16x32_bf16 v[84:87], v[200:203], v[172:175], v[84:87]
    v_mfma_f32_16x16x32_bf16 v[88:91], v[200:203], v[176:179], v[88:91]
    v_mfma_f32_16x16x32_bf16 v[92:95], v[200:203], v[180:183], v[92:95]
    s_waitcnt vmcnt(25)
    v_mfma_f32_16x16x32_bf16 v[16:19], v[220:223], v[204:207], v[16:19]
    s_waitcnt vmcnt(24)
    v_mfma_f32_16x16x32_bf16 v[20:23], v[220:223], v[208:211], v[20:23]
    s_waitcnt vmcnt(23)
    v_mfma_f32_16x16x32_bf16 v[32:35], v[224:227], v[204:207], v[32:35]
    buffer_load_dwordx4 v[168:171], v4, s[8:11], s40 offen sc1
    v_mfma_f32_16x16x32_bf16 v[36:39], v[224:227], v[208:211], v[36:39]
    buffer_load_dwordx4 v[184:187], v8, s[8:11], s41 offen offset:0 sc1
    s_waitcnt vmcnt(24)
    v_mfma_f32_16x16x32_bf16 v[24:27], v[220:223], v[212:215], v[24:27]
    buffer_load_dwordx4 v[172:175], v5, s[8:11], s40 offen sc1
    v_mfma_f32_16x16x32_bf16 v[40:43], v[224:227], v[212:215], v[40:43]
    buffer_load_dwordx4 v[188:191], v8, s[8:11], s41 offen offset:1024 sc1
    s_waitcnt vmcnt(25)
    v_mfma_f32_16x16x32_bf16 v[48:51], v[228:231], v[204:207], v[48:51]
    buffer_load_dwordx4 v[176:179], v6, s[8:11], s40 offen sc1
    v_mfma_f32_16x16x32_bf16 v[52:55], v[228:231], v[208:211], v[52:55]
    v_mfma_f32_16x16x32_bf16 v[56:59], v[228:231], v[212:215], v[56:59]
    buffer_load_dwordx4 v[192:195], v8, s[8:11], s41 offen offset:2048 sc1
    s_waitcnt vmcnt(26)
    v_mfma_f32_16x16x32_bf16 v[28:31], v[220:223], v[216:219], v[28:31]
    buffer_load_dwordx4 v[180:183], v7, s[8:11], s40 offen sc1
    v_mfma_f32_16x16x32_bf16 v[44:47], v[224:227], v[216:219], v[44:47]
    buffer_load_dwordx4 v[196:199], v8, s[8:11], s41 offen offset:3072 sc1
    v_mfma_f32_16x16x32_bf16 v[60:63], v[228:231], v[216:219], v[60:63]
    s_add_u32 s40, s40, 4096
    s_waitcnt vmcnt(27)
    v_mfma_f32_16x16x32_bf16 v[64:67], v[232:235], v[204:207], v[64:67]
    buffer_load_dwordx4 v[200:203], v9, s[8:11], s41 offen sc1
    v_mfma_f32_16x16x32_bf16 v[68:71], v[232:235], v[208:211], v[68:71]
    s_add_u32 s41, s41, 20480
    v_mfma_f32_16x16x32_bf16 v[72:75], v[232:235], v[212:215], v[72:75]
    v_mfma_f32_16x16x32_bf16 v[76:79], v[232:235], v[216:219], v[76:79]
    s_waitcnt vmcnt(27)
    v_mfma_f32_16x16x32_bf16 v[80:83], v[236:239], v[204:207], v[80:83]
    v_mfma_f32_16x16x32_bf16 v[84:87], v[236:239], v[208:211], v[84:87]
    v_mfma_f32_16x16x32_bf16 v[88:91], v[236:239], v[212:215], v[88:91]
    v_mfma_f32_16x16x32_bf16 v[92:95], v[236:239], v[216:219], v[92:95]
    s_waitcnt vmcnt(25)
    v_mfma_f32_16x16x32_bf16 v[16:19], v[112:115], v[96:99], v[16:19]
    s_waitcnt vmcnt(24)
    v_mfma_f32_16x16x32_bf16 v[20:23], v[112:115], v[100:103], v[20:23]
    s_waitcnt vmcnt(23)
    v_mfma_f32_16x16x32_bf16 v[32:35], v[116:119], v[96:99], v[32:35]
    buffer_load_dwordx4 v[204:207], v4, s[8:11], s40 offen sc1
    v_mfma_f32_16x16x32_bf16 v[36:39], v[116:119], v[100:103], v[36:39]
    buffer_load_dwordx4 v[220:223], v8, s[8:11], s41 offen offset:0 sc1
    s_waitcnt vmcnt(24)
    v_mfma_f32_16x16x32_bf16 v[24:27], v[112:115], v[104:107], v[24:27]
    buffer_load_dwordx4 v[208:211], v5, s[8:11], s40 offen sc1
    v_mfma_f32_16x16x32_bf16 v[40:43], v[116:119], v[104:107], v[40:43]
    buffer_load_dwordx4 v[224:227], v8, s[8:11], s41 offen offset:1024 sc1
    s_waitcnt vmcnt(25)
    v_mfma_f32_16x16x32_bf16 v[48:51], v[120:123], v[96:99], v[48:51]
    buffer_load_dwordx4 v[212:215], v6, s[8:11], s40 offen sc1
    v_mfma_f32_16x16x32_bf16 v[52:55], v[120:123], v[100:103], v[52:55]
    v_mfma_f32_16x16x32_bf16 v[56:59], v[120:123], v[104:107], v[56:59]
    buffer_load_dwordx4 v[228:231], v8, s[8:11], s41 offen offset:2048 sc1
    s_waitcnt vmcnt(26)
    v_mfma_f32_16x16x32_bf16 v[28:31], v[112:115], v[108:111], v[28:31]
    buffer_load_dwordx4 v[216:219], v7, s[8:11], s40 offen sc1
    v_mfma_f32_16x16x32_bf16 v[44:47], v[116:119], v[108:111], v[44:47]
    buffer_load_dwordx4 v[232:235], v8, s[8:11], s41 offen offset:3072 sc1
    v_mfma_f32_16x16x32_bf16 v[60:63], v[120:123], v[108:111], v[60:63]
    s_add_u32 s40, s40, 4096
    s_waitcnt vmcnt(27)
    v_mfma_f32_16x16x32_bf16 v[64:67], v[124:127], v[96:99], v[64:67]
    buffer_load_dwordx4 v[236:239], v9, s[8:11], s41 offen sc1
    v_mfma_f32_16x16x32_bf16 v[68:71], v[124:127], v[100:103], v[68:71]
    s_add_u32 s41, s41, 20480
    v_mfma_f32_16x16x32_bf16 v[72:75], v[124:127], v[104:107], v[72:75]
    v_mfma_f32_16x16x32_bf16 v[76:79], v[124:127], v[108:111], v[76:79]
    s_waitcnt vmcnt(27)
    v_mfma_f32_16x16x32_bf16 v[80:83], v[128:131], v[96:99], v[80:83]
    v_mfma_f32_16x16x32_bf16 v[84:87], v[128:131], v[100:103], v[84:87]
    v_mfma_f32_16x16x32_bf16 v[88:91], v[128:131], v[104:107], v[88:91]
    v_mfma_f32_16x16x32_bf16 v[92:95], v[128:131], v[108:111], v[92:95]
KC_loop:
    s_waitcnt vmcnt(25)
    v_mfma_f32_16x16x32_bf16 v[16:19], v[148:151], v[132:135], v[16:19]
    s_waitcnt vmcnt(24)
    v_mfma_f32_16x16x32_bf16 v[20:23], v[148:151], v[136:139], v[20:23]
    s_waitcnt vmcnt(23)
    v_mfma_f32_16x16x32_bf16 v[32:35], v[152:155], v[132:135], v[32:35]
    buffer_load_dwordx4 v[96:99], v4, s[8:11], s40 offen sc1
    v_mfma_f32_16x16x32_bf16 v[36:39], v[152:155], v[136:139], v[36:39]
    buffer_load_dwordx4 v[112:115], v8, s[8:11], s41 offen offset:0 sc1
    s_waitcnt vmcnt(24)
    v_mfma_f32_16x16x32_bf16 v[24:27], v[148:151], v[140:143], v[24:27]
    buffer_load_dwordx4 v[100:103], v5, s[8:11], s40 offen sc1
    v_mfma_f32_16x16x32_bf16 v[40:43], v[152:155], v[140:143], v[40:43]
    buffer_load_dwordx4 v[116:119], v8, s[8:11], s41 offen offset:1024 sc1
    s_waitcnt vmcnt(25)
    v_mfma_f32_16x16x32_bf16 v[48:51], v[156:159], v[132:135], v[48:51]
    buffer_load_dwordx4 v[104:107], v6, s[8:11], s40 offen sc1
    v_mfma_f32_16x16x32_bf16 v[52:55], v[156:159], v[136:139], v[52:55]
    v_mfma_f32_16x16x32_bf16 v[56:59], v[156:159], v[140:143], v[56:59]
    buffer_load_dwordx4 v[120:123], v8, s[8:11], s41 offen offset:2048 sc1
    s_waitcnt vmcnt(26)
    v_mfma_f32_16x16x32_bf16 v[28:31], v[148:151], v[144:147], v[28:31]
    buffer_load_dwordx4 v[108:111], v7, s[8:11], s40 offen sc1
    v_mfma_f32_16x16x32_bf16 v[44:47], v[152:155], v[144:147], v[44:47]
    buffer_load_dwordx4 v[124:127], v8, s[8:11], s41 offen offset:3072 sc1
    v_mfma_f32_16x16x32_bf16 v[60:63], v[156:159], v[144:147], v[60:63]
    s_add_u32 s40, s40, 4096
    s_waitcnt vmcnt(27)
    v_mfma_f32_16x16x32_bf16 v[64:67], v[160:163], v[132:135], v[64:67]
    buffer_load_dwordx4 v[128:131], v9, s[8:11], s41 offen sc1
    v_mfma_f32_16x16x32_bf16 v[68:71], v[160:163], v[136:139], v[68:71]
    s_add_u32 s41, s41, 20480
    v_mfma_f32_16x16x32_bf16 v[72:75], v[160:163], v[140:143], v[72:75]
    v_mfma_f32_16x16x32_bf16 v[76:79], v[160:163], v[144:147], v[76:79]
    s_waitcnt vmcnt(27)
    v_mfma_f32_16x16x32_bf16 v[80:83], v[164:167], v[132:135], v[80:83]
    v_mfma_f32_16x16x32_bf16 v[84:87], v[164:167], v[136:139], v[84:87]
    v_mfma_f32_16x16x32_bf16 v[88:91], v[164:167], v[140:143], v[88:91]
    v_mfma_f32_16x16x32_bf16 v[92:95], v[164:167], v[144:147], v[92:95]
    s_waitcnt vmcnt(25)
    v_mfma_f32_16x16x32_bf16 v[16:19], v[184:187], v[168:171], v[16:19]
    s_waitcnt vmcnt(24)
    v_mfma_f32_16x16x32_bf16 v[20:23], v[184:187], v[172:175], v[20:23]
    s_waitcnt vmcnt(23)
    v_mfma_f32_16x16x32_bf16 v[32:35], v[188:191], v[168:171], v[32:35]
    buffer_load_dwordx4 v[132:135], v4, s[8:11], s40 offen sc1
    v_mfma_f32_16x16x32_bf16 v[36:39], v[188:191], v[172:175], v[36:39]
    buffer_load_dwordx4 v[148:151], v8, s[8:11], s41 offen offset:0 sc1
    s_waitcnt vmcnt(24)
    v_mfma_f32_16x16x32_bf16 v[24:27], v[184:187], v[176:179], v[24:27]
    buffer_load_dwordx4 v[136:139], v5, s[8:11], s40 offen sc1
    v_mfma_f32_16x16x32_bf16 v[40:43], v[188:191], v[176:179], v[40:43]
    buffer_load_dwordx4 v[152:155], v8, s[8:11], s41 offen offset:1024 sc1
    s_waitcnt vmcnt(25)
    v_mfma_f32_16x16x32_bf16 v[48:51], v[192:195], v[168:171], v[48:51]
    buffer_load_dwordx4 v[140:143], v6, s[8:11], s40 offen sc1
    v_mfma_f32_16x16x32_bf16 v[52:55], v[192:195], v[172:175], v[52:55]
    v_mfma_f32_16x16x32_bf16 v[56:59], v[192:195], v[176:179], v[56:59]
    buffer_load_dwordx4 v[156:159], v8, s[8:11], s41 offen offset:2048 sc1
    s_waitcnt vmcnt(26)
    v_mfma_f32_16x16x32_bf16 v[28:31], v[184:187], v[180:183], v[28:31]
    buffer_load_dwordx4 v[144:147], v7, s[8:11], s40 offen sc1
    v_mfma_f32_16x16x32_bf16 v[44:47], v[188:191], v[180:183], v[44:47]
    buffer_load_dwordx4 v[160:163], v8, s[8:11], s41 offen offset:3072 sc1
    v_mfma_f32_16x16x32_bf16 v[60:63], v[192:195], v[180:183], v[60:63]
    s_add_u32 s40, s40, 4096
    s_waitcnt vmcnt(27)
    v_mfma_f32_16x16x32_bf16 v[64:67], v[196:199], v[168:171], v[64:67]
    buffer_load_dwordx4 v[164:167], v9, s[8:11], s41 offen sc1
    v_mfma_f32_16x16x32_bf16 v[68:71], v[196:199], v[172:175], v[68:71]
    s_add_u32 s41, s41, 20480
    v_mfma_f32_16x16x32_bf16 v[72:75], v[196:199], v[176:179], v[72:75]
    v_mfma_f32_16x16x32_bf16 v[76:79], v[196:199], v[180:183], v[76:79]
    s_waitcnt vmcnt(27)
    v_mfma_f32_16x16x32_bf16 v[80:83], v[200:203], v[168:171], v[80:83]
    v_mfma_f32_16x16x32_bf16 v[84:87], v[200:203], v[172:175], v[84:87]
    v_mfma_f32_16x16x32_bf16 v[88:91], v[200:203], v[176:179], v[88:91]
    v_mfma_f32_16x16x32_bf16 v[92:95], v[200:203], v[180:183], v[92:95]
    s_waitcnt vmcnt(25)
    v_mfma_f32_16x16x32_bf16 v[16:19], v[220:223], v[204:207], v[16:19]
    s_waitcnt vmcnt(24)
    v_mfma_f32_16x16x32_bf16 v[20:23], v[220:223], v[208:211], v[20:23]
    s_waitcnt vmcnt(23)
    v_mfma_f32_16x16x32_bf16 v[32:35], v[224:227], v[204:207], v[32:35]
    buffer_load_dwordx4 v[168:171], v4, s[8:11], s40 offen sc1
    v_mfma_f32_16x16x32_bf16 v[36:39], v[224:227], v[208:211], v[36:39]
    buffer_load_dwordx4 v[184:187], v8, s[8:11], s41 offen offset:0 sc1
    s_waitcnt vmcnt(24)
    v_mfma_f32_16x16x32_bf16 v[24:27], v[220:223], v[212:215], v[24:27]
    buffer_load_dwordx4 v[172:175], v5, s[8:11], s40 offen sc1
    v_mfma_f32_16x16x32_bf16 v[40:43], v[224:227], v[212:215], v[40:43]
    buffer_load_dwordx4 v[188:191], v8, s[8:11], s41 offen offset:1024 sc1
    s_waitcnt vmcnt(25)
    v_mfma_f32_16x16x32_bf16 v[48:51], v[228:231], v[204:207], v[48:51]
    buffer_load_dwordx4 v[176:179], v6, s[8:11], s40 offen sc1
    v_mfma_f32_16x16x32_bf16 v[52:55], v[228:231], v[208:211], v[52:55]
    v_mfma_f32_16x16x32_bf16 v[56:59], v[228:231], v[212:215], v[56:59]
    buffer_load_dwordx4 v[192:195], v8, s[8:11], s41 offen offset:2048 sc1
    s_waitcnt vmcnt(26)
    v_mfma_f32_16x16x32_bf16 v[28:31], v[220:223], v[216:219], v[28:31]
    buffer_load_dwordx4 v[180:183], v7, s[8:11], s40 offen sc1
    v_mfma_f32_16x16x32_bf16 v[44:47], v[224:227], v[216:219], v[44:47]
    buffer_load_dwordx4 v[196:199], v8, s[8:11], s41 offen offset:3072 sc1
    v_mfma_f32_16x16x32_bf16 v[60:63], v[228:231], v[216:219], v[60:63]
    s_add_u32 s40, s40, 4096
    s_waitcnt vmcnt(27)
    v_mfma_f32_16x16x32_bf16 v[64:67], v[232:235], v[204:207], v[64:67]
    buffer_load_dwordx4 v[200:203], v9, s[8:11], s41 offen sc1
    v_mfma_f32_16x16x32_bf16 v[68:71], v[232:235], v[208:211], v[68:71]
    s_add_u32 s41, s41, 20480
    v_mfma_f32_16x16x32_bf16 v[72:75], v[232:235], v[212:215], v[72:75]
    v_mfma_f32_16x16x32_bf16 v[76:79], v[232:235], v[216:219], v[76:79]
    s_waitcnt vmcnt(27)
    v_mfma_f32_16x16x32_bf16 v[80:83], v[236:239], v[204:207], v[80:83]
    v_mfma_f32_16x16x32_bf16 v[84:87], v[236:239], v[208:211], v[84:87]
    v_mfma_f32_16x16x32_bf16 v[88:91], v[236:239], v[212:215], v[88:91]
    v_mfma_f32_16x16x32_bf16 v[92:95], v[236:239], v[216:219], v[92:95]
    s_waitcnt vmcnt(25)
    v_mfma_f32_16x16x32_bf16 v[16:19], v[112:115], v[96:99], v[16:19]
    s_waitcnt vmcnt(24)
    v_mfma_f32_16x16x32_bf16 v[20:23], v[112:115], v[100:103], v[20:23]
    s_waitcnt vmcnt(23)
    v_mfma_f32_16x16x32_bf16 v[32:35], v[116:119], v[96:99], v[32:35]
    buffer_load_dwordx4 v[204:207], v4, s[8:11], s40 offen sc1
    v_mfma_f32_16x16x32_bf16 v[36:39], v[116:119], v[100:103], v[36:39]
    buffer_load_dwordx4 v[220:223], v8, s[8:11], s41 offen offset:0 sc1
    s_waitcnt vmcnt(24)
    v_mfma_f32_16x16x32_bf16 v[24:27], v[112:115], v[104:107], v[24:27]
    buffer_load_dwordx4 v[208:211], v5, s[8:11], s40 offen sc1
    v_mfma_f32_16x16x32_bf16 v[40:43], v[116:119], v[104:107], v[40:43]
    buffer_load_dwordx4 v[224:227], v8, s[8:11], s41 offen offset:1024 sc1
    s_waitcnt vmcnt(25)
    v_mfma_f32_16x16x32_bf16 v[48:51], v[120:123], v[96:99], v[48:51]
    buffer_load_dwordx4 v[212:215], v6, s[8:11], s40 offen sc1
    v_mfma_f32_16x16x32_bf16 v[52:55], v[120:123], v[100:103], v[52:55]
    v_mfma_f32_16x16x32_bf16 v[56:59], v[120:123], v[104:107], v[56:59]
    buffer_load_dwordx4 v[228:231], v8, s[8:11], s41 offen offset:2048 sc1
    s_waitcnt vmcnt(26)
    v_mfma_f32_16x16x32_bf16 v[28:31], v[112:115], v[108:111], v[28:31]
    buffer_load_dwordx4 v[216:219], v7, s[8:11], s40 offen sc1
    v_mfma_f32_16x16x32_bf16 v[44:47], v[116:119], v[108:111], v[44:47]
    buffer_load_dwordx4 v[232:235], v8, s[8:11], s41 offen offset:3072 sc1
    v_mfma_f32_16x16x32_bf16 v[60:63], v[120:123], v[108:111], v[60:63]
    s_add_u32 s40, s40, 4096
    s_waitcnt vmcnt(27)
    v_mfma_f32_16x16x32_bf16 v[64:67], v[124:127], v[96:99], v[64:67]
    buffer_load_dwordx4 v[236:239], v9, s[8:11], s41 offen sc1
    v_mfma_f32_16x16x32_bf16 v[68:71], v[124:127], v[100:103], v[68:71]
    s_add_u32 s41, s41, 20480
    v_mfma_f32_16x16x32_bf16 v[72:75], v[124:127], v[104:107], v[72:75]
    v_mfma_f32_16x16x32_bf16 v[76:79], v[124:127], v[108:111], v[76:79]
    s_waitcnt vmcnt(27)
    v_mfma_f32_16x16x32_bf16 v[80:83], v[128:131], v[96:99], v[80:83]
    v_mfma_f32_16x16x32_bf16 v[84:87], v[128:131], v[100:103], v[84:87]
    v_mfma_f32_16x16x32_bf16 v[88:91], v[128:131], v[104:107], v[88:91]
    v_mfma_f32_16x16x32_bf16 v[92:95], v[128:131], v[108:111], v[92:95]
    s_add_u32 s35, s35, 1
    s_cmp_lt_u32 s35, 2
    s_cbranch_scc1 KC_loop
    s_waitcnt vmcnt(25)
    v_mfma_f32_16x16x32_bf16 v[16:19], v[148:151], v[132:135], v[16:19]
    s_waitcnt vmcnt(24)
    v_mfma_f32_16x16x32_bf16 v[20:23], v[148:151], v[136:139], v[20:23]
    s_waitcnt vmcnt(23)
    v_mfma_f32_16x16x32_bf16 v[32:35], v[152:155], v[132:135], v[32:35]
    buffer_load_dword v3, v2, s[8:11], s45 offen sc1
    v_mfma_f32_16x16x32_bf16 v[36:39], v[152:155], v[136:139], v[36:39]
    buffer_load_dwordx4 v[96:99], v4, s[8:11], s40 offen sc1
    s_waitcnt vmcnt(24)
    v_mfma_f32_16x16x32_bf16 v[24:27], v[148:151], v[140:143], v[24:27]
    buffer_load_dwordx4 v[112:115], v8, s[8:11], s41 offen offset:0 sc1
    v_mfma_f32_16x16x32_bf16 v[40:43], v[152:155], v[140:143], v[40:43]
    buffer_load_dwordx4 v[100:103], v5, s[8:11], s40 offen sc1
    s_waitcnt vmcnt(25)
    v_mfma_f32_16x16x32_bf16 v[48:51], v[156:159], v[132:135], v[48:51]
    buffer_load_dwordx4 v[116:119], v8, s[8:11], s41 offen offset:1024 sc1
    v_mfma_f32_16x16x32_bf16 v[52:55], v[156:159], v[136:139], v[52:55]
    buffer_load_dwordx4 v[104:107], v6, s[8:11], s40 offen sc1
    v_mfma_f32_16x16x32_bf16 v[56:59], v[156:159], v[140:143], v[56:59]
    buffer_load_dwordx4 v[120:123], v8, s[8:11], s41 offen offset:2048 sc1
    s_waitcnt vmcnt(27)
    v_mfma_f32_16x16x32_bf16 v[28:31], v[148:151], v[144:147], v[28:31]
    buffer_load_dwordx4 v[108:111], v7, s[8:11], s40 offen sc1
    v_mfma_f32_16x16x32_bf16 v[44:47], v[152:155], v[144:147], v[44:47]
    buffer_load_dwordx4 v[124:127], v8, s[8:11], s41 offen offset:3072 sc1
    v_mfma_f32_16x16x32_bf16 v[60:63], v[156:159], v[144:147], v[60:63]
    s_add_u32 s40, s40, 4096
    s_waitcnt vmcnt(28)
    v_mfma_f32_16x16x32_bf16 v[64:67], v[160:163], v[132:135], v[64:67]
    buffer_load_dwordx4 v[128:131], v9, s[8:11], s41 offen sc1
    v_mfma_f32_16x16x32_bf16 v[68:71], v[160:163], v[136:139], v[68:71]
    s_add_u32 s41, s41, 20480
    v_mfma_f32_16x16x32_bf16 v[72:75], v[160:163], v[140:143], v[72:75]
    v_mfma_f32_16x16x32_bf16 v[76:79], v[160:163], v[144:147], v[76:79]
    s_waitcnt vmcnt(28)
    v_mfma_f32_16x16x32_bf16 v[80:83], v[164:167], v[132:135], v[80:83]
    v_mfma_f32_16x16x32_bf16 v[84:87], v[164:167], v[136:139], v[84:87]
    v_mfma_f32_16x16x32_bf16 v[88:91], v[164:167], v[140:143], v[88:91]
    v_mfma_f32_16x16x32_bf16 v[92:95], v[164:167], v[144:147], v[92:95]
    s_waitcnt vmcnt(26)
    v_mfma_f32_16x16x32_bf16 v[16:19], v[184:187], v[168:171], v[16:19]
    s_waitcnt vmcnt(25)
    v_mfma_f32_16x16x32_bf16 v[20:23], v[184:187], v[172:175], v[20:23]
    s_waitcnt vmcnt(24)
    v_mfma_f32_16x16x32_bf16 v[32:35], v[188:191], v[168:171], v[32:35]
    buffer_load_dwordx4 v[132:135], v4, s[8:11], s40 offen sc1
    v_mfma_f32_16x16x32_bf16 v[36:39], v[188:191], v[172:175], v[36:39]
    buffer_load_dwordx4 v[148:151], v8, s[8:11], s41 offen offset:0 sc1
    s_waitcnt vmcnt(25)
    v_mfma_f32_16x16x32_bf16 v[24:27], v[184:187], v[176:179], v[24:27]
    buffer_load_dwordx4 v[136:139], v5, s[8:11], s40 offen sc1
    v_mfma_f32_16x16x32_bf16 v[40:43], v[188:191], v[176:179], v[40:43]
    buffer_load_dwordx4 v[152:155], v8, s[8:11], s41 offen offset:1024 sc1
    s_waitcnt vmcnt(26)
    v_mfma_f32_16x16x32_bf16 v[48:51], v[192:195], v[168:171], v[48:51]
    buffer_load_dwordx4 v[140:143], v6, s[8:11], s40 offen sc1
    v_mfma_f32_16x16x32_bf16 v[52:55], v[192:195], v[172:175], v[52:55]
    v_mfma_f32_16x16x32_bf16 v[56:59], v[192:195], v[176:179], v[56:59]
    buffer_load_dwordx4 v[156:159], v8, s[8:11], s41 offen offset:2048 sc1
    s_waitcnt vmcnt(27)
    v_mfma_f32_16x16x32_bf16 v[28:31], v[184:187], v[180:183], v[28:31]
    buffer_load_dwordx4 v[144:147], v7, s[8:11], s40 offen sc1
    v_mfma_f32_16x16x32_bf16 v[44:47], v[188:191], v[180:183], v[44:47]
    buffer_load_dwordx4 v[160:163], v8, s[8:11], s41 offen offset:3072 sc1
    v_mfma_f32_16x16x32_bf16 v[60:63], v[192:195], v[180:183], v[60:63]
    s_add_u32 s40, s40, 4096
    s_waitcnt vmcnt(28)
    v_mfma_f32_16x16x32_bf16 v[64:67], v[196:199], v[168:171], v[64:67]
    buffer_load_dwordx4 v[164:167], v9, s[8:11], s41 offen sc1
    v_mfma_f32_16x16x32_bf16 v[68:71], v[196:199], v[172:175], v[68:71]
    s_add_u32 s41, s41, 20480
    v_mfma_f32_16x16x32_bf16 v[72:75], v[196:199], v[176:179], v[72:75]
    v_mfma_f32_16x16x32_bf16 v[76:79], v[196:199], v[180:183], v[76:79]
    s_waitcnt vmcnt(28)
    v_mfma_f32_16x16x32_bf16 v[80:83], v[200:203], v[168:171], v[80:83]
    v_mfma_f32_16x16x32_bf16 v[84:87], v[200:203], v[172:175], v[84:87]
    v_mfma_f32_16x16x32_bf16 v[88:91], v[200:203], v[176:179], v[88:91]
    v_mfma_f32_16x16x32_bf16 v[92:95], v[200:203], v[180:183], v[92:95]
    s_mov_b32 s40, s42
    s_mov_b32 s41, s43
    s_waitcnt vmcnt(18)
    s_mov_b32 s47, 0
KC_poll:
    v_cmp_ne_u32 vcc, 1, v3
    s_add_u32 s47, s47, 1
    s_cmp_gt_u32 s47, 0x40000
    s_cbranch_scc1 KC_polled
    s_cbranch_vccz KC_polled
    s_branch KC_slow
KC_polled:
    v_mfma_f32_16x16x32_bf16 v[16:19], v[220:223], v[204:207], v[16:19]
    v_mfma_f32_16x16x32_bf16 v[20:23], v[220:223], v[208:211], v[20:23]
    v_mfma_f32_16x16x32_bf16 v[32:35], v[224:227], v[204:207], v[32:35]
    buffer_load_dwordx4 v[168:171], v4, s[8:11], s40 offen sc1
    v_mfma_f32_16x16x32_bf16 v[36:39], v[224:227], v[208:211], v[36:39]
    buffer_load_dwordx4 v[184:187], v8, s[8:11], s41 offen offset:0 sc1
    v_mfma_f32_16x16x32_bf16 v[24:27], v[220:223], v[212:215], v[24:27]
    buffer_load_dwordx4 v[172:175], v5, s[8:11], s40 offen sc1
    v_mfma_f32_16x16x32_bf16 v[40:43], v[224:227], v[212:215], v[40:43]
    buffer_load_dwordx4 v[188:191], v8, s[8:11], s41 offen offset:1024 sc1
    v_mfma_f32_16x16x32_bf16 v[48:51], v[228:231], v[204:207], v[48:51]
    buffer_load_dwordx4 v[176:179], v6, s[8:11], s40 offen sc1
    v_mfma_f32_16x16x32_bf16 v[52:55], v[228:231], v[208:211], v[52:55]
    v_mfma_f32_16x16x32_bf16 v[56:59], v[228:231], v[212:215], v[56:59]
    buffer_load_dwordx4 v[192:195], v8, s[8:11], s41 offen offset:2048 sc1
    v_mfma_f32_16x16x32_bf16 v[28:31], v[220:223], v[216:219], v[28:31]
    buffer_load_dwordx4 v[180:183], v7, s[8:11], s40 offen sc1
    v_mfma_f32_16x16x32_bf16 v[44:47], v[224:227], v[216:219], v[44:47]
    buffer_load_dwordx4 v[196:199], v8, s[8:11], s41 offen offset:3072 sc1
    v_mfma_f32_16x16x32_bf16 v[60:63], v[228:231], v[216:219], v[60:63]
    s_add_u32 s40, s40, 4096
    v_mfma_f32_16x16x32_bf16 v[64:67], v[232:235], v[204:207], v[64:67]
    buffer_load_dwordx4 v[200:203], v9, s[8:11], s41 offen sc1
    v_mfma_f32_16x16x32_bf16 v[68:71], v[232:235], v[208:211], v[68:71]
    s_add_u32 s41, s41, 20480
    v_mfma_f32_16x16x32_bf16 v[72:75], v[232:235], v[212:215], v[72:75]
    v_mfma_f32_16x16x32_bf16 v[76:79], v[232:235], v[216:219], v[76:79]
    v_mfma_f32_16x16x32_bf16 v[80:83], v[236:239], v[204:207], v[80:83]
    v_mfma_f32_16x16x32_bf16 v[84:87], v[236:239], v[208:211], v[84:87]
    v_mfma_f32_16x16x32_bf16 v[88:91], v[236:239], v[212:215], v[88:91]
    v_mfma_f32_16x16x32_bf16 v[92:95], v[236:239], v[216:219], v[92:95]
    s_waitcnt vmcnt(25)
    v_mfma_f32_16x16x32_bf16 v[16:19], v[112:115], v[96:99], v[16:19]
    s_waitcnt vmcnt(24)
    v_mfma_f32_16x16x32_bf16 v[20:23], v[112:115], v[100:103], v[20:23]
    s_waitcnt vmcnt(23)
    v_mfma_f32_16x16x32_bf16 v[32:35], v[116:119], v[96:99], v[32:35]
    buffer_load_dwordx4 v[204:207], v4, s[8:11], s40 offen sc1
    v_mfma_f32_16x16x32_bf16 v[36:39], v[116:119], v[100:103], v[36:39]
    buffer_load_dwordx4 v[220:223], v8, s[8:11], s41 offen offset:0 sc1
    s_waitcnt vmcnt(24)
    v_mfma_f32_16x16x32_bf16 v[24:27], v[112:115], v[104:107], v[24:27]
    buffer_load_dwordx4 v[208:211], v5, s[8:11], s40 offen sc1
    v_mfma_f32_16x16x32_bf16 v[40:43], v[116:119], v[104:107], v[40:43]
    buffer_load_dwordx4 v[224:227], v8, s[8:11], s41 offen offset:1024 sc1
    s_waitcnt vmcnt(25)
    v_mfma_f32_16x16x32_bf16 v[48:51], v[120:123], v[96:99], v[48:51]
    buffer_load_dwordx4 v[212:215], v6, s[8:11], s40 offen sc1
    v_mfma_f32_16x16x32_bf16 v[52:55], v[120:123], v[100:103], v[52:55]
    v_mfma_f32_16x16x32_bf16 v[56:59], v[120:123], v[104:107], v[56:59]
    buffer_load_dwordx4 v[228:231], v8, s[8:11], s41 offen offset:2048 sc1
    s_waitcnt vmcnt(26)
    v_mfma_f32_16x16x32_bf16 v[28:31], v[112:115], v[108:111], v[28:31]
    buffer_load_dwordx4 v[216:219], v7, s[8:11], s40 offen sc1
    v_mfma_f32_16x16x32_bf16 v[44:47], v[116:119], v[108:111], v[44:47]
    buffer_load_dwordx4 v[232:235], v8, s[8:11], s41 offen offset:3072 sc1
    v_mfma_f32_16x16x32_bf16 v[60:63], v[120:123], v[108:111], v[60:63]
    s_add_u32 s40, s40, 4096
    s_waitcnt vmcnt(27)
    v_mfma_f32_16x16x32_bf16 v[64:67], v[124:127], v[96:99], v[64:67]
    buffer_load_dwordx4 v[236:239], v9, s[8:11], s41 offen sc1
    v_mfma_f32_16x16x32_bf16 v[68:71], v[124:127], v[100:103], v[68:71]
    s_add_u32 s41, s41, 20480
    v_mfma_f32_16x16x32_bf16 v[72:75], v[124:127], v[104:107], v[72:75]
    v_mfma_f32_16x16x32_bf16 v[76:79], v[124:127], v[108:111], v[76:79]
    s_waitcnt vmcnt(27)
    v_mfma_f32_16x16x32_bf16 v[80:83], v[128:131], v[96:99], v[80:83]
    v_mfma_f32_16x16x32_bf16 v[84:87], v[128:131], v[100:103], v[84:87]
    v_mfma_f32_16x16x32_bf16 v[88:91], v[128:131], v[104:107], v[88:91]
    v_mfma_f32_16x16x32_bf16 v[92:95], v[128:131], v[108:111], v[92:95]
    s_waitcnt vmcnt(25)
    v_mfma_f32_16x16x32_bf16 v[16:19], v[148:151], v[132:135], v[16:19]
    s_waitcnt vmcnt(24)
    v_mfma_f32_16x16x32_bf16 v[20:23], v[148:151], v[136:139], v[20:23]
    s_waitcnt vmcnt(23)
    v_mfma_f32_16x16x32_bf16 v[32:35], v[152:155], v[132:135], v[32:35]
    buffer_load_dwordx4 v[96:99], v4, s[8:11], s40 offen sc1
    v_mfma_f32_16x16x32_bf16 v[36:39], v[152:155], v[136:139], v[36:39]
    buffer_load_dwordx4 v[112:115], v8, s[8:11], s41 offen offset:0 sc1
    s_waitcnt vmcnt(24)
    v_mfma_f32_16x16x32_bf16 v[24:27], v[148:151], v[140:143], v[24:27]
    buffer_load_dwordx4 v[100:103], v5, s[8:11], s40 offen sc1
    v_mfma_f32_16x16x32_bf16 v[40:43], v[152:155], v[140:143], v[40:43]
    buffer_load_dwordx4 v[116:119], v8, s[8:11], s41 offen offset:1024 sc1
    s_waitcnt vmcnt(25)
    v_mfma_f32_16x16x32_bf16 v[48:51], v[156:159], v[132:135], v[48:51]
    buffer_load_dwordx4 v[104:107], v6, s[8:11], s40 offen sc1
    v_mfma_f32_16x16x32_bf16 v[52:55], v[156:159], v[136:139], v[52:55]
    v_mfma_f32_16x16x32_bf16 v[56:59], v[156:159], v[140:143], v[56:59]
    buffer_load_dwordx4 v[120:123], v8, s[8:11], s41 offen offset:2048 sc1
    s_waitcnt vmcnt(26)
    v_mfma_f32_16x16x32_bf16 v[28:31], v[148:151], v[144:147], v[28:31]
    buffer_load_dwordx4 v[108:111], v7, s[8:11], s40 offen sc1
    v_mfma_f32_16x16x32_bf16 v[44:47], v[152:155], v[144:147], v[44:47]
    buffer_load_dwordx4 v[124:127], v8, s[8:11], s41 offen offset:3072 sc1
    v_mfma_f32_16x16x32_bf16 v[60:63], v[156:159], v[144:147], v[60:63]
    s_add_u32 s40, s40, 4096
    s_waitcnt vmcnt(27)
    v_mfma_f32_16x16x32_bf16 v[64:67], v[160:163], v[132:135], v[64:67]
    buffer_load_dwordx4 v[128:131], v9, s[8:11], s41 offen sc1
    v_mfma_f32_16x16x32_bf16 v[68:71], v[160:163], v[136:139], v[68:71]
    s_add_u32 s41, s41, 20480
    v_mfma_f32_16x16x32_bf16 v[72:75], v[160:163], v[140:143], v[72:75]
    v_mfma_f32_16x16x32_bf16 v[76:79], v[160:163], v[144:147], v[76:79]
    s_waitcnt vmcnt(27)
    v_mfma_f32_16x16x32_bf16 v[80:83], v[164:167], v[132:135], v[80:83]
    v_mfma_f32_16x16x32_bf16 v[84:87], v[164:167], v[136:139], v[84:87]
    v_mfma_f32_16x16x32_bf16 v[88:91], v[164:167], v[140:143], v[88:91]
    v_mfma_f32_16x16x32_bf16 v[92:95], v[164:167], v[144:147], v[92:95]
    s_waitcnt vmcnt(25)
    v_mfma_f32_16x16x32_bf16 v[16:19], v[184:187], v[168:171], v[16:19]
    s_waitcnt vmcnt(24)
    v_mfma_f32_16x16x32_bf16 v[20:23], v[184:187], v[172:175], v[20:23]
    s_waitcnt vmcnt(23)
    v_mfma_f32_16x16x32_bf16 v[32:35], v[188:191], v[168:171], v[32:35]
    buffer_load_dwordx4 v[132:135], v4, s[8:11], s40 offen sc1
    v_mfma_f32_16x16x32_bf16 v[36:39], v[188:191], v[172:175], v[36:39]
    buffer_load_dwordx4 v[148:151], v8, s[8:11], s41 offen offset:0 sc1
    s_waitcnt vmcnt(24)
    v_mfma_f32_16x16x32_bf16 v[24:27], v[184:187], v[176:179], v[24:27]
    buffer_load_dwordx4 v[136:139], v5, s[8:11], s40 offen sc1
    v_mfma_f32_16x16x32_bf16 v[40:43], v[188:191], v[176:179], v[40:43]
    buffer_load_dwordx4 v[152:155], v8, s[8:11], s41 offen offset:1024 sc1
    s_waitcnt vmcnt(25)
    v_mfma_f32_16x16x32_bf16 v[48:51], v[192:195], v[168:171], v[48:51]
    buffer_load_dwordx4 v[140:143], v6, s[8:11], s40 offen sc1
    v_mfma_f32_16x16x32_bf16 v[52:55], v[192:195], v[172:175], v[52:55]
    v_mfma_f32_16x16x32_bf16 v[56:59], v[192:195], v[176:179], v[56:59]
    buffer_load_dwordx4 v[156:159], v8, s[8:11], s41 offen offset:2048 sc1
    s_waitcnt vmcnt(26)
    v_mfma_f32_16x16x32_bf16 v[28:31], v[184:187], v[180:183], v[28:31]
    buffer_load_dwordx4 v[144:147], v7, s[8:11], s40 offen sc1
    v_mfma_f32_16x16x32_bf16 v[44:47], v[188:191], v[180:183], v[44:47]
    buffer_load_dwordx4 v[160:163], v8, s[8:11], s41 offen offset:3072 sc1
    v_mfma_f32_16x16x32_bf16 v[60:63], v[192:195], v[180:183], v[60:63]
    s_add_u32 s40, s40, 4096
    s_waitcnt vmcnt(27)
    v_mfma_f32_16x16x32_bf16 v[64:67], v[196:199], v[168:171], v[64:67]
    buffer_load_dwordx4 v[164:167], v9, s[8:11], s41 offen sc1
    v_mfma_f32_16x16x32_bf16 v[68:71], v[196:199], v[172:175], v[68:71]
    s_add_u32 s41, s41, 20480
    v_mfma_f32_16x16x32_bf16 v[72:75], v[196:199], v[176:179], v[72:75]
    v_mfma_f32_16x16x32_bf16 v[76:79], v[196:199], v[180:183], v[76:79]
    s_waitcnt vmcnt(27)
    v_mfma_f32_16x16x32_bf16 v[80:83], v[200:203], v[168:171], v[80:83]
    v_mfma_f32_16x16x32_bf16 v[84:87], v[200:203], v[172:175], v[84:87]
    v_mfma_f32_16x16x32_bf16 v[88:91], v[200:203], v[176:179], v[88:91]
    v_mfma_f32_16x16x32_bf16 v[92:95], v[200:203], v[180:183], v[92:95]
    s_cmp_lt_u32 s32, 2
    s_cselect_b32 s40, s40, 0x7f000000
    s_cselect_b32 s41, s41, 0x7f000000
    s_waitcnt vmcnt(25)
    v_mfma_f32_16x16x32_bf16 v[16:19], v[220:223], v[204:207], v[16:19]
    s_waitcnt vmcnt(24)
    v_mfma_f32_16x16x32_bf16 v[20:23], v[220:223], v[208:211], v[20:23]
    s_waitcnt vmcnt(23)
    v_mfma_f32_16x16x32_bf16 v[32:35], v[224:227], v[204:207], v[32:35]
    buffer_load_dwordx4 v[168:171], v4, s[8:11], s40 offen sc1
    v_mfma_f32_16x16x32_bf16 v[36:39], v[224:227], v[208:211], v[36:39]
    buffer_load_dwordx4 v[184:187], v8, s[8:11], s41 offen offset:0 sc1
    s_waitcnt vmcnt(24)
    v_mfma_f32_16x16x32_bf16 v[24:27], v[220:223], v[212:215], v[24:27]
    buffer_load_dwordx4 v[172:175], v5, s[8:11], s40 offen sc1
    v_mfma_f32_16x16x32_bf16 v[40:43], v[224:227], v[212:215], v[40:43]
    buffer_load_dwordx4 v[188:191], v8, s[8:11], s41 offen offset:1024 sc1
    s_waitcnt vmcnt(25)
    v_mfma_f32_16x16x32_bf16 v[48:51], v[228:231], v[204:207], v[48:51]
    buffer_load_dwordx4 v[176:179], v6, s[8:11], s40 offen sc1
    v_mfma_f32_16x16x32_bf16 v[52:55], v[228:231], v[208:211], v[52:55]
    v_mfma_f32_16x16x32_bf16 v[56:59], v[228:231], v[212:215], v[56:59]
    buffer_load_dwordx4 v[192:195], v8, s[8:11], s41 offen offset:2048 sc1
    s_waitcnt vmcnt(26)
    v_mfma_f32_16x16x32_bf16 v[28:31], v[220:223], v[216:219], v[28:31]
    buffer_load_dwordx4 v[180:183], v7, s[8:11], s40 offen sc1
    v_mfma_f32_16x16x32_bf16 v[44:47], v[224:227], v[216:219], v[44:47]
    buffer_load_dwordx4 v[196:199], v8, s[8:11], s41 offen offset:3072 sc1
    v_mfma_f32_16x16x32_bf16 v[60:63], v[228:231], v[216:219], v[60:63]
    s_add_u32 s40, s40, 4096
    s_waitcnt vmcnt(27)
    v_mfma_f32_16x16x32_bf16 v[64:67], v[232:235], v[204:207], v[64:67]
    buffer_load_dwordx4 v[200:203], v9, s[8:11], s41 offen sc1
    v_mfma_f32_16x16x32_bf16 v[68:71], v[232:235], v[208:211], v[68:71]
    s_add_u32 s41, s41, 20480
    v_mfma_f32_16x16x32_bf16 v[72:75], v[232:235], v[212:215], v[72:75]
    v_mfma_f32_16x16x32_bf16 v[76:79], v[232:235], v[216:219], v[76:79]
    s_waitcnt vmcnt(27)
    v_mfma_f32_16x16x32_bf16 v[80:83], v[236:239], v[204:207], v[80:83]
    v_mfma_f32_16x16x32_bf16 v[84:87], v[236:239], v[208:211], v[84:87]
    v_mfma_f32_16x16x32_bf16 v[88:91], v[236:239], v[212:215], v[88:91]
    v_mfma_f32_16x16x32_bf16 v[92:95], v[236:239], v[216:219], v[92:95]
    s_waitcnt vmcnt(25)
    v_mfma_f32_16x16x32_bf16 v[16:19], v[112:115], v[96:99], v[16:19]
    s_waitcnt vmcnt(24)
    v_mfma_f32_16x16x32_bf16 v[20:23], v[112:115], v[100:103], v[20:23]
    s_waitcnt vmcnt(23)
    v_mfma_f32_16x16x32_bf16 v[32:35], v[116:119], v[96:99], v[32:35]
    v_mfma_f32_16x16x32_bf16 v[36:39], v[116:119], v[100:103], v[36:39]
    s_waitcnt vmcnt(22)
    v_mfma_f32_16x16x32_bf16 v[24:27], v[112:115], v[104:107], v[24:27]
    v_mfma_f32_16x16x32_bf16 v[40:43], v[116:119], v[104:107], v[40:43]
    s_waitcnt vmcnt(21)
    v_mfma_f32_16x16x32_bf16 v[48:51], v[120:123], v[96:99], v[48:51]
    v_mfma_f32_16x16x32_bf16 v[52:55], v[120:123], v[100:103], v[52:55]
    v_mfma_f32_16x16x32_bf16 v[56:59], v[120:123], v[104:107], v[56:59]
    s_waitcnt vmcnt(20)
    v_mfma_f32_16x16x32_bf16 v[28:31], v[112:115], v[108:111], v[28:31]
    v_mfma_f32_16x16x32_bf16 v[44:47], v[116:119], v[108:111], v[44:47]
    v_mfma_f32_16x16x32_bf16 v[60:63], v[120:123], v[108:111], v[60:63]
    s_waitcnt vmcnt(19)
    v_mfma_f32_16x16x32_bf16 v[64:67], v[124:127], v[96:99], v[64:67]
    v_mfma_f32_16x16x32_bf16 v[68:71], v[124:127], v[100:103], v[68:71]
    v_mfma_f32_16x16x32_bf16 v[72:75], v[124:127], v[104:107], v[72:75]
    v_mfma_f32_16x16x32_bf16 v[76:79], v[124:127], v[108:111], v[76:79]
    s_waitcnt vmcnt(18)
    v_mfma_f32_16x16x32_bf16 v[80:83], v[128:131], v[96:99], v[80:83]
    v_mfma_f32_16x16x32_bf16 v[84:87], v[128:131], v[100:103], v[84:87]
    v_mfma_f32_16x16x32_bf16 v[88:91], v[128:131], v[104:107], v[88:91]
    v_mfma_f32_16x16x32_bf16 v[92:95], v[128:131], v[108:111], v[92:95]
    s_waitcnt vmcnt(16)
    v_mfma_f32_16x16x32_bf16 v[16:19], v[148:151], v[132:135], v[16:19]
    s_waitcnt vmcnt(15)
    v_mfma_f32_16x16x32_bf16 v[20:23], v[148:151], v[136:139], v[20:23]
    s_waitcnt vmcnt(14)
    v_mfma_f32_16x16x32_bf16 v[32:35], v[152:155], v[132:135], v[32:35]
    v_mfma_f32_16x16x32_bf16 v[36:39], v[152:155], v[136:139], v[36:39]
    s_waitcnt vmcnt(13)
    v_mfma_f32_16x16x32_bf16 v[24:27], v[148:151], v[140:143], v[24:27]
    v_mfma_f32_16x16x32_bf16 v[40:43], v[152:155], v[140:143], v[40:43]
    s_waitcnt vmcnt(12)
    v_mfma_f32_16x16x32_bf16 v[48:51], v[156:159], v[132:135], v[48:51]
    v_mfma_f32_16x16x32_bf16 v[52:55], v[156:159], v[136:139], v[52:55]
    v_mfma_f32_16x16x32_bf16 v[56:59], v[156:159], v[140:143], v[56:59]
    s_waitcnt vmcnt(11)
    v_mfma_f32_16x16x32_bf16 v[28:31], v[148:151], v[144:147], v[28:31]
    v_mfma_f32_16x16x32_bf16 v[44:47], v[152:155], v[144:147], v[44:47]
    v_mfma_f32_16x16x32_bf16 v[60:63], v[156:159], v[144:147], v[60:63]
    s_waitcnt vmcnt(10)
    v_mfma_f32_16x16x32_bf16 v[64:67], v[160:163], v[132:135], v[64:67]
    v_mfma_f32_16x16x32_bf16 v[68:71], v[160:163], v[136:139], v[68:71]
    v_mfma_f32_16x16x32_bf16 v[72:75], v[160:163], v[140:143], v[72:75]
    v_mfma_f32_16x16x32_bf16 v[76:79], v[160:163], v[144:147], v[76:79]
    s_waitcnt vmcnt(9)
    v_mfma_f32_16x16x32_bf16 v[80:83], v[164:167], v[132:135], v[80:83]
    v_mfma_f32_16x16x32_bf16 v[84:87], v[164:167], v[136:139], v[84:87]
    v_mfma_f32_16x16x32_bf16 v[88:91], v[164:167], v[140:143], v[88:91]
    v_mfma_f32_16x16x32_bf16 v[92:95], v[164:167], v[144:147], v[92:95]
    s_waitcnt vmcnt(0)
KC_join:
    v_mfma_f32_16x16x32_bf16 v[20:23], v[184:187], v[172:175], v[20:23]
    v_mfma_f32_16x16x32_bf16 v[36:39], v[188:191], v[172:175], v[36:39]
    v_mfma_f32_16x16x32_bf16 v[24:27], v[184:187], v[176:179], v[24:27]
    v_mfma_f32_16x16x32_bf16 v[40:43], v[188:191], v[176:179], v[40:43]
    v_mfma_f32_16x16x32_bf16 v[52:55], v[192:195], v[172:175], v[52:55]
    v_mfma_f32_16x16x32_bf16 v[56:59], v[192:195], v[176:179], v[56:59]
    v_mfma_f32_16x16x32_bf16 v[28:31], v[184:187], v[180:183], v[28:31]
    v_mfma_f32_16x16x32_bf16 v[44:47], v[188:191], v[180:183], v[44:47]
    v_mfma_f32_16x16x32_bf16 v[60:63], v[192:195], v[180:183], v[60:63]
    ds_write_b128 v10, v[20:23] offset:0
    v_mfma_f32_16x16x32_bf16 v[68:71], v[196:199], v[172:175], v[68:71]
    ds_write_b128 v10, v[36:39] offset:1024
    v_mfma_f32_16x16x32_bf16 v[72:75], v[196:199], v[176:179], v[72:75]
    ds_write_b128 v11, v[24:27] offset:5120
    v_mfma_f32_16x16x32_bf16 v[76:79], v[196:199], v[180:183], v[76:79]
    ds_write_b128 v11, v[40:43] offset:6144
    v_mfma_f32_16x16x32_bf16 v[84:87], v[200:203], v[172:175], v[84:87]
    ds_write_b128 v10, v[52:55] offset:2048
    v_mfma_f32_16x16x32_bf16 v[88:91], v[200:203], v[176:179], v[88:91]
    ds_write_b128 v11, v[56:59] offset:7168
    v_mfma_f32_16x16x32_bf16 v[92:95], v[200:203], v[180:183], v[92:95]
    ds_write_b128 v12, v[28:31] offset:10240
    v_mfma_f32_16x16x32_bf16 v[16:19], v[184:187], v[168:171], v[16:19]
    ds_write_b128 v12, v[44:47] offset:11264
    v_mfma_f32_16x16x32_bf16 v[32:35], v[188:191], v[168:171], v[32:35]
    ds_write_b128 v12, v[60:63] offset:12288
    v_mfma_f32_16x16x32_bf16 v[48:51], v[192:195], v[168:171], v[48:51]
    ds_write_b128 v10, v[68:71] offset:3072
    v_mfma_f32_16x16x32_bf16 v[64:67], v[196:199], v[168:171], v[64:67]
    ds_write_b128 v11, v[72:75] offset:8192
    v_mfma_f32_16x16x32_bf16 v[80:83], v[200:203], v[168:171], v[80:83]
    ds_write_b128 v12, v[76:79] offset:13312
    ds_write_b128 v10, v[84:87] offset:4096
    ds_write_b128 v11, v[88:91] offset:9216
    ds_write_b128 v12, v[92:95] offset:14336
    s_waitcnt lgkmcnt(0)
    s_barrier
    ds_read_b128 v[96:99], v13 offset:0
    ds_read_b128 v[100:103], v13 offset:5120
    ds_read_b128 v[104:107], v13 offset:10240
    ds_read_b128 v[108:111], v13 offset:1024
    ds_read_b128 v[112:115], v13 offset:6144
    ds_read_b128 v[116:119], v13 offset:11264
    ds_read_b128 v[120:123], v13 offset:2048
    ds_read_b128 v[124:127], v13 offset:7168
    ds_read_b128 v[128:131], v13 offset:12288
    ds_read_b128 v[132:135], v13 offset:3072
    ds_read_b128 v[136:139], v13 offset:8192
    ds_read_b128 v[140:143], v13 offset:13312
    ds_read_b128 v[144:147], v13 offset:4096
    ds_read_b128 v[148:151], v13 offset:9216
    ds_read_b128 v[152:155], v13 offset:14336
    s_waitcnt lgkmcnt(14)
    v_add_f32 v16, v16, v96
    v_add_f32 v17, v17, v97
    v_add_f32 v18, v18, v98
    v_add_f32 v19, v19, v99
    s_waitcnt lgkmcnt(12)
    v_add_f32 v100, v100, v104
    v_add_f32 v101, v101, v105
    v_add_f32 v102, v102, v106
    v_add_f32 v103, v103, v107
    v_add_f32 v16, v16, v100
    v_add_f32 v17, v17, v101
    v_add_f32 v18, v18, v102
    v_add_f32 v19, v19, v103
    v_cvt_pk_bf16_f32 v160, v16, v17
    v_cvt_pk_bf16_f32 v161, v18, v19
    s_waitcnt lgkmcnt(11)
    v_add_f32 v32, v32, v108
    v_add_f32 v33, v33, v109
    v_add_f32 v34, v34, v110
    v_add_f32 v35, v35, v111
    s_waitcnt lgkmcnt(9)
    v_add_f32 v112, v112, v116
    v_add_f32 v113, v113, v117
    v_add_f32 v114, v114, v118
    v_add_f32 v115, v115, v119
    v_add_f32 v32, v32, v112
    v_add_f32 v33, v33, v113
    v_add_f32 v34, v34, v114
    v_add_f32 v35, v35, v115
    v_cvt_pk_bf16_f32 v162, v32, v33
    v_cvt_pk_bf16_f32 v163, v34, v35
    buffer_store_dwordx4 v[160:163], v14, s[12:15], s46 offen offset:0
    s_waitcnt lgkmcnt(8)
    v_add_f32 v48, v48, v120
    v_add_f32 v49, v49, v121
    v_add_f32 v50, v50, v122
    v_add_f32 v51, v51, v123
    s_waitcnt lgkmcnt(6)
    v_add_f32 v124, v124, v128
    v_add_f32 v125, v125, v129
    v_add_f32 v126, v126, v130
    v_add_f32 v127, v127, v131
    v_add_f32 v48, v48, v124
    v_add_f32 v49, v49, v125
    v_add_f32 v50, v50, v126
    v_add_f32 v51, v51, v127
    v_cvt_pk_bf16_f32 v164, v48, v49
    v_cvt_pk_bf16_f32 v165, v50, v51
    s_waitcnt lgkmcnt(5)
    v_add_f32 v64, v64, v132
    v_add_f32 v65, v65, v133
    v_add_f32 v66, v66, v134
    v_add_f32 v67, v67, v135
    s_waitcnt lgkmcnt(3)
    v_add_f32 v136, v136, v140
    v_add_f32 v137, v137, v141
    v_add_f32 v138, v138, v142
    v_add_f32 v139, v139, v143
    v_add_f32 v64, v64, v136
    v_add_f32 v65, v65, v137
    v_add_f32 v66, v66, v138
    v_add_f32 v67, v67, v139
    v_cvt_pk_bf16_f32 v166, v64, v65
    v_cvt_pk_bf16_f32 v167, v66, v67
    buffer_store_dwordx4 v[164:167], v14, s[12:15], s46 offen offset:64
    s_waitcnt lgkmcnt(2)
    v_add_f32 v80, v80, v144
    v_add_f32 v81, v81, v145
    v_add_f32 v82, v82, v146
    v_add_f32 v83, v83, v147
    s_waitcnt lgkmcnt(0)
    v_add_f32 v148, v148, v152
    v_add_f32 v149, v149, v153
    v_add_f32 v150, v150, v154
    v_add_f32 v151, v151, v155
    v_add_f32 v80, v80, v148
    v_add_f32 v81, v81, v149
    v_add_f32 v82, v82, v150
    v_add_f32 v83, v83, v151
    v_cvt_pk_bf16_f32 v168, v80, v81
    v_cvt_pk_bf16_f32 v169, v82, v83
    s_mov_b32 exec_hi, 0
    buffer_store_dwordx2 v[168:169], v15, s[12:15], s46 offen offset:128
    s_endpgm
KC_slow:
    v_mfma_f32_16x16x32_bf16 v[16:19], v[220:223], v[204:207], v[16:19]
    v_mfma_f32_16x16x32_bf16 v[20:23], v[220:223], v[208:211], v[20:23]
    v_mfma_f32_16x16x32_bf16 v[32:35], v[224:227], v[204:207], v[32:35]
    v_mfma_f32_16x16x32_bf16 v[36:39], v[224:227], v[208:211], v[36:39]
    buffer_load_dwordx4 v[184:187], v8, s[8:11], s41 offen offset:0 sc1
    v_mfma_f32_16x16x32_bf16 v[24:27], v[220:223], v[212:215], v[24:27]
    v_mfma_f32_16x16x32_bf16 v[40:43], v[224:227], v[212:215], v[40:43]
    buffer_load_dwordx4 v[188:191], v8, s[8:11], s41 offen offset:1024 sc1
    v_mfma_f32_16x16x32_bf16 v[48:51], v[228:231], v[204:207], v[48:51]
    v_mfma_f32_16x16x32_bf16 v[52:55], v[228:231], v[208:211], v[52:55]
    buffer_load_dwordx4 v[192:195], v8, s[8:11], s41 offen offset:2048 sc1
    v_mfma_f32_16x16x32_bf16 v[56:59], v[228:231], v[212:215], v[56:59]
    v_mfma_f32_16x16x32_bf16 v[28:31], v[220:223], v[216:219], v[28:31]
    buffer_load_dwordx4 v[196:199], v8, s[8:11], s41 offen offset:3072 sc1
    v_mfma_f32_16x16x32_bf16 v[44:47], v[224:227], v[216:219], v[44:47]
    v_mfma_f32_16x16x32_bf16 v[60:63], v[228:231], v[216:219], v[60:63]
    buffer_load_dwordx4 v[200:203], v9, s[8:11], s41 offen sc1
    v_mfma_f32_16x16x32_bf16 v[64:67], v[232:235], v[204:207], v[64:67]
    v_mfma_f32_16x16x32_bf16 v[68:71], v[232:235], v[208:211], v[68:71]
    s_add_u32 s41, s41, 20480
    v_mfma_f32_16x16x32_bf16 v[72:75], v[232:235], v[212:215], v[72:75]
    v_mfma_f32_16x16x32_bf16 v[76:79], v[232:235], v[216:219], v[76:79]
    v_mfma_f32_16x16x32_bf16 v[80:83], v[236:239], v[204:207], v[80:83]
    v_mfma_f32_16x16x32_bf16 v[84:87], v[236:239], v[208:211], v[84:87]
    v_mfma_f32_16x16x32_bf16 v[88:91], v[236:239], v[212:215], v[88:91]
    v_mfma_f32_16x16x32_bf16 v[92:95], v[236:239], v[216:219], v[92:95]
    s_waitcnt vmcnt(21)
    v_mfma_f32_16x16x32_bf16 v[16:19], v[112:115], v[96:99], v[16:19]
    s_waitcnt vmcnt(20)
    v_mfma_f32_16x16x32_bf16 v[20:23], v[112:115], v[100:103], v[20:23]
    s_waitcnt vmcnt(19)
    v_mfma_f32_16x16x32_bf16 v[32:35], v[116:119], v[96:99], v[32:35]
    v_mfma_f32_16x16x32_bf16 v[36:39], v[116:119], v[100:103], v[36:39]
    buffer_load_dwordx4 v[220:223], v8, s[8:11], s41 offen offset:0 sc1
    s_waitcnt vmcnt(19)
    v_mfma_f32_16x16x32_bf16 v[24:27], v[112:115], v[104:107], v[24:27]
    v_mfma_f32_16x16x32_bf16 v[40:43], v[116:119], v[104:107], v[40:43]
    buffer_load_dwordx4 v[224:227], v8, s[8:11], s41 offen offset:1024 sc1
    s_waitcnt vmcnt(19)
    v_mfma_f32_16x16x32_bf16 v[48:51], v[120:123], v[96:99], v[48:51]
    v_mfma_f32_16x16x32_bf16 v[52:55], v[120:123], v[100:103], v[52:55]
    buffer_load_dwordx4 v[228:231], v8, s[8:11], s41 offen offset:2048 sc1
    v_mfma_f32_16x16x32_bf16 v[56:59], v[120:123], v[104:107], v[56:59]
    s_waitcnt vmcnt(19)
    v_mfma_f32_16x16x32_bf16 v[28:31], v[112:115], v[108:111], v[28:31]
    buffer_load_dwordx4 v[232:235], v8, s[8:11], s41 offen offset:3072 sc1
    v_mfma_f32_16x16x32_bf16 v[44:47], v[116:119], v[108:111], v[44:47]
    v_mfma_f32_16x16x32_bf16 v[60:63], v[120:123], v[108:111], v[60:63]
    buffer_load_dwordx4 v[236:239], v9, s[8:11], s41 offen sc1
    s_waitcnt vmcnt(20)
    v_mfma_f32_16x16x32_bf16 v[64:67], v[124:127], v[96:99], v[64:67]
    v_mfma_f32_16x16x32_bf16 v[68:71], v[124:127], v[100:103], v[68:71]
    s_add_u32 s41, s41, 20480
    v_mfma_f32_16x16x32_bf16 v[72:75], v[124:127], v[104:107], v[72:75]
    v_mfma_f32_16x16x32_bf16 v[76:79], v[124:127], v[108:111], v[76:79]
    s_waitcnt vmcnt(19)
    v_mfma_f32_16x16x32_bf16 v[80:83], v[128:131], v[96:99], v[80:83]
    v_mfma_f32_16x16x32_bf16 v[84:87], v[128:131], v[100:103], v[84:87]
    v_mfma_f32_16x16x32_bf16 v[88:91], v[128:131], v[104:107], v[88:91]
    v_mfma_f32_16x16x32_bf16 v[92:95], v[128:131], v[108:111], v[92:95]
    s_waitcnt vmcnt(17)
    v_mfma_f32_16x16x32_bf16 v[16:19], v[148:151], v[132:135], v[16:19]
    s_waitcnt vmcnt(16)
    v_mfma_f32_16x16x32_bf16 v[20:23], v[148:151], v[136:139], v[20:23]
    s_waitcnt vmcnt(15)
    v_mfma_f32_16x16x32_bf16 v[32:35], v[152:155], v[132:135], v[32:35]
    v_mfma_f32_16x16x32_bf16 v[36:39], v[152:155], v[136:139], v[36:39]
    buffer_load_dwordx4 v[112:115], v8, s[8:11], s41 offen offset:0 sc1
    s_waitcnt vmcnt(15)
    v_mfma_f32_16x16x32_bf16 v[24:27], v[148:151], v[140:143], v[24:27]
    v_mfma_f32_16x16x32_bf16 v[40:43], v[152:155], v[140:143], v[40:43]
    buffer_load_dwordx4 v[116:119], v8, s[8:11], s41 offen offset:1024 sc1
    s_waitcnt vmcnt(15)
    v_mfma_f32_16x16x32_bf16 v[48:51], v[156:159], v[132:135], v[48:51]
    v_mfma_f32_16x16x32_bf16 v[52:55], v[156:159], v[136:139], v[52:55]
    buffer_load_dwordx4 v[120:123], v8, s[8:11], s41 offen offset:2048 sc1
    v_mfma_f32_16x16x32_bf16 v[56:59], v[156:159], v[140:143], v[56:59]
    s_waitcnt vmcnt(15)
    v_mfma_f32_16x16x32_bf16 v[28:31], v[148:151], v[144:147], v[28:31]
    buffer_load_dwordx4 v[124:127], v8, s[8:11], s41 offen offset:3072 sc1
    v_mfma_f32_16x16x32_bf16 v[44:47], v[152:155], v[144:147], v[44:47]
    v_mfma_f32_16x16x32_bf16 v[60:63], v[156:159], v[144:147], v[60:63]
    buffer_load_dwordx4 v[128:131], v9, s[8:11], s41 offen sc1
    s_waitcnt vmcnt(16)
    v_mfma_f32_16x16x32_bf16 v[64:67], v[160:163], v[132:135], v[64:67]
    v_mfma_f32_16x16x32_bf16 v[68:71], v[160:163], v[136:139], v[68:71]
    s_add_u32 s41, s41, 20480
    v_mfma_f32_16x16x32_bf16 v[72:75], v[160:163], v[140:143], v[72:75]
    v_mfma_f32_16x16x32_bf16 v[76:79], v[160:163], v[144:147], v[76:79]
    s_waitcnt vmcnt(15)
    v_mfma_f32_16x16x32_bf16 v[80:83], v[164:167], v[132:135], v[80:83]
    v_mfma_f32_16x16x32_bf16 v[84:87], v[164:167], v[136:139], v[84:87]
    v_mfma_f32_16x16x32_bf16 v[88:91], v[164:167], v[140:143], v[88:91]
    v_mfma_f32_16x16x32_bf16 v[92:95], v[164:167], v[144:147], v[92:95]
    buffer_load_dwordx4 v[148:151], v8, s[8:11], s41 offen offset:0 sc1
    buffer_load_dwordx4 v[152:155], v8, s[8:11], s41 offen offset:1024 sc1
    buffer_load_dwordx4 v[156:159], v8, s[8:11], s41 offen offset:2048 sc1
    buffer_load_dwordx4 v[160:163], v8, s[8:11], s41 offen offset:3072 sc1
    buffer_load_dwordx4 v[164:167], v9, s[8:11], s41 offen sc1
    s_add_u32 s41, s41, 20480
    s_setprio 3
KC_spin:
    buffer_load_dword v3, v2, s[8:11], s45 offen sc1
    s_add_u32 s47, s47, 1
    s_waitcnt vmcnt(0)
    v_cmp_ne_u32 vcc, 1, v3
    s_cmp_gt_u32 s47, 0x40000
    s_cbranch_scc1 KC_spun
    s_cbranch_vccz KC_spun
    s_sleep 1
    s_branch KC_spin
KC_spun:
    buffer_load_dwordx4 v[168:171], v4, s[8:11], s40 offen sc1
    buffer_load_dwordx4 v[172:175], v5, s[8:11], s40 offen sc1
    buffer_load_dwordx4 v[176:179], v6, s[8:11], s40 offen sc1
    buffer_load_dwordx4 v[180:183], v7, s[8:11], s40 offen sc1
    s_add_u32 s40, s40, 4096
    buffer_load_dwordx4 v[204:207], v4, s[8:11], s40 offen sc1
    buffer_load_dwordx4 v[208:211], v5, s[8:11], s40 offen sc1
    buffer_load_dwordx4 v[212:215], v6, s[8:11], s40 offen sc1
    buffer_load_dwordx4 v[216:219], v7, s[8:11], s40 offen sc1
    s_add_u32 s40, s40, 4096
    buffer_load_dwordx4 v[96:99], v4, s[8:11], s40 offen sc1
    buffer_load_dwordx4 v[100:103], v5, s[8:11], s40 offen sc1
    buffer_load_dwordx4 v[104:107], v6, s[8:11], s40 offen sc1
    buffer_load_dwordx4 v[108:111], v7, s[8:11], s40 offen sc1
    s_add_u32 s40, s40, 4096
    buffer_load_dwordx4 v[132:135], v4, s[8:11], s40 offen sc1
    buffer_load_dwordx4 v[136:139], v5, s[8:11], s40 offen sc1
    buffer_load_dwordx4 v[140:143], v6, s[8:11], s40 offen sc1
    buffer_load_dwordx4 v[144:147], v7, s[8:11], s40 offen sc1
    s_add_u32 s40, s40, 4096
    s_cmp_lt_u32 s32, 2
    s_cselect_b32 s40, s40, 0x7f000000
    s_cselect_b32 s41, s41, 0x7f000000
    buffer_load_dwordx4 v[240:243], v4, s[8:11], s40 offen sc1
    buffer_load_dwordx4 v[244:247], v5, s[8:11], s40 offen sc1
    buffer_load_dwordx4 v[248:251], v6, s[8:11], s40 offen sc1
    buffer_load_dwordx4 v[252:255], v7, s[8:11], s40 offen sc1
    s_waitcnt vmcnt(19)
    v_mfma_f32_16x16x32_bf16 v[16:19], v[184:187], v[168:171], v[16:19]
    s_waitcnt vmcnt(18)
    v_mfma_f32_16x16x32_bf16 v[20:23], v[184:187], v[172:175], v[20:23]
    v_mfma_f32_16x16x32_bf16 v[32:35], v[188:191], v[168:171], v[32:35]
    v_mfma_f32_16x16x32_bf16 v[36:39], v[188:191], v[172:175], v[36:39]
    s_waitcnt vmcnt(17)
    v_mfma_f32_16x16x32_bf16 v[24:27], v[184:187], v[176:179], v[24:27]
    v_mfma_f32_16x16x32_bf16 v[40:43], v[188:191], v[176:179], v[40:43]
    v_mfma_f32_16x16x32_bf16 v[48:51], v[192:195], v[168:171], v[48:51]
    v_mfma_f32_16x16x32_bf16 v[52:55], v[192:195], v[172:175], v[52:55]
    v_mfma_f32_16x16x32_bf16 v[56:59], v[192:195], v[176:179], v[56:59]
    s_waitcnt vmcnt(16)
    v_mfma_f32_16x16x32_bf16 v[28:31], v[184:187], v[180:183], v[28:31]
    v_mfma_f32_16x16x32_bf16 v[44:47], v[188:191], v[180:183], v[44:47]
    v_mfma_f32_16x16x32_bf16 v[60:63], v[192:195], v[180:183], v[60:63]
    v_mfma_f32_16x16x32_bf16 v[64:67], v[196:199], v[168:171], v[64:67]
    v_mfma_f32_16x16x32_bf16 v[68:71], v[196:199], v[172:175], v[68:71]
    v_mfma_f32_16x16x32_bf16 v[72:75], v[196:199], v[176:179], v[72:75]
    v_mfma_f32_16x16x32_bf16 v[76:79], v[196:199], v[180:183], v[76:79]
    v_mfma_f32_16x16x32_bf16 v[80:83], v[200:203], v[168:171], v[80:83]
    v_mfma_f32_16x16x32_bf16 v[84:87], v[200:203], v[172:175], v[84:87]
    v_mfma_f32_16x16x32_bf16 v[88:91], v[200:203], v[176:179], v[88:91]
    v_mfma_f32_16x16x32_bf16 v[92:95], v[200:203], v[180:183], v[92:95]
    buffer_load_dwordx4 v[184:187], v8, s[8:11], s41 offen offset:0 sc1
    buffer_load_dwordx4 v[188:191], v8, s[8:11], s41 offen offset:1024 sc1
    buffer_load_dwordx4 v[192:195], v8, s[8:11], s41 offen offset:2048 sc1
    buffer_load_dwordx4 v[196:199], v8, s[8:11], s41 offen offset:3072 sc1
    buffer_load_dwordx4 v[200:203], v9, s[8:11], s41 offen sc1
    s_add_u32 s41, s41, 20480
    s_waitcnt vmcnt(20)
    v_mfma_f32_16x16x32_bf16 v[16:19], v[220:223], v[204:207], v[16:19]
    s_waitcnt vmcnt(19)
    v_mfma_f32_16x16x32_bf16 v[20:23], v[220:223], v[208:211], v[20:23]
    v_mfma_f32_16x16x32_bf16 v[32:35], v[224:227], v[204:207], v[32:35]
    v_mfma_f32_16x16x32_bf16 v[36:39], v[224:227], v[208:211], v[36:39]
    s_waitcnt vmcnt(18)
    v_mfma_f32_16x16x32_bf16 v[24:27], v[220:223], v[212:215], v[24:27]
    v_mfma_f32_16x16x32_bf16 v[40:43], v[224:227], v[212:215], v[40:43]
    v_mfma_f32_16x16x32_bf16 v[48:51], v[228:231], v[204:207], v[48:51]
    v_mfma_f32_16x16x32_bf16 v[52:55], v[228:231], v[208:211], v[52:55]
    v_mfma_f32_16x16x32_bf16 v[56:59], v[228:231], v[212:215], v[56:59]
    s_waitcnt vmcnt(17)
    v_mfma_f32_16x16x32_bf16 v[28:31], v[220:223], v[216:219], v[28:31]
    v_mfma_f32_16x16x32_bf16 v[44:47], v[224:227], v[216:219], v[44:47]
    v_mfma_f32_16x16x32_bf16 v[60:63], v[228:231], v[216:219], v[60:63]
    v_mfma_f32_16x16x32_bf16 v[64:67], v[232:235], v[204:207], v[64:67]
    v_mfma_f32_16x16x32_bf16 v[68:71], v[232:235], v[208:211], v[68:71]
    v_mfma_f32_16x16x32_bf16 v[72:75], v[232:235], v[212:215], v[72:75]
    v_mfma_f32_16x16x32_bf16 v[76:79], v[232:235], v[216:219], v[76:79]
    v_mfma_f32_16x16x32_bf16 v[80:83], v[236:239], v[204:207], v[80:83]
    v_mfma_f32_16x16x32_bf16 v[84:87], v[236:239], v[208:211], v[84:87]
    v_mfma_f32_16x16x32_bf16 v[88:91], v[236:239], v[212:215], v[88:91]
    v_mfma_f32_16x16x32_bf16 v[92:95], v[236:239], v[216:219], v[92:95]
    s_waitcnt vmcnt(16)
    v_mfma_f32_16x16x32_bf16 v[16:19], v[112:115], v[96:99], v[16:19]
    s_waitcnt vmcnt(15)
    v_mfma_f32_16x16x32_bf16 v[20:23], v[112:115], v[100:103], v[20:23]
    v_mfma_f32_16x16x32_bf16 v[32:35], v[116:119], v[96:99], v[32:35]
    v_mfma_f32_16x16x32_bf16 v[36:39], v[116:119], v[100:103], v[36:39]
    s_waitcnt vmcnt(14)
    v_mfma_f32_16x16x32_bf16 v[24:27], v[112:115], v[104:107], v[24:27]
    v_mfma_f32_16x16x32_bf16 v[40:43], v[116:119], v[104:107], v[40:43]
    v_mfma_f32_16x16x32_bf16 v[48:51], v[120:123], v[96:99], v[48:51]
    v_mfma_f32_16x16x32_bf16 v[52:55], v[120:123], v[100:103], v[52:55]
    v_mfma_f32_16x16x32_bf16 v[56:59], v[120:123], v[104:107], v[56:59]
    s_waitcnt vmcnt(13)
    v_mfma_f32_16x16x32_bf16 v[28:31], v[112:115], v[108:111], v[28:31]
    v_mfma_f32_16x16x32_bf16 v[44:47], v[116:119], v[108:111], v[44:47]
    v_mfma_f32_16x16x32_bf16 v[60:63], v[120:123], v[108:111], v[60:63]
    v_mfma_f32_16x16x32_bf16 v[64:67], v[124:127], v[96:99], v[64:67]
    v_mfma_f32_16x16x32_bf16 v[68:71], v[124:127], v[100:103], v[68:71]
    v_mfma_f32_16x16x32_bf16 v[72:75], v[124:127], v[104:107], v[72:75]
    v_mfma_f32_16x16x32_bf16 v[76:79], v[124:127], v[108:111], v[76:79]
    v_mfma_f32_16x16x32_bf16 v[80:83], v[128:131], v[96:99], v[80:83]
    v_mfma_f32_16x16x32_bf16 v[84:87], v[128:131], v[100:103], v[84:87]
    v_mfma_f32_16x16x32_bf16 v[88:91], v[128:131], v[104:107], v[88:91]
    v_mfma_f32_16x16x32_bf16 v[92:95], v[128:131], v[108:111], v[92:95]
    s_waitcnt vmcnt(12)
    v_mfma_f32_16x16x32_bf16 v[16:19], v[148:151], v[132:135], v[16:19]
    s_waitcnt vmcnt(11)
    v_mfma_f32_16x16x32_bf16 v[20:23], v[148:151], v[136:139], v[20:23]
    v_mfma_f32_16x16x32_bf16 v[32:35], v[152:155], v[132:135], v[32:35]
    v_mfma_f32_16x16x32_bf16 v[36:39], v[152:155], v[136:139], v[36:39]
    s_waitcnt vmcnt(10)
    v_mfma_f32_16x16x32_bf16 v[24:27], v[148:151], v[140:143], v[24:27]
    v_mfma_f32_16x16x32_bf16 v[40:43], v[152:155], v[140:143], v[40:43]
    v_mfma_f32_16x16x32_bf16 v[48:51], v[156:159], v[132:135], v[48:51]
    v_mfma_f32_16x16x32_bf16 v[52:55], v[156:159], v[136:139], v[52:55]
    v_mfma_f32_16x16x32_bf16 v[56:59], v[156:159], v[140:143], v[56:59]
    s_waitcnt vmcnt(9)
    v_mfma_f32_16x16x32_bf16 v[28:31], v[148:151], v[144:147], v[28:31]
    v_mfma_f32_16x16x32_bf16 v[44:47], v[152:155], v[144:147], v[44:47]
    v_mfma_f32_16x16x32_bf16 v[60:63], v[156:159], v[144:147], v[60:63]
    v_mfma_f32_16x16x32_bf16 v[64:67], v[160:163], v[132:135], v[64:67]
    v_mfma_f32_16x16x32_bf16 v[68:71], v[160:163], v[136:139], v[68:71]
    v_mfma_f32_16x16x32_bf16 v[72:75], v[160:163], v[140:143], v[72:75]
    v_mfma_f32_16x16x32_bf16 v[76:79], v[160:163], v[144:147], v[76:79]
    v_mfma_f32_16x16x32_bf16 v[80:83], v[164:167], v[132:135], v[80:83]
    v_mfma_f32_16x16x32_bf16 v[84:87], v[164:167], v[136:139], v[84:87]
    v_mfma_f32_16x16x32_bf16 v[88:91], v[164:167], v[140:143], v[88:91]
    v_mfma_f32_16x16x32_bf16 v[92:95], v[164:167], v[144:147], v[92:95]
    s_waitcnt vmcnt(8)
    v_mov_b32 v168, v240
    v_mov_b32 v169, v241
    v_mov_b32 v170, v242
    v_mov_b32 v171, v243
    s_waitcnt vmcnt(7)
    v_mov_b32 v172, v244
    v_mov_b32 v173, v245
    v_mov_b32 v174, v246
    v_mov_b32 v175, v247
    s_waitcnt vmcnt(6)
    v_mov_b32 v176, v248
    v_mov_b32 v177, v249
    v_mov_b32 v178, v250
    v_mov_b32 v179, v251
    s_waitcnt vmcnt(5)
    v_mov_b32 v180, v252
    v_mov_b32 v181, v253
    v_mov_b32 v182, v254
    v_mov_b32 v183, v255
    s_waitcnt vmcnt(0)
    s_nop 1
    s_branch KC_join
K23_exit:

    s_endpgm
k23_fused_kernel_end:
.section .rodata,"a"
.p2align 6
.amdhsa_kernel k23_fused_kernel
  .amdhsa_next_free_vgpr 256
  .amdhsa_next_free_sgpr 102
  .amdhsa_accum_offset 256
  .amdhsa_group_segment_fixed_size 0
  .amdhsa_kernarg_size 96
  .amdhsa_user_sgpr_count 2
  .amdhsa_user_sgpr_kernarg_segment_ptr 1
  .amdhsa_system_sgpr_workgroup_id_x 1
.end_amdhsa_kernel
```
